```python
import torch

def _softmax(x, axis=-1):
    return torch.softmax(x, dim=axis)
def _gelu(x):
    return torch.nn.functional.gelu(x, approximate="tanh")
def _silu(x):
    return torch.nn.functional.silu(x)
def _sigmoid(x):
    return torch.sigmoid(x)
def _layernorm(x, axis=-1, eps=1e-5):
    m = x.mean(dim=axis, keepdim=True)
    v = x.var(dim=axis, keepdim=True, unbiased=False)
    return (x - m) / torch.sqrt(v + eps)
def _scatter_add(tgt, idx, src, axis=0):
    return tgt.clone().index_add_(axis, idx, src)
def _segment_sum(src, seg, n):
    out = torch.zeros((n,) + src.shape[1:], dtype=src.dtype)
    return out.index_add_(0, seg, src)
def _pad(x, pw):
    flat = tuple(v for pair in reversed(pw) for v in pair)
    return torch.nn.functional.pad(x, flat)

kernel_name = 'sequential_preLN__linear_kernel_hedgehog__glu_gated_glu__prompt'

def setup_inputs():

    _w = (lambda a: (lambda t: t.to(torch.bfloat16) if t.is_floating_point() else t)(torch.as_tensor(a)))
    def _A_setup():
        B, S, D, H = 1, 2048, 1024, 32
        Dh = D // H
        return {
            "x": _w((lambda *s: torch.randn(*s, dtype=torch.bfloat16) * 0.05)(B, S, D)),
            "wqkv": _w((lambda *s: torch.randn(*s, dtype=torch.bfloat16) * 0.2)(D, 3 * D)),
            "w_phi": _w((lambda *s: torch.randn(*s, dtype=torch.bfloat16) * 0.2)(H, Dh, Dh) * (Dh ** -0.5)),
            "wo": _w((lambda *s: torch.randn(*s, dtype=torch.bfloat16) * 0.05)(D, D)),
        }
    _A_in = _A_setup()

    def _B_setup():
        B, S, D, F = 1, 2048, 1024, 3584
        return {
            "x": _w((lambda *s: torch.randn(*s, dtype=torch.bfloat16) * 0.05)(B, S, D)),
            "w_gate": _w((lambda *s: torch.randn(*s, dtype=torch.bfloat16) * 0.05)(D, F)),
            "w_up": _w((lambda *s: torch.randn(*s, dtype=torch.bfloat16) * 0.05)(D, F)),
            "w_down": _w((lambda *s: torch.randn(*s, dtype=torch.bfloat16) * 0.05)(F, D)),
        }
    _B_in = _B_setup()

    return {
        "A_x": _A_in["x"],
        "A_wqkv": _A_in["wqkv"],
        "A_w_phi": _A_in["w_phi"],
        "A_wo": _A_in["wo"],
        "B_x": _B_in["x"],
        "B_w_gate": _B_in["w_gate"],
        "B_w_up": _B_in["w_up"],
        "B_w_down": _B_in["w_down"],
    }

def reference(A_x, A_wqkv, A_w_phi, A_wo, B_x, B_w_gate, B_w_up, B_w_down):
    def _A_ref(x, wqkv, w_phi, wo):
        B, S, D = x.shape
        H = 32; Dh = D // H
        qkv = (lambda x, *d: x.permute(*d))((x @ wqkv).reshape(B, S, 3, H, Dh), 2, 0, 3, 1, 4)
        q, k, v = qkv[0], qkv[1], qkv[2]
        pq = torch.einsum("bhsd,hdf->bhsf", q, w_phi)
        pk = torch.einsum("bhsd,hdf->bhsf", k, w_phi)
        phi_q = torch.concatenate([_softmax(pq, axis=-1), _softmax(-pq, axis=-1)], axis=-1)
        phi_k = torch.concatenate([_softmax(pk, axis=-1), _softmax(-pk, axis=-1)], axis=-1)
        kv = torch.einsum("bhsf,bhsd->bhfd", phi_k, v)
        z  = torch.einsum("bhsf->bhf", phi_k)
        num = torch.einsum("bhqf,bhfd->bhqd", phi_q, kv)
        den = torch.einsum("bhqf,bhf->bhq", phi_q, z)[..., None] + 1e-6
        o = num / den
        return (lambda x, *d: x.permute(*d))(o, 0, 2, 1, 3).reshape(B, S, D) @ wo

    def _B_ref(x, w_gate, w_up, w_down):
        g = torch.einsum("bsd,df->bsf", x, w_gate)
        u = torch.einsum("bsd,df->bsf", x, w_up)
        h = _sigmoid(g) * u
        return torch.einsum("bsf,fd->bsd", h, w_down)

    x = A_x
    h = x + _A_ref(_layernorm(x, axis=-1), A_wqkv, A_w_phi, A_wo)
    h2 = h + _B_ref(_layernorm(h, axis=-1), B_w_gate, B_w_up, B_w_down)
    return h2
```

```asm
; @launch grid=(256,1,1) block=(256,1,1) lds=163840
.amdgcn_target "amdgcn-amd-amdhsa--gfx950"
.text
.globl sequential_preLN__linear_kernel_hedgehog__glu_gated_glu__prompt_kernel
.p2align 12
.p2align 8
.type sequential_preLN__linear_kernel_hedgehog__glu_gated_glu__prompt_kernel,@function
sequential_preLN__linear_kernel_hedgehog__glu_gated_glu__prompt_kernel:
  s_load_dwordx16 s[52:67], s[0:1], 0
  s_load_dwordx2 s[4:5], s[0:1], 80
  s_load_dwordx2 s[68:69], s[0:1], 64
  v_lshrrev_b32 v2, 6, v0
  v_and_b32 v1, 63, v0
  v_readfirstlane_b32 s24, v2
  s_cmp_ge_u32 s2, 256
  s_cbranch_scc1 L_end
  s_getpc_b64 s[78:79]
L_pc:
  s_and_b32 s25, s2, 7
  s_lshr_b32 s26, s2, 3
  s_lshl_b32 s101, s26, 2
  s_add_u32 s101, s101, s24
  s_mul_i32 s101, s101, 768
  s_add_u32 s101, s101, L_pc-L_pc
  v_min_u32 v12, 5, v1
  v_lshl_add_u32 v12, v12, 7, s101
  v_min_u32 v12, L_end-L_pc, v12
  global_load_dword v0, v12, s[78:79]
  v_lshlrev_b32 v3, 4, v1
  s_and_b32 s32, s26, 7
  s_lshr_b32 s35, s26, 3
  s_and_b32 s34, s25, 1
  s_lshl_b32 s34, s34, 3
  s_lshr_b32 s36, s25, 1
  s_lshl_b32 s36, s36, 2
  s_add_u32 s27, s34, s32
  s_add_u32 s28, s36, s35
  s_lshl_b32 s37, s24, 12
  s_lshl_b32 s41, s27, 4
  s_add_u32 s40, s41, s28
  s_lshl_b32 s41, s40, 14
  s_add_u32 s41, s41, s37
  v_add_u32 v10, s41, v3
  s_waitcnt lgkmcnt(0)
  global_load_dwordx4 v[24:27], v10, s[52:53] offset:0
  global_load_dwordx4 v[28:31], v10, s[52:53] offset:1024
  global_load_dwordx4 v[32:35], v10, s[52:53] offset:2048
  global_load_dwordx4 v[36:39], v10, s[52:53] offset:3072
  s_lshl_b32 s29, s32, 1
  s_xor_b32 s33, s25, 1
  s_lshl_b32 s33, s33, 2
  s_add_u32 s33, s33, s35
  s_and_b32 s35, s26, 3
  s_add_u32 s30, s36, s35
  s_lshr_b32 s35, s26, 2
  s_lshl_b32 s35, s35, 1
  s_and_b32 s31, s25, 1
  s_add_u32 s31, s31, s35
  s_mov_b32 s29, 0
  s_add_u32 s8, s4, 0x3c00000
  s_addc_u32 s9, s5, 0
  s_load_dword s6, s[8:9], 0
  s_mov_b32 s12, s54
  s_mov_b32 s13, s55
  s_mov_b32 s14, 0x600000
  s_mov_b32 s15, 0x00020000
  s_sub_u32 s43, s29, 1
  s_barrier
  s_mul_i32 s34, s24, 3
  v_min_u32 v12, 2, v1
  v_add_u32 v12, s34, v12
  v_and_b32 v13, 1, v12
  v_lshrrev_b32 v12, 1, v12
  v_lshlrev_b32 v12, 16, v12
  v_lshl_add_u32 v12, v13, 7, v12
  s_lshl_b32 s34, s2, 8
  s_add_u32 s34, s34, 0x3ba0000
  v_add_u32 v12, s34, v12
  global_load_dword v0, v12, s[4:5] sc1
  s_mov_b32 s20, s56
  s_mov_b32 s21, s57
  s_mov_b32 s22, 0x10000
  s_mov_b32 s23, 0x00020000
  s_lshl_b32 s34, s24, 10
  s_add_u32 m0, s34, 147456
  s_lshl_b32 s35, s28, 12
  s_add_u32 s34, s34, s35
  buffer_load_dwordx4 v3, s[20:23], s34 offen lds
  s_lshl_b32 s34, s26, 2
  s_add_u32 s34, s34, s24
  s_mul_i32 s34, s34, 12288
  s_lshr_b32 s35, s25, 1
  s_lshl_b32 s35, s35, 9
  s_add_u32 s84, s34, s35
  s_and_b32 s35, s25, 1
  v_and_b32 v13, 3, v1
  v_bfe_u32 v14, v1, 2, 2
  v_cmp_eq_u32 vcc, 3, v14
  v_lshrrev_b32 v12, 4, v1
  v_lshl_add_u32 v12, v12, 8, s35
  v_cndmask_b32_e64 v14, v14, v13, vcc
  v_cndmask_b32 v13, v13, 3, vcc
  v_cndmask_b32 v15, 0, 1, vcc
  v_xor_b32 v12, v12, v15
  v_min_u32 v14, 2, v14
  v_mul_u32_u24 v12, 6144, v12
  v_lshl_add_u32 v12, v13, 7, v12
  v_lshl_add_u32 v117, v14, 11, v12
  s_mov_b32 exec_lo, 0x6ff06ff0
  s_mov_b32 exec_hi, 0x6ff06ff0
  buffer_load_dword v0, v117, s[12:15], s84 offen
  s_mov_b64 exec, -1
  s_lshl_b32 s41, s28, 4
  s_add_u32 s41, s41, s27
  s_lshl_b32 s41, s41, 2
  s_add_u32 s41, s41, s24
  s_lshl_b32 s34, s41, 11
  v_add_u32 v11, s34, v3
  s_lshl_b32 s42, s28, 7
  v_lshrrev_b32 v12, 3, v1
  v_bfe_u32 v13, v1, 1, 2
  v_lshrrev_b32 v14, 1, v12
  v_xor_b32 v13, v13, v14
  v_and_b32 v14, 1, v1
  v_lshlrev_b32_e64 v14, 4, v14
  v_lshl_add_u32 v13, v13, 5, v14
  v_mul_u32_u24 v12, 6144, v12
  v_add3_u32 v4, v12, v13, s42
  v_add_u32 v5, 48128, v4
  v_add_u32 v6, 96256, v4
  v_add_u32 v7, 144384, v4
  s_and_b32 s50, s24, 1
  s_mul_i32 s50, s50, 196608
  s_lshr_b32 s51, s24, 1
  s_lshl_b32 s51, s51, 11
  s_add_u32 s50, s50, s51
  s_add_u32 s50, s50, 2048
  s_mul_i32 s51, s24, 196608
  s_mov_b32 s48, 0x3fb8aa3b
  s_mov_b32 s49, 0xbfb8aa3b
  s_mov_b32 s36, 0xffff0000
  v_mov_b32 v80, 0x3f803f80
  v_mov_b32 v81, 0x3f803f80
  v_mov_b32 v82, 0x3f803f80
  v_mov_b32 v83, 0x3f803f80
  v_mov_b32 v92, 0x3a800000
  v_mov_b32 v93, 0x3727c5ac
  v_lshrrev_b32 v12, 2, v1
  v_bfe_u32 v13, v1, 3, 2
  v_and_b32 v14, 3, v1
  v_lshlrev_b32_e64 v14, 3, v14
  v_lshl_add_u32 v14, v13, 5, v14
  v_lshl_add_u32 v16, v12, 7, v14
  v_xor_b32 v17, 32, v16
  v_xor_b32 v18, 64, v16
  v_xor_b32 v19, 96, v16
  v_add_u32 v20, 65536, v16
  v_add_u32 v21, 65536, v17
  v_add_u32 v22, 65536, v18
  v_add_u32 v23, 65536, v19
  s_and_b32 s34, s40, 240
  s_lshl_b32 s34, s34, 8
  s_bfe_u32 s35, s40, 0x40000
  s_lshl_b32 s35, s35, 3
  s_add_u32 s34, s34, s35
  s_add_u32 s34, s34, 0x3ba0000
  v_lshlrev_b32 v124, 8, v1
  v_add_u32 v124, s34, v124
  s_and_b32 s34, s40, 255
  s_lshl_b32 s34, s34, 8
  s_add_u32 s34, s34, 0x3ba0000
  v_and_b32 v125, 15, v1
  v_lshl_add_u32 v125, v125, 3, s34
  s_lshl_b32 s35, s24, 5
  s_add_u32 s34, s34, s35
  s_add_u32 s86, s4, s34
  s_addc_u32 s87, s5, 0
  s_mul_i32 s34, s24, 4160
  s_add_u32 s34, s34, 98304
  v_add_u32 v112, s34, v3
  v_and_b32 v12, 7, v1
  v_bfe_u32 v13, v1, 3, 2
  v_lshrrev_b32 v14, 5, v1
  v_mul_u32_u24 v113, 2080, v12
  v_lshl_add_u32 v113, v13, 3, v113
  v_lshl_add_u32 v113, v14, 6, v113
  s_lshl_b32 s34, s24, 9
  s_add_u32 s34, s34, 98304
  v_add_u32 v113, s34, v113
  s_and_b32 s35, s40, 1
  v_lshl_add_u32 v13, v13, 1, s35
  v_add_u32 v15, 0, v13
  v_lshrrev_b32 v15, 3, v15
  v_add_u32 v13, v13, v15
  v_lshlrev_b32 v12, 4, v12
  v_lshl_add_u32 v12, v13, 7, v12
  v_lshl_add_u32 v12, v14, 10, v12
  s_lshr_b32 s34, s40, 1
  s_mul_i32 s34, s34, 32768
  s_lshl_b32 s35, s24, 13
  s_add_u32 s34, s34, s35
  s_add_u32 s34, s34, 0x1000
  v_add_u32 v114, s34, v12
  v_add_u32 v116, 4096, v114
  s_lshl_b32 s34, s40, 9
  s_lshl_b32 s35, s24, 7
  s_add_u32 s34, s34, s35
  s_add_u32 s34, s34, 0x3b40000
  v_add_u32 v115, s34, v3
  s_waitcnt vmcnt(3)
  v_mfma_f32_16x16x32_bf16 v[84:87], v[80:83], v[24:27], 0
  v_mfma_f32_16x16x32_bf16 v[88:91], v[80:83], v[32:35], 0
  v_mfma_f32_16x16x32_bf16 v[84:87], v[80:83], v[28:31], v[84:87]
  v_mfma_f32_16x16x32_bf16 v[88:91], v[80:83], v[36:39], v[88:91]
  v_lshlrev_b32 v48, 16, v24
  v_and_b32 v49, s36, v24
  v_lshlrev_b32 v50, 16, v25
  v_and_b32 v51, s36, v25
  v_lshlrev_b32 v52, 16, v26
  v_and_b32 v53, s36, v26
  v_lshlrev_b32 v54, 16, v27
  v_and_b32 v55, s36, v27
  v_lshlrev_b32 v56, 16, v28
  v_and_b32 v57, s36, v28
  v_lshlrev_b32 v58, 16, v29
  v_and_b32 v59, s36, v29
  v_lshlrev_b32 v60, 16, v30
  v_add_f32_dpp v84, v84, v84 row_ror:8 row_mask:0xf bank_mask:0xf
  v_and_b32 v61, s36, v30
  v_lshlrev_b32_e64 v62, 16, v31
  v_add_f32_dpp v88, v88, v88 row_ror:8 row_mask:0xf bank_mask:0xf
  v_and_b32 v63, s36, v31
  v_lshlrev_b32 v64, 16, v32
  v_add_f32_dpp v84, v84, v84 row_ror:4 row_mask:0xf bank_mask:0xf
  v_and_b32 v65, s36, v32
  v_lshlrev_b32 v66, 16, v33
  v_add_f32_dpp v88, v88, v88 row_ror:4 row_mask:0xf bank_mask:0xf
  v_and_b32 v67, s36, v33
  v_lshlrev_b32 v68, 16, v34
  v_add_f32_dpp v84, v84, v84 row_ror:2 row_mask:0xf bank_mask:0xf
  v_and_b32 v69, s36, v34
  v_lshlrev_b32 v70, 16, v35
  v_add_f32_dpp v88, v88, v88 row_ror:2 row_mask:0xf bank_mask:0xf
  v_and_b32 v71, s36, v35
  v_lshlrev_b32 v72, 16, v36
  v_add_f32_dpp v84, v84, v84 row_ror:1 row_mask:0xf bank_mask:0xf
  v_and_b32 v73, s36, v36
  v_lshlrev_b32 v74, 16, v37
  v_add_f32_dpp v88, v88, v88 row_ror:1 row_mask:0xf bank_mask:0xf
  v_and_b32 v75, s36, v37
  v_lshlrev_b32 v76, 16, v38
  v_and_b32 v77, s36, v38
  v_lshlrev_b32 v78, 16, v39
  v_and_b32_e64 v79, s36, v39
  v_mul_f32 v12, 0x3a800000, v84
  v_mul_f32 v13, 0x3a800000, v88
  v_pk_add_f32 v[48:49], v[48:49], v[12:13] op_sel_hi:[1,0] neg_lo:[0,1] neg_hi:[0,1]
  v_pk_add_f32 v[50:51], v[50:51], v[12:13] op_sel_hi:[1,0] neg_lo:[0,1] neg_hi:[0,1]
  v_pk_add_f32 v[52:53], v[52:53], v[12:13] op_sel_hi:[1,0] neg_lo:[0,1] neg_hi:[0,1]
  v_pk_add_f32 v[54:55], v[54:55], v[12:13] op_sel_hi:[1,0] neg_lo:[0,1] neg_hi:[0,1]
  v_pk_add_f32 v[56:57], v[56:57], v[12:13] op_sel_hi:[1,0] neg_lo:[0,1] neg_hi:[0,1]
  v_pk_add_f32 v[58:59], v[58:59], v[12:13] op_sel_hi:[1,0] neg_lo:[0,1] neg_hi:[0,1]
  v_pk_add_f32 v[60:61], v[60:61], v[12:13] op_sel_hi:[1,0] neg_lo:[0,1] neg_hi:[0,1]
  v_pk_add_f32 v[62:63], v[62:63], v[12:13] op_sel_hi:[1,0] neg_lo:[0,1] neg_hi:[0,1]
  v_pk_add_f32 v[64:65], v[64:65], v[12:13] op_sel:[0,1] op_sel_hi:[1,1] neg_lo:[0,1] neg_hi:[0,1]
  v_pk_add_f32 v[66:67], v[66:67], v[12:13] op_sel:[0,1] op_sel_hi:[1,1] neg_lo:[0,1] neg_hi:[0,1]
  v_pk_add_f32 v[68:69], v[68:69], v[12:13] op_sel:[0,1] op_sel_hi:[1,1] neg_lo:[0,1] neg_hi:[0,1]
  v_pk_add_f32 v[70:71], v[70:71], v[12:13] op_sel:[0,1] op_sel_hi:[1,1] neg_lo:[0,1] neg_hi:[0,1]
  v_pk_add_f32 v[72:73], v[72:73], v[12:13] op_sel:[0,1] op_sel_hi:[1,1] neg_lo:[0,1] neg_hi:[0,1]
  v_pk_add_f32 v[74:75], v[74:75], v[12:13] op_sel:[0,1] op_sel_hi:[1,1] neg_lo:[0,1] neg_hi:[0,1]
  v_pk_add_f32 v[76:77], v[76:77], v[12:13] op_sel:[0,1] op_sel_hi:[1,1] neg_lo:[0,1] neg_hi:[0,1]
  v_pk_add_f32 v[78:79], v[78:79], v[12:13] op_sel:[0,1] op_sel_hi:[1,1] neg_lo:[0,1] neg_hi:[0,1]
  v_pk_mul_f32 v[96:97], v[48:49], v[48:49]
  v_pk_mul_f32 v[98:99], v[50:51], v[50:51]
  v_pk_fma_f32 v[96:97], v[52:53], v[52:53], v[96:97]
  v_pk_fma_f32 v[98:99], v[54:55], v[54:55], v[98:99]
  v_pk_fma_f32 v[96:97], v[56:57], v[56:57], v[96:97]
  v_pk_fma_f32 v[98:99], v[58:59], v[58:59], v[98:99]
  v_pk_fma_f32 v[96:97], v[60:61], v[60:61], v[96:97]
  v_pk_fma_f32 v[98:99], v[62:63], v[62:63], v[98:99]
  v_pk_mul_f32 v[100:101], v[64:65], v[64:65]
  v_pk_mul_f32 v[102:103], v[66:67], v[66:67]
  v_pk_fma_f32 v[100:101], v[68:69], v[68:69], v[100:101]
  v_pk_fma_f32 v[102:103], v[70:71], v[70:71], v[102:103]
  v_pk_fma_f32 v[100:101], v[72:73], v[72:73], v[100:101]
  v_pk_fma_f32 v[102:103], v[74:75], v[74:75], v[102:103]
  v_pk_fma_f32 v[100:101], v[76:77], v[76:77], v[100:101]
  v_pk_fma_f32 v[102:103], v[78:79], v[78:79], v[102:103]
  v_pk_add_f32 v[96:97], v[96:97], v[98:99]
  v_pk_add_f32 v[100:101], v[100:101], v[102:103]
  v_add_f32 v14, v96, v97
  v_add_f32 v15, v100, v101
  s_nop 0
  v_add_f32_dpp v14, v14, v14 row_ror:8 row_mask:0xf bank_mask:0xf
  v_add_f32_dpp v15, v15, v15 row_ror:8 row_mask:0xf bank_mask:0xf
  s_nop 0
  v_add_f32_dpp v14, v14, v14 row_ror:4 row_mask:0xf bank_mask:0xf
  v_add_f32_dpp v15, v15, v15 row_ror:4 row_mask:0xf bank_mask:0xf
  s_nop 0
  v_add_f32_dpp v14, v14, v14 row_ror:2 row_mask:0xf bank_mask:0xf
  v_add_f32_dpp v15, v15, v15 row_ror:2 row_mask:0xf bank_mask:0xf
  s_nop 0
  v_add_f32_dpp v14, v14, v14 row_ror:1 row_mask:0xf bank_mask:0xf
  v_add_f32_dpp v15, v15, v15 row_ror:1 row_mask:0xf bank_mask:0xf
  s_nop 1
  v_permlane16_swap_b32 v14, v15
  v_add_f32 v14, v14, v15
  v_mov_b32 v15, v14
  s_nop 1
  v_permlane32_swap_b32 v14, v15
  v_add_f32 v14, v14, v15
  v_fma_f32 v14, v14, v92, v93
  v_mov_b32 v15, v14
  s_nop 1
  v_permlane16_swap_b32 v14, v15
  v_rsq_f32 v96, v14
  v_rsq_f32_e64 v97, v15
  s_nop 0
  v_pk_mul_f32 v[48:49], v[48:49], v[96:97] op_sel_hi:[1,0]
  v_pk_mul_f32 v[50:51], v[50:51], v[96:97] op_sel_hi:[1,0]
  v_pk_mul_f32 v[52:53], v[52:53], v[96:97] op_sel_hi:[1,0]
  v_pk_mul_f32 v[54:55], v[54:55], v[96:97] op_sel_hi:[1,0]
  v_pk_mul_f32 v[56:57], v[56:57], v[96:97] op_sel_hi:[1,0]
  v_pk_mul_f32 v[58:59], v[58:59], v[96:97] op_sel_hi:[1,0]
  v_pk_mul_f32 v[60:61], v[60:61], v[96:97] op_sel_hi:[1,0]
  v_pk_mul_f32 v[62:63], v[62:63], v[96:97] op_sel_hi:[1,0]
  v_cvt_pk_bf16_f32 v24, v48, v49
  v_cvt_pk_bf16_f32 v25, v50, v51
  v_cvt_pk_bf16_f32 v26, v52, v53
  v_cvt_pk_bf16_f32 v27, v54, v55
  v_cvt_pk_bf16_f32 v28, v56, v57
  v_cvt_pk_bf16_f32 v29, v58, v59
  v_cvt_pk_bf16_f32 v30, v60, v61
  v_cvt_pk_bf16_f32 v31, v62, v63
  ds_write_b128 v112, v[24:27] offset:0
  ds_write_b128 v112, v[28:31] offset:1024
  v_pk_mul_f32 v[64:65], v[64:65], v[96:97] op_sel:[0,1] op_sel_hi:[1,1]
  v_pk_mul_f32 v[66:67], v[66:67], v[96:97] op_sel:[0,1] op_sel_hi:[1,1]
  v_pk_mul_f32 v[68:69], v[68:69], v[96:97] op_sel:[0,1] op_sel_hi:[1,1]
  v_pk_mul_f32 v[70:71], v[70:71], v[96:97] op_sel:[0,1] op_sel_hi:[1,1]
  v_pk_mul_f32 v[72:73], v[72:73], v[96:97] op_sel:[0,1] op_sel_hi:[1,1]
  v_pk_mul_f32 v[74:75], v[74:75], v[96:97] op_sel:[0,1] op_sel_hi:[1,1]
  v_pk_mul_f32 v[76:77], v[76:77], v[96:97] op_sel:[0,1] op_sel_hi:[1,1]
  v_pk_mul_f32 v[78:79], v[78:79], v[96:97] op_sel:[0,1] op_sel_hi:[1,1]
  v_cvt_pk_bf16_f32 v32, v64, v65
  v_cvt_pk_bf16_f32 v33, v66, v67
  v_cvt_pk_bf16_f32 v34, v68, v69
  v_cvt_pk_bf16_f32 v35, v70, v71
  v_cvt_pk_bf16_f32 v36, v72, v73
  v_cvt_pk_bf16_f32 v37, v74, v75
  v_cvt_pk_bf16_f32 v38, v76, v77
  v_cvt_pk_bf16_f32 v39, v78, v79
  ds_write_b128 v112, v[32:35] offset:2080
  ds_write_b128 v112, v[36:39] offset:3104
  v_mul_f32 v49, v14, v96
  v_mul_f32 v51, v15, v97
  v_mov_b32 v48, v12
  v_mov_b32 v50, v13
  s_mov_b64 exec, 0xff
  global_store_dwordx4 v115, v[48:51], s[4:5] sc1
  s_mov_b64 exec, -1
  s_waitcnt lgkmcnt(0)
  s_barrier
  ds_read_b64 v[56:57], v113 offset:0
  ds_read_b64 v[58:59], v113 offset:32
  ds_read_b64 v[60:61], v113 offset:128
  ds_read_b64 v[62:63], v113 offset:160
  ds_read_b64 v[64:65], v113 offset:256
  ds_read_b64 v[66:67], v113 offset:288
  ds_read_b64 v[68:69], v113 offset:384
  ds_read_b64 v[70:71], v113 offset:416
  s_waitcnt lgkmcnt(6)
  global_store_dwordx4 v114, v[56:59], s[4:5] offset:-4096 sc1
  s_waitcnt lgkmcnt(4)
  global_store_dwordx4 v114, v[60:63], s[4:5] offset:-2048 sc1
  s_waitcnt lgkmcnt(2)
  global_store_dwordx4 v116, v[64:67], s[4:5] offset:-4096 sc1
  s_waitcnt lgkmcnt(0)
  global_store_dwordx4 v116, v[68:71], s[4:5] offset:-2048 sc1
  s_add_u32 s38, s50, 0
  s_add_u32 m0, s37, 0
  s_nop 0
  buffer_load_dwordx4 v4, s[12:15], s38 offen offset:0  lds
  buffer_load_dwordx4 v5, s[12:15], s38 offen offset:1024  lds
  buffer_load_dwordx4 v6, s[12:15], s38 offen offset:2048  lds
  buffer_load_dwordx4 v7, s[12:15], s38 offen offset:3072  lds
  s_add_u32 s38, s50, 393216
  s_add_u32 m0, s37, 16384
  s_nop 0
  buffer_load_dwordx4 v4, s[12:15], s38 offen offset:0  lds
  buffer_load_dwordx4 v5, s[12:15], s38 offen offset:1024  lds
  buffer_load_dwordx4 v6, s[12:15], s38 offen offset:2048  lds
  buffer_load_dwordx4 v7, s[12:15], s38 offen offset:3072  lds
  s_mul_i32 s6, s6, 0x9e3779b1
  s_add_u32 s6, s6, 0x7f4a7c15
  s_xor_b32 s7, s6, 0x5bd1e995
  s_lshl_b32 s44, s27, 3
  s_lshl_b32 s34, s24, 1
  s_add_u32 s44, s44, s34
  s_mul_i32 s45, s44, 32768
  s_lshl_b32 s39, s29, 11
  v_add_u32 v8, s45, v3
  v_add_u32 v9, 32768, v8
  s_mov_b32 s16, s4
  s_mov_b32 s17, s5
  s_mov_b32 s18, 0x400400
  s_mov_b32 s19, 0x00020000
  s_and_b32 s34, s26, 0
  s_mul_i32 s34, s34, 32
  s_lshr_b32 s35, s26, 0
  s_add_u32 s34, s34, s35
  s_lshl_b32 s34, s34, 1
  s_lshr_b32 s35, s24, 1
  s_add_u32 s34, s34, s35
  s_mul_i32 s34, s34, 28
  s_add_u32 s34, s34, 0
  v_min_u32 v25, 27, v1
  v_add_u32 v25, s34, v25
  v_mul_u32_u24 v110, 9363, v25
  v_lshrrev_b32 v110, 16, v110
  v_mul_u32_u24 v110, 6272, v110
  v_lshl_add_u32 v25, v25, 7, v110
  s_lshr_b32 s34, s33, 2
  s_mul_i32 s34, s34, 896
  v_add_u32 v25, s34, v25
  s_bitcmp1_b32 s24, 0
  s_cselect_b32 s80, s64, s62
  s_cselect_b32 s81, s65, s63
  v_mov_b32 v26, v11
  v_mov_b32 v27, v117
  s_mov_b64 exec, 0
  s_cmp_eq_u32 s24, 0
  s_cbranch_scc1 L_pad_0a_0
  s_cmp_eq_u32 s24, 1
  s_cbranch_scc1 L_pad_0a_1
  s_cmp_eq_u32 s24, 2
  s_cbranch_scc1 L_pad_0a_2
  s_branch L_pad_0a_3
L_ret_0a:
  s_mov_b64 exec, -1
  s_branch L_body
.p2align 12
L_body:
L_pad_0a_0:
  s_cbranch_execz L_pad_0a_4
  s_waitcnt vmcnt(8)
  s_barrier
  s_cmp_eq_u32 s24, 0
  s_cbranch_scc0 L_nosig_1
  v_mov_b32 v120, s6
  v_mov_b32_e64 v121, s7
  s_mov_b32 exec_lo, 0xffff
  s_mov_b32 exec_hi, 0
  global_store_dwordx2 v124, v[120:121], s[4:5] sc1
  s_mov_b64 exec, -1
L_nosig_1:
  s_add_u32 s38, s50, 786432
  s_add_u32 m0, s37, 32768
  s_nop 0
  buffer_load_dwordx4 v4, s[12:15], s38 offen offset:0  lds
  buffer_load_dwordx4 v5, s[12:15], s38 offen offset:1024  lds
  buffer_load_dwordx4 v6, s[12:15], s38 offen offset:2048  lds
  buffer_load_dwordx4 v7, s[12:15], s38 offen offset:3072  lds
  s_add_u32 s38, s50, 1179648
  s_add_u32 m0, s37, 49152
  s_nop 0
  buffer_load_dwordx4 v4, s[12:15], s38 offen offset:0  lds
  buffer_load_dwordx4 v5, s[12:15], s38 offen offset:1024  lds
  buffer_load_dwordx4 v6, s[12:15], s38 offen offset:2048  lds
  buffer_load_dwordx4 v7, s[12:15], s38 offen offset:3072  lds
  s_add_u32 s38, s50, 1572864
  s_add_u32 m0, s37, 65536
  s_nop 0
  buffer_load_dwordx4 v4, s[12:15], s38 offen offset:0  lds
  buffer_load_dwordx4 v5, s[12:15], s38 offen offset:1024  lds
  buffer_load_dwordx4 v6, s[12:15], s38 offen offset:2048  lds
  buffer_load_dwordx4 v7, s[12:15], s38 offen offset:3072  lds
  v_lshrrev_b32 v12, 2, v1
  v_and_b32 v13, 3, v1
  v_lshlrev_b32 v13, 3, v13
  v_lshl_add_u32 v12, v12, 6, v13
  v_add_u32 v12, 147456, v12
  ds_read_b64_tr_b16 v[104:105], v12 offset:0
  ds_read_b64_tr_b16 v[106:107], v12 offset:1024
  ds_read_b64_tr_b16 v[108:109], v12 offset:32
  ds_read_b64_tr_b16 v[110:111], v12 offset:1056
  ds_read_b64_tr_b16 v[112:113], v12 offset:2048
  ds_read_b64_tr_b16 v[114:115], v12 offset:3072
  ds_read_b64_tr_b16 v[116:117], v12 offset:2080
  ds_read_b64_tr_b16 v[118:119], v12 offset:3104
  s_waitcnt lgkmcnt(0)
  s_mov_b32 s34, 0
L_poll_3:
  s_load_dwordx8 s[88:95], s[86:87], 0 glc
  s_add_u32 s34, s34, 1
  s_waitcnt lgkmcnt(0)
  s_xor_b64 s[88:89], s[88:89], s[6:7]
  s_xor_b64 s[90:91], s[90:91], s[6:7]
  s_xor_b64 s[92:93], s[92:93], s[6:7]
  s_xor_b64 s[94:95], s[94:95], s[6:7]
  s_or_b64 s[88:89], s[88:89], s[90:91]
  s_or_b64 s[92:93], s[92:93], s[94:95]
  s_or_b64 s[88:89], s[88:89], s[92:93]
  s_cbranch_scc0 L_go_4
  s_cmp_lt_u32 s34, 0x40000
  s_cbranch_scc1 L_poll_3
L_go_4:
L_nopoll_2:
  s_waitcnt vmcnt(13)
  s_cmp_eq_u32 s24, 0
  s_cbranch_scc1 L_w0_5
  s_waitcnt vmcnt(12)
L_w0_5:
  s_barrier
L_p1:
  buffer_load_dwordx4 a[0:3], v8, s[16:19], s39 offen offset:0 sc1
  buffer_load_dwordx4 a[4:7], v9, s[16:19], s39 offen offset:0 sc1
  buffer_load_dwordx4 a[8:11], v8, s[16:19], s39 offen offset:1024 sc1
  buffer_load_dwordx4 a[12:15], v9, s[16:19], s39 offen offset:1024 sc1
  ds_read_b64_tr_b16 v[168:169], v16 offset:0
  ds_read_b64_tr_b16 v[170:171], v16 offset:2048
  ds_read_b64_tr_b16 v[172:173], v16 offset:4096
  ds_read_b64_tr_b16 v[174:175], v16 offset:6144
  ds_read_b64_tr_b16 v[176:177], v17 offset:0
  ds_read_b64_tr_b16 v[178:179], v17 offset:2048
  ds_read_b64_tr_b16 v[180:181], v17 offset:4096
  ds_read_b64_tr_b16 v[182:183], v17 offset:6144
  buffer_load_dwordx4 a[16:19], v8, s[16:19], s39 offen offset:2048 sc1
  buffer_load_dwordx4 a[20:23], v9, s[16:19], s39 offen offset:2048 sc1
  buffer_load_dwordx4 a[24:27], v8, s[16:19], s39 offen offset:3072 sc1
  buffer_load_dwordx4 a[28:31], v9, s[16:19], s39 offen offset:3072 sc1
  s_add_u32 s39, s39, 4096
  s_add_u32 s38, s50, 1966080
  s_add_u32 m0, s37, 81920
  s_nop 0
  buffer_load_dwordx4 v4, s[12:15], s38 offen offset:0  lds
  buffer_load_dwordx4 v5, s[12:15], s38 offen offset:1024  lds
  buffer_load_dwordx4 v6, s[12:15], s38 offen offset:2048  lds
  buffer_load_dwordx4 v7, s[12:15], s38 offen offset:3072  lds
  s_waitcnt vmcnt(8) lgkmcnt(4)
  v_mfma_f32_16x16x32_bf16 v[40:43], v[168:171], a[0:3], 0
  ds_read_b64_tr_b16 v[184:185], v18 offset:0
  buffer_load_dwordx4 a[32:35], v8, s[16:19], s39 offen offset:0 sc1
  v_mfma_f32_16x16x32_bf16 v[40:43], v[172:175], a[8:11], v[40:43]
  ds_read_b64_tr_b16 v[186:187], v18 offset:2048
  v_mfma_f32_16x16x32_bf16 v[44:47], v[172:175], a[12:15], 0
  ds_read_b64_tr_b16 v[188:189], v18 offset:4096
  v_mfma_f32_16x16x32_bf16 v[44:47], v[168:171], a[4:7], v[44:47]
  s_waitcnt lgkmcnt(3)
  ds_read_b64_tr_b16 v[190:191], v18 offset:6144
  buffer_load_dwordx4 a[36:39], v9, s[16:19], s39 offen offset:0 sc1
  v_mfma_f32_16x16x32_bf16 v[52:55], v[176:179], a[4:7], 0
  ds_read_b64_tr_b16 v[192:193], v19 offset:0
  v_mfma_f32_16x16x32_bf16 v[52:55], v[180:183], a[12:15], v[52:55]
  ds_read_b64_tr_b16 v[194:195], v19 offset:2048
  v_mfma_f32_16x16x32_bf16 v[48:51], v[180:183], a[8:11], 0
  ds_read_b64_tr_b16 v[196:197], v19 offset:4096
  v_mfma_f32_16x16x32_bf16 v[48:51], v[176:179], a[0:3], v[48:51]
  s_waitcnt lgkmcnt(3)
  ds_read_b64_tr_b16 v[198:199], v19 offset:6144
  buffer_load_dwordx4 a[40:43], v8, s[16:19], s39 offen offset:1024 sc1
  v_mfma_f32_16x16x32_bf16 v[56:59], v[184:187], a[0:3], 0
  ds_read_b64_tr_b16 v[168:169], v16 offset:8192
  v_and_b32_e64 v200, 15, v1
  v_mfma_f32_16x16x32_bf16 v[56:59], v[188:191], a[8:11], v[56:59]
  ds_read_b64_tr_b16 v[170:171], v16 offset:10240
  v_lshrrev_b32 v201, 4, v1
  v_mfma_f32_16x16x32_bf16 v[60:63], v[188:191], a[12:15], 0
  ds_read_b64_tr_b16 v[172:173], v16 offset:12288
  buffer_load_dwordx4 a[44:47], v9, s[16:19], s39 offen offset:1024 sc1
  v_mfma_f32_16x16x32_bf16 v[60:63], v[184:187], a[4:7], v[60:63]
  s_waitcnt lgkmcnt(3)
  ds_read_b64_tr_b16 v[174:175], v16 offset:14336
  v_mfma_f32_16x16x32_bf16 v[68:71], v[192:195], a[4:7], 0
  ds_read_b64_tr_b16 v[176:177], v17 offset:8192
  v_and_b32 v202, 7, v200
  v_mfma_f32_16x16x32_bf16 v[68:71], v[196:199], a[12:15], v[68:71]
  ds_read_b64_tr_b16 v[178:179], v17 offset:10240
  v_lshlrev_b32 v202, 1, v202
  v_mfma_f32_16x16x32_bf16 v[64:67], v[196:199], a[8:11], 0
  ds_read_b64_tr_b16 v[180:181], v17 offset:12288
  v_lshrrev_b32_e64 v203, 3, v200
  v_mfma_f32_16x16x32_bf16 v[64:67], v[192:195], a[0:3], v[64:67]
  s_waitcnt lgkmcnt(3)
  ds_read_b64_tr_b16 v[182:183], v17 offset:14336
  v_mfma_f32_16x16x32_bf16 v[72:75], v[168:171], a[0:3], 0
  ds_read_b64_tr_b16 v[184:185], v18 offset:8192
  v_or_b32 v202, v202, v203
  v_mfma_f32_16x16x32_bf16 v[72:75], v[172:175], a[8:11], v[72:75]
  ds_read_b64_tr_b16 v[186:187], v18 offset:10240
  v_xor_b32_e64 v201, v201, v202
  v_mfma_f32_16x16x32_bf16 v[76:79], v[172:175], a[12:15], 0
  ds_read_b64_tr_b16 v[188:189], v18 offset:12288
  v_lshlrev_b32 v201, 3, v201
  v_mfma_f32_16x16x32_bf16 v[76:79], v[168:171], a[4:7], v[76:79]
  s_waitcnt lgkmcnt(3)
  ds_read_b64_tr_b16 v[190:191], v18 offset:14336
  v_mfma_f32_16x16x32_bf16 v[84:87], v[176:179], a[4:7], 0
  ds_read_b64_tr_b16 v[192:193], v19 offset:8192
  v_lshl_add_u32 v200, v200, 7, v201
  v_mfma_f32_16x16x32_bf16 v[84:87], v[180:183], a[12:15], v[84:87]
  s_add_u32 s34, s37, 98304
  ds_read_b64_tr_b16 v[194:195], v19 offset:10240
  v_add_u32_e64 v248, s34, v200
  v_mfma_f32_16x16x32_bf16 v[80:83], v[180:183], a[8:11], 0
  ds_read_b64_tr_b16 v[196:197], v19 offset:12288
  v_xor_b32 v249, 32, v248
  v_mfma_f32_16x16x32_bf16 v[80:83], v[176:179], a[0:3], v[80:83]
  s_waitcnt vmcnt(28) lgkmcnt(3)
  ds_read_b64_tr_b16 v[198:199], v19 offset:14336
  v_mfma_f32_16x16x32_bf16 v[88:91], v[184:187], a[0:3], 0
  s_barrier
  ds_read_b64_tr_b16 v[168:169], v16 offset:16384
  v_mfma_f32_16x16x32_bf16 v[88:91], v[188:191], a[8:11], v[88:91]
  ds_read_b64_tr_b16 v[170:171], v16 offset:18432
  v_xor_b32 v250, 64, v248
  v_mfma_f32_16x16x32_bf16 v[92:95], v[188:191], a[12:15], 0
  ds_read_b64_tr_b16 v[172:173], v16 offset:20480
  v_xor_b32 v251, 96, v248
  v_mfma_f32_16x16x32_bf16 v[92:95], v[184:187], a[4:7], v[92:95]
  s_waitcnt lgkmcnt(3)
  ds_read_b64_tr_b16 v[174:175], v16 offset:22528
  v_mfma_f32_16x16x32_bf16 v[100:103], v[192:195], a[4:7], 0
  ds_read_b64_tr_b16 v[176:177], v17 offset:16384
  v_lshrrev_b32 v200, 2, v1
  v_mfma_f32_16x16x32_bf16 v[100:103], v[196:199], a[12:15], v[100:103]
  ds_read_b64_tr_b16 v[178:179], v17 offset:18432
  v_and_b32 v201, 3, v1
  v_mfma_f32_16x16x32_bf16 v[96:99], v[196:199], a[8:11], 0
  ds_read_b64_tr_b16 v[180:181], v17 offset:20480
  v_and_b32 v202, 7, v200
  v_mfma_f32_16x16x32_bf16 v[96:99], v[192:195], a[0:3], v[96:99]
  s_waitcnt vmcnt(8) lgkmcnt(3)
  ds_read_b64_tr_b16 v[182:183], v17 offset:22528
  v_mfma_f32_16x16x32_bf16 v[40:43], v[168:171], a[16:19], v[40:43]
  ds_read_b64_tr_b16 v[184:185], v18 offset:16384
  buffer_load_dwordx4 a[48:51], v8, s[16:19], s39 offen offset:2048 sc1
  v_mfma_f32_16x16x32_bf16 v[40:43], v[172:175], a[24:27], v[40:43]
  ds_read_b64_tr_b16 v[186:187], v18 offset:18432
  v_lshlrev_b32 v202, 1, v202
  v_mfma_f32_16x16x32_bf16 v[44:47], v[172:175], a[28:31], v[44:47]
  ds_read_b64_tr_b16 v[188:189], v18 offset:20480
  buffer_load_dwordx4 a[52:55], v9, s[16:19], s39 offen offset:2048 sc1
  v_mfma_f32_16x16x32_bf16 v[44:47], v[168:171], a[20:23], v[44:47]
  s_waitcnt lgkmcnt(3)
  ds_read_b64_tr_b16 v[190:191], v18 offset:22528
  v_mfma_f32_16x16x32_bf16 v[52:55], v[176:179], a[20:23], v[52:55]
  ds_read_b64_tr_b16 v[192:193], v19 offset:16384
  v_lshrrev_b32 v203, 3, v200
  v_mfma_f32_16x16x32_bf16 v[52:55], v[180:183], a[28:31], v[52:55]
  ds_read_b64_tr_b16 v[194:195], v19 offset:18432
  v_or_b32 v202, v202, v203
  v_mfma_f32_16x16x32_bf16 v[48:51], v[180:183], a[24:27], v[48:51]
  ds_read_b64_tr_b16 v[196:197], v19 offset:20480
  buffer_load_dwordx4 a[56:59], v8, s[16:19], s39 offen offset:3072 sc1
  v_mfma_f32_16x16x32_bf16 v[48:51], v[176:179], a[16:19], v[48:51]
  s_waitcnt lgkmcnt(3)
  ds_read_b64_tr_b16 v[198:199], v19 offset:22528
  v_mfma_f32_16x16x32_bf16 v[56:59], v[184:187], a[16:19], v[56:59]
  ds_read_b64_tr_b16 v[168:169], v16 offset:24576
  v_xor_b32 v201, v201, v202
  v_mfma_f32_16x16x32_bf16 v[56:59], v[188:191], a[24:27], v[56:59]
  ds_read_b64_tr_b16 v[170:171], v16 offset:26624
  buffer_load_dwordx4 a[60:63], v9, s[16:19], s39 offen offset:3072 sc1
  v_mfma_f32_16x16x32_bf16 v[60:63], v[188:191], a[28:31], v[60:63]
  s_add_u32 s39, s39, 4096
  ds_read_b64_tr_b16 v[172:173], v16 offset:28672
  v_mfma_f32_16x16x32_bf16 v[60:63], v[184:187], a[20:23], v[60:63]
  s_waitcnt lgkmcnt(3)
  ds_read_b64_tr_b16 v[174:175], v16 offset:30720
  v_mfma_f32_16x16x32_bf16 v[68:71], v[192:195], a[20:23], v[68:71]
  ds_read_b64_tr_b16 v[176:177], v17 offset:24576
  v_lshlrev_b32 v201, 3, v201
  v_mfma_f32_16x16x32_bf16 v[68:71], v[196:199], a[28:31], v[68:71]
  ds_read_b64_tr_b16 v[178:179], v17 offset:26624
  v_lshl_add_u32 v200, v200, 7, v201
  v_mfma_f32_16x16x32_bf16 v[64:67], v[196:199], a[24:27], v[64:67]
  s_and_b32 s34, s24, 1
  ds_read_b64_tr_b16 v[180:181], v17 offset:28672
  s_lshl_b32 s34, s34, 1
  v_mfma_f32_16x16x32_bf16 v[64:67], v[192:195], a[16:19], v[64:67]
  s_waitcnt lgkmcnt(3)
  ds_read_b64_tr_b16 v[182:183], v17 offset:30720
  v_mfma_f32_16x16x32_bf16 v[72:75], v[168:171], a[16:19], v[72:75]
  s_and_b32 s10, s27, 1
  ds_read_b64_tr_b16 v[184:185], v18 offset:24576
  s_or_b32 s34, s34, s10
  v_mfma_f32_16x16x32_bf16 v[72:75], v[172:175], a[24:27], v[72:75]
  s_lshl_b32 s34, s34, 5
  ds_read_b64_tr_b16 v[186:187], v18 offset:26624
  s_lshr_b32 s35, s24, 1
  v_mfma_f32_16x16x32_bf16 v[76:79], v[172:175], a[28:31], v[76:79]
  s_lshl_b32 s36, s35, 6
  ds_read_b64_tr_b16 v[188:189], v18 offset:28672
  s_lshl_b32 s35, s35, 14
  v_mfma_f32_16x16x32_bf16 v[76:79], v[168:171], a[20:23], v[76:79]
  s_waitcnt lgkmcnt(3)
  ds_read_b64_tr_b16 v[190:191], v18 offset:30720
  v_mfma_f32_16x16x32_bf16 v[84:87], v[176:179], a[20:23], v[84:87]
  s_add_u32 s35, s35, 98304
  ds_read_b64_tr_b16 v[192:193], v19 offset:24576
  v_xor_b32 v201, s34, v200
  v_mfma_f32_16x16x32_bf16 v[84:87], v[180:183], a[28:31], v[84:87]
  ds_read_b64_tr_b16 v[194:195], v19 offset:26624
  v_add_u32 v10, s35, v201
  v_mfma_f32_16x16x32_bf16 v[80:83], v[180:183], a[24:27], v[80:83]
  ds_read_b64_tr_b16 v[196:197], v19 offset:28672
  v_xor_b32 v11, 32, v10
  v_mfma_f32_16x16x32_bf16 v[80:83], v[176:179], a[16:19], v[80:83]
  s_waitcnt vmcnt(28) lgkmcnt(3)
  ds_read_b64_tr_b16 v[198:199], v19 offset:30720
  v_mfma_f32_16x16x32_bf16 v[88:91], v[184:187], a[16:19], v[88:91]
  s_barrier
  ds_read_b64_tr_b16 v[168:169], v16 offset:32768
  v_mfma_f32_16x16x32_bf16 v[88:91], v[188:191], a[24:27], v[88:91]
  ds_read_b64_tr_b16 v[170:171], v16 offset:34816
  v_xor_b32 v201, s36, v200
  v_mfma_f32_16x16x32_bf16 v[92:95], v[188:191], a[28:31], v[92:95]
  ds_read_b64_tr_b16 v[172:173], v16 offset:36864
  v_add_u32 v12, 131072, v201
  v_mfma_f32_16x16x32_bf16 v[92:95], v[184:187], a[20:23], v[92:95]
  s_waitcnt lgkmcnt(3)
  ds_read_b64_tr_b16 v[174:175], v16 offset:38912
  v_mfma_f32_16x16x32_bf16 v[100:103], v[192:195], a[20:23], v[100:103]
  ds_read_b64_tr_b16 v[176:177], v17 offset:32768
  v_xor_b32 v13, 32, v12
  v_mfma_f32_16x16x32_bf16 v[100:103], v[196:199], a[28:31], v[100:103]
  s_lshl_b32 s34, s28, 2
  ds_read_b64_tr_b16 v[178:179], v17 offset:34816
  s_add_u32 s34, s34, s24
  v_mfma_f32_16x16x32_bf16 v[96:99], v[196:199], a[24:27], v[96:99]
  s_mul_i32 s35, s34, 32768
  ds_read_b64_tr_b16 v[180:181], v17 offset:36864
  s_add_u32 s45, s35, 0x3600000
  v_mfma_f32_16x16x32_bf16 v[96:99], v[192:195], a[16:19], v[96:99]
  s_waitcnt vmcnt(4) lgkmcnt(3)
  ds_read_b64_tr_b16 v[182:183], v17 offset:38912
  v_mfma_f32_16x16x32_bf16 v[40:43], v[168:171], a[32:35], v[40:43]
  s_lshl_b32 s36, s27, 11
  ds_read_b64_tr_b16 v[184:185], v18 offset:32768
  buffer_load_dwordx4 a[64:67], v8, s[16:19], s39 offen offset:0 sc1
  v_mfma_f32_16x16x32_bf16 v[40:43], v[172:175], a[40:43], v[40:43]
  s_add_u32 s38, s50, 2359296
  ds_read_b64_tr_b16 v[186:187], v18 offset:34816
  v_mfma_f32_16x16x32_bf16 v[44:47], v[172:175], a[44:47], v[44:47]
  s_add_u32 m0, s37, 0
  ds_read_b64_tr_b16 v[188:189], v18 offset:36864
  buffer_load_dwordx4 v4, s[12:15], s38 offen offset:0  lds
  v_mfma_f32_16x16x32_bf16 v[44:47], v[168:171], a[36:39], v[44:47]
  s_waitcnt lgkmcnt(3)
  ds_read_b64_tr_b16 v[190:191], v18 offset:38912
  v_mfma_f32_16x16x32_bf16 v[52:55], v[176:179], a[36:39], v[52:55]
  s_add_u32 s36, s36, s45
  ds_read_b64_tr_b16 v[192:193], v19 offset:32768
  s_lshl_b32 s35, s34, 12
  v_mfma_f32_16x16x32_bf16 v[52:55], v[180:183], a[44:47], v[52:55]
  s_add_u32 s46, s35, 0x3b00000
  ds_read_b64_tr_b16 v[194:195], v19 offset:34816
  s_lshl_b32 s35, s27, 8
  v_mfma_f32_16x16x32_bf16 v[48:51], v[180:183], a[40:43], v[48:51]
  s_add_u32 s35, s35, s46
  ds_read_b64_tr_b16 v[196:197], v19 offset:36864
  buffer_load_dwordx4 a[68:71], v9, s[16:19], s39 offen offset:0 sc1
  v_mfma_f32_16x16x32_bf16 v[48:51], v[176:179], a[32:35], v[48:51]
  s_waitcnt lgkmcnt(3)
  ds_read_b64_tr_b16 v[198:199], v19 offset:38912
  v_mfma_f32_16x16x32_bf16 v[56:59], v[184:187], a[32:35], v[56:59]
  s_lshl_b32 s10, s10, 6
  ds_read_b64_tr_b16 v[168:169], v16 offset:40960
  v_lshlrev_b32 v15, 2, v1
  v_mfma_f32_16x16x32_bf16 v[56:59], v[188:191], a[40:43], v[56:59]
  ds_read_b64_tr_b16 v[170:171], v16 offset:43008
  buffer_load_dwordx4 v5, s[12:15], s38 offen offset:1024  lds
  v_mfma_f32_16x16x32_bf16 v[60:63], v[188:191], a[44:47], v[60:63]
  ds_read_b64_tr_b16 v[172:173], v16 offset:45056
  v_xor_b32_e64 v15, s10, v15
  v_mfma_f32_16x16x32_bf16 v[60:63], v[184:187], a[36:39], v[60:63]
  s_waitcnt lgkmcnt(3)
  ds_read_b64_tr_b16 v[174:175], v16 offset:47104
  v_mfma_f32_16x16x32_bf16 v[68:71], v[192:195], a[36:39], v[68:71]
  ds_read_b64_tr_b16 v[176:177], v17 offset:40960
  v_add_u32 v15, s35, v15
  v_mfma_f32_16x16x32_bf16 v[68:71], v[196:199], a[44:47], v[68:71]
  ds_read_b64_tr_b16 v[178:179], v17 offset:43008
  buffer_load_dwordx4 a[72:75], v8, s[16:19], s39 offen offset:1024 sc1
  v_mfma_f32_16x16x32_bf16 v[64:67], v[196:199], a[40:43], v[64:67]
  ds_read_b64_tr_b16 v[180:181], v17 offset:45056
  v_add_u32 v14, s36, v3
  v_mfma_f32_16x16x32_bf16 v[64:67], v[192:195], a[32:35], v[64:67]
  s_waitcnt lgkmcnt(3)
  ds_read_b64_tr_b16 v[182:183], v17 offset:47104
  v_mfma_f32_16x16x32_bf16 v[72:75], v[168:171], a[32:35], v[72:75]
  s_lshl_b32 s34, s2, 2
  ds_read_b64_tr_b16 v[184:185], v18 offset:40960
  buffer_load_dwordx4 v6, s[12:15], s38 offen offset:2048  lds
  v_mfma_f32_16x16x32_bf16 v[72:75], v[172:175], a[40:43], v[72:75]
  s_add_u32 s34, s34, s24
  ds_read_b64_tr_b16 v[186:187], v18 offset:43008
  s_mul_i32 s34, s34, 7168
  v_mfma_f32_16x16x32_bf16 v[76:79], v[172:175], a[44:47], v[76:79]
  ds_read_b64_tr_b16 v[188:189], v18 offset:45056
  v_min_u32 v200, 55, v1
  v_mfma_f32_16x16x32_bf16 v[76:79], v[168:171], a[36:39], v[76:79]
  s_waitcnt lgkmcnt(3)
  ds_read_b64_tr_b16 v[190:191], v18 offset:47104
  v_mfma_f32_16x16x32_bf16 v[84:87], v[176:179], a[36:39], v[84:87]
  ds_read_b64_tr_b16 v[192:193], v19 offset:40960
  buffer_load_dwordx4 a[76:79], v9, s[16:19], s39 offen offset:1024 sc1
  v_mfma_f32_16x16x32_bf16 v[84:87], v[180:183], a[44:47], v[84:87]
  ds_read_b64_tr_b16 v[194:195], v19 offset:43008
  v_lshrrev_b32 v201, 3, v200
  v_mfma_f32_16x16x32_bf16 v[80:83], v[180:183], a[40:43], v[80:83]
  ds_read_b64_tr_b16 v[196:197], v19 offset:45056
  v_and_b32 v200, 7, v200
  v_mfma_f32_16x16x32_bf16 v[80:83], v[176:179], a[32:35], v[80:83]
  s_waitcnt vmcnt(31) lgkmcnt(3)
  ds_read_b64_tr_b16 v[198:199], v19 offset:47104
  buffer_load_dwordx4 v7, s[12:15], s38 offen offset:3072  lds
  v_mfma_f32_16x16x32_bf16 v[88:91], v[184:187], a[32:35], v[88:91]
  s_barrier
  ds_read_b64_tr_b16 v[168:169], v16 offset:49152
  v_mfma_f32_16x16x32_bf16 v[88:91], v[188:191], a[40:43], v[88:91]
  ds_read_b64_tr_b16 v[170:171], v16 offset:51200
  v_lshlrev_b32 v200, 4, v200
  v_mfma_f32_16x16x32_bf16 v[92:95], v[188:191], a[44:47], v[92:95]
  ds_read_b64_tr_b16 v[172:173], v16 offset:53248
  v_lshl_add_u32 v200, v201, 10, v200
  v_mfma_f32_16x16x32_bf16 v[92:95], v[184:187], a[36:39], v[92:95]
  s_waitcnt lgkmcnt(3)
  ds_read_b64_tr_b16 v[174:175], v16 offset:55296
  v_mfma_f32_16x16x32_bf16 v[100:103], v[192:195], a[36:39], v[100:103]
  ds_read_b64_tr_b16 v[176:177], v17 offset:49152
  v_add_u32 v24, s34, v200
  v_mfma_f32_16x16x32_bf16 v[100:103], v[196:199], a[44:47], v[100:103]
  s_add_u32 s8, s4, 0x4800000
  s_addc_u32 s9, s5, 0
  ds_read_b64_tr_b16 v[178:179], v17 offset:51200
  s_and_b32 s34, s40, 15
  v_mfma_f32_16x16x32_bf16 v[96:99], v[196:199], a[40:43], v[96:99]
  s_lshl_b32 s34, s34, 8
  ds_read_b64_tr_b16 v[180:181], v17 offset:53248
  s_bfe_u32 s35, s40, 0x40004
  v_mfma_f32_16x16x32_bf16 v[96:99], v[192:195], a[32:35], v[96:99]
  s_waitcnt vmcnt(8) lgkmcnt(3)
  ds_read_b64_tr_b16 v[182:183], v17 offset:55296
  v_mfma_f32_16x16x32_bf16 v[40:43], v[168:171], a[48:51], v[40:43]
  s_lshl_b32 s35, s35, 3
  ds_read_b64_tr_b16 v[184:185], v18 offset:49152
  buffer_load_dwordx4 a[80:83], v8, s[16:19], s39 offen offset:2048 sc1
  v_mfma_f32_16x16x32_bf16 v[40:43], v[172:175], a[56:59], v[40:43]
  s_add_u32 s38, s50, 2752512
  ds_read_b64_tr_b16 v[186:187], v18 offset:51200
  v_mfma_f32_16x16x32_bf16 v[44:47], v[172:175], a[60:63], v[44:47]
  s_add_u32 m0, s37, 16384
  ds_read_b64_tr_b16 v[188:189], v18 offset:53248
  buffer_load_dwordx4 v4, s[12:15], s38 offen offset:0  lds
  v_mfma_f32_16x16x32_bf16 v[44:47], v[168:171], a[52:55], v[44:47]
  s_waitcnt lgkmcnt(3)
  ds_read_b64_tr_b16 v[190:191], v18 offset:55296
  v_mfma_f32_16x16x32_bf16 v[52:55], v[176:179], a[52:55], v[52:55]
  s_add_u32 s34, s34, s35
  ds_read_b64_tr_b16 v[192:193], v19 offset:49152
  s_add_u32 s34, s34, 0x3bb0000
  v_mfma_f32_16x16x32_bf16 v[52:55], v[180:183], a[60:63], v[52:55]
  ds_read_b64_tr_b16 v[194:195], v19 offset:51200
  v_lshlrev_b32 v252, 12, v1
  v_mfma_f32_16x16x32_bf16 v[48:51], v[180:183], a[56:59], v[48:51]
  ds_read_b64_tr_b16 v[196:197], v19 offset:53248
  buffer_load_dwordx4 a[84:87], v9, s[16:19], s39 offen offset:2048 sc1
  v_mfma_f32_16x16x32_bf16 v[48:51], v[176:179], a[48:51], v[48:51]
  s_waitcnt lgkmcnt(3)
  ds_read_b64_tr_b16 v[198:199], v19 offset:55296
  v_mfma_f32_16x16x32_bf16 v[56:59], v[184:187], a[48:51], v[56:59]
  ds_read_b64_tr_b16 v[168:169], v16 offset:57344
  v_add_u32 v252, s34, v252
  v_mfma_f32_16x16x32_bf16 v[56:59], v[188:191], a[56:59], v[56:59]
  s_and_b32 s34, s40, 255
  ds_read_b64_tr_b16 v[170:171], v16 offset:59392
  buffer_load_dwordx4 v5, s[12:15], s38 offen offset:1024  lds
  v_mfma_f32_16x16x32_bf16 v[60:63], v[188:191], a[60:63], v[60:63]
  s_lshl_b32 s34, s34, 8
  ds_read_b64_tr_b16 v[172:173], v16 offset:61440
  s_add_u32 s34, s34, 0x3bb0000
  v_mfma_f32_16x16x32_bf16 v[60:63], v[184:187], a[52:55], v[60:63]
  s_waitcnt lgkmcnt(3)
  ds_read_b64_tr_b16 v[174:175], v16 offset:63488
  v_mfma_f32_16x16x32_bf16 v[68:71], v[192:195], a[52:55], v[68:71]
  ds_read_b64_tr_b16 v[176:177], v17 offset:57344
  v_and_b32 v253, 15, v1
  v_mfma_f32_16x16x32_bf16 v[68:71], v[196:199], a[60:63], v[68:71]
  ds_read_b64_tr_b16 v[178:179], v17 offset:59392
  buffer_load_dwordx4 a[88:91], v8, s[16:19], s39 offen offset:3072 sc1
  v_mfma_f32_16x16x32_bf16 v[64:67], v[196:199], a[56:59], v[64:67]
  ds_read_b64_tr_b16 v[180:181], v17 offset:61440
  v_lshl_add_u32 v253, v253, 3, s34
  v_mfma_f32_16x16x32_bf16 v[64:67], v[192:195], a[48:51], v[64:67]
  s_waitcnt lgkmcnt(3)
  ds_read_b64_tr_b16 v[182:183], v17 offset:63488
  v_mfma_f32_16x16x32_bf16 v[72:75], v[168:171], a[48:51], v[72:75]
  ds_read_b64_tr_b16 v[184:185], v18 offset:57344
  buffer_load_dwordx4 v6, s[12:15], s38 offen offset:2048  lds
  v_mfma_f32_16x16x32_bf16 v[72:75], v[172:175], a[56:59], v[72:75]
  ds_read_b64_tr_b16 v[186:187], v18 offset:59392
  v_mfma_f32_16x16x32_bf16 v[76:79], v[172:175], a[60:63], v[76:79]
  ds_read_b64_tr_b16 v[188:189], v18 offset:61440
  v_mfma_f32_16x16x32_bf16 v[76:79], v[168:171], a[52:55], v[76:79]
  s_waitcnt lgkmcnt(3)
  ds_read_b64_tr_b16 v[190:191], v18 offset:63488
  v_mfma_f32_16x16x32_bf16 v[84:87], v[176:179], a[52:55], v[84:87]
  ds_read_b64_tr_b16 v[192:193], v19 offset:57344
  buffer_load_dwordx4 a[92:95], v9, s[16:19], s39 offen offset:3072 sc1
  v_mfma_f32_16x16x32_bf16 v[84:87], v[180:183], a[60:63], v[84:87]
  s_add_u32 s39, s39, 4096
  ds_read_b64_tr_b16 v[194:195], v19 offset:59392
  v_mfma_f32_16x16x32_bf16 v[80:83], v[180:183], a[56:59], v[80:83]
  ds_read_b64_tr_b16 v[196:197], v19 offset:61440
  v_mfma_f32_16x16x32_bf16 v[80:83], v[176:179], a[48:51], v[80:83]
  s_waitcnt vmcnt(35) lgkmcnt(3)
  ds_read_b64_tr_b16 v[198:199], v19 offset:63488
  v_mfma_f32_16x16x32_bf16 v[88:91], v[184:187], a[48:51], v[88:91]
  s_barrier
  ds_read_b64_tr_b16 v[168:169], v20 offset:0
  v_mfma_f32_16x16x32_bf16 v[88:91], v[188:191], a[56:59], v[88:91]
  ds_read_b64_tr_b16 v[170:171], v20 offset:2048
  v_mfma_f32_16x16x32_bf16 v[92:95], v[188:191], a[60:63], v[92:95]
  ds_read_b64_tr_b16 v[172:173], v20 offset:4096
  v_mfma_f32_16x16x32_bf16 v[92:95], v[184:187], a[52:55], v[92:95]
  s_waitcnt lgkmcnt(3)
  ds_read_b64_tr_b16 v[174:175], v20 offset:6144
  v_mfma_f32_16x16x32_bf16 v[100:103], v[192:195], a[52:55], v[100:103]
  ds_read_b64_tr_b16 v[176:177], v21 offset:0
  v_mfma_f32_16x16x32_bf16 v[100:103], v[196:199], a[60:63], v[100:103]
  ds_read_b64_tr_b16 v[178:179], v21 offset:2048
  v_mfma_f32_16x16x32_bf16 v[96:99], v[196:199], a[56:59], v[96:99]
  ds_read_b64_tr_b16 v[180:181], v21 offset:4096
  v_mfma_f32_16x16x32_bf16 v[96:99], v[192:195], a[48:51], v[96:99]
  s_waitcnt vmcnt(8) lgkmcnt(3)
  ds_read_b64_tr_b16 v[182:183], v21 offset:6144
  v_mfma_f32_16x16x32_bf16 v[40:43], v[168:171], a[64:67], v[40:43]
  ds_read_b64_tr_b16 v[184:185], v22 offset:0
  buffer_load_dwordx4 a[96:99], v8, s[16:19], s39 offen offset:0 sc1
  v_mfma_f32_16x16x32_bf16 v[40:43], v[172:175], a[72:75], v[40:43]
  ds_read_b64_tr_b16 v[186:187], v22 offset:2048
  v_mfma_f32_16x16x32_bf16 v[44:47], v[172:175], a[76:79], v[44:47]
  ds_read_b64_tr_b16 v[188:189], v22 offset:4096
  buffer_load_dwordx4 v7, s[12:15], s38 offen offset:3072  lds
  v_mfma_f32_16x16x32_bf16 v[44:47], v[168:171], a[68:71], v[44:47]
  s_waitcnt lgkmcnt(3)
  ds_read_b64_tr_b16 v[190:191], v22 offset:6144
  v_mfma_f32_16x16x32_bf16 v[52:55], v[176:179], a[68:71], v[52:55]
  ds_read_b64_tr_b16 v[192:193], v23 offset:0
  v_mfma_f32_16x16x32_bf16 v[52:55], v[180:183], a[76:79], v[52:55]
  ds_read_b64_tr_b16 v[194:195], v23 offset:2048
  v_mfma_f32_16x16x32_bf16 v[48:51], v[180:183], a[72:75], v[48:51]
  ds_read_b64_tr_b16 v[196:197], v23 offset:4096
  buffer_load_dwordx4 a[100:103], v9, s[16:19], s39 offen offset:0 sc1
  v_mfma_f32_16x16x32_bf16 v[48:51], v[176:179], a[64:67], v[48:51]
  s_waitcnt lgkmcnt(3)
  ds_read_b64_tr_b16 v[198:199], v23 offset:6144
  v_mfma_f32_16x16x32_bf16 v[56:59], v[184:187], a[64:67], v[56:59]
  s_add_u32 s38, s50, 3145728
  ds_read_b64_tr_b16 v[168:169], v20 offset:8192
  v_mfma_f32_16x16x32_bf16 v[56:59], v[188:191], a[72:75], v[56:59]
  s_add_u32 m0, s37, 32768
  ds_read_b64_tr_b16 v[170:171], v20 offset:10240
  buffer_load_dwordx4 v4, s[12:15], s38 offen offset:0  lds
  v_mfma_f32_16x16x32_bf16 v[60:63], v[188:191], a[76:79], v[60:63]
  ds_read_b64_tr_b16 v[172:173], v20 offset:12288
  v_mfma_f32_16x16x32_bf16 v[60:63], v[184:187], a[68:71], v[60:63]
  s_waitcnt lgkmcnt(3)
  ds_read_b64_tr_b16 v[174:175], v20 offset:14336
  v_mfma_f32_16x16x32_bf16 v[68:71], v[192:195], a[68:71], v[68:71]
  ds_read_b64_tr_b16 v[176:177], v21 offset:8192
  v_mfma_f32_16x16x32_bf16 v[68:71], v[196:199], a[76:79], v[68:71]
  ds_read_b64_tr_b16 v[178:179], v21 offset:10240
  buffer_load_dwordx4 a[104:107], v8, s[16:19], s39 offen offset:1024 sc1
  v_mfma_f32_16x16x32_bf16 v[64:67], v[196:199], a[72:75], v[64:67]
  ds_read_b64_tr_b16 v[180:181], v21 offset:12288
  v_mfma_f32_16x16x32_bf16 v[64:67], v[192:195], a[64:67], v[64:67]
  s_waitcnt lgkmcnt(3)
  ds_read_b64_tr_b16 v[182:183], v21 offset:14336
  v_mfma_f32_16x16x32_bf16 v[72:75], v[168:171], a[64:67], v[72:75]
  ds_read_b64_tr_b16 v[184:185], v22 offset:8192
  buffer_load_dwordx4 v5, s[12:15], s38 offen offset:1024  lds
  v_mfma_f32_16x16x32_bf16 v[72:75], v[172:175], a[72:75], v[72:75]
  ds_read_b64_tr_b16 v[186:187], v22 offset:10240
  v_mfma_f32_16x16x32_bf16 v[76:79], v[172:175], a[76:79], v[76:79]
  ds_read_b64_tr_b16 v[188:189], v22 offset:12288
  v_mfma_f32_16x16x32_bf16 v[76:79], v[168:171], a[68:71], v[76:79]
  s_waitcnt lgkmcnt(3)
  ds_read_b64_tr_b16 v[190:191], v22 offset:14336
  v_mfma_f32_16x16x32_bf16 v[84:87], v[176:179], a[68:71], v[84:87]
  ds_read_b64_tr_b16 v[192:193], v23 offset:8192
  buffer_load_dwordx4 a[108:111], v9, s[16:19], s39 offen offset:1024 sc1
  v_mfma_f32_16x16x32_bf16 v[84:87], v[180:183], a[76:79], v[84:87]
  ds_read_b64_tr_b16 v[194:195], v23 offset:10240
  v_mfma_f32_16x16x32_bf16 v[80:83], v[180:183], a[72:75], v[80:83]
  ds_read_b64_tr_b16 v[196:197], v23 offset:12288
  v_mfma_f32_16x16x32_bf16 v[80:83], v[176:179], a[64:67], v[80:83]
  s_waitcnt vmcnt(30) lgkmcnt(3)
  ds_read_b64_tr_b16 v[198:199], v23 offset:14336
  v_mfma_f32_16x16x32_bf16 v[88:91], v[184:187], a[64:67], v[88:91]
  s_barrier
  ds_read_b64_tr_b16 v[168:169], v20 offset:16384
  v_mfma_f32_16x16x32_bf16 v[88:91], v[188:191], a[72:75], v[88:91]
  ds_read_b64_tr_b16 v[170:171], v20 offset:18432
  v_mfma_f32_16x16x32_bf16 v[92:95], v[188:191], a[76:79], v[92:95]
  ds_read_b64_tr_b16 v[172:173], v20 offset:20480
  v_mfma_f32_16x16x32_bf16 v[92:95], v[184:187], a[68:71], v[92:95]
  s_waitcnt lgkmcnt(3)
  ds_read_b64_tr_b16 v[174:175], v20 offset:22528
  v_mfma_f32_16x16x32_bf16 v[100:103], v[192:195], a[68:71], v[100:103]
  ds_read_b64_tr_b16 v[176:177], v21 offset:16384
  v_mfma_f32_16x16x32_bf16 v[100:103], v[196:199], a[76:79], v[100:103]
  ds_read_b64_tr_b16 v[178:179], v21 offset:18432
  v_mfma_f32_16x16x32_bf16 v[96:99], v[196:199], a[72:75], v[96:99]
  ds_read_b64_tr_b16 v[180:181], v21 offset:20480
  v_mfma_f32_16x16x32_bf16 v[96:99], v[192:195], a[64:67], v[96:99]
  s_waitcnt vmcnt(7) lgkmcnt(3)
  ds_read_b64_tr_b16 v[182:183], v21 offset:22528
  v_mfma_f32_16x16x32_bf16 v[40:43], v[168:171], a[80:83], v[40:43]
  ds_read_b64_tr_b16 v[184:185], v22 offset:16384
  buffer_load_dwordx4 a[112:115], v8, s[16:19], s39 offen offset:2048 sc1
  v_mfma_f32_16x16x32_bf16 v[40:43], v[172:175], a[88:91], v[40:43]
  ds_read_b64_tr_b16 v[186:187], v22 offset:18432
  v_mfma_f32_16x16x32_bf16 v[44:47], v[172:175], a[92:95], v[44:47]
  ds_read_b64_tr_b16 v[188:189], v22 offset:20480
  buffer_load_dwordx4 v6, s[12:15], s38 offen offset:2048  lds
  v_mfma_f32_16x16x32_bf16 v[44:47], v[168:171], a[84:87], v[44:47]
  s_waitcnt lgkmcnt(3)
  ds_read_b64_tr_b16 v[190:191], v22 offset:22528
  v_mfma_f32_16x16x32_bf16 v[52:55], v[176:179], a[84:87], v[52:55]
L_pad_0a_1:
  s_cbranch_execz L_pad_0a_5
  ds_read_b64_tr_b16 v[192:193], v23 offset:16384
  v_mfma_f32_16x16x32_bf16 v[52:55], v[180:183], a[92:95], v[52:55]
  ds_read_b64_tr_b16 v[194:195], v23 offset:18432
  v_mfma_f32_16x16x32_bf16 v[48:51], v[180:183], a[88:91], v[48:51]
  ds_read_b64_tr_b16 v[196:197], v23 offset:20480
  buffer_load_dwordx4 a[116:119], v9, s[16:19], s39 offen offset:2048 sc1
  v_mfma_f32_16x16x32_bf16 v[48:51], v[176:179], a[80:83], v[48:51]
  s_waitcnt lgkmcnt(3)
  ds_read_b64_tr_b16 v[198:199], v23 offset:22528
  v_mfma_f32_16x16x32_bf16 v[56:59], v[184:187], a[80:83], v[56:59]
  ds_read_b64_tr_b16 v[168:169], v20 offset:24576
  v_mfma_f32_16x16x32_bf16 v[56:59], v[188:191], a[88:91], v[56:59]
  ds_read_b64_tr_b16 v[170:171], v20 offset:26624
  buffer_load_dwordx4 v7, s[12:15], s38 offen offset:3072  lds
  v_mfma_f32_16x16x32_bf16 v[60:63], v[188:191], a[92:95], v[60:63]
  ds_read_b64_tr_b16 v[172:173], v20 offset:28672
  v_mfma_f32_16x16x32_bf16 v[60:63], v[184:187], a[84:87], v[60:63]
  s_waitcnt lgkmcnt(3)
  ds_read_b64_tr_b16 v[174:175], v20 offset:30720
  v_mfma_f32_16x16x32_bf16 v[68:71], v[192:195], a[84:87], v[68:71]
  ds_read_b64_tr_b16 v[176:177], v21 offset:24576
  v_mfma_f32_16x16x32_bf16 v[68:71], v[196:199], a[92:95], v[68:71]
  ds_read_b64_tr_b16 v[178:179], v21 offset:26624
  buffer_load_dwordx4 a[120:123], v8, s[16:19], s39 offen offset:3072 sc1
  v_mfma_f32_16x16x32_bf16 v[64:67], v[196:199], a[88:91], v[64:67]
  s_add_u32 s38, s50, 3538944
  ds_read_b64_tr_b16 v[180:181], v21 offset:28672
  v_mfma_f32_16x16x32_bf16 v[64:67], v[192:195], a[80:83], v[64:67]
  s_waitcnt lgkmcnt(3)
  ds_read_b64_tr_b16 v[182:183], v21 offset:30720
  v_mfma_f32_16x16x32_bf16 v[72:75], v[168:171], a[80:83], v[72:75]
  s_add_u32 m0, s37, 49152
  ds_read_b64_tr_b16 v[184:185], v22 offset:24576
  buffer_load_dwordx4 v4, s[12:15], s38 offen offset:0  lds
  v_mfma_f32_16x16x32_bf16 v[72:75], v[172:175], a[88:91], v[72:75]
  ds_read_b64_tr_b16 v[186:187], v22 offset:26624
  v_mfma_f32_16x16x32_bf16 v[76:79], v[172:175], a[92:95], v[76:79]
  ds_read_b64_tr_b16 v[188:189], v22 offset:28672
  v_mfma_f32_16x16x32_bf16 v[76:79], v[168:171], a[84:87], v[76:79]
  s_waitcnt lgkmcnt(3)
  ds_read_b64_tr_b16 v[190:191], v22 offset:30720
  v_mfma_f32_16x16x32_bf16 v[84:87], v[176:179], a[84:87], v[84:87]
  ds_read_b64_tr_b16 v[192:193], v23 offset:24576
  buffer_load_dwordx4 a[124:127], v9, s[16:19], s39 offen offset:3072 sc1
  v_mfma_f32_16x16x32_bf16 v[84:87], v[180:183], a[92:95], v[84:87]
  ds_read_b64_tr_b16 v[194:195], v23 offset:26624
  v_mfma_f32_16x16x32_bf16 v[80:83], v[180:183], a[88:91], v[80:83]
  ds_read_b64_tr_b16 v[196:197], v23 offset:28672
  v_mfma_f32_16x16x32_bf16 v[80:83], v[176:179], a[80:83], v[80:83]
  s_waitcnt vmcnt(21) lgkmcnt(3)
  ds_read_b64_tr_b16 v[198:199], v23 offset:30720
  buffer_load_dwordx4 v5, s[12:15], s38 offen offset:1024  lds
  v_mfma_f32_16x16x32_bf16 v[88:91], v[184:187], a[80:83], v[88:91]
  s_barrier
  ds_read_b64_tr_b16 v[168:169], v16 offset:0
  v_mfma_f32_16x16x32_bf16 v[88:91], v[188:191], a[88:91], v[88:91]
  s_add_u32 s39, s39, 4096
  ds_read_b64_tr_b16 v[170:171], v16 offset:2048
  v_mfma_f32_16x16x32_bf16 v[92:95], v[188:191], a[92:95], v[92:95]
  ds_read_b64_tr_b16 v[172:173], v16 offset:4096
  v_mfma_f32_16x16x32_bf16 v[92:95], v[184:187], a[84:87], v[92:95]
  s_waitcnt lgkmcnt(3)
  ds_read_b64_tr_b16 v[174:175], v16 offset:6144
  v_mfma_f32_16x16x32_bf16 v[100:103], v[192:195], a[84:87], v[100:103]
  ds_read_b64_tr_b16 v[176:177], v17 offset:0
  v_mfma_f32_16x16x32_bf16 v[100:103], v[196:199], a[92:95], v[100:103]
  ds_read_b64_tr_b16 v[178:179], v17 offset:2048
  v_mfma_f32_16x16x32_bf16 v[96:99], v[196:199], a[88:91], v[96:99]
  ds_read_b64_tr_b16 v[180:181], v17 offset:4096
  v_mfma_f32_16x16x32_bf16 v[96:99], v[192:195], a[80:83], v[96:99]
  s_waitcnt vmcnt(8) lgkmcnt(3)
  ds_read_b64_tr_b16 v[182:183], v17 offset:6144
  v_mfma_f32_16x16x32_bf16 v[40:43], v[168:171], a[96:99], v[40:43]
  ds_read_b64_tr_b16 v[184:185], v18 offset:0
  buffer_load_dwordx4 a[128:131], v8, s[16:19], s39 offen offset:0 sc1
  v_mfma_f32_16x16x32_bf16 v[40:43], v[172:175], a[104:107], v[40:43]
  ds_read_b64_tr_b16 v[186:187], v18 offset:2048
  v_mfma_f32_16x16x32_bf16 v[44:47], v[172:175], a[108:111], v[44:47]
  ds_read_b64_tr_b16 v[188:189], v18 offset:4096
  buffer_load_dwordx4 v6, s[12:15], s38 offen offset:2048  lds
  v_mfma_f32_16x16x32_bf16 v[44:47], v[168:171], a[100:103], v[44:47]
  s_waitcnt lgkmcnt(3)
  ds_read_b64_tr_b16 v[190:191], v18 offset:6144
  v_mfma_f32_16x16x32_bf16 v[52:55], v[176:179], a[100:103], v[52:55]
  ds_read_b64_tr_b16 v[192:193], v19 offset:0
  v_mfma_f32_16x16x32_bf16 v[52:55], v[180:183], a[108:111], v[52:55]
  ds_read_b64_tr_b16 v[194:195], v19 offset:2048
  v_mfma_f32_16x16x32_bf16 v[48:51], v[180:183], a[104:107], v[48:51]
  ds_read_b64_tr_b16 v[196:197], v19 offset:4096
  buffer_load_dwordx4 a[132:135], v9, s[16:19], s39 offen offset:0 sc1
  v_mfma_f32_16x16x32_bf16 v[48:51], v[176:179], a[96:99], v[48:51]
  s_waitcnt lgkmcnt(3)
  ds_read_b64_tr_b16 v[198:199], v19 offset:6144
  v_mfma_f32_16x16x32_bf16 v[56:59], v[184:187], a[96:99], v[56:59]
  ds_read_b64_tr_b16 v[168:169], v16 offset:8192
  v_mfma_f32_16x16x32_bf16 v[56:59], v[188:191], a[104:107], v[56:59]
  ds_read_b64_tr_b16 v[170:171], v16 offset:10240
  buffer_load_dwordx4 v7, s[12:15], s38 offen offset:3072  lds
  v_mfma_f32_16x16x32_bf16 v[60:63], v[188:191], a[108:111], v[60:63]
  ds_read_b64_tr_b16 v[172:173], v16 offset:12288
  v_mfma_f32_16x16x32_bf16 v[60:63], v[184:187], a[100:103], v[60:63]
  s_waitcnt lgkmcnt(3)
  ds_read_b64_tr_b16 v[174:175], v16 offset:14336
  v_mfma_f32_16x16x32_bf16 v[68:71], v[192:195], a[100:103], v[68:71]
  ds_read_b64_tr_b16 v[176:177], v17 offset:8192
  v_mfma_f32_16x16x32_bf16 v[68:71], v[196:199], a[108:111], v[68:71]
  ds_read_b64_tr_b16 v[178:179], v17 offset:10240
  buffer_load_dwordx4 a[136:139], v8, s[16:19], s39 offen offset:1024 sc1
  v_mfma_f32_16x16x32_bf16 v[64:67], v[196:199], a[104:107], v[64:67]
  s_add_u32 s38, s50, 3932160
  ds_read_b64_tr_b16 v[180:181], v17 offset:12288
  v_mfma_f32_16x16x32_bf16 v[64:67], v[192:195], a[96:99], v[64:67]
  s_waitcnt lgkmcnt(3)
  ds_read_b64_tr_b16 v[182:183], v17 offset:14336
  v_mfma_f32_16x16x32_bf16 v[72:75], v[168:171], a[96:99], v[72:75]
  s_add_u32 m0, s37, 65536
  ds_read_b64_tr_b16 v[184:185], v18 offset:8192
  buffer_load_dwordx4 v4, s[12:15], s38 offen offset:0  lds
  v_mfma_f32_16x16x32_bf16 v[72:75], v[172:175], a[104:107], v[72:75]
  ds_read_b64_tr_b16 v[186:187], v18 offset:10240
  v_mfma_f32_16x16x32_bf16 v[76:79], v[172:175], a[108:111], v[76:79]
  ds_read_b64_tr_b16 v[188:189], v18 offset:12288
  v_mfma_f32_16x16x32_bf16 v[76:79], v[168:171], a[100:103], v[76:79]
  s_waitcnt lgkmcnt(3)
  ds_read_b64_tr_b16 v[190:191], v18 offset:14336
  v_mfma_f32_16x16x32_bf16 v[84:87], v[176:179], a[100:103], v[84:87]
  ds_read_b64_tr_b16 v[192:193], v19 offset:8192
  buffer_load_dwordx4 a[140:143], v9, s[16:19], s39 offen offset:1024 sc1
  v_mfma_f32_16x16x32_bf16 v[84:87], v[180:183], a[108:111], v[84:87]
  ds_read_b64_tr_b16 v[194:195], v19 offset:10240
  v_mfma_f32_16x16x32_bf16 v[80:83], v[180:183], a[104:107], v[80:83]
  ds_read_b64_tr_b16 v[196:197], v19 offset:12288
  v_mfma_f32_16x16x32_bf16 v[80:83], v[176:179], a[96:99], v[80:83]
  s_waitcnt vmcnt(20) lgkmcnt(3)
  ds_read_b64_tr_b16 v[198:199], v19 offset:14336
  v_mfma_f32_16x16x32_bf16 v[88:91], v[184:187], a[96:99], v[88:91]
  s_barrier
  ds_read_b64_tr_b16 v[168:169], v16 offset:16384
  v_mfma_f32_16x16x32_bf16 v[88:91], v[188:191], a[104:107], v[88:91]
  ds_read_b64_tr_b16 v[170:171], v16 offset:18432
  v_mfma_f32_16x16x32_bf16 v[92:95], v[188:191], a[108:111], v[92:95]
  ds_read_b64_tr_b16 v[172:173], v16 offset:20480
  v_mfma_f32_16x16x32_bf16 v[92:95], v[184:187], a[100:103], v[92:95]
  s_waitcnt lgkmcnt(3)
  ds_read_b64_tr_b16 v[174:175], v16 offset:22528
  v_mfma_f32_16x16x32_bf16 v[100:103], v[192:195], a[100:103], v[100:103]
  ds_read_b64_tr_b16 v[176:177], v17 offset:16384
  v_mfma_f32_16x16x32_bf16 v[100:103], v[196:199], a[108:111], v[100:103]
  ds_read_b64_tr_b16 v[178:179], v17 offset:18432
  v_mfma_f32_16x16x32_bf16 v[96:99], v[196:199], a[104:107], v[96:99]
  ds_read_b64_tr_b16 v[180:181], v17 offset:20480
  v_mfma_f32_16x16x32_bf16 v[96:99], v[192:195], a[96:99], v[96:99]
  s_waitcnt vmcnt(8) lgkmcnt(3)
  ds_read_b64_tr_b16 v[182:183], v17 offset:22528
  v_mfma_f32_16x16x32_bf16 v[40:43], v[168:171], a[112:115], v[40:43]
  ds_read_b64_tr_b16 v[184:185], v18 offset:16384
  buffer_load_dwordx4 a[144:147], v8, s[16:19], s39 offen offset:2048 sc1
  v_mfma_f32_16x16x32_bf16 v[40:43], v[172:175], a[120:123], v[40:43]
  ds_read_b64_tr_b16 v[186:187], v18 offset:18432
  v_mfma_f32_16x16x32_bf16 v[44:47], v[172:175], a[124:127], v[44:47]
  ds_read_b64_tr_b16 v[188:189], v18 offset:20480
  buffer_load_dwordx4 v5, s[12:15], s38 offen offset:1024  lds
  v_mfma_f32_16x16x32_bf16 v[44:47], v[168:171], a[116:119], v[44:47]
  s_waitcnt lgkmcnt(3)
  ds_read_b64_tr_b16 v[190:191], v18 offset:22528
  v_mfma_f32_16x16x32_bf16 v[52:55], v[176:179], a[116:119], v[52:55]
  ds_read_b64_tr_b16 v[192:193], v19 offset:16384
  v_mfma_f32_16x16x32_bf16 v[52:55], v[180:183], a[124:127], v[52:55]
  ds_read_b64_tr_b16 v[194:195], v19 offset:18432
  v_mfma_f32_16x16x32_bf16 v[48:51], v[180:183], a[120:123], v[48:51]
  ds_read_b64_tr_b16 v[196:197], v19 offset:20480
  buffer_load_dwordx4 a[148:151], v9, s[16:19], s39 offen offset:2048 sc1
  v_mfma_f32_16x16x32_bf16 v[48:51], v[176:179], a[112:115], v[48:51]
  s_waitcnt lgkmcnt(3)
  ds_read_b64_tr_b16 v[198:199], v19 offset:22528
  v_mfma_f32_16x16x32_bf16 v[56:59], v[184:187], a[112:115], v[56:59]
  ds_read_b64_tr_b16 v[168:169], v16 offset:24576
  v_mfma_f32_16x16x32_bf16 v[56:59], v[188:191], a[120:123], v[56:59]
  ds_read_b64_tr_b16 v[170:171], v16 offset:26624
  buffer_load_dwordx4 v6, s[12:15], s38 offen offset:2048  lds
  v_mfma_f32_16x16x32_bf16 v[60:63], v[188:191], a[124:127], v[60:63]
  ds_read_b64_tr_b16 v[172:173], v16 offset:28672
  v_mfma_f32_16x16x32_bf16 v[60:63], v[184:187], a[116:119], v[60:63]
  s_waitcnt lgkmcnt(3)
  ds_read_b64_tr_b16 v[174:175], v16 offset:30720
  v_mfma_f32_16x16x32_bf16 v[68:71], v[192:195], a[116:119], v[68:71]
  ds_read_b64_tr_b16 v[176:177], v17 offset:24576
  v_mfma_f32_16x16x32_bf16 v[68:71], v[196:199], a[124:127], v[68:71]
  ds_read_b64_tr_b16 v[178:179], v17 offset:26624
  buffer_load_dwordx4 a[152:155], v8, s[16:19], s39 offen offset:3072 sc1
  v_mfma_f32_16x16x32_bf16 v[64:67], v[196:199], a[120:123], v[64:67]
  ds_read_b64_tr_b16 v[180:181], v17 offset:28672
  v_mfma_f32_16x16x32_bf16 v[64:67], v[192:195], a[112:115], v[64:67]
  s_waitcnt lgkmcnt(3)
  ds_read_b64_tr_b16 v[182:183], v17 offset:30720
  v_mfma_f32_16x16x32_bf16 v[72:75], v[168:171], a[112:115], v[72:75]
  ds_read_b64_tr_b16 v[184:185], v18 offset:24576
  buffer_load_dwordx4 v7, s[12:15], s38 offen offset:3072  lds
  v_mfma_f32_16x16x32_bf16 v[72:75], v[172:175], a[120:123], v[72:75]
  ds_read_b64_tr_b16 v[186:187], v18 offset:26624
  v_mfma_f32_16x16x32_bf16 v[76:79], v[172:175], a[124:127], v[76:79]
  ds_read_b64_tr_b16 v[188:189], v18 offset:28672
  v_mfma_f32_16x16x32_bf16 v[76:79], v[168:171], a[116:119], v[76:79]
  s_waitcnt lgkmcnt(3)
  ds_read_b64_tr_b16 v[190:191], v18 offset:30720
  v_mfma_f32_16x16x32_bf16 v[84:87], v[176:179], a[116:119], v[84:87]
  ds_read_b64_tr_b16 v[192:193], v19 offset:24576
  buffer_load_dwordx4 a[156:159], v9, s[16:19], s39 offen offset:3072 sc1
  v_mfma_f32_16x16x32_bf16 v[84:87], v[180:183], a[124:127], v[84:87]
  s_add_u32 s39, s39, 4096
  ds_read_b64_tr_b16 v[194:195], v19 offset:26624
  v_mfma_f32_16x16x32_bf16 v[80:83], v[180:183], a[120:123], v[80:83]
  ds_read_b64_tr_b16 v[196:197], v19 offset:28672
  v_mfma_f32_16x16x32_bf16 v[80:83], v[176:179], a[112:115], v[80:83]
  s_waitcnt vmcnt(18) lgkmcnt(3)
  ds_read_b64_tr_b16 v[198:199], v19 offset:30720
  v_mfma_f32_16x16x32_bf16 v[88:91], v[184:187], a[112:115], v[88:91]
  s_barrier
  ds_read_b64_tr_b16 v[168:169], v16 offset:32768
  v_mfma_f32_16x16x32_bf16 v[88:91], v[188:191], a[120:123], v[88:91]
  ds_read_b64_tr_b16 v[170:171], v16 offset:34816
  v_mfma_f32_16x16x32_bf16 v[92:95], v[188:191], a[124:127], v[92:95]
  ds_read_b64_tr_b16 v[172:173], v16 offset:36864
  v_mfma_f32_16x16x32_bf16 v[92:95], v[184:187], a[116:119], v[92:95]
  s_waitcnt lgkmcnt(3)
  ds_read_b64_tr_b16 v[174:175], v16 offset:38912
  v_mfma_f32_16x16x32_bf16 v[100:103], v[192:195], a[116:119], v[100:103]
  ds_read_b64_tr_b16 v[176:177], v17 offset:32768
  v_mfma_f32_16x16x32_bf16 v[100:103], v[196:199], a[124:127], v[100:103]
  ds_read_b64_tr_b16 v[178:179], v17 offset:34816
  v_mfma_f32_16x16x32_bf16 v[96:99], v[196:199], a[120:123], v[96:99]
  ds_read_b64_tr_b16 v[180:181], v17 offset:36864
  v_mfma_f32_16x16x32_bf16 v[96:99], v[192:195], a[112:115], v[96:99]
  s_waitcnt vmcnt(7) lgkmcnt(3)
  ds_read_b64_tr_b16 v[182:183], v17 offset:38912
  v_mfma_f32_16x16x32_bf16 v[40:43], v[168:171], a[128:131], v[40:43]
  ds_read_b64_tr_b16 v[184:185], v18 offset:32768
  buffer_load_dwordx4 a[160:163], v8, s[16:19], s39 offen offset:0 sc1
  v_mfma_f32_16x16x32_bf16 v[40:43], v[172:175], a[136:139], v[40:43]
  s_add_u32 s38, s50, 4325376
  ds_read_b64_tr_b16 v[186:187], v18 offset:34816
  v_mfma_f32_16x16x32_bf16 v[44:47], v[172:175], a[140:143], v[44:47]
  s_add_u32 m0, s37, 81920
  ds_read_b64_tr_b16 v[188:189], v18 offset:36864
  buffer_load_dwordx4 v4, s[12:15], s38 offen offset:0  lds
  v_mfma_f32_16x16x32_bf16 v[44:47], v[168:171], a[132:135], v[44:47]
  s_waitcnt lgkmcnt(3)
  ds_read_b64_tr_b16 v[190:191], v18 offset:38912
  v_mfma_f32_16x16x32_bf16 v[52:55], v[176:179], a[132:135], v[52:55]
  ds_read_b64_tr_b16 v[192:193], v19 offset:32768
  v_mfma_f32_16x16x32_bf16 v[52:55], v[180:183], a[140:143], v[52:55]
  ds_read_b64_tr_b16 v[194:195], v19 offset:34816
  v_mfma_f32_16x16x32_bf16 v[48:51], v[180:183], a[136:139], v[48:51]
  ds_read_b64_tr_b16 v[196:197], v19 offset:36864
  buffer_load_dwordx4 a[164:167], v9, s[16:19], s39 offen offset:0 sc1
  v_mfma_f32_16x16x32_bf16 v[48:51], v[176:179], a[128:131], v[48:51]
  s_waitcnt lgkmcnt(3)
  ds_read_b64_tr_b16 v[198:199], v19 offset:38912
  v_mfma_f32_16x16x32_bf16 v[56:59], v[184:187], a[128:131], v[56:59]
  ds_read_b64_tr_b16 v[168:169], v16 offset:40960
  v_mfma_f32_16x16x32_bf16 v[56:59], v[188:191], a[136:139], v[56:59]
  ds_read_b64_tr_b16 v[170:171], v16 offset:43008
  buffer_load_dwordx4 v5, s[12:15], s38 offen offset:1024  lds
  v_mfma_f32_16x16x32_bf16 v[60:63], v[188:191], a[140:143], v[60:63]
  ds_read_b64_tr_b16 v[172:173], v16 offset:45056
  v_mfma_f32_16x16x32_bf16 v[60:63], v[184:187], a[132:135], v[60:63]
  s_waitcnt lgkmcnt(3)
  ds_read_b64_tr_b16 v[174:175], v16 offset:47104
  v_mfma_f32_16x16x32_bf16 v[68:71], v[192:195], a[132:135], v[68:71]
  ds_read_b64_tr_b16 v[176:177], v17 offset:40960
  v_mfma_f32_16x16x32_bf16 v[68:71], v[196:199], a[140:143], v[68:71]
  ds_read_b64_tr_b16 v[178:179], v17 offset:43008
  buffer_load_dwordx4 a[168:171], v8, s[16:19], s39 offen offset:1024 sc1
  v_mfma_f32_16x16x32_bf16 v[64:67], v[196:199], a[136:139], v[64:67]
  ds_read_b64_tr_b16 v[180:181], v17 offset:45056
  v_mfma_f32_16x16x32_bf16 v[64:67], v[192:195], a[128:131], v[64:67]
  s_waitcnt lgkmcnt(3)
  ds_read_b64_tr_b16 v[182:183], v17 offset:47104
  v_mfma_f32_16x16x32_bf16 v[72:75], v[168:171], a[128:131], v[72:75]
  ds_read_b64_tr_b16 v[184:185], v18 offset:40960
  buffer_load_dwordx4 v6, s[12:15], s38 offen offset:2048  lds
  v_mfma_f32_16x16x32_bf16 v[72:75], v[172:175], a[136:139], v[72:75]
  ds_read_b64_tr_b16 v[186:187], v18 offset:43008
  v_mfma_f32_16x16x32_bf16 v[76:79], v[172:175], a[140:143], v[76:79]
  ds_read_b64_tr_b16 v[188:189], v18 offset:45056
  v_mfma_f32_16x16x32_bf16 v[76:79], v[168:171], a[132:135], v[76:79]
  s_waitcnt lgkmcnt(3)
  ds_read_b64_tr_b16 v[190:191], v18 offset:47104
  v_mfma_f32_16x16x32_bf16 v[84:87], v[176:179], a[132:135], v[84:87]
  ds_read_b64_tr_b16 v[192:193], v19 offset:40960
  buffer_load_dwordx4 a[172:175], v9, s[16:19], s39 offen offset:1024 sc1
  v_mfma_f32_16x16x32_bf16 v[84:87], v[180:183], a[140:143], v[84:87]
  ds_read_b64_tr_b16 v[194:195], v19 offset:43008
  v_mfma_f32_16x16x32_bf16 v[80:83], v[180:183], a[136:139], v[80:83]
  ds_read_b64_tr_b16 v[196:197], v19 offset:45056
  v_mfma_f32_16x16x32_bf16 v[80:83], v[176:179], a[128:131], v[80:83]
  s_waitcnt vmcnt(17) lgkmcnt(3)
  ds_read_b64_tr_b16 v[198:199], v19 offset:47104
  buffer_load_dwordx4 v7, s[12:15], s38 offen offset:3072  lds
  v_mfma_f32_16x16x32_bf16 v[88:91], v[184:187], a[128:131], v[88:91]
  s_barrier
  ds_read_b64_tr_b16 v[168:169], v16 offset:49152
  v_mfma_f32_16x16x32_bf16 v[88:91], v[188:191], a[136:139], v[88:91]
  ds_read_b64_tr_b16 v[170:171], v16 offset:51200
  v_mfma_f32_16x16x32_bf16 v[92:95], v[188:191], a[140:143], v[92:95]
  ds_read_b64_tr_b16 v[172:173], v16 offset:53248
  v_mfma_f32_16x16x32_bf16 v[92:95], v[184:187], a[132:135], v[92:95]
  s_waitcnt lgkmcnt(3)
  ds_read_b64_tr_b16 v[174:175], v16 offset:55296
  v_mfma_f32_16x16x32_bf16 v[100:103], v[192:195], a[132:135], v[100:103]
  ds_read_b64_tr_b16 v[176:177], v17 offset:49152
  v_mfma_f32_16x16x32_bf16 v[100:103], v[196:199], a[140:143], v[100:103]
  ds_read_b64_tr_b16 v[178:179], v17 offset:51200
  v_mfma_f32_16x16x32_bf16 v[96:99], v[196:199], a[136:139], v[96:99]
  ds_read_b64_tr_b16 v[180:181], v17 offset:53248
  v_mfma_f32_16x16x32_bf16 v[96:99], v[192:195], a[128:131], v[96:99]
  s_waitcnt vmcnt(8) lgkmcnt(3)
  ds_read_b64_tr_b16 v[182:183], v17 offset:55296
  v_mfma_f32_16x16x32_bf16 v[40:43], v[168:171], a[144:147], v[40:43]
  ds_read_b64_tr_b16 v[184:185], v18 offset:49152
  buffer_load_dwordx4 a[176:179], v8, s[16:19], s39 offen offset:2048 sc1
  v_mfma_f32_16x16x32_bf16 v[40:43], v[172:175], a[152:155], v[40:43]
  s_add_u32 s38, s50, 4718592
  ds_read_b64_tr_b16 v[186:187], v18 offset:51200
  v_mfma_f32_16x16x32_bf16 v[44:47], v[172:175], a[156:159], v[44:47]
  s_add_u32 m0, s37, 0
  ds_read_b64_tr_b16 v[188:189], v18 offset:53248
  buffer_load_dwordx4 v4, s[12:15], s38 offen offset:0  lds
  v_mfma_f32_16x16x32_bf16 v[44:47], v[168:171], a[148:151], v[44:47]
  s_waitcnt lgkmcnt(3)
  ds_read_b64_tr_b16 v[190:191], v18 offset:55296
  v_mfma_f32_16x16x32_bf16 v[52:55], v[176:179], a[148:151], v[52:55]
  ds_read_b64_tr_b16 v[192:193], v19 offset:49152
  v_mfma_f32_16x16x32_bf16 v[52:55], v[180:183], a[156:159], v[52:55]
  ds_read_b64_tr_b16 v[194:195], v19 offset:51200
  v_mfma_f32_16x16x32_bf16 v[48:51], v[180:183], a[152:155], v[48:51]
  ds_read_b64_tr_b16 v[196:197], v19 offset:53248
  buffer_load_dwordx4 a[180:183], v9, s[16:19], s39 offen offset:2048 sc1
  v_mfma_f32_16x16x32_bf16 v[48:51], v[176:179], a[144:147], v[48:51]
  s_waitcnt lgkmcnt(3)
  ds_read_b64_tr_b16 v[198:199], v19 offset:55296
  v_mfma_f32_16x16x32_bf16 v[56:59], v[184:187], a[144:147], v[56:59]
  ds_read_b64_tr_b16 v[168:169], v16 offset:57344
  v_mfma_f32_16x16x32_bf16 v[56:59], v[188:191], a[152:155], v[56:59]
  ds_read_b64_tr_b16 v[170:171], v16 offset:59392
  buffer_load_dwordx4 v5, s[12:15], s38 offen offset:1024  lds
  v_mfma_f32_16x16x32_bf16 v[60:63], v[188:191], a[156:159], v[60:63]
  ds_read_b64_tr_b16 v[172:173], v16 offset:61440
  v_mfma_f32_16x16x32_bf16 v[60:63], v[184:187], a[148:151], v[60:63]
  s_waitcnt lgkmcnt(3)
  ds_read_b64_tr_b16 v[174:175], v16 offset:63488
  v_mfma_f32_16x16x32_bf16 v[68:71], v[192:195], a[148:151], v[68:71]
  ds_read_b64_tr_b16 v[176:177], v17 offset:57344
  v_mfma_f32_16x16x32_bf16 v[68:71], v[196:199], a[156:159], v[68:71]
  ds_read_b64_tr_b16 v[178:179], v17 offset:59392
  buffer_load_dwordx4 a[184:187], v8, s[16:19], s39 offen offset:3072 sc1
  v_mfma_f32_16x16x32_bf16 v[64:67], v[196:199], a[152:155], v[64:67]
  ds_read_b64_tr_b16 v[180:181], v17 offset:61440
  v_mfma_f32_16x16x32_bf16 v[64:67], v[192:195], a[144:147], v[64:67]
  s_waitcnt lgkmcnt(3)
  ds_read_b64_tr_b16 v[182:183], v17 offset:63488
  v_mfma_f32_16x16x32_bf16 v[72:75], v[168:171], a[144:147], v[72:75]
  ds_read_b64_tr_b16 v[184:185], v18 offset:57344
  buffer_load_dwordx4 v6, s[12:15], s38 offen offset:2048  lds
  v_mfma_f32_16x16x32_bf16 v[72:75], v[172:175], a[152:155], v[72:75]
  ds_read_b64_tr_b16 v[186:187], v18 offset:59392
  v_mfma_f32_16x16x32_bf16 v[76:79], v[172:175], a[156:159], v[76:79]
  ds_read_b64_tr_b16 v[188:189], v18 offset:61440
  v_mfma_f32_16x16x32_bf16 v[76:79], v[168:171], a[148:151], v[76:79]
  s_waitcnt lgkmcnt(3)
  ds_read_b64_tr_b16 v[190:191], v18 offset:63488
  v_mfma_f32_16x16x32_bf16 v[84:87], v[176:179], a[148:151], v[84:87]
  ds_read_b64_tr_b16 v[192:193], v19 offset:57344
  buffer_load_dwordx4 a[188:191], v9, s[16:19], s39 offen offset:3072 sc1
  v_mfma_f32_16x16x32_bf16 v[84:87], v[180:183], a[156:159], v[84:87]
  s_add_u32 s39, s39, 4096
  ds_read_b64_tr_b16 v[194:195], v19 offset:59392
  v_mfma_f32_16x16x32_bf16 v[80:83], v[180:183], a[152:155], v[80:83]
  s_lshl_b32 s101, s26, 2
  ds_read_b64_tr_b16 v[196:197], v19 offset:61440
  v_mfma_f32_16x16x32_bf16 v[80:83], v[176:179], a[144:147], v[80:83]
  s_waitcnt vmcnt(16) lgkmcnt(3)
  ds_read_b64_tr_b16 v[198:199], v19 offset:63488
  v_mfma_f32_16x16x32_bf16 v[88:91], v[184:187], a[144:147], v[88:91]
  s_barrier
  ds_read_b64_tr_b16 v[168:169], v20 offset:0
  v_mfma_f32_16x16x32_bf16 v[88:91], v[188:191], a[152:155], v[88:91]
  s_add_u32 s101, s101, s24
  ds_read_b64_tr_b16 v[170:171], v20 offset:2048
  v_mfma_f32_16x16x32_bf16 v[92:95], v[188:191], a[156:159], v[92:95]
  s_mul_i32 s101, s101, 256
  ds_read_b64_tr_b16 v[172:173], v20 offset:4096
  v_mfma_f32_16x16x32_bf16 v[92:95], v[184:187], a[148:151], v[92:95]
  s_waitcnt lgkmcnt(3)
  ds_read_b64_tr_b16 v[174:175], v20 offset:6144
  v_mfma_f32_16x16x32_bf16 v[100:103], v[192:195], a[148:151], v[100:103]
  s_add_u32 s101, s101, L_kepi-L_pc
  ds_read_b64_tr_b16 v[176:177], v21 offset:0
  v_min_u32 v208, 1, v1
  v_mfma_f32_16x16x32_bf16 v[100:103], v[196:199], a[156:159], v[100:103]
  ds_read_b64_tr_b16 v[178:179], v21 offset:2048
  v_lshl_add_u32 v208, v208, 7, s101
  v_mfma_f32_16x16x32_bf16 v[96:99], v[196:199], a[152:155], v[96:99]
  ds_read_b64_tr_b16 v[180:181], v21 offset:4096
  v_min_u32 v208, L_p3-L_pc, v208
  v_mfma_f32_16x16x32_bf16 v[96:99], v[192:195], a[144:147], v[96:99]
  s_waitcnt vmcnt(8) lgkmcnt(3)
  ds_read_b64_tr_b16 v[182:183], v21 offset:6144
  global_load_dword v0, v208, s[78:79]
  v_mfma_f32_16x16x32_bf16 v[40:43], v[168:171], a[160:163], v[40:43]
  ds_read_b64_tr_b16 v[184:185], v22 offset:0
  v_mfma_f32_16x16x32_bf16 v[40:43], v[172:175], a[168:171], v[40:43]
  ds_read_b64_tr_b16 v[186:187], v22 offset:2048
  buffer_load_dwordx4 a[192:195], v8, s[16:19], s39 offen offset:0 sc1
  v_mfma_f32_16x16x32_bf16 v[44:47], v[172:175], a[172:175], v[44:47]
  ds_read_b64_tr_b16 v[188:189], v22 offset:4096
  v_mfma_f32_16x16x32_bf16 v[44:47], v[168:171], a[164:167], v[44:47]
  s_waitcnt lgkmcnt(3)
  ds_read_b64_tr_b16 v[190:191], v22 offset:6144
  v_mfma_f32_16x16x32_bf16 v[52:55], v[176:179], a[164:167], v[52:55]
  ds_read_b64_tr_b16 v[192:193], v23 offset:0
  v_mfma_f32_16x16x32_bf16 v[52:55], v[180:183], a[172:175], v[52:55]
  ds_read_b64_tr_b16 v[194:195], v23 offset:2048
  buffer_load_dwordx4 v7, s[12:15], s38 offen offset:3072  lds
  v_mfma_f32_16x16x32_bf16 v[48:51], v[180:183], a[168:171], v[48:51]
  ds_read_b64_tr_b16 v[196:197], v23 offset:4096
  v_mfma_f32_16x16x32_bf16 v[48:51], v[176:179], a[160:163], v[48:51]
  s_waitcnt lgkmcnt(3)
  ds_read_b64_tr_b16 v[198:199], v23 offset:6144
  v_mfma_f32_16x16x32_bf16 v[56:59], v[184:187], a[160:163], v[56:59]
  ds_read_b64_tr_b16 v[168:169], v20 offset:8192
  buffer_load_dwordx4 a[196:199], v9, s[16:19], s39 offen offset:0 sc1
  v_mfma_f32_16x16x32_bf16 v[56:59], v[188:191], a[168:171], v[56:59]
  s_add_u32 s38, s50, 5111808
  ds_read_b64_tr_b16 v[170:171], v20 offset:10240
  v_mfma_f32_16x16x32_bf16 v[60:63], v[188:191], a[172:175], v[60:63]
  s_add_u32 m0, s37, 16384
  ds_read_b64_tr_b16 v[172:173], v20 offset:12288
  v_mfma_f32_16x16x32_bf16 v[60:63], v[184:187], a[164:167], v[60:63]
  s_waitcnt lgkmcnt(3)
  ds_read_b64_tr_b16 v[174:175], v20 offset:14336
  v_mfma_f32_16x16x32_bf16 v[68:71], v[192:195], a[164:167], v[68:71]
  ds_read_b64_tr_b16 v[176:177], v21 offset:8192
  buffer_load_dwordx4 v4, s[12:15], s38 offen offset:0  lds
  v_mfma_f32_16x16x32_bf16 v[68:71], v[196:199], a[172:175], v[68:71]
  ds_read_b64_tr_b16 v[178:179], v21 offset:10240
  v_mfma_f32_16x16x32_bf16 v[64:67], v[196:199], a[168:171], v[64:67]
  ds_read_b64_tr_b16 v[180:181], v21 offset:12288
  v_mfma_f32_16x16x32_bf16 v[64:67], v[192:195], a[160:163], v[64:67]
  s_waitcnt lgkmcnt(3)
  ds_read_b64_tr_b16 v[182:183], v21 offset:14336
  buffer_load_dwordx4 a[200:203], v8, s[16:19], s39 offen offset:1024 sc1
  v_mfma_f32_16x16x32_bf16 v[72:75], v[168:171], a[160:163], v[72:75]
  ds_read_b64_tr_b16 v[184:185], v22 offset:8192
  v_mfma_f32_16x16x32_bf16 v[72:75], v[172:175], a[168:171], v[72:75]
  ds_read_b64_tr_b16 v[186:187], v22 offset:10240
  v_mfma_f32_16x16x32_bf16 v[76:79], v[172:175], a[172:175], v[76:79]
  ds_read_b64_tr_b16 v[188:189], v22 offset:12288
  v_mfma_f32_16x16x32_bf16 v[76:79], v[168:171], a[164:167], v[76:79]
  s_waitcnt lgkmcnt(3)
  ds_read_b64_tr_b16 v[190:191], v22 offset:14336
  buffer_load_dwordx4 v5, s[12:15], s38 offen offset:1024  lds
  v_mfma_f32_16x16x32_bf16 v[84:87], v[176:179], a[164:167], v[84:87]
  ds_read_b64_tr_b16 v[192:193], v23 offset:8192
  v_mfma_f32_16x16x32_bf16 v[84:87], v[180:183], a[172:175], v[84:87]
  ds_read_b64_tr_b16 v[194:195], v23 offset:10240
  v_mfma_f32_16x16x32_bf16 v[80:83], v[180:183], a[168:171], v[80:83]
  ds_read_b64_tr_b16 v[196:197], v23 offset:12288
  buffer_load_dwordx4 a[204:207], v9, s[16:19], s39 offen offset:1024 sc1
  v_mfma_f32_16x16x32_bf16 v[80:83], v[176:179], a[160:163], v[80:83]
  s_waitcnt vmcnt(15) lgkmcnt(3)
  ds_read_b64_tr_b16 v[198:199], v23 offset:14336
  v_mfma_f32_16x16x32_bf16 v[88:91], v[184:187], a[160:163], v[88:91]
  s_barrier
  ds_read_b64_tr_b16 v[168:169], v20 offset:16384
  v_mfma_f32_16x16x32_bf16 v[88:91], v[188:191], a[168:171], v[88:91]
  ds_read_b64_tr_b16 v[170:171], v20 offset:18432
  v_mfma_f32_16x16x32_bf16 v[92:95], v[188:191], a[172:175], v[92:95]
  ds_read_b64_tr_b16 v[172:173], v20 offset:20480
  v_mfma_f32_16x16x32_bf16 v[92:95], v[184:187], a[164:167], v[92:95]
  s_waitcnt lgkmcnt(3)
  ds_read_b64_tr_b16 v[174:175], v20 offset:22528
  v_mfma_f32_16x16x32_bf16 v[100:103], v[192:195], a[164:167], v[100:103]
  ds_read_b64_tr_b16 v[176:177], v21 offset:16384
  v_mfma_f32_16x16x32_bf16 v[100:103], v[196:199], a[172:175], v[100:103]
  ds_read_b64_tr_b16 v[178:179], v21 offset:18432
  v_mfma_f32_16x16x32_bf16 v[96:99], v[196:199], a[168:171], v[96:99]
  ds_read_b64_tr_b16 v[180:181], v21 offset:20480
  v_mfma_f32_16x16x32_bf16 v[96:99], v[192:195], a[160:163], v[96:99]
  s_waitcnt vmcnt(8) lgkmcnt(3)
  ds_read_b64_tr_b16 v[182:183], v21 offset:22528
  v_mfma_f32_16x16x32_bf16 v[40:43], v[168:171], a[176:179], v[40:43]
  ds_read_b64_tr_b16 v[184:185], v22 offset:16384
  buffer_load_dwordx4 a[208:211], v8, s[16:19], s39 offen offset:2048 sc1
  v_mfma_f32_16x16x32_bf16 v[40:43], v[172:175], a[184:187], v[40:43]
  ds_read_b64_tr_b16 v[186:187], v22 offset:18432
  v_mfma_f32_16x16x32_bf16 v[44:47], v[172:175], a[188:191], v[44:47]
  ds_read_b64_tr_b16 v[188:189], v22 offset:20480
  buffer_load_dwordx4 v6, s[12:15], s38 offen offset:2048  lds
  v_mfma_f32_16x16x32_bf16 v[44:47], v[168:171], a[180:183], v[44:47]
  s_waitcnt lgkmcnt(3)
  ds_read_b64_tr_b16 v[190:191], v22 offset:22528
  v_mfma_f32_16x16x32_bf16 v[52:55], v[176:179], a[180:183], v[52:55]
  ds_read_b64_tr_b16 v[192:193], v23 offset:16384
  v_mfma_f32_16x16x32_bf16 v[52:55], v[180:183], a[188:191], v[52:55]
  ds_read_b64_tr_b16 v[194:195], v23 offset:18432
  v_mfma_f32_16x16x32_bf16 v[48:51], v[180:183], a[184:187], v[48:51]
  ds_read_b64_tr_b16 v[196:197], v23 offset:20480
  buffer_load_dwordx4 a[212:215], v9, s[16:19], s39 offen offset:2048 sc1
  v_mfma_f32_16x16x32_bf16 v[48:51], v[176:179], a[176:179], v[48:51]
  s_waitcnt lgkmcnt(3)
  ds_read_b64_tr_b16 v[198:199], v23 offset:22528
  v_mfma_f32_16x16x32_bf16 v[56:59], v[184:187], a[176:179], v[56:59]
  ds_read_b64_tr_b16 v[168:169], v20 offset:24576
  v_mfma_f32_16x16x32_bf16 v[56:59], v[188:191], a[184:187], v[56:59]
  ds_read_b64_tr_b16 v[170:171], v20 offset:26624
  buffer_load_dwordx4 v7, s[12:15], s38 offen offset:3072  lds
  v_mfma_f32_16x16x32_bf16 v[60:63], v[188:191], a[188:191], v[60:63]
  ds_read_b64_tr_b16 v[172:173], v20 offset:28672
  v_mfma_f32_16x16x32_bf16 v[60:63], v[184:187], a[180:183], v[60:63]
  s_waitcnt lgkmcnt(3)
  ds_read_b64_tr_b16 v[174:175], v20 offset:30720
  v_mfma_f32_16x16x32_bf16 v[68:71], v[192:195], a[180:183], v[68:71]
  ds_read_b64_tr_b16 v[176:177], v21 offset:24576
  v_mfma_f32_16x16x32_bf16 v[68:71], v[196:199], a[188:191], v[68:71]
  ds_read_b64_tr_b16 v[178:179], v21 offset:26624
  buffer_load_dwordx4 a[216:219], v8, s[16:19], s39 offen offset:3072 sc1
  v_mfma_f32_16x16x32_bf16 v[64:67], v[196:199], a[184:187], v[64:67]
  s_add_u32 s38, s50, 5505024
  ds_read_b64_tr_b16 v[180:181], v21 offset:28672
  v_mfma_f32_16x16x32_bf16 v[64:67], v[192:195], a[176:179], v[64:67]
  s_waitcnt lgkmcnt(3)
  ds_read_b64_tr_b16 v[182:183], v21 offset:30720
  v_mfma_f32_16x16x32_bf16 v[72:75], v[168:171], a[176:179], v[72:75]
  s_add_u32 m0, s37, 32768
  ds_read_b64_tr_b16 v[184:185], v22 offset:24576
  buffer_load_dwordx4 v4, s[12:15], s38 offen offset:0  lds
  v_mfma_f32_16x16x32_bf16 v[72:75], v[172:175], a[184:187], v[72:75]
  ds_read_b64_tr_b16 v[186:187], v22 offset:26624
  v_mfma_f32_16x16x32_bf16 v[76:79], v[172:175], a[188:191], v[76:79]
L_pad_0a_2:
  s_cbranch_execz L_pad_0a_6
  ds_read_b64_tr_b16 v[188:189], v22 offset:28672
  v_mfma_f32_16x16x32_bf16 v[76:79], v[168:171], a[180:183], v[76:79]
  s_waitcnt lgkmcnt(3)
  ds_read_b64_tr_b16 v[190:191], v22 offset:30720
  v_mfma_f32_16x16x32_bf16 v[84:87], v[176:179], a[180:183], v[84:87]
  ds_read_b64_tr_b16 v[192:193], v23 offset:24576
  buffer_load_dwordx4 a[220:223], v9, s[16:19], s39 offen offset:3072 sc1
  v_mfma_f32_16x16x32_bf16 v[84:87], v[180:183], a[188:191], v[84:87]
  ds_read_b64_tr_b16 v[194:195], v23 offset:26624
  v_mfma_f32_16x16x32_bf16 v[80:83], v[180:183], a[184:187], v[80:83]
  ds_read_b64_tr_b16 v[196:197], v23 offset:28672
  v_mfma_f32_16x16x32_bf16 v[80:83], v[176:179], a[176:179], v[80:83]
  s_waitcnt vmcnt(12) lgkmcnt(3)
  ds_read_b64_tr_b16 v[198:199], v23 offset:30720
  buffer_load_dwordx4 v5, s[12:15], s38 offen offset:1024  lds
  v_mfma_f32_16x16x32_bf16 v[88:91], v[184:187], a[176:179], v[88:91]
  s_barrier
  ds_read_b64_tr_b16 v[168:169], v16 offset:0
  v_mfma_f32_16x16x32_bf16 v[88:91], v[188:191], a[184:187], v[88:91]
  s_add_u32 s39, s39, 4096
  ds_read_b64_tr_b16 v[170:171], v16 offset:2048
  v_mfma_f32_16x16x32_bf16 v[92:95], v[188:191], a[188:191], v[92:95]
  ds_read_b64_tr_b16 v[172:173], v16 offset:4096
  v_mfma_f32_16x16x32_bf16 v[92:95], v[184:187], a[180:183], v[92:95]
  s_waitcnt lgkmcnt(3)
  ds_read_b64_tr_b16 v[174:175], v16 offset:6144
  v_mfma_f32_16x16x32_bf16 v[100:103], v[192:195], a[180:183], v[100:103]
  ds_read_b64_tr_b16 v[176:177], v17 offset:0
  v_mfma_f32_16x16x32_bf16 v[100:103], v[196:199], a[188:191], v[100:103]
  ds_read_b64_tr_b16 v[178:179], v17 offset:2048
  v_mfma_f32_16x16x32_bf16 v[96:99], v[196:199], a[184:187], v[96:99]
  ds_read_b64_tr_b16 v[180:181], v17 offset:4096
  v_mfma_f32_16x16x32_bf16 v[96:99], v[192:195], a[176:179], v[96:99]
  s_waitcnt vmcnt(8) lgkmcnt(3)
  ds_read_b64_tr_b16 v[182:183], v17 offset:6144
  v_mfma_f32_16x16x32_bf16 v[40:43], v[168:171], a[192:195], v[40:43]
  ds_read_b64_tr_b16 v[184:185], v18 offset:0
  buffer_load_dwordx4 a[224:227], v8, s[16:19], s39 offen offset:0 sc1
  v_mfma_f32_16x16x32_bf16 v[40:43], v[172:175], a[200:203], v[40:43]
  ds_read_b64_tr_b16 v[186:187], v18 offset:2048
  v_mfma_f32_16x16x32_bf16 v[44:47], v[172:175], a[204:207], v[44:47]
  ds_read_b64_tr_b16 v[188:189], v18 offset:4096
  buffer_load_dwordx4 v6, s[12:15], s38 offen offset:2048  lds
  v_mfma_f32_16x16x32_bf16 v[44:47], v[168:171], a[196:199], v[44:47]
  s_waitcnt lgkmcnt(3)
  ds_read_b64_tr_b16 v[190:191], v18 offset:6144
  v_mfma_f32_16x16x32_bf16 v[52:55], v[176:179], a[196:199], v[52:55]
  ds_read_b64_tr_b16 v[192:193], v19 offset:0
  v_mfma_f32_16x16x32_bf16 v[52:55], v[180:183], a[204:207], v[52:55]
  ds_read_b64_tr_b16 v[194:195], v19 offset:2048
  v_mfma_f32_16x16x32_bf16 v[48:51], v[180:183], a[200:203], v[48:51]
  ds_read_b64_tr_b16 v[196:197], v19 offset:4096
  buffer_load_dwordx4 a[228:231], v9, s[16:19], s39 offen offset:0 sc1
  v_mfma_f32_16x16x32_bf16 v[48:51], v[176:179], a[192:195], v[48:51]
  s_waitcnt lgkmcnt(3)
  ds_read_b64_tr_b16 v[198:199], v19 offset:6144
  v_mfma_f32_16x16x32_bf16 v[56:59], v[184:187], a[192:195], v[56:59]
  ds_read_b64_tr_b16 v[168:169], v16 offset:8192
  v_mfma_f32_16x16x32_bf16 v[56:59], v[188:191], a[200:203], v[56:59]
  ds_read_b64_tr_b16 v[170:171], v16 offset:10240
  buffer_load_dwordx4 v7, s[12:15], s38 offen offset:3072  lds
  v_mfma_f32_16x16x32_bf16 v[60:63], v[188:191], a[204:207], v[60:63]
  ds_read_b64_tr_b16 v[172:173], v16 offset:12288
  v_mfma_f32_16x16x32_bf16 v[60:63], v[184:187], a[196:199], v[60:63]
  s_waitcnt lgkmcnt(3)
  ds_read_b64_tr_b16 v[174:175], v16 offset:14336
  v_mfma_f32_16x16x32_bf16 v[68:71], v[192:195], a[196:199], v[68:71]
  ds_read_b64_tr_b16 v[176:177], v17 offset:8192
  v_mfma_f32_16x16x32_bf16 v[68:71], v[196:199], a[204:207], v[68:71]
  ds_read_b64_tr_b16 v[178:179], v17 offset:10240
  buffer_load_dwordx4 a[232:235], v8, s[16:19], s39 offen offset:1024 sc1
  v_mfma_f32_16x16x32_bf16 v[64:67], v[196:199], a[200:203], v[64:67]
  s_add_u32 s38, s50, 5898240
  ds_read_b64_tr_b16 v[180:181], v17 offset:12288
  v_mfma_f32_16x16x32_bf16 v[64:67], v[192:195], a[192:195], v[64:67]
  s_waitcnt lgkmcnt(3)
  ds_read_b64_tr_b16 v[182:183], v17 offset:14336
  v_mfma_f32_16x16x32_bf16 v[72:75], v[168:171], a[192:195], v[72:75]
  s_add_u32 m0, s37, 49152
  ds_read_b64_tr_b16 v[184:185], v18 offset:8192
  buffer_load_dwordx4 v4, s[12:15], s38 offen offset:0  lds
  v_mfma_f32_16x16x32_bf16 v[72:75], v[172:175], a[200:203], v[72:75]
  ds_read_b64_tr_b16 v[186:187], v18 offset:10240
  v_mfma_f32_16x16x32_bf16 v[76:79], v[172:175], a[204:207], v[76:79]
  ds_read_b64_tr_b16 v[188:189], v18 offset:12288
  v_mfma_f32_16x16x32_bf16 v[76:79], v[168:171], a[196:199], v[76:79]
  s_waitcnt lgkmcnt(3)
  ds_read_b64_tr_b16 v[190:191], v18 offset:14336
  v_mfma_f32_16x16x32_bf16 v[84:87], v[176:179], a[196:199], v[84:87]
  ds_read_b64_tr_b16 v[192:193], v19 offset:8192
  buffer_load_dwordx4 a[236:239], v9, s[16:19], s39 offen offset:1024 sc1
  v_mfma_f32_16x16x32_bf16 v[84:87], v[180:183], a[204:207], v[84:87]
  ds_read_b64_tr_b16 v[194:195], v19 offset:10240
  v_mfma_f32_16x16x32_bf16 v[80:83], v[180:183], a[200:203], v[80:83]
  ds_read_b64_tr_b16 v[196:197], v19 offset:12288
  v_mfma_f32_16x16x32_bf16 v[80:83], v[176:179], a[192:195], v[80:83]
  s_waitcnt vmcnt(11) lgkmcnt(3)
  ds_read_b64_tr_b16 v[198:199], v19 offset:14336
  v_mfma_f32_16x16x32_bf16 v[88:91], v[184:187], a[192:195], v[88:91]
  s_barrier
  ds_read_b64_tr_b16 v[168:169], v16 offset:16384
  v_mfma_f32_16x16x32_bf16 v[88:91], v[188:191], a[200:203], v[88:91]
  ds_read_b64_tr_b16 v[170:171], v16 offset:18432
  v_mfma_f32_16x16x32_bf16 v[92:95], v[188:191], a[204:207], v[92:95]
  ds_read_b64_tr_b16 v[172:173], v16 offset:20480
  v_mfma_f32_16x16x32_bf16 v[92:95], v[184:187], a[196:199], v[92:95]
  s_waitcnt lgkmcnt(3)
  ds_read_b64_tr_b16 v[174:175], v16 offset:22528
  v_mfma_f32_16x16x32_bf16 v[100:103], v[192:195], a[196:199], v[100:103]
  ds_read_b64_tr_b16 v[176:177], v17 offset:16384
  v_mfma_f32_16x16x32_bf16 v[100:103], v[196:199], a[204:207], v[100:103]
  ds_read_b64_tr_b16 v[178:179], v17 offset:18432
  v_mfma_f32_16x16x32_bf16 v[96:99], v[196:199], a[200:203], v[96:99]
  ds_read_b64_tr_b16 v[180:181], v17 offset:20480
  v_mfma_f32_16x16x32_bf16 v[96:99], v[192:195], a[192:195], v[96:99]
  s_waitcnt vmcnt(8) lgkmcnt(3)
  ds_read_b64_tr_b16 v[182:183], v17 offset:22528
  v_mfma_f32_16x16x32_bf16 v[40:43], v[168:171], a[208:211], v[40:43]
  ds_read_b64_tr_b16 v[184:185], v18 offset:16384
  buffer_load_dwordx4 a[240:243], v8, s[16:19], s39 offen offset:2048 sc1
  v_mfma_f32_16x16x32_bf16 v[40:43], v[172:175], a[216:219], v[40:43]
  ds_read_b64_tr_b16 v[186:187], v18 offset:18432
  v_mfma_f32_16x16x32_bf16 v[44:47], v[172:175], a[220:223], v[44:47]
  ds_read_b64_tr_b16 v[188:189], v18 offset:20480
  buffer_load_dwordx4 v5, s[12:15], s38 offen offset:1024  lds
  v_mfma_f32_16x16x32_bf16 v[44:47], v[168:171], a[212:215], v[44:47]
  s_waitcnt lgkmcnt(3)
  ds_read_b64_tr_b16 v[190:191], v18 offset:22528
  v_mfma_f32_16x16x32_bf16 v[52:55], v[176:179], a[212:215], v[52:55]
  ds_read_b64_tr_b16 v[192:193], v19 offset:16384
  v_mfma_f32_16x16x32_bf16 v[52:55], v[180:183], a[220:223], v[52:55]
  ds_read_b64_tr_b16 v[194:195], v19 offset:18432
  v_mfma_f32_16x16x32_bf16 v[48:51], v[180:183], a[216:219], v[48:51]
  ds_read_b64_tr_b16 v[196:197], v19 offset:20480
  buffer_load_dwordx4 a[244:247], v9, s[16:19], s39 offen offset:2048 sc1
  v_mfma_f32_16x16x32_bf16 v[48:51], v[176:179], a[208:211], v[48:51]
  s_waitcnt lgkmcnt(3)
  ds_read_b64_tr_b16 v[198:199], v19 offset:22528
  v_mfma_f32_16x16x32_bf16 v[56:59], v[184:187], a[208:211], v[56:59]
  ds_read_b64_tr_b16 v[168:169], v16 offset:24576
  v_mfma_f32_16x16x32_bf16 v[56:59], v[188:191], a[216:219], v[56:59]
  ds_read_b64_tr_b16 v[170:171], v16 offset:26624
  buffer_load_dwordx4 v6, s[12:15], s38 offen offset:2048  lds
  v_mfma_f32_16x16x32_bf16 v[60:63], v[188:191], a[220:223], v[60:63]
  ds_read_b64_tr_b16 v[172:173], v16 offset:28672
  v_mfma_f32_16x16x32_bf16 v[60:63], v[184:187], a[212:215], v[60:63]
  s_waitcnt lgkmcnt(3)
  ds_read_b64_tr_b16 v[174:175], v16 offset:30720
  v_mfma_f32_16x16x32_bf16 v[68:71], v[192:195], a[212:215], v[68:71]
  ds_read_b64_tr_b16 v[176:177], v17 offset:24576
  v_mfma_f32_16x16x32_bf16 v[68:71], v[196:199], a[220:223], v[68:71]
  ds_read_b64_tr_b16 v[178:179], v17 offset:26624
  buffer_load_dwordx4 a[248:251], v8, s[16:19], s39 offen offset:3072 sc1
  v_mfma_f32_16x16x32_bf16 v[64:67], v[196:199], a[216:219], v[64:67]
  ds_read_b64_tr_b16 v[180:181], v17 offset:28672
  v_mfma_f32_16x16x32_bf16 v[64:67], v[192:195], a[208:211], v[64:67]
  s_waitcnt lgkmcnt(3)
  ds_read_b64_tr_b16 v[182:183], v17 offset:30720
  v_mfma_f32_16x16x32_bf16 v[72:75], v[168:171], a[208:211], v[72:75]
  ds_read_b64_tr_b16 v[184:185], v18 offset:24576
  buffer_load_dwordx4 v7, s[12:15], s38 offen offset:3072  lds
  v_mfma_f32_16x16x32_bf16 v[72:75], v[172:175], a[216:219], v[72:75]
  ds_read_b64_tr_b16 v[186:187], v18 offset:26624
  v_mfma_f32_16x16x32_bf16 v[76:79], v[172:175], a[220:223], v[76:79]
  ds_read_b64_tr_b16 v[188:189], v18 offset:28672
  v_mfma_f32_16x16x32_bf16 v[76:79], v[168:171], a[212:215], v[76:79]
  s_waitcnt lgkmcnt(3)
  ds_read_b64_tr_b16 v[190:191], v18 offset:30720
  v_mfma_f32_16x16x32_bf16 v[84:87], v[176:179], a[212:215], v[84:87]
  ds_read_b64_tr_b16 v[192:193], v19 offset:24576
  buffer_load_dwordx4 a[252:255], v9, s[16:19], s39 offen offset:3072 sc1
  v_mfma_f32_16x16x32_bf16 v[84:87], v[180:183], a[220:223], v[84:87]
  s_add_u32 s39, s39, 4096
  ds_read_b64_tr_b16 v[194:195], v19 offset:26624
  v_mfma_f32_16x16x32_bf16 v[80:83], v[180:183], a[216:219], v[80:83]
  ds_read_b64_tr_b16 v[196:197], v19 offset:28672
  v_mfma_f32_16x16x32_bf16 v[80:83], v[176:179], a[208:211], v[80:83]
  s_waitcnt vmcnt(10) lgkmcnt(3)
  ds_read_b64_tr_b16 v[198:199], v19 offset:30720
  v_mfma_f32_16x16x32_bf16 v[88:91], v[184:187], a[208:211], v[88:91]
  s_barrier
  ds_read_b64_tr_b16 v[168:169], v16 offset:32768
  v_mfma_f32_16x16x32_bf16 v[88:91], v[188:191], a[216:219], v[88:91]
  ds_read_b64_tr_b16 v[170:171], v16 offset:34816
  v_mfma_f32_16x16x32_bf16 v[92:95], v[188:191], a[220:223], v[92:95]
  ds_read_b64_tr_b16 v[172:173], v16 offset:36864
  v_mfma_f32_16x16x32_bf16 v[92:95], v[184:187], a[212:215], v[92:95]
  s_waitcnt lgkmcnt(3)
  ds_read_b64_tr_b16 v[174:175], v16 offset:38912
  v_mfma_f32_16x16x32_bf16 v[100:103], v[192:195], a[212:215], v[100:103]
  ds_read_b64_tr_b16 v[176:177], v17 offset:32768
  v_mfma_f32_16x16x32_bf16 v[100:103], v[196:199], a[220:223], v[100:103]
  ds_read_b64_tr_b16 v[178:179], v17 offset:34816
  v_mfma_f32_16x16x32_bf16 v[96:99], v[196:199], a[216:219], v[96:99]
  ds_read_b64_tr_b16 v[180:181], v17 offset:36864
  v_mfma_f32_16x16x32_bf16 v[96:99], v[192:195], a[208:211], v[96:99]
  s_waitcnt vmcnt(7) lgkmcnt(3)
  ds_read_b64_tr_b16 v[182:183], v17 offset:38912
  v_mfma_f32_16x16x32_bf16 v[40:43], v[168:171], a[224:227], v[40:43]
  ds_read_b64_tr_b16 v[184:185], v18 offset:32768
  s_mov_b32 exec_lo, 0x100f100f
  s_mov_b32 exec_hi, 0x100f100f
  buffer_load_dword v0, v27, s[12:15], s84 offen
  s_mov_b64 exec, -1
  v_mfma_f32_16x16x32_bf16 v[40:43], v[172:175], a[232:235], v[40:43]
  ds_read_b64_tr_b16 v[186:187], v18 offset:34816
  v_mfma_f32_16x16x32_bf16 v[44:47], v[172:175], a[236:239], v[44:47]
  ds_read_b64_tr_b16 v[188:189], v18 offset:36864
  global_load_dwordx4 v[28:31], v26, s[58:59] offset:0
  v_mfma_f32_16x16x32_bf16 v[44:47], v[168:171], a[228:231], v[44:47]
  s_waitcnt lgkmcnt(3)
  ds_read_b64_tr_b16 v[190:191], v18 offset:38912
  v_mfma_f32_16x16x32_bf16 v[52:55], v[176:179], a[228:231], v[52:55]
  ds_read_b64_tr_b16 v[192:193], v19 offset:32768
  v_mfma_f32_16x16x32_bf16 v[52:55], v[180:183], a[236:239], v[52:55]
  ds_read_b64_tr_b16 v[194:195], v19 offset:34816
  v_mfma_f32_16x16x32_bf16 v[48:51], v[180:183], a[232:235], v[48:51]
  ds_read_b64_tr_b16 v[196:197], v19 offset:36864
  global_load_dwordx4 v[32:35], v26, s[58:59] offset:1024
  v_mfma_f32_16x16x32_bf16 v[48:51], v[176:179], a[224:227], v[48:51]
  s_waitcnt lgkmcnt(3)
  ds_read_b64_tr_b16 v[198:199], v19 offset:38912
  v_mfma_f32_16x16x32_bf16 v[56:59], v[184:187], a[224:227], v[56:59]
  ds_read_b64_tr_b16 v[168:169], v16 offset:40960
  v_mfma_f32_16x16x32_bf16 v[56:59], v[188:191], a[232:235], v[56:59]
  ds_read_b64_tr_b16 v[170:171], v16 offset:43008
  v_mfma_f32_16x16x32_bf16 v[60:63], v[188:191], a[236:239], v[60:63]
  ds_read_b64_tr_b16 v[172:173], v16 offset:45056
  v_mfma_f32_16x16x32_bf16 v[60:63], v[184:187], a[228:231], v[60:63]
  s_waitcnt lgkmcnt(3)
  ds_read_b64_tr_b16 v[174:175], v16 offset:47104
  v_mfma_f32_16x16x32_bf16 v[68:71], v[192:195], a[228:231], v[68:71]
  ds_read_b64_tr_b16 v[176:177], v17 offset:40960
  v_mfma_f32_16x16x32_bf16 v[68:71], v[196:199], a[236:239], v[68:71]
  ds_read_b64_tr_b16 v[178:179], v17 offset:43008
  v_mfma_f32_16x16x32_bf16 v[64:67], v[196:199], a[232:235], v[64:67]
  ds_read_b64_tr_b16 v[180:181], v17 offset:45056
  v_mfma_f32_16x16x32_bf16 v[64:67], v[192:195], a[224:227], v[64:67]
  s_waitcnt lgkmcnt(3)
  ds_read_b64_tr_b16 v[182:183], v17 offset:47104
  v_mfma_f32_16x16x32_bf16 v[72:75], v[168:171], a[224:227], v[72:75]
  ds_read_b64_tr_b16 v[184:185], v18 offset:40960
  v_mfma_f32_16x16x32_bf16 v[72:75], v[172:175], a[232:235], v[72:75]
  ds_read_b64_tr_b16 v[186:187], v18 offset:43008
  v_mfma_f32_16x16x32_bf16 v[76:79], v[172:175], a[236:239], v[76:79]
  ds_read_b64_tr_b16 v[188:189], v18 offset:45056
  v_mfma_f32_16x16x32_bf16 v[76:79], v[168:171], a[228:231], v[76:79]
  s_waitcnt lgkmcnt(3)
  ds_read_b64_tr_b16 v[190:191], v18 offset:47104
  v_mfma_f32_16x16x32_bf16 v[84:87], v[176:179], a[228:231], v[84:87]
  ds_read_b64_tr_b16 v[192:193], v19 offset:40960
  v_mfma_f32_16x16x32_bf16 v[84:87], v[180:183], a[236:239], v[84:87]
  ds_read_b64_tr_b16 v[194:195], v19 offset:43008
  v_mfma_f32_16x16x32_bf16 v[80:83], v[180:183], a[232:235], v[80:83]
  ds_read_b64_tr_b16 v[196:197], v19 offset:45056
  v_mfma_f32_16x16x32_bf16 v[80:83], v[176:179], a[224:227], v[80:83]
  s_waitcnt vmcnt(4) lgkmcnt(3)
  ds_read_b64_tr_b16 v[198:199], v19 offset:47104
  v_mfma_f32_16x16x32_bf16 v[88:91], v[184:187], a[224:227], v[88:91]
  s_barrier
  ds_read_b64_tr_b16 v[168:169], v16 offset:49152
  v_mfma_f32_16x16x32_bf16 v[88:91], v[188:191], a[232:235], v[88:91]
  ds_read_b64_tr_b16 v[170:171], v16 offset:51200
  v_mfma_f32_16x16x32_bf16 v[92:95], v[188:191], a[236:239], v[92:95]
  ds_read_b64_tr_b16 v[172:173], v16 offset:53248
  v_mfma_f32_16x16x32_bf16 v[92:95], v[184:187], a[228:231], v[92:95]
  s_waitcnt lgkmcnt(3)
  ds_read_b64_tr_b16 v[174:175], v16 offset:55296
  v_mfma_f32_16x16x32_bf16 v[100:103], v[192:195], a[228:231], v[100:103]
  ds_read_b64_tr_b16 v[176:177], v17 offset:49152
  v_mfma_f32_16x16x32_bf16 v[100:103], v[196:199], a[236:239], v[100:103]
  ds_read_b64_tr_b16 v[178:179], v17 offset:51200
  v_mfma_f32_16x16x32_bf16 v[96:99], v[196:199], a[232:235], v[96:99]
  ds_read_b64_tr_b16 v[180:181], v17 offset:53248
  v_mfma_f32_16x16x32_bf16 v[96:99], v[192:195], a[224:227], v[96:99]
  s_waitcnt vmcnt(3) lgkmcnt(3)
  ds_read_b64_tr_b16 v[182:183], v17 offset:55296
  v_mfma_f32_16x16x32_bf16 v[40:43], v[168:171], a[240:243], v[40:43]
  ds_read_b64_tr_b16 v[184:185], v18 offset:49152
  v_mfma_f32_16x16x32_bf16 v[40:43], v[172:175], a[248:251], v[40:43]
  ds_read_b64_tr_b16 v[186:187], v18 offset:51200
  v_mfma_f32_16x16x32_bf16 v[44:47], v[172:175], a[252:255], v[44:47]
  ds_read_b64_tr_b16 v[188:189], v18 offset:53248
  v_mfma_f32_16x16x32_bf16 v[44:47], v[168:171], a[244:247], v[44:47]
  s_waitcnt lgkmcnt(3)
  ds_read_b64_tr_b16 v[190:191], v18 offset:55296
  v_mfma_f32_16x16x32_bf16 v[52:55], v[176:179], a[244:247], v[52:55]
  ds_read_b64_tr_b16 v[192:193], v19 offset:49152
  v_mfma_f32_16x16x32_bf16 v[52:55], v[180:183], a[252:255], v[52:55]
  ds_read_b64_tr_b16 v[194:195], v19 offset:51200
  v_mfma_f32_16x16x32_bf16 v[48:51], v[180:183], a[248:251], v[48:51]
  ds_read_b64_tr_b16 v[196:197], v19 offset:53248
  v_mfma_f32_16x16x32_bf16 v[48:51], v[176:179], a[240:243], v[48:51]
  s_waitcnt lgkmcnt(3)
  ds_read_b64_tr_b16 v[198:199], v19 offset:55296
  v_mfma_f32_16x16x32_bf16 v[56:59], v[184:187], a[240:243], v[56:59]
  s_add_u32 s38, s51, 0
  ds_read_b64_tr_b16 v[168:169], v16 offset:57344
  v_mfma_f32_16x16x32_bf16 v[56:59], v[188:191], a[248:251], v[56:59]
  s_add_u32 m0, s37, 0
  ds_read_b64_tr_b16 v[170:171], v16 offset:59392
  buffer_load_dwordx4 v4, s[12:15], s38 offen offset:0  lds
  v_mfma_f32_16x16x32_bf16 v[60:63], v[188:191], a[252:255], v[60:63]
  ds_read_b64_tr_b16 v[172:173], v16 offset:61440
  buffer_load_dwordx4 v5, s[12:15], s38 offen offset:1024  lds
  v_mfma_f32_16x16x32_bf16 v[60:63], v[184:187], a[244:247], v[60:63]
  s_waitcnt lgkmcnt(3)
  ds_read_b64_tr_b16 v[174:175], v16 offset:63488
  v_mfma_f32_16x16x32_bf16 v[68:71], v[192:195], a[244:247], v[68:71]
  ds_read_b64_tr_b16 v[176:177], v17 offset:57344
  v_mfma_f32_16x16x32_bf16 v[68:71], v[196:199], a[252:255], v[68:71]
  ds_read_b64_tr_b16 v[178:179], v17 offset:59392
  buffer_load_dwordx4 v6, s[12:15], s38 offen offset:2048  lds
  v_mfma_f32_16x16x32_bf16 v[64:67], v[196:199], a[248:251], v[64:67]
  ds_read_b64_tr_b16 v[180:181], v17 offset:61440
  v_mfma_f32_16x16x32_bf16 v[64:67], v[192:195], a[240:243], v[64:67]
  s_waitcnt lgkmcnt(3)
  ds_read_b64_tr_b16 v[182:183], v17 offset:63488
  buffer_load_dwordx4 v7, s[12:15], s38 offen offset:3072  lds
  v_mfma_f32_16x16x32_bf16 v[72:75], v[168:171], a[240:243], v[72:75]
  s_add_u32 s38, s51, 786432
  ds_read_b64_tr_b16 v[184:185], v18 offset:57344
  v_mfma_f32_16x16x32_bf16 v[72:75], v[172:175], a[248:251], v[72:75]
  s_add_u32 m0, s37, 81920
  ds_read_b64_tr_b16 v[186:187], v18 offset:59392
  v_mfma_f32_16x16x32_bf16 v[76:79], v[172:175], a[252:255], v[76:79]
  ds_read_b64_tr_b16 v[188:189], v18 offset:61440
  buffer_load_dwordx4 v4, s[12:15], s38 offen offset:0  lds
  v_mfma_f32_16x16x32_bf16 v[76:79], v[168:171], a[244:247], v[76:79]
  s_waitcnt lgkmcnt(3)
  ds_read_b64_tr_b16 v[190:191], v18 offset:63488
  v_mfma_f32_16x16x32_bf16 v[84:87], v[176:179], a[244:247], v[84:87]
  ds_read_b64_tr_b16 v[192:193], v19 offset:57344
  buffer_load_dwordx4 v5, s[12:15], s38 offen offset:1024  lds
  v_mfma_f32_16x16x32_bf16 v[84:87], v[180:183], a[252:255], v[84:87]
  ds_read_b64_tr_b16 v[194:195], v19 offset:59392
  v_cvt_pk_bf16_f32 v120, v40, v41
  v_mfma_f32_16x16x32_bf16 v[80:83], v[180:183], a[248:251], v[80:83]
  ds_read_b64_tr_b16 v[196:197], v19 offset:61440
  v_cvt_pk_bf16_f32 v121, v42, v43
  v_mfma_f32_16x16x32_bf16 v[80:83], v[176:179], a[240:243], v[80:83]
  s_waitcnt lgkmcnt(3)
  ds_read_b64_tr_b16 v[198:199], v19 offset:63488
  buffer_load_dwordx4 v6, s[12:15], s38 offen offset:2048  lds
  v_mfma_f32_16x16x32_bf16 v[88:91], v[184:187], a[240:243], v[88:91]
  v_cvt_pk_bf16_f32 v122, v48, v49
  v_mfma_f32_16x16x32_bf16 v[88:91], v[188:191], a[248:251], v[88:91]
  buffer_load_dwordx4 v7, s[12:15], s38 offen offset:3072  lds
  v_mfma_f32_16x16x32_bf16 v[92:95], v[188:191], a[252:255], v[92:95]
  v_cvt_pk_bf16_f32 v123, v50, v51
  v_mfma_f32_16x16x32_bf16 v[92:95], v[184:187], a[244:247], v[92:95]
  s_waitcnt lgkmcnt(0)
  v_mfma_f32_16x16x32_bf16 v[100:103], v[192:195], a[244:247], v[100:103]
  global_load_dword v0, v25, s[80:81]
  v_mfma_f32_16x16x32_bf16 v[100:103], v[196:199], a[252:255], v[100:103]
  v_cvt_pk_bf16_f32 v124, v56, v57
  v_mfma_f32_16x16x32_bf16 v[96:99], v[196:199], a[248:251], v[96:99]
  v_cvt_pk_bf16_f32 v125, v58, v59
  v_mfma_f32_16x16x32_bf16 v[96:99], v[192:195], a[240:243], v[96:99]
  v_cvt_pk_bf16_f32 v126, v64, v65
L_kepi:
  v_cvt_pk_bf16_f32 v127, v66, v67
  v_cvt_pk_bf16_f32 v128, v44, v45
  v_cvt_pk_bf16_f32 v129, v46, v47
  v_cvt_pk_bf16_f32 v130, v52, v53
  v_cvt_pk_bf16_f32 v131, v54, v55
  v_cvt_pk_bf16_f32 v132, v60, v61
  v_cvt_pk_bf16_f32 v133, v62, v63
  v_cvt_pk_bf16_f32 v134, v68, v69
  v_cvt_pk_bf16_f32 v135, v70, v71
  v_mfma_f32_16x16x32_bf16 v[136:139], v[104:107], v[120:123], 0
  v_cvt_pk_bf16_f32 v40, v72, v73
  v_cvt_pk_bf16_f32 v41, v74, v75
  ds_write_b64 v248, v[40:41] offset:32768
  v_mfma_f32_16x16x32_bf16 v[140:143], v[108:111], v[120:123], 0
  v_cvt_pk_bf16_f32 v42, v80, v81
  v_cvt_pk_bf16_f32 v43, v82, v83
  ds_write_b64 v249, v[42:43] offset:32768
  v_mfma_f32_16x16x32_bf16 v[144:147], v[112:115], v[124:127], 0
  v_cvt_pk_bf16_f32 v44, v88, v89
  v_cvt_pk_bf16_f32 v45, v90, v91
  ds_write_b64 v250, v[44:45] offset:32768
  v_mfma_f32_16x16x32_bf16 v[148:151], v[116:119], v[124:127], 0
  v_cvt_pk_bf16_f32 v46, v96, v97
  v_cvt_pk_bf16_f32 v47, v98, v99
  ds_write_b64 v251, v[46:47] offset:32768
  v_mfma_f32_16x16x32_bf16 v[152:155], v[104:107], v[128:131], 0
  v_cvt_pk_bf16_f32 v48, v76, v77
  v_cvt_pk_bf16_f32 v49, v78, v79
  ds_write_b64 v248, v[48:49] offset:34816
  v_mfma_f32_16x16x32_bf16 v[156:159], v[108:111], v[128:131], 0
  v_cvt_pk_bf16_f32 v50, v84, v85
  v_cvt_pk_bf16_f32 v51, v86, v87
  ds_write_b64 v249, v[50:51] offset:34816
  v_mfma_f32_16x16x32_bf16 v[160:163], v[112:115], v[132:135], 0
  v_cvt_pk_bf16_f32 v52, v92, v93
  v_cvt_pk_bf16_f32 v53, v94, v95
  ds_write_b64 v250, v[52:53] offset:34816
  v_mfma_f32_16x16x32_bf16 v[164:167], v[116:119], v[132:135], 0
  v_cvt_pk_bf16_f32 v54, v100, v101
  v_cvt_pk_bf16_f32 v55, v102, v103
  ds_write_b64 v251, v[54:55] offset:34816
  global_load_dwordx4 v[120:123], v24, s[66:67] offset:384
  v_mov_b32 v56, 0x3f803f80
  v_mov_b32 v57, 0x3f803f80
  v_mov_b32 v58, 0x3f803f80
  v_mov_b32 v59, 0x3f803f80
  v_max3_f32 v200, v136, v137, v138
  v_min3_f32 v201, v136, v137, v138
  v_max3_f32 v200, v200, v139, v140
  v_min3_f32 v201, v201, v139, v140
  v_max3_f32 v200, v200, v141, v142
  v_min3_f32 v201, v201, v141, v142
  v_max_f32 v200, v200, v143
  v_min_f32_e64 v201, v201, v143
  v_max3_f32 v202, v144, v145, v146
  v_min3_f32 v203, v144, v145, v146
  v_max3_f32 v202, v202, v147, v148
  v_min3_f32 v203, v203, v147, v148
  v_max3_f32 v202, v202, v149, v150
  v_min3_f32 v203, v203, v149, v150
  v_max_f32 v202, v202, v151
  v_min_f32 v203, v203, v151
  v_max3_f32 v204, v152, v153, v154
  v_min3_f32 v205, v152, v153, v154
  v_max3_f32 v204, v204, v155, v156
  v_min3_f32 v205, v205, v155, v156
  v_max3_f32 v204, v204, v157, v158
  v_min3_f32 v205, v205, v157, v158
  v_max_f32 v204, v204, v159
  v_min_f32 v205, v205, v159
  v_max3_f32 v206, v160, v161, v162
  v_min3_f32 v207, v160, v161, v162
  v_max3_f32 v206, v206, v163, v164
  v_min3_f32 v207, v207, v163, v164
  v_max3_f32 v206, v206, v165, v166
  v_min3_f32 v207, v207, v165, v166
  v_max_f32 v206, v206, v167
  v_min_f32 v207, v207, v167
  v_permlane16_swap_b32 v200, v202
  v_permlane16_swap_b32 v204, v206
  v_permlane16_swap_b32 v201, v203
  v_permlane16_swap_b32 v205, v207
  v_max_f32 v200, v200, v202
  v_max_f32 v204, v204, v206
  v_min_f32 v201, v201, v203
  v_min_f32 v205, v205, v207
  v_permlane32_swap_b32 v200, v204
  s_nop 0
  v_permlane32_swap_b32 v201, v205
  v_max_f32 v200, v200, v204
  v_min_f32 v201, v201, v205
  v_mul_f32 v200, s49, v200
  v_mul_f32 v201, s48, v201
  v_mov_b32 v204, v200
  v_mov_b32 v205, v201
  s_nop 0
  v_permlane32_swap_b32 v200, v204
  v_permlane32_swap_b32 v201, v205
  v_mov_b32 v202, v200
  v_mov_b32 v206, v204
  v_mov_b32 v203, v201
  v_mov_b32 v207, v205
  v_permlane16_swap_b32 v200, v202
  v_permlane16_swap_b32 v204, v206
  v_permlane16_swap_b32 v201, v203
  v_permlane16_swap_b32 v205, v207
  v_pk_fma_f32 v[216:217], v[136:137], s[48:49], v[200:201] op_sel:[0,1,1] op_sel_hi:[1,1,1]
  v_pk_fma_f32 v[218:219], v[138:139], s[48:49], v[200:201] op_sel:[0,1,1] op_sel_hi:[1,1,1]
  v_pk_fma_f32 v[220:221], v[140:141], s[48:49], v[200:201] op_sel:[0,1,1] op_sel_hi:[1,1,1]
  v_pk_fma_f32 v[222:223], v[142:143], s[48:49], v[200:201] op_sel:[0,1,1] op_sel_hi:[1,1,1]
  v_pk_fma_f32 v[136:137], v[136:137], s[48:49], v[200:201] op_sel_hi:[1,0,0]
  v_pk_fma_f32 v[138:139], v[138:139], s[48:49], v[200:201] op_sel_hi:[1,0,0]
  v_pk_fma_f32 v[140:141], v[140:141], s[48:49], v[200:201] op_sel_hi:[1,0,0]
  v_pk_fma_f32 v[142:143], v[142:143], s[48:49], v[200:201] op_sel_hi:[1,0,0]
  v_exp_f32 v216, v216
  v_exp_f32 v217, v217
  v_exp_f32 v218, v218
  v_exp_f32 v219, v219
  v_exp_f32 v220, v220
  v_exp_f32 v221, v221
  v_exp_f32 v222, v222
  v_exp_f32 v223, v223
  v_exp_f32 v136, v136
  v_exp_f32 v137, v137
  v_exp_f32 v138, v138
  v_exp_f32 v139, v139
  v_exp_f32 v140, v140
  v_exp_f32 v141, v141
  v_exp_f32 v142, v142
  v_exp_f32 v143, v143
  v_pk_add_f32 v[168:169], v[216:217], v[218:219]
  v_pk_add_f32 v[170:171], v[220:221], v[222:223]
  v_pk_add_f32 v[172:173], v[136:137], v[138:139]
  v_pk_add_f32 v[174:175], v[140:141], v[142:143]
  v_pk_add_f32 v[168:169], v[168:169], v[170:171]
  v_pk_add_f32 v[172:173], v[172:173], v[174:175]
  v_add_f32 v209, v168, v169
  v_add_f32 v208, v172, v173
  v_pk_fma_f32 v[224:225], v[144:145], s[48:49], v[202:203] op_sel:[0,1,1] op_sel_hi:[1,1,1]
  v_pk_fma_f32 v[226:227], v[146:147], s[48:49], v[202:203] op_sel:[0,1,1] op_sel_hi:[1,1,1]
  v_pk_fma_f32 v[228:229], v[148:149], s[48:49], v[202:203] op_sel:[0,1,1] op_sel_hi:[1,1,1]
  v_pk_fma_f32 v[230:231], v[150:151], s[48:49], v[202:203] op_sel:[0,1,1] op_sel_hi:[1,1,1]
  v_pk_fma_f32 v[144:145], v[144:145], s[48:49], v[202:203] op_sel_hi:[1,0,0]
  v_pk_fma_f32 v[146:147], v[146:147], s[48:49], v[202:203] op_sel_hi:[1,0,0]
  v_pk_fma_f32 v[148:149], v[148:149], s[48:49], v[202:203] op_sel_hi:[1,0,0]
  v_pk_fma_f32 v[150:151], v[150:151], s[48:49], v[202:203] op_sel_hi:[1,0,0]
  v_exp_f32 v224, v224
  v_exp_f32 v225, v225
  v_exp_f32 v226, v226
  v_exp_f32 v227, v227
  v_exp_f32 v228, v228
  v_exp_f32 v229, v229
  v_exp_f32 v230, v230
  v_exp_f32 v231, v231
  v_exp_f32 v144, v144
  v_exp_f32 v145, v145
  v_exp_f32 v146, v146
  v_exp_f32 v147, v147
  v_exp_f32 v148, v148
  v_exp_f32 v149, v149
  v_exp_f32 v150, v150
  v_exp_f32 v151, v151
  v_pk_add_f32 v[176:177], v[224:225], v[226:227]
  v_pk_add_f32 v[178:179], v[228:229], v[230:231]
  v_pk_add_f32 v[180:181], v[144:145], v[146:147]
  v_pk_add_f32 v[182:183], v[148:149], v[150:151]
  v_pk_add_f32 v[176:177], v[176:177], v[178:179]
  v_pk_add_f32 v[180:181], v[180:181], v[182:183]
  v_add_f32 v211, v176, v177
  v_add_f32 v210, v180, v181
  v_pk_fma_f32 v[232:233], v[152:153], s[48:49], v[204:205] op_sel:[0,1,1] op_sel_hi:[1,1,1]
  v_pk_fma_f32 v[234:235], v[154:155], s[48:49], v[204:205] op_sel:[0,1,1] op_sel_hi:[1,1,1]
  v_pk_fma_f32 v[236:237], v[156:157], s[48:49], v[204:205] op_sel:[0,1,1] op_sel_hi:[1,1,1]
  v_pk_fma_f32 v[238:239], v[158:159], s[48:49], v[204:205] op_sel:[0,1,1] op_sel_hi:[1,1,1]
  v_pk_fma_f32 v[152:153], v[152:153], s[48:49], v[204:205] op_sel_hi:[1,0,0]
  v_pk_fma_f32 v[154:155], v[154:155], s[48:49], v[204:205] op_sel_hi:[1,0,0]
  v_pk_fma_f32 v[156:157], v[156:157], s[48:49], v[204:205] op_sel_hi:[1,0,0]
  v_pk_fma_f32 v[158:159], v[158:159], s[48:49], v[204:205] op_sel_hi:[1,0,0]
  v_exp_f32 v232, v232
  v_exp_f32 v233, v233
  v_exp_f32 v234, v234
  v_exp_f32 v235, v235
  v_exp_f32 v236, v236
  v_exp_f32 v237, v237
  v_exp_f32 v238, v238
  v_exp_f32 v239, v239
  v_exp_f32 v152, v152
  v_exp_f32 v153, v153
  v_exp_f32 v154, v154
  v_exp_f32 v155, v155
  v_exp_f32 v156, v156
  v_exp_f32 v157, v157
  v_exp_f32 v158, v158
  v_exp_f32 v159, v159
  v_pk_add_f32 v[184:185], v[232:233], v[234:235]
  v_pk_add_f32 v[186:187], v[236:237], v[238:239]
  v_pk_add_f32 v[188:189], v[152:153], v[154:155]
  v_pk_add_f32 v[190:191], v[156:157], v[158:159]
  v_pk_add_f32 v[184:185], v[184:185], v[186:187]
  v_pk_add_f32 v[188:189], v[188:189], v[190:191]
  v_add_f32 v213, v184, v185
  v_add_f32 v212, v188, v189
  v_pk_fma_f32 v[240:241], v[160:161], s[48:49], v[206:207] op_sel:[0,1,1] op_sel_hi:[1,1,1]
  v_pk_fma_f32 v[242:243], v[162:163], s[48:49], v[206:207] op_sel:[0,1,1] op_sel_hi:[1,1,1]
  v_pk_fma_f32 v[244:245], v[164:165], s[48:49], v[206:207] op_sel:[0,1,1] op_sel_hi:[1,1,1]
  v_pk_fma_f32 v[246:247], v[166:167], s[48:49], v[206:207] op_sel:[0,1,1] op_sel_hi:[1,1,1]
  v_pk_fma_f32 v[160:161], v[160:161], s[48:49], v[206:207] op_sel_hi:[1,0,0]
  v_pk_fma_f32 v[162:163], v[162:163], s[48:49], v[206:207] op_sel_hi:[1,0,0]
  v_pk_fma_f32 v[164:165], v[164:165], s[48:49], v[206:207] op_sel_hi:[1,0,0]
  v_pk_fma_f32 v[166:167], v[166:167], s[48:49], v[206:207] op_sel_hi:[1,0,0]
  v_exp_f32 v240, v240
  v_exp_f32 v241, v241
  v_exp_f32 v242, v242
  v_exp_f32 v243, v243
  v_exp_f32 v244, v244
  v_exp_f32 v245, v245
  v_exp_f32 v246, v246
  v_exp_f32 v247, v247
  v_exp_f32 v160, v160
  v_exp_f32 v161, v161
  v_exp_f32 v162, v162
  v_exp_f32 v163, v163
  v_exp_f32 v164, v164
  v_exp_f32 v165, v165
L_pad_0a_3:
  s_cbranch_execz L_pad_0a_7
  v_exp_f32 v166, v166
  v_exp_f32_e64 v167, v167
  v_pk_add_f32 v[192:193], v[240:241], v[242:243]
  v_pk_add_f32 v[194:195], v[244:245], v[246:247]
  v_pk_add_f32 v[196:197], v[160:161], v[162:163]
  v_pk_add_f32 v[198:199], v[164:165], v[166:167]
  v_pk_add_f32 v[192:193], v[192:193], v[194:195]
  v_pk_add_f32 v[196:197], v[196:197], v[198:199]
  v_add_f32 v215, v192, v193
  v_add_f32 v214, v196, v197
  v_permlane16_swap_b32 v208, v210
  s_nop 0
  v_permlane16_swap_b32 v212, v214
  v_permlane16_swap_b32 v209, v211
  v_permlane16_swap_b32 v213, v215
  v_add_f32 v208, v208, v210
  v_add_f32 v212, v212, v214
  v_add_f32 v209, v209, v211
  v_add_f32 v213, v213, v215
  v_permlane32_swap_b32 v208, v212
  s_nop 0
  v_permlane32_swap_b32 v209, v213
  v_add_f32 v208, v208, v212
  v_add_f32 v209, v209, v213
  v_rcp_f32 v208, v208
  v_rcp_f32 v209, v209
  v_mov_b32 v212, v208
  v_mov_b32 v213, v209
  s_nop 0
  v_permlane32_swap_b32 v208, v212
  v_permlane32_swap_b32 v209, v213
  v_mov_b32 v210, v208
  v_mov_b32 v214, v212
  v_mov_b32 v211, v209
  v_mov_b32_e64 v215, v213
  v_permlane16_swap_b32 v208, v210
  v_permlane16_swap_b32 v212, v214
  v_permlane16_swap_b32 v209, v211
  v_permlane16_swap_b32 v213, v215
  v_pk_mul_f32 v[136:137], v[136:137], v[208:209] op_sel_hi:[1,0]
  v_pk_mul_f32 v[138:139], v[138:139], v[208:209] op_sel_hi:[1,0]
  v_pk_mul_f32 v[140:141], v[140:141], v[208:209] op_sel_hi:[1,0]
  v_pk_mul_f32 v[142:143], v[142:143], v[208:209] op_sel_hi:[1,0]
  v_cvt_pk_bf16_f32 v168, v136, v137
  v_cvt_pk_bf16_f32 v169, v138, v139
  v_cvt_pk_bf16_f32 v170, v140, v141
  v_cvt_pk_bf16_f32 v171, v142, v143
  ds_write_b64 v248, v[168:169] offset:0
  v_pk_mul_f32 v[216:217], v[216:217], v[208:209] op_sel:[0,1] op_sel_hi:[1,1]
  v_pk_mul_f32 v[218:219], v[218:219], v[208:209] op_sel:[0,1] op_sel_hi:[1,1]
  v_pk_mul_f32 v[220:221], v[220:221], v[208:209] op_sel:[0,1] op_sel_hi:[1,1]
  v_pk_mul_f32 v[222:223], v[222:223], v[208:209] op_sel:[0,1] op_sel_hi:[1,1]
  ds_write_b64 v249, v[170:171] offset:0
  v_cvt_pk_bf16_f32 v172, v216, v217
  v_cvt_pk_bf16_f32 v173, v218, v219
  v_cvt_pk_bf16_f32 v174, v220, v221
  v_cvt_pk_bf16_f32 v175, v222, v223
  ds_write_b64 v250, v[172:173] offset:0
  v_pk_mul_f32 v[144:145], v[144:145], v[210:211] op_sel_hi:[1,0]
  v_pk_mul_f32 v[146:147], v[146:147], v[210:211] op_sel_hi:[1,0]
  v_pk_mul_f32 v[148:149], v[148:149], v[210:211] op_sel_hi:[1,0]
  v_pk_mul_f32 v[150:151], v[150:151], v[210:211] op_sel_hi:[1,0]
  ds_write_b64 v251, v[174:175] offset:0
  v_cvt_pk_bf16_f32 v176, v144, v145
  v_cvt_pk_bf16_f32 v177, v146, v147
  v_cvt_pk_bf16_f32 v178, v148, v149
  v_cvt_pk_bf16_f32 v179, v150, v151
  ds_write_b64 v248, v[176:177] offset:16384
  v_pk_mul_f32 v[224:225], v[224:225], v[210:211] op_sel:[0,1] op_sel_hi:[1,1]
  v_pk_mul_f32 v[226:227], v[226:227], v[210:211] op_sel:[0,1] op_sel_hi:[1,1]
  v_pk_mul_f32 v[228:229], v[228:229], v[210:211] op_sel:[0,1] op_sel_hi:[1,1]
  v_pk_mul_f32 v[230:231], v[230:231], v[210:211] op_sel:[0,1] op_sel_hi:[1,1]
  ds_write_b64 v249, v[178:179] offset:16384
  v_cvt_pk_bf16_f32 v180, v224, v225
  v_cvt_pk_bf16_f32 v181, v226, v227
  v_cvt_pk_bf16_f32 v182, v228, v229
  v_cvt_pk_bf16_f32 v183, v230, v231
  ds_write_b64 v250, v[180:181] offset:16384
  v_pk_mul_f32 v[152:153], v[152:153], v[212:213] op_sel_hi:[1,0]
  v_pk_mul_f32 v[154:155], v[154:155], v[212:213] op_sel_hi:[1,0]
  v_pk_mul_f32 v[156:157], v[156:157], v[212:213] op_sel_hi:[1,0]
  v_pk_mul_f32 v[158:159], v[158:159], v[212:213] op_sel_hi:[1,0]
  ds_write_b64 v251, v[182:183] offset:16384
  v_cvt_pk_bf16_f32 v184, v152, v153
  v_cvt_pk_bf16_f32 v185, v154, v155
  v_cvt_pk_bf16_f32 v186, v156, v157
  v_cvt_pk_bf16_f32 v187, v158, v159
  ds_write_b64 v248, v[184:185] offset:2048
  v_pk_mul_f32 v[232:233], v[232:233], v[212:213] op_sel:[0,1] op_sel_hi:[1,1]
  v_pk_mul_f32 v[234:235], v[234:235], v[212:213] op_sel:[0,1] op_sel_hi:[1,1]
  v_pk_mul_f32 v[236:237], v[236:237], v[212:213] op_sel:[0,1] op_sel_hi:[1,1]
  v_pk_mul_f32 v[238:239], v[238:239], v[212:213] op_sel:[0,1] op_sel_hi:[1,1]
  ds_write_b64 v249, v[186:187] offset:2048
  v_cvt_pk_bf16_f32 v188, v232, v233
  v_cvt_pk_bf16_f32 v189, v234, v235
  v_cvt_pk_bf16_f32 v190, v236, v237
  v_cvt_pk_bf16_f32 v191, v238, v239
  ds_write_b64 v250, v[188:189] offset:2048
  v_pk_mul_f32 v[160:161], v[160:161], v[214:215] op_sel_hi:[1,0]
  v_pk_mul_f32 v[162:163], v[162:163], v[214:215] op_sel_hi:[1,0]
  v_pk_mul_f32 v[164:165], v[164:165], v[214:215] op_sel_hi:[1,0]
  v_pk_mul_f32 v[166:167], v[166:167], v[214:215] op_sel_hi:[1,0]
  ds_write_b64 v251, v[190:191] offset:2048
  v_cvt_pk_bf16_f32 v192, v160, v161
  v_cvt_pk_bf16_f32 v193, v162, v163
  v_cvt_pk_bf16_f32 v194, v164, v165
  v_cvt_pk_bf16_f32 v195, v166, v167
  ds_write_b64 v248, v[192:193] offset:18432
  v_pk_mul_f32 v[240:241], v[240:241], v[214:215] op_sel:[0,1] op_sel_hi:[1,1]
  v_pk_mul_f32 v[242:243], v[242:243], v[214:215] op_sel:[0,1] op_sel_hi:[1,1]
  v_pk_mul_f32 v[244:245], v[244:245], v[214:215] op_sel:[0,1] op_sel_hi:[1,1]
  v_pk_mul_f32 v[246:247], v[246:247], v[214:215] op_sel:[0,1] op_sel_hi:[1,1]
  ds_write_b64 v249, v[194:195] offset:18432
  v_cvt_pk_bf16_f32 v196, v240, v241
  v_cvt_pk_bf16_f32 v197, v242, v243
  v_cvt_pk_bf16_f32 v198, v244, v245
  v_cvt_pk_bf16_f32 v199, v246, v247
  ds_write_b64 v250, v[196:197] offset:18432
  ds_write_b64 v251, v[198:199] offset:18432
  s_waitcnt vmcnt(6)
  v_mfma_f32_16x16x32_bf16 v[36:39], v[56:59], v[28:31], 0
  v_mfma_f32_16x16x32_bf16 v[36:39], v[56:59], v[32:35], v[36:39]
  s_waitcnt lgkmcnt(0)
  s_barrier
  ds_read_b64_tr_b16 v[136:137], v10 offset:0
  ds_read_b64_tr_b16 v[138:139], v10 offset:2048
  ds_read_b64_tr_b16 v[144:145], v12 offset:0
  ds_read_b64_tr_b16 v[146:147], v12 offset:2048
  ds_read_b64_tr_b16 v[148:149], v13 offset:0
  ds_read_b64_tr_b16 v[150:151], v13 offset:2048
  ds_read_b64_tr_b16 v[140:141], v11 offset:0
  ds_read_b64_tr_b16 v[142:143], v11 offset:2048
  ds_read_b64_tr_b16 v[152:153], v10 offset:4096
  ds_read_b64_tr_b16 v[154:155], v10 offset:6144
  ds_read_b64_tr_b16 v[160:161], v12 offset:4096
  ds_read_b64_tr_b16 v[162:163], v12 offset:6144
  ds_read_b64_tr_b16 v[164:165], v13 offset:4096
  ds_read_b64_tr_b16 v[166:167], v13 offset:6144
  s_waitcnt lgkmcnt(12)
  v_mfma_f32_16x16x32_bf16 v[216:219], v[56:59], v[136:139], 0
  ds_read_b64_tr_b16 v[156:157], v11 offset:4096
  s_waitcnt lgkmcnt(11)
  v_mfma_f32_16x16x32_bf16 v[200:203], v[136:139], v[144:147], 0
  ds_read_b64_tr_b16 v[158:159], v11 offset:6144
  s_waitcnt lgkmcnt(10)
  v_mfma_f32_16x16x32_bf16 v[204:207], v[136:139], v[148:151], 0
  ds_read_b64_tr_b16 v[168:169], v10 offset:8192
  ds_read_b64_tr_b16 v[170:171], v10 offset:10240
  s_waitcnt lgkmcnt(10)
  v_mfma_f32_16x16x32_bf16 v[220:223], v[56:59], v[140:143], 0
  ds_read_b64_tr_b16 v[176:177], v12 offset:8192
  v_mfma_f32_16x16x32_bf16 v[208:211], v[140:143], v[144:147], 0
  ds_read_b64_tr_b16 v[178:179], v12 offset:10240
  v_mfma_f32_16x16x32_bf16 v[212:215], v[140:143], v[148:151], 0
  ds_read_b64_tr_b16 v[180:181], v13 offset:8192
  ds_read_b64_tr_b16 v[182:183], v13 offset:10240
  s_waitcnt lgkmcnt(12)
  v_mfma_f32_16x16x32_bf16 v[216:219], v[56:59], v[152:155], v[216:219]
  ds_read_b64_tr_b16 v[172:173], v11 offset:8192
  s_waitcnt lgkmcnt(11)
  v_mfma_f32_16x16x32_bf16 v[200:203], v[152:155], v[160:163], v[200:203]
  ds_read_b64_tr_b16 v[174:175], v11 offset:10240
  s_waitcnt lgkmcnt(10)
  v_mfma_f32_16x16x32_bf16 v[204:207], v[152:155], v[164:167], v[204:207]
  ds_read_b64_tr_b16 v[184:185], v10 offset:12288
  ds_read_b64_tr_b16 v[186:187], v10 offset:14336
  s_waitcnt lgkmcnt(10)
  v_mfma_f32_16x16x32_bf16 v[220:223], v[56:59], v[156:159], v[220:223]
  ds_read_b64_tr_b16 v[192:193], v12 offset:12288
  v_mfma_f32_16x16x32_bf16 v[208:211], v[156:159], v[160:163], v[208:211]
  ds_read_b64_tr_b16 v[194:195], v12 offset:14336
  v_mfma_f32_16x16x32_bf16 v[212:215], v[156:159], v[164:167], v[212:215]
  ds_read_b64_tr_b16 v[196:197], v13 offset:12288
  ds_read_b64_tr_b16 v[198:199], v13 offset:14336
  s_waitcnt lgkmcnt(12)
  v_mfma_f32_16x16x32_bf16 v[216:219], v[56:59], v[168:171], v[216:219]
  ds_read_b64_tr_b16 v[188:189], v11 offset:12288
  s_waitcnt lgkmcnt(11)
  v_mfma_f32_16x16x32_bf16 v[200:203], v[168:171], v[176:179], v[200:203]
  ds_read_b64_tr_b16 v[190:191], v11 offset:14336
  v_add_f32_dpp v36, v36, v36 row_ror:8 row_mask:0xf bank_mask:0xf
  s_waitcnt lgkmcnt(10)
  v_mfma_f32_16x16x32_bf16 v[204:207], v[168:171], v[180:183], v[204:207]
  s_waitcnt lgkmcnt(8)
  v_mfma_f32_16x16x32_bf16 v[220:223], v[56:59], v[172:175], v[220:223]
  v_add_f32_dpp v36, v36, v36 row_ror:4 row_mask:0xf bank_mask:0xf
  v_mfma_f32_16x16x32_bf16 v[208:211], v[172:175], v[176:179], v[208:211]
  v_mfma_f32_16x16x32_bf16 v[212:215], v[172:175], v[180:183], v[212:215]
  v_add_f32_dpp v36, v36, v36 row_ror:2 row_mask:0xf bank_mask:0xf
  s_waitcnt lgkmcnt(6)
  v_mfma_f32_16x16x32_bf16 v[216:219], v[56:59], v[184:187], v[216:219]
  s_waitcnt lgkmcnt(4)
  v_mfma_f32_16x16x32_bf16 v[200:203], v[184:187], v[192:195], v[200:203]
  v_add_f32_dpp v36, v36, v36 row_ror:1 row_mask:0xf bank_mask:0xf
  s_waitcnt lgkmcnt(2)
  v_mfma_f32_16x16x32_bf16 v[204:207], v[184:187], v[196:199], v[204:207]
  s_waitcnt lgkmcnt(0)
  v_mfma_f32_16x16x32_bf16 v[220:223], v[56:59], v[188:191], v[220:223]
  v_mul_f32 v36, 0x3a800000, v36
  v_mfma_f32_16x16x32_bf16 v[208:211], v[188:191], v[192:195], v[208:211]
  v_mfma_f32_16x16x32_bf16 v[212:215], v[188:191], v[196:199], v[212:215]
  ds_read_b64_tr_b16 v[168:169], v16 offset:0
  ds_read_b64_tr_b16 v[170:171], v16 offset:2048
  ds_read_b64_tr_b16 v[172:173], v16 offset:4096
  ds_read_b64_tr_b16 v[174:175], v16 offset:6144
  ds_read_b64_tr_b16 v[176:177], v17 offset:0
  ds_read_b64_tr_b16 v[178:179], v17 offset:2048
  ds_read_b64_tr_b16 v[180:181], v17 offset:4096
  ds_read_b64_tr_b16 v[182:183], v17 offset:6144
  v_cvt_pk_bf16_f32 v224, v200, v201
  v_cvt_pk_bf16_f32 v225, v202, v203
  v_cvt_pk_bf16_f32 v226, v208, v209
  v_cvt_pk_bf16_f32 v227, v210, v211
  global_store_dwordx4 v14, v[224:227], s[4:5] offset:0 sc1
  v_cvt_pk_bf16_f32 v228, v204, v205
  v_cvt_pk_bf16_f32 v229, v206, v207
  v_cvt_pk_bf16_f32 v230, v212, v213
  v_cvt_pk_bf16_f32 v231, v214, v215
  global_store_dwordx4 v14, v[228:231], s[4:5] offset:1024 sc1
  v_permlane16_swap_b32 v216, v220
  s_nop 1
  v_permlane32_swap_b32 v216, v36
  global_store_dword v15, v216, s[4:5] sc1
  s_waitcnt vmcnt(3)
  global_store_dwordx4 v24, v[120:123], s[8:9] sc1
  s_waitcnt lgkmcnt(4)
L_q:
  v_mfma_f32_16x16x32_bf16 v[40:43], v[168:171], a[0:3], 0
  s_add_u32 s38, s51, 1572864
  ds_read_b64_tr_b16 v[184:185], v18 offset:0
  v_mfma_f32_16x16x32_bf16 v[40:43], v[172:175], a[8:11], v[40:43]
  s_add_u32 m0, s37, 16384
  ds_read_b64_tr_b16 v[186:187], v18 offset:2048
  buffer_load_dwordx4 v4, s[12:15], s38 offen offset:0  lds
  v_mfma_f32_16x16x32_bf16 v[44:47], v[172:175], a[12:15], 0
  s_lshl_b32 s34, s24, 16
  ds_read_b64_tr_b16 v[188:189], v18 offset:4096
  s_lshl_b32 s35, s31, 7
  v_mfma_f32_16x16x32_bf16 v[44:47], v[168:171], a[4:7], v[44:47]
  s_waitcnt lgkmcnt(3)
  ds_read_b64_tr_b16 v[190:191], v18 offset:6144
  buffer_load_dwordx4 v5, s[12:15], s38 offen offset:1024  lds
  v_mfma_f32_16x16x32_bf16 v[52:55], v[176:179], a[4:7], 0
  s_add_u32 s42, s34, s35
  ds_read_b64_tr_b16 v[192:193], v19 offset:0
  v_lshrrev_b32_e64 v12, 3, v1
  v_mfma_f32_16x16x32_bf16 v[52:55], v[180:183], a[12:15], v[52:55]
  ds_read_b64_tr_b16 v[194:195], v19 offset:2048
  v_bfe_u32 v13, v1, 1, 2
  v_mfma_f32_16x16x32_bf16 v[48:51], v[180:183], a[8:11], 0
  ds_read_b64_tr_b16 v[196:197], v19 offset:4096
  v_lshrrev_b32 v14, 1, v12
  v_mfma_f32_16x16x32_bf16 v[48:51], v[176:179], a[0:3], v[48:51]
  s_waitcnt lgkmcnt(3)
  ds_read_b64_tr_b16 v[198:199], v19 offset:6144
  buffer_load_dwordx4 v6, s[12:15], s38 offen offset:2048  lds
  v_mfma_f32_16x16x32_bf16 v[56:59], v[184:187], a[0:3], 0
  ds_read_b64_tr_b16 v[168:169], v16 offset:8192
  v_xor_b32_e64 v13, v13, v14
  v_mfma_f32_16x16x32_bf16 v[56:59], v[188:191], a[8:11], v[56:59]
  ds_read_b64_tr_b16 v[170:171], v16 offset:10240
  v_and_b32 v14, 1, v1
  v_mfma_f32_16x16x32_bf16 v[60:63], v[188:191], a[12:15], 0
  ds_read_b64_tr_b16 v[172:173], v16 offset:12288
  buffer_load_dwordx4 v7, s[12:15], s38 offen offset:3072  lds
  v_mfma_f32_16x16x32_bf16 v[60:63], v[184:187], a[4:7], v[60:63]
  s_waitcnt lgkmcnt(3)
  ds_read_b64_tr_b16 v[174:175], v16 offset:14336
  v_mfma_f32_16x16x32_bf16 v[68:71], v[192:195], a[4:7], 0
  ds_read_b64_tr_b16 v[176:177], v17 offset:8192
  v_lshlrev_b32 v14, 4, v14
  v_mfma_f32_16x16x32_bf16 v[68:71], v[196:199], a[12:15], v[68:71]
  ds_read_b64_tr_b16 v[178:179], v17 offset:10240
  v_lshl_add_u32 v13, v13, 5, v14
  v_mfma_f32_16x16x32_bf16 v[64:67], v[196:199], a[8:11], 0
  ds_read_b64_tr_b16 v[180:181], v17 offset:12288
  v_mul_u32_u24 v12, 2048, v12
  v_mfma_f32_16x16x32_bf16 v[64:67], v[192:195], a[0:3], v[64:67]
  s_waitcnt lgkmcnt(3)
  ds_read_b64_tr_b16 v[182:183], v17 offset:14336
  v_mfma_f32_16x16x32_bf16 v[40:43], v[168:171], a[16:19], v[40:43]
  ds_read_b64_tr_b16 v[184:185], v18 offset:8192
  v_add3_u32 v88, v12, v13, s42
  v_mfma_f32_16x16x32_bf16 v[40:43], v[172:175], a[24:27], v[40:43]
  ds_read_b64_tr_b16 v[186:187], v18 offset:10240
  v_add_u32 v89, 15360, v88
  v_mfma_f32_16x16x32_bf16 v[44:47], v[172:175], a[28:31], v[44:47]
  ds_read_b64_tr_b16 v[188:189], v18 offset:12288
  v_add_u32 v90, 30720, v88
  v_mfma_f32_16x16x32_bf16 v[44:47], v[168:171], a[20:23], v[44:47]
  s_waitcnt lgkmcnt(3)
  ds_read_b64_tr_b16 v[190:191], v18 offset:14336
  v_mfma_f32_16x16x32_bf16 v[52:55], v[176:179], a[20:23], v[52:55]
  ds_read_b64_tr_b16 v[192:193], v19 offset:8192
  v_add_u32 v91, 46080, v88
  v_mfma_f32_16x16x32_bf16 v[52:55], v[180:183], a[28:31], v[52:55]
  s_mov_b32 s20, s58
  ds_read_b64_tr_b16 v[194:195], v19 offset:10240
  s_mov_b32 s21, s59
  v_mfma_f32_16x16x32_bf16 v[48:51], v[180:183], a[24:27], v[48:51]
  s_mov_b32 s22, 0x200000
  ds_read_b64_tr_b16 v[196:197], v19 offset:12288
  s_mov_b32 s23, 0x00020000
  v_mfma_f32_16x16x32_bf16 v[48:51], v[176:179], a[16:19], v[48:51]
  s_waitcnt vmcnt(10) lgkmcnt(3)
  ds_read_b64_tr_b16 v[198:199], v19 offset:14336
  v_mfma_f32_16x16x32_bf16 v[56:59], v[184:187], a[16:19], v[56:59]
  s_barrier
  ds_read_b64_tr_b16 v[168:169], v20 offset:16384
  v_mfma_f32_16x16x32_bf16 v[56:59], v[188:191], a[24:27], v[56:59]
  s_lshl_b32 s47, s30, 3
  ds_read_b64_tr_b16 v[170:171], v20 offset:18432
  s_lshl_b32 s34, s24, 1
  v_mfma_f32_16x16x32_bf16 v[60:63], v[188:191], a[28:31], v[60:63]
  s_add_u32 s47, s47, s34
  ds_read_b64_tr_b16 v[172:173], v20 offset:20480
  s_mul_i32 s10, s47, 32768
  v_mfma_f32_16x16x32_bf16 v[60:63], v[184:187], a[20:23], v[60:63]
  s_waitcnt lgkmcnt(3)
  ds_read_b64_tr_b16 v[174:175], v20 offset:22528
  v_mfma_f32_16x16x32_bf16 v[68:71], v[192:195], a[20:23], v[68:71]
  s_lshl_b32 s85, s28, 11
  ds_read_b64_tr_b16 v[176:177], v21 offset:16384
  s_lshl_b32 s36, s31, 11
  v_mfma_f32_16x16x32_bf16 v[68:71], v[196:199], a[28:31], v[68:71]
  s_add_u32 s45, s45, 4096
  ds_read_b64_tr_b16 v[178:179], v21 offset:18432
  v_add_u32 v10, s45, v3
  v_mfma_f32_16x16x32_bf16 v[64:67], v[196:199], a[24:27], v[64:67]
  ds_read_b64_tr_b16 v[180:181], v21 offset:20480
  v_mov_b32 v139, 147712
  v_mfma_f32_16x16x32_bf16 v[64:67], v[192:195], a[16:19], v[64:67]
  s_waitcnt lgkmcnt(3)
  ds_read_b64_tr_b16 v[182:183], v21 offset:22528
  v_mfma_f32_16x16x32_bf16 v[40:43], v[168:171], a[32:35], v[40:43]
  s_add_u32 s38, s51, 2359296
  ds_read_b64_tr_b16 v[184:185], v22 offset:16384
  v_mfma_f32_16x16x32_bf16 v[40:43], v[172:175], a[40:43], v[40:43]
  s_add_u32 m0, s37, 32768
  ds_read_b64_tr_b16 v[186:187], v22 offset:18432
  buffer_load_dwordx4 v4, s[12:15], s38 offen offset:0  lds
  v_mfma_f32_16x16x32_bf16 v[44:47], v[172:175], a[44:47], v[44:47]
  ds_read_b64_tr_b16 v[188:189], v22 offset:20480
  v_and_b32 v12, 1, v1
  v_mfma_f32_16x16x32_bf16 v[44:47], v[168:171], a[36:39], v[44:47]
  s_waitcnt lgkmcnt(3)
  ds_read_b64_tr_b16 v[190:191], v22 offset:22528
  buffer_load_dwordx4 v5, s[12:15], s38 offen offset:1024  lds
  v_mfma_f32_16x16x32_bf16 v[52:55], v[176:179], a[36:39], v[52:55]
  ds_read_b64_tr_b16 v[192:193], v23 offset:16384
  v_lshrrev_b32 v13, 4, v1
  v_mfma_f32_16x16x32_bf16 v[52:55], v[180:183], a[44:47], v[52:55]
  ds_read_b64_tr_b16 v[194:195], v23 offset:18432
  v_lshlrev_b32 v12, 6, v12
  v_mfma_f32_16x16x32_bf16 v[48:51], v[180:183], a[40:43], v[48:51]
  ds_read_b64_tr_b16 v[196:197], v23 offset:20480
  v_lshl_add_u32 v12, v13, 4, v12
  v_mfma_f32_16x16x32_bf16 v[48:51], v[176:179], a[32:35], v[48:51]
  s_waitcnt lgkmcnt(3)
  ds_read_b64_tr_b16 v[198:199], v23 offset:22528
  buffer_load_dwordx4 v6, s[12:15], s38 offen offset:2048  lds
  v_mfma_f32_16x16x32_bf16 v[56:59], v[184:187], a[32:35], v[56:59]
  ds_read_b64_tr_b16 v[168:169], v20 offset:24576
  v_add_u32 v12, 147456, v12
  v_mfma_f32_16x16x32_bf16 v[56:59], v[188:191], a[40:43], v[56:59]
  ds_read_b64_tr_b16 v[170:171], v20 offset:26624
  v_lshl_add_u32 v15, v13, 4, v139
  v_mfma_f32_16x16x32_bf16 v[60:63], v[188:191], a[44:47], v[60:63]
  ds_read_b64_tr_b16 v[172:173], v20 offset:28672
  buffer_load_dwordx4 v7, s[12:15], s38 offen offset:3072  lds
  v_mfma_f32_16x16x32_bf16 v[60:63], v[184:187], a[36:39], v[60:63]
  s_waitcnt lgkmcnt(3)
  ds_read_b64_tr_b16 v[174:175], v20 offset:30720
  v_mfma_f32_16x16x32_bf16 v[68:71], v[192:195], a[36:39], v[68:71]
  ds_read_b64_tr_b16 v[176:177], v21 offset:24576
  v_and_b32 v136, 3, v1
  v_mfma_f32_16x16x32_bf16 v[68:71], v[196:199], a[44:47], v[68:71]
  ds_read_b64_tr_b16 v[178:179], v21 offset:26624
  v_lshrrev_b32_e64 v137, 2, v1
  v_mfma_f32_16x16x32_bf16 v[64:67], v[196:199], a[40:43], v[64:67]
  ds_read_b64_tr_b16 v[180:181], v21 offset:28672
  v_lshlrev_b32 v138, 2, v136
  v_mfma_f32_16x16x32_bf16 v[64:67], v[192:195], a[32:35], v[64:67]
  s_waitcnt lgkmcnt(3)
  ds_read_b64_tr_b16 v[182:183], v21 offset:30720
  v_mfma_f32_16x16x32_bf16 v[40:43], v[168:171], a[48:51], v[40:43]
  ds_read_b64_tr_b16 v[184:185], v22 offset:24576
  v_lshl_add_u32 v138, v137, 8, v138
  v_mfma_f32_16x16x32_bf16 v[40:43], v[172:175], a[56:59], v[40:43]
  ds_read_b64_tr_b16 v[186:187], v22 offset:26624
  v_add_u32 v101, s46, v138
  v_mfma_f32_16x16x32_bf16 v[44:47], v[172:175], a[60:63], v[44:47]
  ds_read_b64_tr_b16 v[188:189], v22 offset:28672
  v_and_b32 v138, 3, v137
  v_mfma_f32_16x16x32_bf16 v[44:47], v[168:171], a[52:55], v[44:47]
  s_waitcnt lgkmcnt(3)
  ds_read_b64_tr_b16 v[190:191], v22 offset:30720
  v_mfma_f32_16x16x32_bf16 v[52:55], v[176:179], a[52:55], v[52:55]
  ds_read_b64_tr_b16 v[192:193], v23 offset:24576
  v_lshlrev_b32 v138, 4, v138
  v_mfma_f32_16x16x32_bf16 v[52:55], v[180:183], a[60:63], v[52:55]
  ds_read_b64_tr_b16 v[194:195], v23 offset:26624
  v_and_b32 v137, 1, v13
  v_mfma_f32_16x16x32_bf16 v[48:51], v[180:183], a[56:59], v[48:51]
  ds_read_b64_tr_b16 v[196:197], v23 offset:28672
  v_lshl_add_u32 v138, v137, 3, v138
  v_mfma_f32_16x16x32_bf16 v[48:51], v[176:179], a[48:51], v[48:51]
  s_waitcnt vmcnt(4) lgkmcnt(3)
  ds_read_b64_tr_b16 v[198:199], v23 offset:30720
  v_mfma_f32_16x16x32_bf16 v[56:59], v[184:187], a[48:51], v[56:59]
  s_barrier
  ds_read_b64_tr_b16 v[168:169], v16 offset:16384
  v_mfma_f32_16x16x32_bf16 v[56:59], v[188:191], a[56:59], v[56:59]
  ds_read_b64_tr_b16 v[170:171], v16 offset:18432
  v_lshrrev_b32 v137, 5, v1
  v_mfma_f32_16x16x32_bf16 v[60:63], v[188:191], a[60:63], v[60:63]
  ds_read_b64_tr_b16 v[172:173], v16 offset:20480
  v_lshl_add_u32 v138, v137, 7, v138
  v_mfma_f32_16x16x32_bf16 v[60:63], v[184:187], a[52:55], v[60:63]
  s_waitcnt lgkmcnt(3)
  ds_read_b64_tr_b16 v[174:175], v16 offset:22528
  v_mfma_f32_16x16x32_bf16 v[68:71], v[192:195], a[52:55], v[68:71]
  s_lshl_b32 s34, s24, 1
  ds_read_b64_tr_b16 v[176:177], v17 offset:16384
  s_add_u32 s34, s34, 147456
  v_mfma_f32_16x16x32_bf16 v[68:71], v[196:199], a[60:63], v[68:71]
  ds_read_b64_tr_b16 v[178:179], v17 offset:18432
  v_add_u32 v95, s34, v138
  v_mfma_f32_16x16x32_bf16 v[64:67], v[196:199], a[56:59], v[64:67]
  ds_read_b64_tr_b16 v[180:181], v17 offset:20480
  v_lshlrev_b32 v136, 4, v136
  v_mfma_f32_16x16x32_bf16 v[64:67], v[192:195], a[48:51], v[64:67]
  s_waitcnt lgkmcnt(3)
  ds_read_b64_tr_b16 v[182:183], v17 offset:22528
  v_mfma_f32_16x16x32_bf16 v[40:43], v[168:171], a[64:67], v[40:43]
  s_add_u32 s38, s51, 3145728
  ds_read_b64_tr_b16 v[184:185], v18 offset:16384
  v_mfma_f32_16x16x32_bf16 v[40:43], v[172:175], a[72:75], v[40:43]
  s_add_u32 m0, s37, 49152
  ds_read_b64_tr_b16 v[186:187], v18 offset:18432
  buffer_load_dwordx4 v4, s[12:15], s38 offen offset:0  lds
  v_mfma_f32_16x16x32_bf16 v[44:47], v[172:175], a[76:79], v[44:47]
  ds_read_b64_tr_b16 v[188:189], v18 offset:20480
  v_bfe_u32 v137, v1, 2, 1
  v_mfma_f32_16x16x32_bf16 v[44:47], v[168:171], a[68:71], v[44:47]
  s_waitcnt lgkmcnt(3)
  ds_read_b64_tr_b16 v[190:191], v18 offset:22528
  buffer_load_dwordx4 v5, s[12:15], s38 offen offset:1024  lds
  v_mfma_f32_16x16x32_bf16 v[52:55], v[176:179], a[68:71], v[52:55]
  ds_read_b64_tr_b16 v[192:193], v19 offset:16384
  v_lshl_add_u32 v136, v137, 3, v136
  v_mfma_f32_16x16x32_bf16 v[52:55], v[180:183], a[76:79], v[52:55]
  ds_read_b64_tr_b16 v[194:195], v19 offset:18432
  v_lshl_add_u32 v136, v13, 1, v136
  v_mfma_f32_16x16x32_bf16 v[48:51], v[180:183], a[72:75], v[48:51]
  s_lshl_b32 s34, s24, 6
  ds_read_b64_tr_b16 v[196:197], v19 offset:20480
  s_add_u32 s34, s34, 147712
  v_mfma_f32_16x16x32_bf16 v[48:51], v[176:179], a[64:67], v[48:51]
  s_waitcnt lgkmcnt(3)
  ds_read_b64_tr_b16 v[198:199], v19 offset:22528
  buffer_load_dwordx4 v6, s[12:15], s38 offen offset:2048  lds
  v_mfma_f32_16x16x32_bf16 v[56:59], v[184:187], a[64:67], v[56:59]
  ds_read_b64_tr_b16 v[168:169], v16 offset:24576
  v_add_u32 v14, s34, v136
  v_mfma_f32_16x16x32_bf16 v[56:59], v[188:191], a[72:75], v[56:59]
  ds_read_b64_tr_b16 v[170:171], v16 offset:26624
  v_lshrrev_b32 v136, 3, v1
  v_mfma_f32_16x16x32_bf16 v[60:63], v[188:191], a[76:79], v[60:63]
  ds_read_b64_tr_b16 v[172:173], v16 offset:28672
  buffer_load_dwordx4 v7, s[12:15], s38 offen offset:3072  lds
  v_mfma_f32_16x16x32_bf16 v[60:63], v[184:187], a[68:71], v[60:63]
  s_waitcnt lgkmcnt(3)
  ds_read_b64_tr_b16 v[174:175], v16 offset:30720
  v_mfma_f32_16x16x32_bf16 v[68:71], v[192:195], a[68:71], v[68:71]
  ds_read_b64_tr_b16 v[176:177], v17 offset:24576
  v_and_b32 v11, 7, v1
  v_mfma_f32_16x16x32_bf16 v[68:71], v[196:199], a[76:79], v[68:71]
  ds_read_b64_tr_b16 v[178:179], v17 offset:26624
  v_lshlrev_b32 v11, 4, v11
  v_mfma_f32_16x16x32_bf16 v[64:67], v[196:199], a[72:75], v[64:67]
  ds_read_b64_tr_b16 v[180:181], v17 offset:28672
  v_lshl_add_u32 v11, v136, 8, v11
  v_mfma_f32_16x16x32_bf16 v[64:67], v[192:195], a[64:67], v[64:67]
  s_waitcnt lgkmcnt(3)
  ds_read_b64_tr_b16 v[182:183], v17 offset:30720
  v_mfma_f32_16x16x32_bf16 v[40:43], v[168:171], a[80:83], v[40:43]
  ds_read_b64_tr_b16 v[184:185], v18 offset:24576
  v_add_u32 v11, s46, v11
  v_mfma_f32_16x16x32_bf16 v[40:43], v[172:175], a[88:91], v[40:43]
  ds_read_b64_tr_b16 v[186:187], v18 offset:26624
  v_and_b32 v136, 15, v1
  v_mfma_f32_16x16x32_bf16 v[44:47], v[172:175], a[92:95], v[44:47]
  ds_read_b64_tr_b16 v[188:189], v18 offset:28672
  v_lshrrev_b32 v137, 2, v136
  v_mfma_f32_16x16x32_bf16 v[44:47], v[168:171], a[84:87], v[44:47]
  s_waitcnt lgkmcnt(3)
  ds_read_b64_tr_b16 v[190:191], v18 offset:30720
  v_mfma_f32_16x16x32_bf16 v[52:55], v[176:179], a[84:87], v[52:55]
  ds_read_b64_tr_b16 v[192:193], v19 offset:24576
  v_cmp_eq_u32_e64 vcc, v13, v137
  v_mfma_f32_16x16x32_bf16 v[52:55], v[180:183], a[92:95], v[52:55]
  ds_read_b64_tr_b16 v[194:195], v19 offset:26624
  v_and_b32 v137, 1, v136
  v_mfma_f32_16x16x32_bf16 v[48:51], v[180:183], a[88:91], v[48:51]
  ds_read_b64_tr_b16 v[196:197], v19 offset:28672
  v_lshlrev_b32 v137, 4, v137
  v_mfma_f32_16x16x32_bf16 v[48:51], v[176:179], a[80:83], v[48:51]
  s_waitcnt vmcnt(4) lgkmcnt(3)
  ds_read_b64_tr_b16 v[198:199], v19 offset:30720
  v_mfma_f32_16x16x32_bf16 v[56:59], v[184:187], a[80:83], v[56:59]
  s_barrier
  s_cmp_eq_u32 s24, 0
  s_cbranch_scc0 L_nosig_6
  v_mov_b32 v254, s6
  v_mov_b32 v255, s7
  s_mov_b32 exec_lo, 0xffff
  s_mov_b32 exec_hi, 0
  global_store_dwordx2 v252, v[254:255], s[4:5] sc1
  s_mov_b64 exec, -1
L_nosig_6:
  ds_read_b64_tr_b16 v[168:169], v16 offset:32768
  v_mfma_f32_16x16x32_bf16 v[56:59], v[188:191], a[88:91], v[56:59]
  ds_read_b64_tr_b16 v[170:171], v16 offset:34816
  v_mov_b32 v138, 0x3f80
  v_mfma_f32_16x16x32_bf16 v[60:63], v[188:191], a[92:95], v[60:63]
  ds_read_b64_tr_b16 v[172:173], v16 offset:36864
  v_lshlrev_b32 v138, v137, v138
  v_mfma_f32_16x16x32_bf16 v[60:63], v[184:187], a[84:87], v[60:63]
  s_waitcnt lgkmcnt(3)
  ds_read_b64_tr_b16 v[174:175], v16 offset:38912
  v_mfma_f32_16x16x32_bf16 v[68:71], v[192:195], a[84:87], v[68:71]
  ds_read_b64_tr_b16 v[176:177], v17 offset:32768
  v_cndmask_b32 v138, 0, v138, vcc
  v_mfma_f32_16x16x32_bf16 v[68:71], v[196:199], a[92:95], v[68:71]
  ds_read_b64_tr_b16 v[178:179], v17 offset:34816
  v_and_b32 v137, 2, v136
  v_mfma_f32_16x16x32_bf16 v[64:67], v[196:199], a[88:91], v[64:67]
  ds_read_b64_tr_b16 v[180:181], v17 offset:36864
  v_cmp_eq_u32 vcc, 0, v137
  v_mfma_f32_16x16x32_bf16 v[64:67], v[192:195], a[80:83], v[64:67]
  s_waitcnt lgkmcnt(3)
  ds_read_b64_tr_b16 v[182:183], v17 offset:38912
  v_mfma_f32_16x16x32_bf16 v[40:43], v[168:171], a[96:99], v[40:43]
  s_add_u32 s38, s51, 3932160
  ds_read_b64_tr_b16 v[184:185], v18 offset:32768
  v_mfma_f32_16x16x32_bf16 v[40:43], v[172:175], a[104:107], v[40:43]
  s_add_u32 m0, s37, 0
  ds_read_b64_tr_b16 v[186:187], v18 offset:34816
  buffer_load_dwordx4 v4, s[12:15], s38 offen offset:0  lds
  v_mfma_f32_16x16x32_bf16 v[44:47], v[172:175], a[108:111], v[44:47]
  ds_read_b64_tr_b16 v[188:189], v18 offset:36864
  v_mov_b32 v72, 0
  v_mfma_f32_16x16x32_bf16 v[44:47], v[168:171], a[100:103], v[44:47]
  s_waitcnt lgkmcnt(3)
  ds_read_b64_tr_b16 v[190:191], v18 offset:38912
  buffer_load_dwordx4 v5, s[12:15], s38 offen offset:1024  lds
  v_mfma_f32_16x16x32_bf16 v[52:55], v[176:179], a[100:103], v[52:55]
  ds_read_b64_tr_b16 v[192:193], v19 offset:32768
  v_mov_b32 v73, 0
  v_mfma_f32_16x16x32_bf16 v[52:55], v[180:183], a[108:111], v[52:55]
  ds_read_b64_tr_b16 v[194:195], v19 offset:34816
  v_cndmask_b32 v74, 0, v138, vcc
  v_mfma_f32_16x16x32_bf16 v[48:51], v[180:183], a[104:107], v[48:51]
  ds_read_b64_tr_b16 v[196:197], v19 offset:36864
  v_cndmask_b32 v75, v138, 0, vcc
  v_mfma_f32_16x16x32_bf16 v[48:51], v[176:179], a[96:99], v[48:51]
  s_waitcnt lgkmcnt(3)
  ds_read_b64_tr_b16 v[198:199], v19 offset:38912
  buffer_load_dwordx4 v6, s[12:15], s38 offen offset:2048  lds
  v_mfma_f32_16x16x32_bf16 v[56:59], v[184:187], a[96:99], v[56:59]
  ds_read_b64_tr_b16 v[168:169], v16 offset:40960
  v_mov_b32_e64 v76, v74
  v_mfma_f32_16x16x32_bf16 v[56:59], v[188:191], a[104:107], v[56:59]
  ds_read_b64_tr_b16 v[170:171], v16 offset:43008
  v_mov_b32 v77, v75
  v_mfma_f32_16x16x32_bf16 v[60:63], v[188:191], a[108:111], v[60:63]
  ds_read_b64_tr_b16 v[172:173], v16 offset:45056
  buffer_load_dwordx4 v7, s[12:15], s38 offen offset:3072  lds
  v_mfma_f32_16x16x32_bf16 v[60:63], v[184:187], a[100:103], v[60:63]
  s_waitcnt lgkmcnt(3)
  ds_read_b64_tr_b16 v[174:175], v16 offset:47104
L_pad_0a_4:
  s_cbranch_execz L_ret_0a
  v_mfma_f32_16x16x32_bf16 v[68:71], v[192:195], a[100:103], v[68:71]
  s_add_u32 m0, s37, 98304
  ds_read_b64_tr_b16 v[176:177], v17 offset:40960
  v_mfma_f32_16x16x32_bf16 v[68:71], v[196:199], a[108:111], v[68:71]
  s_mov_b32 s84, 1572864
  ds_read_b64_tr_b16 v[178:179], v17 offset:43008
  v_mfma_f32_16x16x32_bf16 v[64:67], v[196:199], a[104:107], v[64:67]
  ds_read_b64_tr_b16 v[180:181], v17 offset:45056
  buffer_load_dwordx4 v88, s[20:23], s84 offen offset:0 lds
  v_mfma_f32_16x16x32_bf16 v[64:67], v[192:195], a[96:99], v[64:67]
  s_waitcnt lgkmcnt(3)
  ds_read_b64_tr_b16 v[182:183], v17 offset:47104
  v_mfma_f32_16x16x32_bf16 v[40:43], v[168:171], a[112:115], v[40:43]
  ds_read_b64_tr_b16 v[184:185], v18 offset:40960
  v_mov_b32 v78, 0
  v_mfma_f32_16x16x32_bf16 v[40:43], v[172:175], a[120:123], v[40:43]
  ds_read_b64_tr_b16 v[186:187], v18 offset:43008
  buffer_load_dwordx4 v89, s[20:23], s84 offen offset:1024 lds
  v_mfma_f32_16x16x32_bf16 v[44:47], v[172:175], a[124:127], v[44:47]
  ds_read_b64_tr_b16 v[188:189], v18 offset:45056
  v_mov_b32 v79, 0
  v_mfma_f32_16x16x32_bf16 v[44:47], v[168:171], a[116:119], v[44:47]
  s_waitcnt lgkmcnt(3)
  ds_read_b64_tr_b16 v[190:191], v18 offset:47104
  v_mfma_f32_16x16x32_bf16 v[52:55], v[176:179], a[116:119], v[52:55]
  s_lshl_b32 s34, s24, 11
  ds_read_b64_tr_b16 v[192:193], v19 offset:40960
  s_add_u32 s34, s34, 151552
  v_mfma_f32_16x16x32_bf16 v[52:55], v[180:183], a[124:127], v[52:55]
  ds_read_b64_tr_b16 v[194:195], v19 offset:43008
  buffer_load_dwordx4 v90, s[20:23], s84 offen offset:2048 lds
  v_mfma_f32_16x16x32_bf16 v[48:51], v[180:183], a[120:123], v[48:51]
  ds_read_b64_tr_b16 v[196:197], v19 offset:45056
  v_add_u32_e64 v92, s34, v3
  v_mfma_f32_16x16x32_bf16 v[48:51], v[176:179], a[112:115], v[48:51]
  s_waitcnt vmcnt(7) lgkmcnt(3)
  ds_read_b64_tr_b16 v[198:199], v19 offset:47104
  v_mfma_f32_16x16x32_bf16 v[56:59], v[184:187], a[112:115], v[56:59]
  s_barrier
  ds_read_b64_tr_b16 v[168:169], v16 offset:49152
  v_mfma_f32_16x16x32_bf16 v[56:59], v[188:191], a[120:123], v[56:59]
  ds_read_b64_tr_b16 v[170:171], v16 offset:51200
  buffer_load_dwordx4 v91, s[20:23], s84 offen offset:3072 lds
  v_mfma_f32_16x16x32_bf16 v[60:63], v[188:191], a[124:127], v[60:63]
  ds_read_b64_tr_b16 v[172:173], v16 offset:53248
  v_add_u32 v93, 151552, v3
  v_mfma_f32_16x16x32_bf16 v[60:63], v[184:187], a[116:119], v[60:63]
  s_waitcnt lgkmcnt(3)
  ds_read_b64_tr_b16 v[174:175], v16 offset:55296
  v_mfma_f32_16x16x32_bf16 v[68:71], v[192:195], a[116:119], v[68:71]
  s_lshl_b32 s34, s44, 10
  ds_read_b64_tr_b16 v[176:177], v17 offset:49152
  s_lshl_b32 s35, s28, 7
  v_mfma_f32_16x16x32_bf16 v[68:71], v[196:199], a[124:127], v[68:71]
  s_add_u32 s34, s34, s35
  ds_read_b64_tr_b16 v[178:179], v17 offset:51200
  s_add_u32 s34, s34, 0x3b80000
  v_mfma_f32_16x16x32_bf16 v[64:67], v[196:199], a[120:123], v[64:67]
  ds_read_b64_tr_b16 v[180:181], v17 offset:53248
  v_lshl_add_u32 v94, v1, 2, s34
  v_mfma_f32_16x16x32_bf16 v[64:67], v[192:195], a[112:115], v[64:67]
  s_waitcnt lgkmcnt(3)
  ds_read_b64_tr_b16 v[182:183], v17 offset:55296
  v_mfma_f32_16x16x32_bf16 v[40:43], v[168:171], a[128:131], v[40:43]
  s_add_u32 s38, s51, 4718592
  ds_read_b64_tr_b16 v[184:185], v18 offset:49152
  v_mfma_f32_16x16x32_bf16 v[40:43], v[172:175], a[136:139], v[40:43]
  s_add_u32 m0, s37, 16384
  ds_read_b64_tr_b16 v[186:187], v18 offset:51200
  buffer_load_dwordx4 v4, s[12:15], s38 offen offset:0  lds
  v_mfma_f32_16x16x32_bf16 v[44:47], v[172:175], a[140:143], v[44:47]
  ds_read_b64_tr_b16 v[188:189], v18 offset:53248
  v_bfe_u32 v98, v1, 1, 3
  v_mfma_f32_16x16x32_bf16 v[44:47], v[168:171], a[132:135], v[44:47]
  s_waitcnt lgkmcnt(3)
  ds_read_b64_tr_b16 v[190:191], v18 offset:55296
  buffer_load_dwordx4 v5, s[12:15], s38 offen offset:1024  lds
  v_mfma_f32_16x16x32_bf16 v[52:55], v[176:179], a[132:135], v[52:55]
  ds_read_b64_tr_b16 v[192:193], v19 offset:49152
  v_and_b32 v136, 1, v1
  v_mfma_f32_16x16x32_bf16 v[52:55], v[180:183], a[140:143], v[52:55]
  ds_read_b64_tr_b16 v[194:195], v19 offset:51200
  v_lshlrev_b32 v136, 3, v136
  v_mfma_f32_16x16x32_bf16 v[48:51], v[180:183], a[136:139], v[48:51]
  ds_read_b64_tr_b16 v[196:197], v19 offset:53248
  v_lshl_add_u32 v98, v98, 7, v136
  v_mfma_f32_16x16x32_bf16 v[48:51], v[176:179], a[128:131], v[48:51]
  s_waitcnt lgkmcnt(3)
  ds_read_b64_tr_b16 v[198:199], v19 offset:55296
  buffer_load_dwordx4 v6, s[12:15], s38 offen offset:2048  lds
  v_mfma_f32_16x16x32_bf16 v[56:59], v[184:187], a[128:131], v[56:59]
  s_lshl_b32 s34, s47, 10
  ds_read_b64_tr_b16 v[168:169], v16 offset:57344
  s_add_u32 s34, s34, 0x3b40000
  v_mfma_f32_16x16x32_bf16 v[56:59], v[188:191], a[136:139], v[56:59]
  ds_read_b64_tr_b16 v[170:171], v16 offset:59392
  v_add_u32 v98, s34, v98
  v_mfma_f32_16x16x32_bf16 v[60:63], v[188:191], a[140:143], v[60:63]
  ds_read_b64_tr_b16 v[172:173], v16 offset:61440
  buffer_load_dwordx4 v7, s[12:15], s38 offen offset:3072  lds
  v_mfma_f32_16x16x32_bf16 v[60:63], v[184:187], a[132:135], v[60:63]
  s_waitcnt lgkmcnt(3)
  ds_read_b64_tr_b16 v[174:175], v16 offset:63488
  v_mfma_f32_16x16x32_bf16 v[68:71], v[192:195], a[132:135], v[68:71]
  s_add_u32 m0, s37, 114688
  ds_read_b64_tr_b16 v[176:177], v17 offset:57344
  v_mfma_f32_16x16x32_bf16 v[68:71], v[196:199], a[140:143], v[68:71]
  s_mov_b32 s84, 1835008
  ds_read_b64_tr_b16 v[178:179], v17 offset:59392
  v_mfma_f32_16x16x32_bf16 v[64:67], v[196:199], a[136:139], v[64:67]
  ds_read_b64_tr_b16 v[180:181], v17 offset:61440
  buffer_load_dwordx4 v88, s[20:23], s84 offen offset:0 lds
  v_mfma_f32_16x16x32_bf16 v[64:67], v[192:195], a[128:131], v[64:67]
  s_waitcnt lgkmcnt(3)
  ds_read_b64_tr_b16 v[182:183], v17 offset:63488
  v_mfma_f32_16x16x32_bf16 v[40:43], v[168:171], a[144:147], v[40:43]
  ds_read_b64_tr_b16 v[184:185], v18 offset:57344
  v_add_u32 v96, s10, v3
  v_mfma_f32_16x16x32_bf16 v[40:43], v[172:175], a[152:155], v[40:43]
  ds_read_b64_tr_b16 v[186:187], v18 offset:59392
  buffer_load_dwordx4 v89, s[20:23], s84 offen offset:1024 lds
  v_mfma_f32_16x16x32_bf16 v[44:47], v[172:175], a[156:159], v[44:47]
  ds_read_b64_tr_b16 v[188:189], v18 offset:61440
  v_add_u32 v97, 32768, v96
  v_mfma_f32_16x16x32_bf16 v[44:47], v[168:171], a[148:151], v[44:47]
  s_waitcnt lgkmcnt(3)
  ds_read_b64_tr_b16 v[190:191], v18 offset:63488
  v_mfma_f32_16x16x32_bf16 v[52:55], v[176:179], a[148:151], v[52:55]
  s_and_b32 s34, s40, 240
  ds_read_b64_tr_b16 v[192:193], v19 offset:57344
  s_lshl_b32 s34, s34, 8
  v_mfma_f32_16x16x32_bf16 v[52:55], v[180:183], a[156:159], v[52:55]
  s_bfe_u32 s35, s40, 0x40000
  ds_read_b64_tr_b16 v[194:195], v19 offset:59392
  buffer_load_dwordx4 v90, s[20:23], s84 offen offset:2048 lds
  v_mfma_f32_16x16x32_bf16 v[48:51], v[180:183], a[152:155], v[48:51]
  s_lshl_b32 s35, s35, 3
  ds_read_b64_tr_b16 v[196:197], v19 offset:61440
  s_add_u32 s34, s34, s35
  v_mfma_f32_16x16x32_bf16 v[48:51], v[176:179], a[144:147], v[48:51]
  s_waitcnt vmcnt(11) lgkmcnt(3)
  ds_read_b64_tr_b16 v[198:199], v19 offset:63488
  v_mfma_f32_16x16x32_bf16 v[56:59], v[184:187], a[144:147], v[56:59]
  s_barrier
  ds_read_b64_tr_b16 v[168:169], v16 offset:0
  v_mfma_f32_16x16x32_bf16 v[56:59], v[188:191], a[152:155], v[56:59]
  s_add_u32 s34, s34, 0x3bc0000
  ds_read_b64_tr_b16 v[170:171], v16 offset:2048
  buffer_load_dwordx4 v91, s[20:23], s84 offen offset:3072 lds
  v_mfma_f32_16x16x32_bf16 v[60:63], v[188:191], a[156:159], v[60:63]
  ds_read_b64_tr_b16 v[172:173], v16 offset:4096
  v_lshlrev_b32 v99, 8, v1
  v_mfma_f32_16x16x32_bf16 v[60:63], v[184:187], a[148:151], v[60:63]
  s_waitcnt lgkmcnt(3)
  ds_read_b64_tr_b16 v[174:175], v16 offset:6144
  v_mfma_f32_16x16x32_bf16 v[68:71], v[192:195], a[148:151], v[68:71]
  ds_read_b64_tr_b16 v[176:177], v17 offset:0
  v_add_u32_e64 v99, s34, v99
  v_mfma_f32_16x16x32_bf16 v[68:71], v[196:199], a[156:159], v[68:71]
  s_lshl_b32 s11, s30, 4
  ds_read_b64_tr_b16 v[178:179], v17 offset:2048
  s_add_u32 s11, s11, s31
  v_mfma_f32_16x16x32_bf16 v[64:67], v[196:199], a[152:155], v[64:67]
  s_and_b32 s34, s11, 255
  ds_read_b64_tr_b16 v[180:181], v17 offset:4096
  s_lshl_b32 s34, s34, 8
  v_mfma_f32_16x16x32_bf16 v[64:67], v[192:195], a[144:147], v[64:67]
  s_waitcnt lgkmcnt(3)
  ds_read_b64_tr_b16 v[182:183], v17 offset:6144
  v_mfma_f32_16x16x32_bf16 v[40:43], v[168:171], a[160:163], v[40:43]
  s_add_u32 s38, s51, 5505024
  ds_read_b64_tr_b16 v[184:185], v18 offset:0
  v_mfma_f32_16x16x32_bf16 v[40:43], v[172:175], a[168:171], v[40:43]
  s_add_u32 m0, s37, 32768
  ds_read_b64_tr_b16 v[186:187], v18 offset:2048
  buffer_load_dwordx4 v4, s[12:15], s38 offen offset:0  lds
  v_mfma_f32_16x16x32_bf16 v[44:47], v[172:175], a[172:175], v[44:47]
  s_add_u32 s34, s34, 0x3bc0000
  ds_read_b64_tr_b16 v[188:189], v18 offset:4096
  v_and_b32_e64 v100, 3, v1
  v_mfma_f32_16x16x32_bf16 v[44:47], v[168:171], a[164:167], v[44:47]
  s_waitcnt lgkmcnt(3)
  ds_read_b64_tr_b16 v[190:191], v18 offset:6144
  buffer_load_dwordx4 v5, s[12:15], s38 offen offset:1024  lds
  v_mfma_f32_16x16x32_bf16 v[52:55], v[176:179], a[164:167], v[52:55]
  ds_read_b64_tr_b16 v[192:193], v19 offset:0
  v_lshl_add_u32 v100, v100, 3, s34
  v_mfma_f32_16x16x32_bf16 v[52:55], v[180:183], a[172:175], v[52:55]
  s_add_u32 s86, s4, s34
  s_addc_u32 s87, s5, 0
  ds_read_b64_tr_b16 v[194:195], v19 offset:2048
  v_mfma_f32_16x16x32_bf16 v[48:51], v[180:183], a[168:171], v[48:51]
  ds_read_b64_tr_b16 v[196:197], v19 offset:4096
  v_mfma_f32_16x16x32_bf16 v[48:51], v[176:179], a[160:163], v[48:51]
  s_waitcnt lgkmcnt(3)
  ds_read_b64_tr_b16 v[198:199], v19 offset:6144
  buffer_load_dwordx4 v6, s[12:15], s38 offen offset:2048  lds
  v_mfma_f32_16x16x32_bf16 v[56:59], v[184:187], a[160:163], v[56:59]
  ds_read_b64_tr_b16 v[168:169], v16 offset:8192
  v_mfma_f32_16x16x32_bf16 v[56:59], v[188:191], a[168:171], v[56:59]
  ds_read_b64_tr_b16 v[170:171], v16 offset:10240
  v_mfma_f32_16x16x32_bf16 v[60:63], v[188:191], a[172:175], v[60:63]
  ds_read_b64_tr_b16 v[172:173], v16 offset:12288
  buffer_load_dwordx4 v7, s[12:15], s38 offen offset:3072  lds
  v_mfma_f32_16x16x32_bf16 v[60:63], v[184:187], a[164:167], v[60:63]
  s_waitcnt lgkmcnt(3)
  ds_read_b64_tr_b16 v[174:175], v16 offset:14336
  v_mfma_f32_16x16x32_bf16 v[68:71], v[192:195], a[164:167], v[68:71]
  s_add_u32 m0, s37, 65536
  ds_read_b64_tr_b16 v[176:177], v17 offset:8192
  v_mfma_f32_16x16x32_bf16 v[68:71], v[196:199], a[172:175], v[68:71]
  s_mov_b32 s84, 1048576
  ds_read_b64_tr_b16 v[178:179], v17 offset:10240
  v_mfma_f32_16x16x32_bf16 v[64:67], v[196:199], a[168:171], v[64:67]
  ds_read_b64_tr_b16 v[180:181], v17 offset:12288
  buffer_load_dwordx4 v88, s[20:23], s84 offen offset:0 lds
  v_mfma_f32_16x16x32_bf16 v[64:67], v[192:195], a[160:163], v[64:67]
  s_waitcnt lgkmcnt(3)
  ds_read_b64_tr_b16 v[182:183], v17 offset:14336
  v_mfma_f32_16x16x32_bf16 v[40:43], v[168:171], a[176:179], v[40:43]
  ds_read_b64_tr_b16 v[184:185], v18 offset:8192
  v_mfma_f32_16x16x32_bf16 v[40:43], v[172:175], a[184:187], v[40:43]
  ds_read_b64_tr_b16 v[186:187], v18 offset:10240
  buffer_load_dwordx4 v89, s[20:23], s84 offen offset:1024 lds
  v_mfma_f32_16x16x32_bf16 v[44:47], v[172:175], a[188:191], v[44:47]
  ds_read_b64_tr_b16 v[188:189], v18 offset:12288
  v_mfma_f32_16x16x32_bf16 v[44:47], v[168:171], a[180:183], v[44:47]
  s_waitcnt lgkmcnt(3)
  ds_read_b64_tr_b16 v[190:191], v18 offset:14336
  v_mfma_f32_16x16x32_bf16 v[52:55], v[176:179], a[180:183], v[52:55]
  ds_read_b64_tr_b16 v[192:193], v19 offset:8192
  v_mfma_f32_16x16x32_bf16 v[52:55], v[180:183], a[188:191], v[52:55]
  ds_read_b64_tr_b16 v[194:195], v19 offset:10240
  buffer_load_dwordx4 v90, s[20:23], s84 offen offset:2048 lds
  v_mfma_f32_16x16x32_bf16 v[48:51], v[180:183], a[184:187], v[48:51]
  ds_read_b64_tr_b16 v[196:197], v19 offset:12288
  v_mfma_f32_16x16x32_bf16 v[48:51], v[176:179], a[176:179], v[48:51]
  s_waitcnt vmcnt(11) lgkmcnt(3)
  ds_read_b64_tr_b16 v[198:199], v19 offset:14336
  v_mfma_f32_16x16x32_bf16 v[56:59], v[184:187], a[176:179], v[56:59]
  s_barrier
  ds_read_b64_tr_b16 v[168:169], v16 offset:16384
  v_mfma_f32_16x16x32_bf16 v[56:59], v[188:191], a[184:187], v[56:59]
  ds_read_b64_tr_b16 v[170:171], v16 offset:18432
  buffer_load_dwordx4 v91, s[20:23], s84 offen offset:3072 lds
  v_mfma_f32_16x16x32_bf16 v[60:63], v[188:191], a[188:191], v[60:63]
  ds_read_b64_tr_b16 v[172:173], v16 offset:20480
  v_mfma_f32_16x16x32_bf16 v[60:63], v[184:187], a[180:183], v[60:63]
  s_waitcnt lgkmcnt(3)
  ds_read_b64_tr_b16 v[174:175], v16 offset:22528
  v_mfma_f32_16x16x32_bf16 v[68:71], v[192:195], a[180:183], v[68:71]
  ds_read_b64_tr_b16 v[176:177], v17 offset:16384
  v_mfma_f32_16x16x32_bf16 v[68:71], v[196:199], a[188:191], v[68:71]
  ds_read_b64_tr_b16 v[178:179], v17 offset:18432
  v_mfma_f32_16x16x32_bf16 v[64:67], v[196:199], a[184:187], v[64:67]
  ds_read_b64_tr_b16 v[180:181], v17 offset:20480
  v_mfma_f32_16x16x32_bf16 v[64:67], v[192:195], a[176:179], v[64:67]
  s_waitcnt lgkmcnt(3)
  ds_read_b64_tr_b16 v[182:183], v17 offset:22528
  v_mfma_f32_16x16x32_bf16 v[40:43], v[168:171], a[192:195], v[40:43]
  ds_read_b64_tr_b16 v[184:185], v18 offset:16384
  global_load_dwordx2 v[254:255], v253, s[4:5] sc1
  v_mfma_f32_16x16x32_bf16 v[40:43], v[172:175], a[200:203], v[40:43]
  s_add_u32 m0, s37, 81920
  ds_read_b64_tr_b16 v[186:187], v18 offset:18432
  v_mfma_f32_16x16x32_bf16 v[44:47], v[172:175], a[204:207], v[44:47]
  s_mov_b32 s84, 1310720
  ds_read_b64_tr_b16 v[188:189], v18 offset:20480
  buffer_load_dwordx4 v88, s[20:23], s84 offen offset:0 lds
  v_mfma_f32_16x16x32_bf16 v[44:47], v[168:171], a[196:199], v[44:47]
  s_waitcnt lgkmcnt(3)
  ds_read_b64_tr_b16 v[190:191], v18 offset:22528
  v_mfma_f32_16x16x32_bf16 v[52:55], v[176:179], a[196:199], v[52:55]
  ds_read_b64_tr_b16 v[192:193], v19 offset:16384
  buffer_load_dwordx4 v89, s[20:23], s84 offen offset:1024 lds
  v_mfma_f32_16x16x32_bf16 v[52:55], v[180:183], a[204:207], v[52:55]
  ds_read_b64_tr_b16 v[194:195], v19 offset:18432
  v_mfma_f32_16x16x32_bf16 v[48:51], v[180:183], a[200:203], v[48:51]
  ds_read_b64_tr_b16 v[196:197], v19 offset:20480
  v_mfma_f32_16x16x32_bf16 v[48:51], v[176:179], a[192:195], v[48:51]
  s_waitcnt lgkmcnt(3)
  ds_read_b64_tr_b16 v[198:199], v19 offset:22528
  v_mfma_f32_16x16x32_bf16 v[56:59], v[184:187], a[192:195], v[56:59]
  ds_read_b64_tr_b16 v[168:169], v16 offset:24576
  buffer_load_dwordx4 v90, s[20:23], s84 offen offset:2048 lds
  v_mfma_f32_16x16x32_bf16 v[56:59], v[188:191], a[200:203], v[56:59]
  ds_read_b64_tr_b16 v[170:171], v16 offset:26624
  v_mfma_f32_16x16x32_bf16 v[60:63], v[188:191], a[204:207], v[60:63]
  ds_read_b64_tr_b16 v[172:173], v16 offset:28672
  v_mfma_f32_16x16x32_bf16 v[60:63], v[184:187], a[196:199], v[60:63]
  s_waitcnt lgkmcnt(3)
  ds_read_b64_tr_b16 v[174:175], v16 offset:30720
  buffer_load_dwordx4 v91, s[20:23], s84 offen offset:3072 lds
  v_mfma_f32_16x16x32_bf16 v[68:71], v[192:195], a[196:199], v[68:71]
  ds_read_b64_tr_b16 v[176:177], v17 offset:24576
  v_mfma_f32_16x16x32_bf16 v[68:71], v[196:199], a[204:207], v[68:71]
  ds_read_b64_tr_b16 v[178:179], v17 offset:26624
  v_mfma_f32_16x16x32_bf16 v[64:67], v[196:199], a[200:203], v[64:67]
  ds_read_b64_tr_b16 v[180:181], v17 offset:28672
  v_mfma_f32_16x16x32_bf16 v[64:67], v[192:195], a[192:195], v[64:67]
  s_waitcnt lgkmcnt(3)
  ds_read_b64_tr_b16 v[182:183], v17 offset:30720
  v_mfma_f32_16x16x32_bf16 v[40:43], v[168:171], a[208:211], v[40:43]
  ds_read_b64_tr_b16 v[184:185], v18 offset:24576
  v_mfma_f32_16x16x32_bf16 v[40:43], v[172:175], a[216:219], v[40:43]
  ds_read_b64_tr_b16 v[186:187], v18 offset:26624
  v_mfma_f32_16x16x32_bf16 v[44:47], v[172:175], a[220:223], v[44:47]
  ds_read_b64_tr_b16 v[188:189], v18 offset:28672
  v_mfma_f32_16x16x32_bf16 v[44:47], v[168:171], a[212:215], v[44:47]
  s_waitcnt lgkmcnt(3)
  ds_read_b64_tr_b16 v[190:191], v18 offset:30720
  v_mfma_f32_16x16x32_bf16 v[52:55], v[176:179], a[212:215], v[52:55]
  ds_read_b64_tr_b16 v[192:193], v19 offset:24576
  v_mfma_f32_16x16x32_bf16 v[52:55], v[180:183], a[220:223], v[52:55]
  ds_read_b64_tr_b16 v[194:195], v19 offset:26624
  v_mfma_f32_16x16x32_bf16 v[48:51], v[180:183], a[216:219], v[48:51]
  ds_read_b64_tr_b16 v[196:197], v19 offset:28672
  v_mfma_f32_16x16x32_bf16 v[48:51], v[176:179], a[208:211], v[48:51]
  s_waitcnt vmcnt(9) lgkmcnt(3)
  ds_read_b64_tr_b16 v[198:199], v19 offset:30720
  v_mfma_f32_16x16x32_bf16 v[56:59], v[184:187], a[208:211], v[56:59]
  s_barrier
  ds_read_b64_tr_b16 v[168:169], v16 offset:32768
  v_mfma_f32_16x16x32_bf16 v[56:59], v[188:191], a[216:219], v[56:59]
  ds_read_b64_tr_b16 v[170:171], v16 offset:34816
  v_mfma_f32_16x16x32_bf16 v[60:63], v[188:191], a[220:223], v[60:63]
  ds_read_b64_tr_b16 v[172:173], v16 offset:36864
  v_mfma_f32_16x16x32_bf16 v[60:63], v[184:187], a[212:215], v[60:63]
  s_waitcnt lgkmcnt(3)
  ds_read_b64_tr_b16 v[174:175], v16 offset:38912
  v_mfma_f32_16x16x32_bf16 v[68:71], v[192:195], a[212:215], v[68:71]
  ds_read_b64_tr_b16 v[176:177], v17 offset:32768
  v_mfma_f32_16x16x32_bf16 v[68:71], v[196:199], a[220:223], v[68:71]
  ds_read_b64_tr_b16 v[178:179], v17 offset:34816
  v_mfma_f32_16x16x32_bf16 v[64:67], v[196:199], a[216:219], v[64:67]
  ds_read_b64_tr_b16 v[180:181], v17 offset:36864
  v_mfma_f32_16x16x32_bf16 v[64:67], v[192:195], a[208:211], v[64:67]
  s_waitcnt vmcnt(4) lgkmcnt(3)
  ds_read_b64_tr_b16 v[182:183], v17 offset:38912
  v_cmp_ne_u64 vcc, s[6:7], v[254:255]
  s_cbranch_vccnz L_slow_7
L_back_8:
  v_mfma_f32_16x16x32_bf16 v[40:43], v[168:171], a[224:227], v[40:43]
  ds_read_b64_tr_b16 v[184:185], v18 offset:32768
  global_load_dwordx4 v[24:27], v11, s[4:5] offset:0 sc1
  v_mfma_f32_16x16x32_bf16 v[40:43], v[172:175], a[232:235], v[40:43]
  ds_read_b64_tr_b16 v[186:187], v18 offset:34816
  v_mfma_f32_16x16x32_bf16 v[44:47], v[172:175], a[236:239], v[44:47]
  ds_read_b64_tr_b16 v[188:189], v18 offset:36864
  global_load_dwordx4 v[28:31], v11, s[4:5] offset:2048 sc1
  v_mfma_f32_16x16x32_bf16 v[44:47], v[168:171], a[228:231], v[44:47]
  s_waitcnt lgkmcnt(3)
  ds_read_b64_tr_b16 v[190:191], v18 offset:38912
  v_mfma_f32_16x16x32_bf16 v[52:55], v[176:179], a[228:231], v[52:55]
  ds_read_b64_tr_b16 v[192:193], v19 offset:32768
  v_mfma_f32_16x16x32_bf16 v[52:55], v[180:183], a[236:239], v[52:55]
  ds_read_b64_tr_b16 v[194:195], v19 offset:34816
  v_mfma_f32_16x16x32_bf16 v[48:51], v[180:183], a[232:235], v[48:51]
  ds_read_b64_tr_b16 v[196:197], v19 offset:36864
  global_load_dword v32, v101, s[4:5] offset:128 sc1
  v_mfma_f32_16x16x32_bf16 v[48:51], v[176:179], a[224:227], v[48:51]
  s_waitcnt lgkmcnt(3)
  ds_read_b64_tr_b16 v[198:199], v19 offset:38912
  v_mfma_f32_16x16x32_bf16 v[56:59], v[184:187], a[224:227], v[56:59]
  ds_read_b64_tr_b16 v[168:169], v16 offset:40960
  v_mfma_f32_16x16x32_bf16 v[56:59], v[188:191], a[232:235], v[56:59]
  ds_read_b64_tr_b16 v[170:171], v16 offset:43008
  global_load_dwordx4 a[0:3], v10, s[4:5] offset:-4096 sc1
  v_mfma_f32_16x16x32_bf16 v[60:63], v[188:191], a[236:239], v[60:63]
  ds_read_b64_tr_b16 v[172:173], v16 offset:45056
  v_mfma_f32_16x16x32_bf16 v[60:63], v[184:187], a[228:231], v[60:63]
  s_waitcnt lgkmcnt(3)
  ds_read_b64_tr_b16 v[174:175], v16 offset:47104
  v_mfma_f32_16x16x32_bf16 v[68:71], v[192:195], a[228:231], v[68:71]
  ds_read_b64_tr_b16 v[176:177], v17 offset:40960
  v_mfma_f32_16x16x32_bf16 v[68:71], v[196:199], a[236:239], v[68:71]
  ds_read_b64_tr_b16 v[178:179], v17 offset:43008
  global_load_dwordx4 a[64:67], v10, s[4:5] offset:-3072 sc1
  v_mfma_f32_16x16x32_bf16 v[64:67], v[196:199], a[232:235], v[64:67]
  ds_read_b64_tr_b16 v[180:181], v17 offset:45056
  v_mfma_f32_16x16x32_bf16 v[64:67], v[192:195], a[224:227], v[64:67]
  s_waitcnt lgkmcnt(3)
  ds_read_b64_tr_b16 v[182:183], v17 offset:47104
  v_mfma_f32_16x16x32_bf16 v[40:43], v[168:171], a[240:243], v[40:43]
  ds_read_b64_tr_b16 v[184:185], v18 offset:40960
  global_load_dwordx4 a[4:7], v10, s[4:5] offset:-2048 sc1
  v_mfma_f32_16x16x32_bf16 v[40:43], v[172:175], a[248:251], v[40:43]
  ds_read_b64_tr_b16 v[186:187], v18 offset:43008
  v_mfma_f32_16x16x32_bf16 v[44:47], v[172:175], a[252:255], v[44:47]
  ds_read_b64_tr_b16 v[188:189], v18 offset:45056
  v_mfma_f32_16x16x32_bf16 v[44:47], v[168:171], a[244:247], v[44:47]
  s_waitcnt lgkmcnt(3)
  ds_read_b64_tr_b16 v[190:191], v18 offset:47104
  v_mfma_f32_16x16x32_bf16 v[52:55], v[176:179], a[244:247], v[52:55]
  ds_read_b64_tr_b16 v[192:193], v19 offset:40960
  global_load_dwordx4 a[68:71], v10, s[4:5] offset:-1024 sc1
  v_mfma_f32_16x16x32_bf16 v[52:55], v[180:183], a[252:255], v[52:55]
  ds_read_b64_tr_b16 v[194:195], v19 offset:43008
  v_add_u32 v10, 4096, v10
  v_mfma_f32_16x16x32_bf16 v[48:51], v[180:183], a[248:251], v[48:51]
  ds_read_b64_tr_b16 v[196:197], v19 offset:45056
  v_mfma_f32_16x16x32_bf16 v[48:51], v[176:179], a[240:243], v[48:51]
  s_waitcnt lgkmcnt(3)
  ds_read_b64_tr_b16 v[198:199], v19 offset:47104
  global_load_dwordx4 a[8:11], v10, s[4:5] offset:-4096 sc1
  v_mfma_f32_16x16x32_bf16 v[56:59], v[184:187], a[240:243], v[56:59]
  v_mfma_f32_16x16x32_bf16 v[56:59], v[188:191], a[248:251], v[56:59]
  v_mfma_f32_16x16x32_bf16 v[60:63], v[188:191], a[252:255], v[60:63]
  v_mfma_f32_16x16x32_bf16 v[60:63], v[184:187], a[244:247], v[60:63]
  s_waitcnt lgkmcnt(0)
  global_load_dwordx4 a[72:75], v10, s[4:5] offset:-3072 sc1
  v_mfma_f32_16x16x32_bf16 v[68:71], v[192:195], a[244:247], v[68:71]
  v_mfma_f32_16x16x32_bf16 v[68:71], v[196:199], a[252:255], v[68:71]
  v_mfma_f32_16x16x32_bf16 v[64:67], v[196:199], a[248:251], v[64:67]
  v_mfma_f32_16x16x32_bf16 v[64:67], v[192:195], a[240:243], v[64:67]
L_qe:
  global_load_dwordx4 a[12:15], v10, s[4:5] offset:-2048 sc1
  v_cvt_pk_bf16_f32 v120, v40, v41
  v_cvt_pk_bf16_f32 v121, v42, v43
  v_cvt_pk_bf16_f32 v122, v48, v49
  v_cvt_pk_bf16_f32 v123, v50, v51
  v_cvt_pk_bf16_f32 v124, v56, v57
  v_cvt_pk_bf16_f32 v125, v58, v59
  s_nop 0
  v_cvt_pk_bf16_f32 v126, v64, v65
  v_cvt_pk_bf16_f32 v127, v66, v67
  v_cvt_pk_bf16_f32 v128, v44, v45
  v_cvt_pk_bf16_f32 v129, v46, v47
  v_cvt_pk_bf16_f32 v130, v52, v53
  global_load_dwordx4 a[76:79], v10, s[4:5] offset:-1024 sc1
  v_add_u32 v10, 4096, v10
  v_cvt_pk_bf16_f32 v131, v54, v55
  v_cvt_pk_bf16_f32 v132, v60, v61
  v_cvt_pk_bf16_f32 v133, v62, v63
  v_cvt_pk_bf16_f32 v134, v68, v69
  v_cvt_pk_bf16_f32 v135, v70, v71
  v_mfma_f32_16x16x32_bf16 v[136:139], v[104:107], v[120:123], 0
  v_mfma_f32_16x16x32_bf16 v[140:143], v[108:111], v[120:123], 0
  v_mfma_f32_16x16x32_bf16 v[144:147], v[112:115], v[124:127], 0
  v_mfma_f32_16x16x32_bf16 v[148:151], v[116:119], v[124:127], 0
  v_mfma_f32_16x16x32_bf16 v[152:155], v[104:107], v[128:131], 0
  global_load_dwordx4 a[16:19], v10, s[4:5] offset:-4096 sc1
  v_mfma_f32_16x16x32_bf16 v[156:159], v[108:111], v[128:131], 0
  v_mfma_f32_16x16x32_bf16 v[160:163], v[112:115], v[132:135], 0
  v_mfma_f32_16x16x32_bf16 v[164:167], v[116:119], v[132:135], 0
  s_barrier
  v_max3_f32 v200, v136, v137, v138
  v_min3_f32 v201, v136, v137, v138
  v_max3_f32 v200, v200, v139, v140
  v_min3_f32 v201, v201, v139, v140
  v_max3_f32 v200, v200, v141, v142
  v_min3_f32 v201, v201, v141, v142
  v_max_f32 v200, v200, v143
  global_load_dwordx4 a[80:83], v10, s[4:5] offset:-3072 sc1
  v_min_f32_e64 v201, v201, v143
  v_max3_f32 v202, v144, v145, v146
  v_min3_f32 v203, v144, v145, v146
  v_max3_f32 v202, v202, v147, v148
  v_min3_f32 v203, v203, v147, v148
  v_max3_f32 v202, v202, v149, v150
  v_min3_f32 v203, v203, v149, v150
  v_max_f32 v202, v202, v151
  v_min_f32 v203, v203, v151
  v_max3_f32 v204, v152, v153, v154
  global_load_dwordx4 a[20:23], v10, s[4:5] offset:-2048 sc1
  v_min3_f32 v205, v152, v153, v154
  v_max3_f32 v204, v204, v155, v156
  v_min3_f32 v205, v205, v155, v156
  v_max3_f32 v204, v204, v157, v158
  v_min3_f32 v205, v205, v157, v158
  v_max_f32 v204, v204, v159
  v_min_f32 v205, v205, v159
  v_max3_f32 v206, v160, v161, v162
  v_min3_f32 v207, v160, v161, v162
  v_max3_f32 v206, v206, v163, v164
  global_load_dwordx4 a[84:87], v10, s[4:5] offset:-1024 sc1
  v_add_u32 v10, 4096, v10
  v_min3_f32 v207, v207, v163, v164
  v_max3_f32 v206, v206, v165, v166
  v_min3_f32 v207, v207, v165, v166
  v_max_f32 v206, v206, v167
  v_min_f32 v207, v207, v167
  v_permlane16_swap_b32 v200, v202
  v_permlane16_swap_b32 v204, v206
  v_permlane16_swap_b32 v201, v203
  v_permlane16_swap_b32 v205, v207
  v_max_f32 v200, v200, v202
  v_max_f32 v204, v204, v206
  global_load_dwordx4 a[24:27], v10, s[4:5] offset:-4096 sc1
  v_min_f32 v201, v201, v203
  v_min_f32 v205, v205, v207
  v_permlane32_swap_b32 v200, v204
  s_nop 0
  v_permlane32_swap_b32 v201, v205
  v_max_f32 v200, v200, v204
  v_min_f32 v201, v201, v205
  v_mul_f32 v200, s49, v200
  v_mul_f32 v201, s48, v201
  v_mov_b32 v204, v200
  v_mov_b32 v205, v201
  global_load_dwordx4 a[88:91], v10, s[4:5] offset:-3072 sc1
  v_permlane32_swap_b32 v200, v204
  v_permlane32_swap_b32 v201, v205
  v_mov_b32 v202, v200
  v_mov_b32 v206, v204
  v_mov_b32 v203, v201
  v_mov_b32_e64 v207, v205
  v_permlane16_swap_b32 v200, v202
  v_permlane16_swap_b32 v204, v206
  v_permlane16_swap_b32 v201, v203
  v_permlane16_swap_b32 v205, v207
  global_load_dwordx4 a[28:31], v10, s[4:5] offset:-2048 sc1
  v_pk_fma_f32 v[216:217], v[136:137], s[48:49], v[200:201] op_sel:[0,1,1] op_sel_hi:[1,1,1]
  v_pk_fma_f32 v[218:219], v[138:139], s[48:49], v[200:201] op_sel:[0,1,1] op_sel_hi:[1,1,1]
  v_pk_fma_f32 v[220:221], v[140:141], s[48:49], v[200:201] op_sel:[0,1,1] op_sel_hi:[1,1,1]
  v_pk_fma_f32 v[222:223], v[142:143], s[48:49], v[200:201] op_sel:[0,1,1] op_sel_hi:[1,1,1]
  v_pk_fma_f32 v[136:137], v[136:137], s[48:49], v[200:201] op_sel_hi:[1,0,0]
  v_pk_fma_f32 v[138:139], v[138:139], s[48:49], v[200:201] op_sel_hi:[1,0,0]
  v_pk_fma_f32 v[140:141], v[140:141], s[48:49], v[200:201] op_sel_hi:[1,0,0]
  v_pk_fma_f32 v[142:143], v[142:143], s[48:49], v[200:201] op_sel_hi:[1,0,0]
  v_exp_f32 v216, v216
  v_exp_f32 v217, v217
  v_exp_f32_e64 v218, v218
  global_load_dwordx4 a[92:95], v10, s[4:5] offset:-1024 sc1
  v_add_u32 v10, 4096, v10
  v_exp_f32 v219, v219
  v_exp_f32 v220, v220
  v_exp_f32 v221, v221
  v_exp_f32 v222, v222
  v_exp_f32 v223, v223
  v_exp_f32 v136, v136
  v_exp_f32 v137, v137
  v_exp_f32 v138, v138
  v_exp_f32 v139, v139
  v_exp_f32 v140, v140
  global_load_dwordx4 a[32:35], v10, s[4:5] offset:-4096 sc1
  v_exp_f32 v141, v141
  v_exp_f32 v142, v142
  v_exp_f32_e64 v143, v143
  v_pk_add_f32 v[168:169], v[216:217], v[218:219]
  v_pk_add_f32 v[170:171], v[220:221], v[222:223]
  v_pk_add_f32 v[172:173], v[136:137], v[138:139]
  v_pk_add_f32 v[174:175], v[140:141], v[142:143]
  v_pk_add_f32 v[168:169], v[168:169], v[170:171]
  v_pk_add_f32 v[172:173], v[172:173], v[174:175]
  v_add_f32 v209, v168, v169
  global_load_dwordx4 a[96:99], v10, s[4:5] offset:-3072 sc1
  v_add_f32 v208, v172, v173
  v_pk_fma_f32 v[224:225], v[144:145], s[48:49], v[202:203] op_sel:[0,1,1] op_sel_hi:[1,1,1]
  v_pk_fma_f32 v[226:227], v[146:147], s[48:49], v[202:203] op_sel:[0,1,1] op_sel_hi:[1,1,1]
  v_pk_fma_f32 v[228:229], v[148:149], s[48:49], v[202:203] op_sel:[0,1,1] op_sel_hi:[1,1,1]
  v_pk_fma_f32 v[230:231], v[150:151], s[48:49], v[202:203] op_sel:[0,1,1] op_sel_hi:[1,1,1]
  v_pk_fma_f32 v[144:145], v[144:145], s[48:49], v[202:203] op_sel_hi:[1,0,0]
  v_pk_fma_f32 v[146:147], v[146:147], s[48:49], v[202:203] op_sel_hi:[1,0,0]
  v_pk_fma_f32 v[148:149], v[148:149], s[48:49], v[202:203] op_sel_hi:[1,0,0]
  v_pk_fma_f32 v[150:151], v[150:151], s[48:49], v[202:203] op_sel_hi:[1,0,0]
  v_exp_f32 v224, v224
  v_exp_f32 v225, v225
  global_load_dwordx4 a[36:39], v10, s[4:5] offset:-2048 sc1
  v_exp_f32 v226, v226
  v_exp_f32 v227, v227
  v_exp_f32 v228, v228
  v_exp_f32 v229, v229
  v_exp_f32 v230, v230
  v_exp_f32 v231, v231
  v_exp_f32 v144, v144
  v_exp_f32 v145, v145
  v_exp_f32 v146, v146
  v_exp_f32 v147, v147
  global_load_dwordx4 a[100:103], v10, s[4:5] offset:-1024 sc1
  v_add_u32 v10, 4096, v10
  v_exp_f32 v148, v148
  v_exp_f32 v149, v149
  v_exp_f32 v150, v150
  v_exp_f32 v151, v151
  v_pk_add_f32 v[176:177], v[224:225], v[226:227]
  v_pk_add_f32 v[178:179], v[228:229], v[230:231]
  v_pk_add_f32 v[180:181], v[144:145], v[146:147]
L_pad_0a_5:
  s_cbranch_execz L_ret_0a
  v_pk_add_f32 v[182:183], v[148:149], v[150:151]
  v_pk_add_f32 v[176:177], v[176:177], v[178:179]
  v_pk_add_f32 v[180:181], v[180:181], v[182:183]
  global_load_dwordx4 a[40:43], v10, s[4:5] offset:-4096 sc1
  v_add_f32 v211, v176, v177
  v_add_f32_e64 v210, v180, v181
  v_pk_fma_f32 v[232:233], v[152:153], s[48:49], v[204:205] op_sel:[0,1,1] op_sel_hi:[1,1,1]
  v_pk_fma_f32 v[234:235], v[154:155], s[48:49], v[204:205] op_sel:[0,1,1] op_sel_hi:[1,1,1]
  v_pk_fma_f32 v[236:237], v[156:157], s[48:49], v[204:205] op_sel:[0,1,1] op_sel_hi:[1,1,1]
  v_pk_fma_f32 v[238:239], v[158:159], s[48:49], v[204:205] op_sel:[0,1,1] op_sel_hi:[1,1,1]
  v_pk_fma_f32 v[152:153], v[152:153], s[48:49], v[204:205] op_sel_hi:[1,0,0]
  v_pk_fma_f32 v[154:155], v[154:155], s[48:49], v[204:205] op_sel_hi:[1,0,0]
  v_pk_fma_f32 v[156:157], v[156:157], s[48:49], v[204:205] op_sel_hi:[1,0,0]
  v_pk_fma_f32 v[158:159], v[158:159], s[48:49], v[204:205] op_sel_hi:[1,0,0]
  v_exp_f32 v232, v232
  global_load_dwordx4 a[104:107], v10, s[4:5] offset:-3072 sc1
  v_exp_f32 v233, v233
  v_exp_f32 v234, v234
  v_exp_f32 v235, v235
  v_exp_f32 v236, v236
  v_exp_f32 v237, v237
  v_exp_f32 v238, v238
  v_exp_f32 v239, v239
  v_exp_f32 v152, v152
  v_exp_f32 v153, v153
  v_exp_f32 v154, v154
  global_load_dwordx4 a[44:47], v10, s[4:5] offset:-2048 sc1
  v_exp_f32 v155, v155
  v_exp_f32 v156, v156
  v_exp_f32 v157, v157
  v_exp_f32 v158, v158
  v_exp_f32 v159, v159
  v_pk_add_f32 v[184:185], v[232:233], v[234:235]
  v_pk_add_f32 v[186:187], v[236:237], v[238:239]
  v_pk_add_f32 v[188:189], v[152:153], v[154:155]
  v_pk_add_f32 v[190:191], v[156:157], v[158:159]
  v_pk_add_f32 v[184:185], v[184:185], v[186:187]
  global_load_dwordx4 a[108:111], v10, s[4:5] offset:-1024 sc1
  v_add_u32 v10, 4096, v10
  v_pk_add_f32 v[188:189], v[188:189], v[190:191]
  v_add_f32 v213, v184, v185
  v_add_f32 v212, v188, v189
  v_pk_fma_f32 v[240:241], v[160:161], s[48:49], v[206:207] op_sel:[0,1,1] op_sel_hi:[1,1,1]
  v_pk_fma_f32 v[242:243], v[162:163], s[48:49], v[206:207] op_sel:[0,1,1] op_sel_hi:[1,1,1]
  v_pk_fma_f32 v[244:245], v[164:165], s[48:49], v[206:207] op_sel:[0,1,1] op_sel_hi:[1,1,1]
  v_pk_fma_f32 v[246:247], v[166:167], s[48:49], v[206:207] op_sel:[0,1,1] op_sel_hi:[1,1,1]
  v_pk_fma_f32 v[160:161], v[160:161], s[48:49], v[206:207] op_sel_hi:[1,0,0]
  v_pk_fma_f32 v[162:163], v[162:163], s[48:49], v[206:207] op_sel_hi:[1,0,0]
  v_pk_fma_f32 v[164:165], v[164:165], s[48:49], v[206:207] op_sel_hi:[1,0,0]
  v_pk_fma_f32 v[166:167], v[166:167], s[48:49], v[206:207] op_sel_hi:[1,0,0]
  global_load_dwordx4 a[48:51], v10, s[4:5] offset:-4096 sc1
  v_exp_f32 v240, v240
  v_exp_f32 v241, v241
  v_exp_f32 v242, v242
  v_exp_f32 v243, v243
  v_exp_f32 v244, v244
  v_exp_f32 v245, v245
  v_exp_f32 v246, v246
  v_exp_f32 v247, v247
  v_exp_f32 v160, v160
  v_exp_f32 v161, v161
  global_load_dwordx4 a[112:115], v10, s[4:5] offset:-3072 sc1
  v_exp_f32 v162, v162
  v_exp_f32 v163, v163
  v_exp_f32 v164, v164
  v_exp_f32 v165, v165
  v_exp_f32 v166, v166
  v_exp_f32 v167, v167
  v_pk_add_f32 v[192:193], v[240:241], v[242:243]
  v_pk_add_f32 v[194:195], v[244:245], v[246:247]
  v_pk_add_f32 v[196:197], v[160:161], v[162:163]
  v_pk_add_f32 v[198:199], v[164:165], v[166:167]
  global_load_dwordx4 a[52:55], v10, s[4:5] offset:-2048 sc1
  v_pk_add_f32 v[192:193], v[192:193], v[194:195]
  v_pk_add_f32 v[196:197], v[196:197], v[198:199]
  v_add_f32 v215, v192, v193
  v_add_f32 v214, v196, v197
  v_permlane16_swap_b32 v208, v210
  s_nop 0
  v_permlane16_swap_b32 v212, v214
  v_permlane16_swap_b32 v209, v211
  v_permlane16_swap_b32 v213, v215
  v_add_f32 v208, v208, v210
  v_add_f32 v212, v212, v214
  v_add_f32 v209, v209, v211
  global_load_dwordx4 a[116:119], v10, s[4:5] offset:-1024 sc1
  v_add_u32 v10, 4096, v10
  v_add_f32 v213, v213, v215
  v_permlane32_swap_b32 v208, v212
  s_nop 0
  v_permlane32_swap_b32 v209, v213
  v_add_f32 v208, v208, v212
  v_add_f32 v209, v209, v213
  v_rcp_f32 v208, v208
  v_rcp_f32 v209, v209
  v_mov_b32 v212, v208
  v_mov_b32 v213, v209
  s_nop 0
  v_permlane32_swap_b32 v208, v212
  global_load_dwordx4 a[56:59], v10, s[4:5] offset:-4096 sc1
  v_permlane32_swap_b32 v209, v213
  v_mov_b32 v210, v208
  v_mov_b32 v214, v212
  v_mov_b32 v211, v209
  v_mov_b32_e64 v215, v213
  v_permlane16_swap_b32 v208, v210
  v_permlane16_swap_b32 v212, v214
  v_permlane16_swap_b32 v209, v211
  v_permlane16_swap_b32 v213, v215
  v_pk_mul_f32 v[136:137], v[136:137], v[208:209] op_sel_hi:[1,0]
  global_load_dwordx4 a[120:123], v10, s[4:5] offset:-3072 sc1
  v_pk_mul_f32 v[138:139], v[138:139], v[208:209] op_sel_hi:[1,0]
  v_pk_mul_f32 v[140:141], v[140:141], v[208:209] op_sel_hi:[1,0]
  v_pk_mul_f32 v[142:143], v[142:143], v[208:209] op_sel_hi:[1,0]
  v_pk_mul_f32 v[216:217], v[216:217], v[208:209] op_sel:[0,1] op_sel_hi:[1,1]
  v_pk_mul_f32 v[218:219], v[218:219], v[208:209] op_sel:[0,1] op_sel_hi:[1,1]
  v_pk_mul_f32 v[220:221], v[220:221], v[208:209] op_sel:[0,1] op_sel_hi:[1,1]
  v_pk_mul_f32 v[222:223], v[222:223], v[208:209] op_sel:[0,1] op_sel_hi:[1,1]
  v_pk_mul_f32 v[144:145], v[144:145], v[210:211] op_sel_hi:[1,0]
  v_pk_mul_f32 v[146:147], v[146:147], v[210:211] op_sel_hi:[1,0]
  v_pk_mul_f32 v[148:149], v[148:149], v[210:211] op_sel_hi:[1,0]
  v_pk_mul_f32 v[150:151], v[150:151], v[210:211] op_sel_hi:[1,0]
  global_load_dwordx4 a[60:63], v10, s[4:5] offset:-2048 sc1
  v_pk_mul_f32 v[224:225], v[224:225], v[210:211] op_sel:[0,1] op_sel_hi:[1,1]
  v_pk_mul_f32 v[226:227], v[226:227], v[210:211] op_sel:[0,1] op_sel_hi:[1,1]
  v_pk_mul_f32 v[228:229], v[228:229], v[210:211] op_sel:[0,1] op_sel_hi:[1,1]
  v_pk_mul_f32 v[230:231], v[230:231], v[210:211] op_sel:[0,1] op_sel_hi:[1,1]
  v_pk_mul_f32 v[152:153], v[152:153], v[212:213] op_sel_hi:[1,0]
  v_pk_mul_f32 v[154:155], v[154:155], v[212:213] op_sel_hi:[1,0]
  v_pk_mul_f32 v[156:157], v[156:157], v[212:213] op_sel_hi:[1,0]
  v_pk_mul_f32 v[158:159], v[158:159], v[212:213] op_sel_hi:[1,0]
  v_pk_mul_f32 v[232:233], v[232:233], v[212:213] op_sel:[0,1] op_sel_hi:[1,1]
  v_pk_mul_f32 v[234:235], v[234:235], v[212:213] op_sel:[0,1] op_sel_hi:[1,1]
  global_load_dwordx4 a[124:127], v10, s[4:5] offset:-1024 sc1
  v_add_u32 v10, 4096, v10
  v_pk_mul_f32 v[236:237], v[236:237], v[212:213] op_sel:[0,1] op_sel_hi:[1,1]
  v_pk_mul_f32 v[238:239], v[238:239], v[212:213] op_sel:[0,1] op_sel_hi:[1,1]
  v_pk_mul_f32 v[160:161], v[160:161], v[214:215] op_sel_hi:[1,0]
  v_pk_mul_f32 v[162:163], v[162:163], v[214:215] op_sel_hi:[1,0]
  v_pk_mul_f32 v[164:165], v[164:165], v[214:215] op_sel_hi:[1,0]
  v_pk_mul_f32 v[166:167], v[166:167], v[214:215] op_sel_hi:[1,0]
  v_pk_mul_f32 v[240:241], v[240:241], v[214:215] op_sel:[0,1] op_sel_hi:[1,1]
  v_pk_mul_f32 v[242:243], v[242:243], v[214:215] op_sel:[0,1] op_sel_hi:[1,1]
  v_pk_mul_f32 v[244:245], v[244:245], v[214:215] op_sel:[0,1] op_sel_hi:[1,1]
  v_pk_mul_f32 v[246:247], v[246:247], v[214:215] op_sel:[0,1] op_sel_hi:[1,1]
  s_waitcnt vmcnt(32)
  v_pk_add_f32 v[24:25], v[24:25], v[28:29]
  v_pk_add_f32 v[26:27], v[26:27], v[30:31]
  s_waitcnt vmcnt(30)
  v_mfma_f32_16x16x32_bf16 v[40:43], v[76:79], a[0:3], 0
  v_add_f32_dpp v24, v24, v24 row_ror:8 row_mask:0xf bank_mask:0xf
  v_add_f32_dpp v25, v25, v25 row_ror:8 row_mask:0xf bank_mask:0xf
  v_mfma_f32_16x16x32_bf16 v[44:47], v[76:79], a[64:67], 0
  s_waitcnt vmcnt(28)
  v_add_f32_dpp v26, v26, v26 row_ror:8 row_mask:0xf bank_mask:0xf
  v_add_f32_dpp v27, v27, v27 row_ror:8 row_mask:0xf bank_mask:0xf
  v_mfma_f32_16x16x32_bf16 v[48:51], v[74:77], a[2:5], 0
  s_lshl_b32 s101, s26, 2
  s_add_u32 s101, s101, s24
  s_mul_i32 s101, s101, 512
  s_add_u32 s101, s101, L_p2-L_pc
  v_min_u32 v13, 3, v1
  v_lshl_add_u32 v13, v13, 7, s101
  v_min_u32 v13, L_end-L_pc, v13
  global_load_dword v0, v13, s[78:79]
  v_cvt_pk_bf16_f32 v33, v32, v32
  v_mfma_f32_16x16x32_bf16 v[52:55], v[74:77], a[66:69], 0
  s_waitcnt vmcnt(27)
  v_lshlrev_b32 v34, 16, v33
  v_mfma_f32_16x16x32_bf16 v[40:43], v[74:77], a[6:9], v[40:43]
  v_permlane16_swap_b32 v24, v25
  v_mfma_f32_16x16x32_bf16 v[44:47], v[74:77], a[70:73], v[44:47]
  s_waitcnt vmcnt(25)
  v_permlane16_swap_b32 v26, v27
  v_mfma_f32_16x16x32_bf16 v[48:51], v[74:77], a[10:13], v[48:51]
  buffer_load_dwordx4 v[104:107], v96, s[16:19], s36 offen offset:0 sc1
  v_add_f32 v24, v24, v25
  v_mfma_f32_16x16x32_bf16 v[52:55], v[74:77], a[74:77], v[52:55]
  s_waitcnt vmcnt(24)
  v_add_f32 v26, v26, v27
  v_sub_f32 v34, v32, v34
  v_mfma_f32_16x16x32_bf16 v[40:43], v[74:77], a[14:17], v[40:43]
  v_cvt_pk_bf16_f32 v34, v34, v34
  v_mfma_f32_16x16x32_bf16 v[44:47], v[74:77], a[78:81], v[44:47]
  s_waitcnt vmcnt(22)
  v_permlane32_swap_b32 v24, v26
  v_mfma_f32_16x16x32_bf16 v[48:51], v[74:77], a[18:21], v[48:51]
  buffer_load_dwordx4 v[108:111], v96, s[16:19], s36 offen offset:1024 sc1
  v_add_f32 v24, v24, v26
  v_mfma_f32_16x16x32_bf16 v[52:55], v[74:77], a[82:85], v[52:55]
  s_waitcnt vmcnt(21)
  ds_write_b16 v95, v33
  v_cvt_pk_bf16_f32 v24, v24, v24
  v_mfma_f32_16x16x32_bf16 v[40:43], v[74:77], a[22:25], v[40:43]
  ds_write_b16 v95, v34 offset:64
  ds_write_b16 v14, v24
  v_mfma_f32_16x16x32_bf16 v[44:47], v[74:77], a[86:89], v[44:47]
  s_waitcnt vmcnt(19)
  v_cvt_pk_bf16_f32 v168, v136, v137
  v_cvt_pk_bf16_f32 v169, v138, v139
  v_mfma_f32_16x16x32_bf16 v[48:51], v[74:77], a[26:29], v[48:51]
  buffer_load_dwordx4 v[112:115], v97, s[16:19], s36 offen offset:0 sc1
  v_cvt_pk_bf16_f32 v170, v140, v141
  v_mfma_f32_16x16x32_bf16 v[52:55], v[74:77], a[90:93], v[52:55]
  s_waitcnt vmcnt(18)
  v_cvt_pk_bf16_f32 v171, v142, v143
  v_cvt_pk_bf16_f32 v172, v216, v217
  v_mfma_f32_16x16x32_bf16 v[40:43], v[74:77], a[30:33], v[40:43]
  v_cvt_pk_bf16_f32 v173, v218, v219
  v_cvt_pk_bf16_f32 v174, v220, v221
  v_mfma_f32_16x16x32_bf16 v[44:47], v[74:77], a[94:97], v[44:47]
  s_waitcnt vmcnt(16)
  v_cvt_pk_bf16_f32 v175, v222, v223
  v_cvt_pk_bf16_f32 v176, v144, v145
  v_mfma_f32_16x16x32_bf16 v[48:51], v[74:77], a[34:37], v[48:51]
  buffer_load_dwordx4 v[116:119], v97, s[16:19], s36 offen offset:1024 sc1
  v_cvt_pk_bf16_f32 v177, v146, v147
  v_mfma_f32_16x16x32_bf16 v[52:55], v[74:77], a[98:101], v[52:55]
  s_waitcnt vmcnt(15)
  v_cvt_pk_bf16_f32 v178, v148, v149
  v_cvt_pk_bf16_f32 v179, v150, v151
  v_mfma_f32_16x16x32_bf16 v[40:43], v[74:77], a[38:41], v[40:43]
  v_cvt_pk_bf16_f32 v180, v224, v225
  v_cvt_pk_bf16_f32 v181, v226, v227
  v_mfma_f32_16x16x32_bf16 v[44:47], v[74:77], a[102:105], v[44:47]
  s_waitcnt vmcnt(13)
  v_cvt_pk_bf16_f32 v182, v228, v229
  v_cvt_pk_bf16_f32 v183, v230, v231
  v_mfma_f32_16x16x32_bf16 v[48:51], v[74:77], a[42:45], v[48:51]
  global_load_dwordx2 v[248:249], v98, s[4:5] offset:0 sc1
  v_cvt_pk_bf16_f32 v184, v152, v153
  v_mfma_f32_16x16x32_bf16 v[52:55], v[74:77], a[106:109], v[52:55]
  s_waitcnt vmcnt(12)
  v_cvt_pk_bf16_f32 v185, v154, v155
  v_cvt_pk_bf16_f32 v186, v156, v157
  v_mfma_f32_16x16x32_bf16 v[40:43], v[74:77], a[46:49], v[40:43]
  v_cvt_pk_bf16_f32 v187, v158, v159
  v_cvt_pk_bf16_f32 v188, v232, v233
  v_mfma_f32_16x16x32_bf16 v[44:47], v[74:77], a[110:113], v[44:47]
  s_waitcnt vmcnt(10)
  v_cvt_pk_bf16_f32 v189, v234, v235
  v_cvt_pk_bf16_f32 v190, v236, v237
  v_mfma_f32_16x16x32_bf16 v[48:51], v[74:77], a[50:53], v[48:51]
  global_load_dwordx2 v[250:251], v98, s[4:5] offset:1024 sc1
  v_cvt_pk_bf16_f32 v191, v238, v239
  v_mfma_f32_16x16x32_bf16 v[52:55], v[74:77], a[114:117], v[52:55]
  s_waitcnt vmcnt(9)
  v_cvt_pk_bf16_f32 v192, v160, v161
  v_cvt_pk_bf16_f32 v193, v162, v163
  v_mfma_f32_16x16x32_bf16 v[40:43], v[74:77], a[54:57], v[40:43]
  v_cvt_pk_bf16_f32 v194, v164, v165
  v_cvt_pk_bf16_f32 v195, v166, v167
  v_mfma_f32_16x16x32_bf16 v[44:47], v[74:77], a[118:121], v[44:47]
  s_waitcnt vmcnt(7)
  v_cvt_pk_bf16_f32 v196, v240, v241
  v_cvt_pk_bf16_f32 v197, v242, v243
  v_mfma_f32_16x16x32_bf16 v[48:51], v[74:77], a[58:61], v[48:51]
  s_add_u32 m0, s37, 0
  s_mov_b32 s84, 0
  buffer_load_dwordx4 v88, s[20:23], s84 offen offset:0 lds
  v_cvt_pk_bf16_f32 v198, v244, v245
  v_mfma_f32_16x16x32_bf16 v[52:55], v[74:77], a[122:125], v[52:55]
  s_waitcnt vmcnt(8)
  v_cvt_pk_bf16_f32 v199, v246, v247
  v_mfma_f32_16x16x32_bf16 v[40:43], v[72:75], a[60:63], v[40:43]
  v_mfma_f32_16x16x32_bf16 v[44:47], v[72:75], a[124:127], v[44:47]
  v_cvt_pk_bf16_f32 v58, v48, v49
  v_cvt_pk_bf16_f32 v59, v50, v51
  s_nop 4
  v_cvt_pk_bf16_f32 v56, v40, v41
  v_cvt_pk_bf16_f32 v57, v42, v43
  ds_write_b128 v92, v[56:59] offset:0
  v_cvt_pk_bf16_f32 v62, v52, v53
  v_cvt_pk_bf16_f32 v63, v54, v55
  v_cvt_pk_bf16_f32 v60, v44, v45
  v_cvt_pk_bf16_f32 v61, v46, v47
  ds_write_b128 v92, v[60:63] offset:1024
  buffer_load_dwordx4 v89, s[20:23], s84 offen offset:1024 lds
  buffer_load_dwordx4 v90, s[20:23], s84 offen offset:2048 lds
  buffer_load_dwordx4 v91, s[20:23], s84 offen offset:3072 lds
  s_waitcnt lgkmcnt(0)
  s_barrier
  ds_read_b128 v[208:211], v15 offset:0
  ds_read_b128 v[220:223], v15 offset:64
  ds_read_b128 v[232:235], v15 offset:128
  ds_read_b128 v[244:247], v15 offset:192
  ds_read_b128 v[200:203], v93 offset:0
  ds_read_b128 v[204:207], v93 offset:1024
  s_add_u32 s16, s4, 0x880000
  s_addc_u32 s17, s5, 0
  s_mov_b32 s18, 0x400400
  s_mov_b32 s19, 0x00020000
  s_waitcnt lgkmcnt(4)
  v_mfma_f32_16x16x32_bf16 v[48:51], v[208:211], v[168:171], 0
  ds_read_b128 v[212:215], v93 offset:2048
  v_mfma_f32_16x16x32_bf16 v[48:51], v[220:223], v[172:175], v[48:51]
  ds_read_b128 v[216:219], v93 offset:3072
  v_mfma_f32_16x16x32_bf16 v[72:75], v[208:211], v[184:187], 0
  ds_read_b128 v[224:227], v93 offset:4096
  v_mfma_f32_16x16x32_bf16 v[72:75], v[220:223], v[188:191], v[72:75]
  ds_read_b128 v[228:231], v93 offset:5120
  s_waitcnt lgkmcnt(6)
  v_mfma_f32_16x16x32_bf16 v[60:63], v[232:235], v[176:179], 0
  ds_read_b128 v[236:239], v93 offset:6144
  v_mfma_f32_16x16x32_bf16 v[60:63], v[244:247], v[180:183], v[60:63]
  ds_read_b128 v[240:243], v93 offset:7168
  v_mfma_f32_16x16x32_bf16 v[84:87], v[232:235], v[192:195], 0
  ds_read_b128 v[32:35], v12 offset:0
  v_mfma_f32_16x16x32_bf16 v[84:87], v[244:247], v[196:199], v[84:87]
  ds_read_b128 v[36:39], v12 offset:128
  s_waitcnt lgkmcnt(6)
  v_mfma_f32_16x16x32_bf16 v[40:43], v[200:203], v[168:171], 0
  v_mfma_f32_16x16x32_bf16 v[40:43], v[212:215], v[172:175], v[40:43]
  v_add_f32 v48, 0x358637bd, v48
  v_add_f32 v72, 0x358637bd, v72
  v_mfma_f32_16x16x32_bf16 v[44:47], v[204:207], v[168:171], 0
  v_rcp_f32 v48, v48
  v_mfma_f32_16x16x32_bf16 v[44:47], v[216:219], v[172:175], v[44:47]
  v_rcp_f32 v72, v72
  v_mfma_f32_16x16x32_bf16 v[64:67], v[200:203], v[184:187], 0
  v_add_f32 v60, 0x358637bd, v60
  v_add_f32 v84, 0x358637bd, v84
  v_mfma_f32_16x16x32_bf16 v[64:67], v[212:215], v[188:191], v[64:67]
  v_rcp_f32_e64 v60, v60
  v_mfma_f32_16x16x32_bf16 v[68:71], v[204:207], v[184:187], 0
  v_rcp_f32 v84, v84
  v_mfma_f32_16x16x32_bf16 v[68:71], v[216:219], v[188:191], v[68:71]
  v_mul_f32 v40, v48, v40
  v_mul_f32 v41, v48, v41
  s_waitcnt lgkmcnt(2)
  v_mfma_f32_16x16x32_bf16 v[52:55], v[224:227], v[176:179], 0
  v_mul_f32 v42, v48, v42
  v_mul_f32 v43, v48, v43
  v_mfma_f32_16x16x32_bf16 v[52:55], v[236:239], v[180:183], v[52:55]
  v_mul_f32 v44, v48, v44
  v_mul_f32 v45, v48, v45
  v_mfma_f32_16x16x32_bf16 v[56:59], v[228:231], v[176:179], 0
  v_mul_f32 v46, v48, v46
  v_mul_f32 v47, v48, v47
  v_mfma_f32_16x16x32_bf16 v[56:59], v[240:243], v[180:183], v[56:59]
  v_cvt_pk_bf16_f32 v120, v40, v41
  v_cvt_pk_bf16_f32 v121, v42, v43
  v_mfma_f32_16x16x32_bf16 v[76:79], v[224:227], v[192:195], 0
  v_cvt_pk_bf16_f32 v122, v44, v45
  v_cvt_pk_bf16_f32 v123, v46, v47
  v_mfma_f32_16x16x32_bf16 v[76:79], v[236:239], v[196:199], v[76:79]
  buffer_store_dwordx4 v[120:123], v8, s[16:19], s85 offen offset:0 sc1
  v_mul_f32 v64, v72, v64
  v_mfma_f32_16x16x32_bf16 v[80:83], v[228:231], v[192:195], 0
  v_mul_f32 v65, v72, v65
  v_mul_f32 v66, v72, v66
  v_mfma_f32_16x16x32_bf16 v[80:83], v[240:243], v[196:199], v[80:83]
  v_mul_f32 v67, v72, v67
  v_mul_f32 v68, v72, v68
  v_mul_f32 v69, v72, v69
  v_mul_f32 v70, v72, v70
  v_mul_f32 v71, v72, v71
  v_cvt_pk_bf16_f32 v128, v64, v65
  v_cvt_pk_bf16_f32 v129, v66, v67
  v_cvt_pk_bf16_f32 v130, v68, v69
  v_cvt_pk_bf16_f32 v131, v70, v71
  buffer_store_dwordx4 v[128:131], v9, s[16:19], s85 offen offset:0 sc1
  s_waitcnt lgkmcnt(0)
  v_pk_mul_f32 v[52:53], v[52:53], v[60:61] op_sel_hi:[1,0]
  v_pk_mul_f32 v[54:55], v[54:55], v[60:61] op_sel_hi:[1,0]
  v_pk_mul_f32 v[56:57], v[56:57], v[60:61] op_sel_hi:[1,0]
  v_pk_mul_f32 v[58:59], v[58:59], v[60:61] op_sel_hi:[1,0]
  v_pk_mul_f32 v[76:77], v[76:77], v[84:85] op_sel_hi:[1,0]
  v_pk_mul_f32 v[78:79], v[78:79], v[84:85] op_sel_hi:[1,0]
  v_pk_mul_f32 v[80:81], v[80:81], v[84:85] op_sel_hi:[1,0]
  v_pk_mul_f32 v[82:83], v[82:83], v[84:85] op_sel_hi:[1,0]
  v_mfma_f32_16x16x32_bf16 v[136:139], v[32:35], v[120:123], 0
  v_cvt_pk_bf16_f32 v124, v52, v53
  v_cvt_pk_bf16_f32 v125, v54, v55
  v_mfma_f32_16x16x32_bf16 v[140:143], v[32:35], v[128:131], 0
  v_cvt_pk_bf16_f32 v126, v56, v57
  v_cvt_pk_bf16_f32 v127, v58, v59
  buffer_store_dwordx4 v[124:127], v8, s[16:19], s85 offen offset:1024 sc1
  v_cvt_pk_bf16_f32 v132, v76, v77
  v_cvt_pk_bf16_f32 v133, v78, v79
  v_mfma_f32_16x16x32_bf16 v[136:139], v[36:39], v[124:127], v[136:139]
  v_cvt_pk_bf16_f32 v134, v80, v81
  v_cvt_pk_bf16_f32 v135, v82, v83
  buffer_store_dwordx4 v[132:135], v9, s[16:19], s85 offen offset:1024 sc1
  s_nop 0
  v_mfma_f32_16x16x32_bf16 v[140:143], v[36:39], v[132:135], v[140:143]
  v_mov_b32 v8, v96
  v_mov_b32 v9, v97
  s_nop 0
  v_add_f32 v136, v136, v137
  s_nop 3
  v_add_f32 v137, v140, v141
  s_nop 1
  v_permlane16_swap_b32 v136, v137
  s_mov_b32 exec_hi, 0
  global_store_dword v94, v136, s[4:5] sc1
  s_mov_b64 exec, -1
L_p2:
  s_waitcnt vmcnt(9)
  s_add_u32 m0, s37, 16384
  s_mov_b32 s84, 262144
  buffer_load_dwordx4 v88, s[20:23], s84 offen offset:0 lds
  s_mov_b32 s35, 0xffff0000
  v_lshlrev_b32 v40, 16, v104
  v_and_b32 v41, s35, v104
  v_lshlrev_b32 v42, 16, v105
  v_and_b32 v43, s35, v105
  v_pk_mul_f32 v[40:41], v[40:41], v[248:249] op_sel:[0,1] op_sel_hi:[1,1]
  v_pk_mul_f32 v[42:43], v[42:43], v[248:249] op_sel:[0,1] op_sel_hi:[1,1]
  v_lshlrev_b32 v48, 16, v106
  buffer_load_dwordx4 v89, s[20:23], s84 offen offset:1024 lds
  v_and_b32 v49, s35, v106
  v_lshlrev_b32 v50, 16, v107
  v_and_b32 v51, s35, v107
  v_pk_mul_f32 v[48:49], v[48:49], v[248:249] op_sel:[0,1] op_sel_hi:[1,1]
  v_pk_mul_f32 v[50:51], v[50:51], v[248:249] op_sel:[0,1] op_sel_hi:[1,1]
  v_lshlrev_b32 v56, 16, v108
  v_and_b32 v57, s35, v108
  buffer_load_dwordx4 v90, s[20:23], s84 offen offset:2048 lds
  v_lshlrev_b32 v58, 16, v109
  v_and_b32_e64 v59, s35, v109
  v_pk_mul_f32 v[56:57], v[56:57], v[248:249] op_sel:[0,1] op_sel_hi:[1,1]
  v_pk_mul_f32 v[58:59], v[58:59], v[248:249] op_sel:[0,1] op_sel_hi:[1,1]
  v_lshlrev_b32 v64, 16, v110
  v_and_b32 v65, s35, v110
  v_lshlrev_b32 v66, 16, v111
  buffer_load_dwordx4 v91, s[20:23], s84 offen offset:3072 lds
  v_and_b32 v67, s35, v111
  v_pk_mul_f32 v[64:65], v[64:65], v[248:249] op_sel:[0,1] op_sel_hi:[1,1]
  v_pk_mul_f32 v[66:67], v[66:67], v[248:249] op_sel:[0,1] op_sel_hi:[1,1]
  v_lshlrev_b32 v44, 16, v112
  v_and_b32 v45, s35, v112
  v_lshlrev_b32 v46, 16, v113
  v_and_b32 v47, s35, v113
  s_add_u32 m0, s37, 32768
  s_mov_b32 s84, 524288
  buffer_load_dwordx4 v88, s[20:23], s84 offen offset:0 lds
  v_pk_mul_f32 v[44:45], v[44:45], v[250:251] op_sel:[0,1] op_sel_hi:[1,1]
  v_pk_mul_f32 v[46:47], v[46:47], v[250:251] op_sel:[0,1] op_sel_hi:[1,1]
  v_lshlrev_b32 v52, 16, v114
  v_and_b32 v53, s35, v114
  v_lshlrev_b32 v54, 16, v115
  v_and_b32 v55, s35, v115
  v_pk_mul_f32 v[52:53], v[52:53], v[250:251] op_sel:[0,1] op_sel_hi:[1,1]
  v_pk_mul_f32 v[54:55], v[54:55], v[250:251] op_sel:[0,1] op_sel_hi:[1,1]
  buffer_load_dwordx4 v89, s[20:23], s84 offen offset:1024 lds
  v_lshlrev_b32 v60, 16, v116
  v_and_b32 v61, s35, v116
  v_lshlrev_b32 v62, 16, v117
  v_and_b32 v63, s35, v117
  v_pk_mul_f32 v[60:61], v[60:61], v[250:251] op_sel:[0,1] op_sel_hi:[1,1]
  v_pk_mul_f32 v[62:63], v[62:63], v[250:251] op_sel:[0,1] op_sel_hi:[1,1]
  v_lshlrev_b32 v68, 16, v118
  buffer_load_dwordx4 v90, s[20:23], s84 offen offset:2048 lds
  v_and_b32 v69, s35, v118
  v_lshlrev_b32 v70, 16, v119
  v_and_b32 v71, s35, v119
  v_pk_mul_f32 v[68:69], v[68:69], v[250:251] op_sel:[0,1] op_sel_hi:[1,1]
  v_pk_mul_f32 v[70:71], v[70:71], v[250:251] op_sel:[0,1] op_sel_hi:[1,1]
  s_lshl_b32 s34, s47, 10
  s_add_u32 s34, s34, 0x3b80000
  buffer_load_dwordx4 v91, s[20:23], s84 offen offset:3072 lds
  v_lshl_add_u32 v10, v1, 2, s34
  s_lshl_b32 s34, s47, 10
  s_lshl_b32 s35, s31, 7
  s_add_u32 s34, s34, s35
  s_add_u32 s34, s34, 0x3b60000
  v_lshl_add_u32 v11, v1, 2, s34
  s_lshl_b32 s85, s31, 11
  s_waitcnt vmcnt(8)
  s_barrier
  s_cmp_eq_u32 s24, 0
  s_cbranch_scc0 L_nosig_9
  v_mov_b32 v24, s6
  v_mov_b32 v25, s7
  s_mov_b32 exec_lo, 0xffff
  s_mov_b32 exec_hi, 0
  global_store_dwordx2 v99, v[24:25], s[4:5] sc1
  s_mov_b64 exec, -1
L_nosig_9:
  s_add_u32 m0, s37, 49152
  s_mov_b32 s84, 786432
  buffer_load_dwordx4 v88, s[20:23], s84 offen offset:0 lds
  buffer_load_dwordx4 v89, s[20:23], s84 offen offset:1024 lds
  buffer_load_dwordx4 v90, s[20:23], s84 offen offset:2048 lds
  buffer_load_dwordx4 v91, s[20:23], s84 offen offset:3072 lds
  s_cmp_eq_u32 s24, 1
  s_cbranch_scc0 L_nopoll_10
  s_mov_b32 s34, 0
L_poll_11:
  s_load_dwordx8 s[88:95], s[86:87], 0 glc
  s_add_u32 s34, s34, 1
  s_waitcnt lgkmcnt(0)
  s_xor_b64 s[88:89], s[88:89], s[6:7]
  s_xor_b64 s[90:91], s[90:91], s[6:7]
  s_xor_b64 s[92:93], s[92:93], s[6:7]
  s_xor_b64 s[94:95], s[94:95], s[6:7]
  s_or_b64 s[88:89], s[88:89], s[90:91]
  s_or_b64 s[92:93], s[92:93], s[94:95]
  s_or_b64 s[88:89], s[88:89], s[92:93]
  s_cbranch_scc0 L_go_12
  s_cmp_lt_u32 s34, 0x40000
  s_cbranch_scc1 L_poll_11
L_go_12:
  s_branch L_polled_13
L_nopoll_10:
  s_mov_b64 exec, 0
  s_cmp_eq_u32 s24, 0
  s_cbranch_scc1 L_pad_2b_0
  s_cmp_eq_u32 s24, 2
  s_cbranch_scc1 L_pad_2b_1
  s_branch L_pad_2b_2
L_ret_2b:
  s_mov_b64 exec, -1
L_polled_13:
  s_waitcnt vmcnt(0)
  s_barrier
L_p2l:
  s_mov_b32 s39, 0
  buffer_load_dwordx4 a[0:3], v8, s[16:19], s39 offen offset:0 sc1
  buffer_load_dwordx4 a[4:7], v9, s[16:19], s39 offen offset:0 sc1
  buffer_load_dwordx4 a[8:11], v8, s[16:19], s39 offen offset:1024 sc1
  buffer_load_dwordx4 a[12:15], v9, s[16:19], s39 offen offset:1024 sc1
  ds_read_b64_tr_b16 v[168:169], v16 offset:0
  ds_read_b64_tr_b16 v[170:171], v16 offset:2048
  ds_read_b64_tr_b16 v[172:173], v16 offset:4096
  ds_read_b64_tr_b16 v[174:175], v16 offset:6144
  ds_read_b64_tr_b16 v[176:177], v17 offset:0
  ds_read_b64_tr_b16 v[178:179], v17 offset:2048
  ds_read_b64_tr_b16 v[180:181], v17 offset:4096
  ds_read_b64_tr_b16 v[182:183], v17 offset:6144
  buffer_load_dwordx4 a[16:19], v8, s[16:19], s39 offen offset:2048 sc1
  buffer_load_dwordx4 a[20:23], v9, s[16:19], s39 offen offset:2048 sc1
  global_load_dwordx2 v[26:27], v100, s[4:5] offset:32 sc1
  buffer_load_dwordx4 a[24:27], v8, s[16:19], s39 offen offset:3072 sc1
  buffer_load_dwordx4 a[28:31], v9, s[16:19], s39 offen offset:3072 sc1
  s_mov_b32 s39, 4096
  buffer_load_dwordx4 a[32:35], v8, s[16:19], s39 offen offset:0 sc1
  buffer_load_dwordx4 a[36:39], v9, s[16:19], s39 offen offset:0 sc1
  buffer_load_dwordx4 a[40:43], v8, s[16:19], s39 offen offset:1024 sc1
  buffer_load_dwordx4 a[44:47], v9, s[16:19], s39 offen offset:1024 sc1
  s_waitcnt vmcnt(9) lgkmcnt(4)
  v_mfma_f32_16x16x32_bf16 v[40:43], v[168:171], a[0:3], v[40:43]
  s_and_b32 s10, s33, 1
  ds_read_b64_tr_b16 v[184:185], v18 offset:0
  buffer_load_dwordx4 a[48:51], v8, s[16:19], s39 offen offset:2048 sc1
  v_mfma_f32_16x16x32_bf16 v[40:43], v[172:175], a[8:11], v[40:43]
  s_lshl_b32 s34, s10, 1
  ds_read_b64_tr_b16 v[186:187], v18 offset:2048
  s_mul_i32 s35, s24, 229376
  v_mfma_f32_16x16x32_bf16 v[44:47], v[172:175], a[12:15], v[44:47]
  s_mul_i32 s36, s33, 224
  ds_read_b64_tr_b16 v[188:189], v18 offset:4096
  s_add_u32 s35, s35, s36
  v_mfma_f32_16x16x32_bf16 v[44:47], v[168:171], a[4:7], v[44:47]
  s_waitcnt lgkmcnt(3)
  ds_read_b64_tr_b16 v[190:191], v18 offset:6144
  v_mfma_f32_16x16x32_bf16 v[52:55], v[176:179], a[4:7], v[52:55]
  s_mov_b32 s36, 7168
  ds_read_b64_tr_b16 v[192:193], v19 offset:0
  buffer_load_dwordx4 a[52:55], v9, s[16:19], s39 offen offset:2048 sc1
  v_mfma_f32_16x16x32_bf16 v[52:55], v[180:183], a[12:15], v[52:55]
  s_mov_b32 s8, 4682
  ds_read_b64_tr_b16 v[194:195], v19 offset:2048
  s_mul_i32 s77, s24, 7168
  v_mfma_f32_16x16x32_bf16 v[48:51], v[180:183], a[8:11], v[48:51]
  ds_read_b64_tr_b16 v[196:197], v19 offset:4096
  v_add_u32 v32, 0, v1
  v_mfma_f32_16x16x32_bf16 v[48:51], v[176:179], a[0:3], v[48:51]
  s_waitcnt vmcnt(11) lgkmcnt(3)
  ds_read_b64_tr_b16 v[198:199], v19 offset:6144
  v_mfma_f32_16x16x32_bf16 v[56:59], v[184:187], a[0:3], v[56:59]
  ds_read_b64_tr_b16 v[168:169], v16 offset:8192
  buffer_load_dwordx4 a[56:59], v8, s[16:19], s39 offen offset:3072 sc1
  v_mfma_f32_16x16x32_bf16 v[56:59], v[188:191], a[8:11], v[56:59]
  ds_read_b64_tr_b16 v[170:171], v16 offset:10240
  v_mul_u32_u24 v33, s8, v32
  v_mfma_f32_16x16x32_bf16 v[60:63], v[188:191], a[12:15], v[60:63]
  ds_read_b64_tr_b16 v[172:173], v16 offset:12288
  v_lshrrev_b32 v33, 16, v33
  v_mfma_f32_16x16x32_bf16 v[60:63], v[184:187], a[4:7], v[60:63]
  s_waitcnt lgkmcnt(3)
  ds_read_b64_tr_b16 v[174:175], v16 offset:14336
  v_mfma_f32_16x16x32_bf16 v[68:71], v[192:195], a[4:7], v[68:71]
  ds_read_b64_tr_b16 v[176:177], v17 offset:8192
  buffer_load_dwordx4 a[60:63], v9, s[16:19], s39 offen offset:3072 sc1
  v_mfma_f32_16x16x32_bf16 v[68:71], v[196:199], a[12:15], v[68:71]
  ds_read_b64_tr_b16 v[178:179], v17 offset:10240
  v_mul_u32_u24 v34, 14, v33
  v_mfma_f32_16x16x32_bf16 v[64:67], v[196:199], a[8:11], v[64:67]
  ds_read_b64_tr_b16 v[180:181], v17 offset:12288
  v_sub_u32 v34, v32, v34
  v_mfma_f32_16x16x32_bf16 v[64:67], v[192:195], a[0:3], v[64:67]
  s_waitcnt vmcnt(8) lgkmcnt(3)
  ds_read_b64_tr_b16 v[182:183], v17 offset:14336
  v_cmp_ne_u64_e64 vcc, s[6:7], v[26:27]
  s_cbranch_vccnz L_slow_14
L_back_15:
  v_mfma_f32_16x16x32_bf16 v[40:43], v[168:171], a[16:19], v[40:43]
  s_mov_b32 s39, 8192
  ds_read_b64_tr_b16 v[184:185], v18 offset:8192
  buffer_load_dwordx4 a[64:67], v8, s[16:19], s39 offen offset:0 sc1
  v_mfma_f32_16x16x32_bf16 v[40:43], v[172:175], a[24:27], v[40:43]
  ds_read_b64_tr_b16 v[186:187], v18 offset:10240
  v_add_u32 v34, s34, v34
  v_mfma_f32_16x16x32_bf16 v[44:47], v[172:175], a[28:31], v[44:47]
  ds_read_b64_tr_b16 v[188:189], v18 offset:12288
  v_subrev_u32 v35, 14, v34
  v_mfma_f32_16x16x32_bf16 v[44:47], v[168:171], a[20:23], v[44:47]
  s_waitcnt lgkmcnt(3)
  ds_read_b64_tr_b16 v[190:191], v18 offset:14336
  v_mfma_f32_16x16x32_bf16 v[52:55], v[176:179], a[20:23], v[52:55]
  ds_read_b64_tr_b16 v[192:193], v19 offset:8192
  buffer_load_dwordx4 a[68:71], v9, s[16:19], s39 offen offset:0 sc1
  v_mfma_f32_16x16x32_bf16 v[52:55], v[180:183], a[28:31], v[52:55]
  ds_read_b64_tr_b16 v[194:195], v19 offset:10240
  v_min_u32 v34, v34, v35
  v_mfma_f32_16x16x32_bf16 v[48:51], v[180:183], a[24:27], v[48:51]
  ds_read_b64_tr_b16 v[196:197], v19 offset:12288
  v_lshlrev_b32_e64 v34, 4, v34
  v_mfma_f32_16x16x32_bf16 v[48:51], v[176:179], a[16:19], v[48:51]
  s_waitcnt vmcnt(10) lgkmcnt(3)
  ds_read_b64_tr_b16 v[198:199], v19 offset:14336
  v_mfma_f32_16x16x32_bf16 v[56:59], v[184:187], a[16:19], v[56:59]
  ds_read_b64_tr_b16 v[168:169], v16 offset:16384
  buffer_load_dwordx4 a[72:75], v8, s[16:19], s39 offen offset:1024 sc1
  v_mfma_f32_16x16x32_bf16 v[56:59], v[188:191], a[24:27], v[56:59]
  ds_read_b64_tr_b16 v[170:171], v16 offset:18432
  v_mad_u32_u24 v34, v33, s36, v34
  v_mfma_f32_16x16x32_bf16 v[60:63], v[188:191], a[28:31], v[60:63]
  ds_read_b64_tr_b16 v[172:173], v16 offset:20480
  v_add_u32 v34, s35, v34
  v_mfma_f32_16x16x32_bf16 v[60:63], v[184:187], a[20:23], v[60:63]
  s_waitcnt lgkmcnt(3)
  ds_read_b64_tr_b16 v[174:175], v16 offset:22528
  v_mfma_f32_16x16x32_bf16 v[68:71], v[192:195], a[20:23], v[68:71]
L_pad_0a_6:
  s_cbranch_execz L_ret_0a
  ds_read_b64_tr_b16 v[176:177], v17 offset:16384
  buffer_load_dwordx4 a[76:79], v9, s[16:19], s39 offen offset:1024 sc1
  v_mfma_f32_16x16x32_bf16 v[68:71], v[196:199], a[28:31], v[68:71]
  ds_read_b64_tr_b16 v[178:179], v17 offset:18432
  v_subrev_u32_e64 v4, 0, v34
  v_mfma_f32_16x16x32_bf16 v[64:67], v[196:199], a[24:27], v[64:67]
  ds_read_b64_tr_b16 v[180:181], v17 offset:20480
  v_add_u32 v32, 64, v1
  v_mfma_f32_16x16x32_bf16 v[64:67], v[192:195], a[16:19], v[64:67]
  s_waitcnt vmcnt(8) lgkmcnt(3)
  ds_read_b64_tr_b16 v[182:183], v17 offset:22528
  v_mfma_f32_16x16x32_bf16 v[40:43], v[168:171], a[32:35], v[40:43]
  ds_read_b64_tr_b16 v[184:185], v18 offset:16384
  buffer_load_dwordx4 a[80:83], v8, s[16:19], s39 offen offset:2048 sc1
  v_mfma_f32_16x16x32_bf16 v[40:43], v[172:175], a[40:43], v[40:43]
  ds_read_b64_tr_b16 v[186:187], v18 offset:18432
  v_mul_u32_u24 v33, s8, v32
  v_mfma_f32_16x16x32_bf16 v[44:47], v[172:175], a[44:47], v[44:47]
  ds_read_b64_tr_b16 v[188:189], v18 offset:20480
  v_lshrrev_b32 v33, 16, v33
  v_mfma_f32_16x16x32_bf16 v[44:47], v[168:171], a[36:39], v[44:47]
  s_waitcnt lgkmcnt(3)
  ds_read_b64_tr_b16 v[190:191], v18 offset:22528
  v_mfma_f32_16x16x32_bf16 v[52:55], v[176:179], a[36:39], v[52:55]
  ds_read_b64_tr_b16 v[192:193], v19 offset:16384
  buffer_load_dwordx4 a[84:87], v9, s[16:19], s39 offen offset:2048 sc1
  v_mfma_f32_16x16x32_bf16 v[52:55], v[180:183], a[44:47], v[52:55]
  ds_read_b64_tr_b16 v[194:195], v19 offset:18432
  global_load_dwordx2 v[26:27], v100, s[4:5] offset:64 sc1
  v_mfma_f32_16x16x32_bf16 v[48:51], v[180:183], a[40:43], v[48:51]
  ds_read_b64_tr_b16 v[196:197], v19 offset:20480
  v_mul_u32_u24 v34, 14, v33
  v_mfma_f32_16x16x32_bf16 v[48:51], v[176:179], a[32:35], v[48:51]
  s_waitcnt vmcnt(11) lgkmcnt(3)
  ds_read_b64_tr_b16 v[198:199], v19 offset:22528
  v_mfma_f32_16x16x32_bf16 v[56:59], v[184:187], a[32:35], v[56:59]
  ds_read_b64_tr_b16 v[168:169], v16 offset:24576
  buffer_load_dwordx4 a[88:91], v8, s[16:19], s39 offen offset:3072 sc1
  v_mfma_f32_16x16x32_bf16 v[56:59], v[188:191], a[40:43], v[56:59]
  ds_read_b64_tr_b16 v[170:171], v16 offset:26624
  v_sub_u32 v34, v32, v34
  v_mfma_f32_16x16x32_bf16 v[60:63], v[188:191], a[44:47], v[60:63]
  ds_read_b64_tr_b16 v[172:173], v16 offset:28672
  v_add_u32 v34, s34, v34
  v_mfma_f32_16x16x32_bf16 v[60:63], v[184:187], a[36:39], v[60:63]
  s_waitcnt lgkmcnt(3)
  ds_read_b64_tr_b16 v[174:175], v16 offset:30720
  v_mfma_f32_16x16x32_bf16 v[68:71], v[192:195], a[36:39], v[68:71]
  ds_read_b64_tr_b16 v[176:177], v17 offset:24576
  buffer_load_dwordx4 a[92:95], v9, s[16:19], s39 offen offset:3072 sc1
  v_mfma_f32_16x16x32_bf16 v[68:71], v[196:199], a[44:47], v[68:71]
  ds_read_b64_tr_b16 v[178:179], v17 offset:26624
  v_subrev_u32 v35, 14, v34
  v_mfma_f32_16x16x32_bf16 v[64:67], v[196:199], a[40:43], v[64:67]
  ds_read_b64_tr_b16 v[180:181], v17 offset:28672
  v_min_u32 v34, v34, v35
  v_mfma_f32_16x16x32_bf16 v[64:67], v[192:195], a[32:35], v[64:67]
  s_waitcnt vmcnt(9) lgkmcnt(3)
  ds_read_b64_tr_b16 v[182:183], v17 offset:30720
  v_mfma_f32_16x16x32_bf16 v[40:43], v[168:171], a[48:51], v[40:43]
  s_mov_b32 s39, 12288
  ds_read_b64_tr_b16 v[184:185], v18 offset:24576
  buffer_load_dwordx4 a[96:99], v8, s[16:19], s39 offen offset:0 sc1
  v_mfma_f32_16x16x32_bf16 v[40:43], v[172:175], a[56:59], v[40:43]
  ds_read_b64_tr_b16 v[186:187], v18 offset:26624
  v_lshlrev_b32 v34, 4, v34
  v_mfma_f32_16x16x32_bf16 v[44:47], v[172:175], a[60:63], v[44:47]
  ds_read_b64_tr_b16 v[188:189], v18 offset:28672
  v_mad_u32_u24 v34, v33, s36, v34
  v_mfma_f32_16x16x32_bf16 v[44:47], v[168:171], a[52:55], v[44:47]
  s_waitcnt lgkmcnt(3)
  ds_read_b64_tr_b16 v[190:191], v18 offset:30720
  v_mfma_f32_16x16x32_bf16 v[52:55], v[176:179], a[52:55], v[52:55]
  ds_read_b64_tr_b16 v[192:193], v19 offset:24576
  buffer_load_dwordx4 a[100:103], v9, s[16:19], s39 offen offset:0 sc1
  v_mfma_f32_16x16x32_bf16 v[52:55], v[180:183], a[60:63], v[52:55]
  ds_read_b64_tr_b16 v[194:195], v19 offset:26624
  v_add_u32 v34, s35, v34
  v_mfma_f32_16x16x32_bf16 v[48:51], v[180:183], a[56:59], v[48:51]
  ds_read_b64_tr_b16 v[196:197], v19 offset:28672
  v_subrev_u32 v5, 1024, v34
  v_mfma_f32_16x16x32_bf16 v[48:51], v[176:179], a[48:51], v[48:51]
  s_waitcnt vmcnt(11) lgkmcnt(3)
  ds_read_b64_tr_b16 v[198:199], v19 offset:30720
  v_mfma_f32_16x16x32_bf16 v[56:59], v[184:187], a[48:51], v[56:59]
  ds_read_b64_tr_b16 v[168:169], v16 offset:32768
  buffer_load_dwordx4 a[104:107], v8, s[16:19], s39 offen offset:1024 sc1
  v_mfma_f32_16x16x32_bf16 v[56:59], v[188:191], a[56:59], v[56:59]
  ds_read_b64_tr_b16 v[170:171], v16 offset:34816
  v_add_u32 v32, 128, v1
  v_mfma_f32_16x16x32_bf16 v[60:63], v[188:191], a[60:63], v[60:63]
  ds_read_b64_tr_b16 v[172:173], v16 offset:36864
  v_mul_u32_u24 v33, s8, v32
  v_mfma_f32_16x16x32_bf16 v[60:63], v[184:187], a[52:55], v[60:63]
  s_waitcnt lgkmcnt(3)
  ds_read_b64_tr_b16 v[174:175], v16 offset:38912
  v_mfma_f32_16x16x32_bf16 v[68:71], v[192:195], a[52:55], v[68:71]
  ds_read_b64_tr_b16 v[176:177], v17 offset:32768
  buffer_load_dwordx4 a[108:111], v9, s[16:19], s39 offen offset:1024 sc1
  v_mfma_f32_16x16x32_bf16 v[68:71], v[196:199], a[60:63], v[68:71]
  ds_read_b64_tr_b16 v[178:179], v17 offset:34816
  v_lshrrev_b32 v33, 16, v33
  v_mfma_f32_16x16x32_bf16 v[64:67], v[196:199], a[56:59], v[64:67]
  ds_read_b64_tr_b16 v[180:181], v17 offset:36864
  v_mul_u32_u24 v34, 14, v33
  v_mfma_f32_16x16x32_bf16 v[64:67], v[192:195], a[48:51], v[64:67]
  s_waitcnt vmcnt(9) lgkmcnt(3)
  ds_read_b64_tr_b16 v[182:183], v17 offset:38912
  v_mfma_f32_16x16x32_bf16 v[40:43], v[168:171], a[64:67], v[40:43]
  ds_read_b64_tr_b16 v[184:185], v18 offset:32768
  buffer_load_dwordx4 a[112:115], v8, s[16:19], s39 offen offset:2048 sc1
  v_mfma_f32_16x16x32_bf16 v[40:43], v[172:175], a[72:75], v[40:43]
  ds_read_b64_tr_b16 v[186:187], v18 offset:34816
  v_sub_u32 v34, v32, v34
  v_mfma_f32_16x16x32_bf16 v[44:47], v[172:175], a[76:79], v[44:47]
  ds_read_b64_tr_b16 v[188:189], v18 offset:36864
  v_add_u32 v34, s34, v34
  v_mfma_f32_16x16x32_bf16 v[44:47], v[168:171], a[68:71], v[44:47]
  s_waitcnt lgkmcnt(3)
  ds_read_b64_tr_b16 v[190:191], v18 offset:38912
  v_mfma_f32_16x16x32_bf16 v[52:55], v[176:179], a[68:71], v[52:55]
  ds_read_b64_tr_b16 v[192:193], v19 offset:32768
  buffer_load_dwordx4 a[116:119], v9, s[16:19], s39 offen offset:2048 sc1
  v_mfma_f32_16x16x32_bf16 v[52:55], v[180:183], a[76:79], v[52:55]
  ds_read_b64_tr_b16 v[194:195], v19 offset:34816
  v_subrev_u32 v35, 14, v34
  v_mfma_f32_16x16x32_bf16 v[48:51], v[180:183], a[72:75], v[48:51]
  ds_read_b64_tr_b16 v[196:197], v19 offset:36864
  v_min_u32 v34, v34, v35
  v_mfma_f32_16x16x32_bf16 v[48:51], v[176:179], a[64:67], v[48:51]
  s_waitcnt vmcnt(11) lgkmcnt(3)
  ds_read_b64_tr_b16 v[198:199], v19 offset:38912
  v_mfma_f32_16x16x32_bf16 v[56:59], v[184:187], a[64:67], v[56:59]
  ds_read_b64_tr_b16 v[168:169], v16 offset:40960
  buffer_load_dwordx4 a[120:123], v8, s[16:19], s39 offen offset:3072 sc1
  v_mfma_f32_16x16x32_bf16 v[56:59], v[188:191], a[72:75], v[56:59]
  ds_read_b64_tr_b16 v[170:171], v16 offset:43008
  v_lshlrev_b32 v34, 4, v34
  v_mfma_f32_16x16x32_bf16 v[60:63], v[188:191], a[76:79], v[60:63]
  ds_read_b64_tr_b16 v[172:173], v16 offset:45056
  v_mad_u32_u24 v34, v33, s36, v34
  v_mfma_f32_16x16x32_bf16 v[60:63], v[184:187], a[68:71], v[60:63]
  s_waitcnt lgkmcnt(3)
  ds_read_b64_tr_b16 v[174:175], v16 offset:47104
  v_mfma_f32_16x16x32_bf16 v[68:71], v[192:195], a[68:71], v[68:71]
  ds_read_b64_tr_b16 v[176:177], v17 offset:40960
  buffer_load_dwordx4 a[124:127], v9, s[16:19], s39 offen offset:3072 sc1
  v_mfma_f32_16x16x32_bf16 v[68:71], v[196:199], a[76:79], v[68:71]
  ds_read_b64_tr_b16 v[178:179], v17 offset:43008
  v_add_u32 v34, s35, v34
  v_mfma_f32_16x16x32_bf16 v[64:67], v[196:199], a[72:75], v[64:67]
  ds_read_b64_tr_b16 v[180:181], v17 offset:45056
  v_subrev_u32 v6, 2048, v34
  v_mfma_f32_16x16x32_bf16 v[64:67], v[192:195], a[64:67], v[64:67]
  s_waitcnt vmcnt(8) lgkmcnt(3)
  ds_read_b64_tr_b16 v[182:183], v17 offset:47104
  v_cmp_ne_u64 vcc, s[6:7], v[26:27]
  s_cbranch_vccnz L_slow_16
L_back_17:
  v_mfma_f32_16x16x32_bf16 v[40:43], v[168:171], a[80:83], v[40:43]
  s_mov_b32 s39, 16384
  ds_read_b64_tr_b16 v[184:185], v18 offset:40960
  buffer_load_dwordx4 a[128:131], v8, s[16:19], s39 offen offset:0 sc1
  v_mfma_f32_16x16x32_bf16 v[40:43], v[172:175], a[88:91], v[40:43]
  ds_read_b64_tr_b16 v[186:187], v18 offset:43008
  v_add_u32 v32, 192, v1
  v_mfma_f32_16x16x32_bf16 v[44:47], v[172:175], a[92:95], v[44:47]
  ds_read_b64_tr_b16 v[188:189], v18 offset:45056
  v_mul_u32_u24 v33, s8, v32
  v_mfma_f32_16x16x32_bf16 v[44:47], v[168:171], a[84:87], v[44:47]
  s_waitcnt lgkmcnt(3)
  ds_read_b64_tr_b16 v[190:191], v18 offset:47104
  v_mfma_f32_16x16x32_bf16 v[52:55], v[176:179], a[84:87], v[52:55]
  ds_read_b64_tr_b16 v[192:193], v19 offset:40960
  buffer_load_dwordx4 a[132:135], v9, s[16:19], s39 offen offset:0 sc1
  v_mfma_f32_16x16x32_bf16 v[52:55], v[180:183], a[92:95], v[52:55]
  ds_read_b64_tr_b16 v[194:195], v19 offset:43008
  v_lshrrev_b32 v33, 16, v33
  v_mfma_f32_16x16x32_bf16 v[48:51], v[180:183], a[88:91], v[48:51]
  ds_read_b64_tr_b16 v[196:197], v19 offset:45056
  v_mul_u32_u24 v34, 14, v33
  v_mfma_f32_16x16x32_bf16 v[48:51], v[176:179], a[80:83], v[48:51]
  s_waitcnt vmcnt(10) lgkmcnt(3)
  ds_read_b64_tr_b16 v[198:199], v19 offset:47104
  v_mfma_f32_16x16x32_bf16 v[56:59], v[184:187], a[80:83], v[56:59]
  ds_read_b64_tr_b16 v[168:169], v16 offset:49152
  buffer_load_dwordx4 a[136:139], v8, s[16:19], s39 offen offset:1024 sc1
  v_mfma_f32_16x16x32_bf16 v[56:59], v[188:191], a[88:91], v[56:59]
  ds_read_b64_tr_b16 v[170:171], v16 offset:51200
  v_sub_u32 v34, v32, v34
  v_mfma_f32_16x16x32_bf16 v[60:63], v[188:191], a[92:95], v[60:63]
  ds_read_b64_tr_b16 v[172:173], v16 offset:53248
  v_add_u32 v34, s34, v34
  v_mfma_f32_16x16x32_bf16 v[60:63], v[184:187], a[84:87], v[60:63]
  s_waitcnt lgkmcnt(3)
  ds_read_b64_tr_b16 v[174:175], v16 offset:55296
  v_mfma_f32_16x16x32_bf16 v[68:71], v[192:195], a[84:87], v[68:71]
  ds_read_b64_tr_b16 v[176:177], v17 offset:49152
  buffer_load_dwordx4 a[140:143], v9, s[16:19], s39 offen offset:1024 sc1
  v_mfma_f32_16x16x32_bf16 v[68:71], v[196:199], a[92:95], v[68:71]
  ds_read_b64_tr_b16 v[178:179], v17 offset:51200
  v_subrev_u32 v35, 14, v34
  v_mfma_f32_16x16x32_bf16 v[64:67], v[196:199], a[88:91], v[64:67]
  ds_read_b64_tr_b16 v[180:181], v17 offset:53248
  v_min_u32 v34, v34, v35
  v_mfma_f32_16x16x32_bf16 v[64:67], v[192:195], a[80:83], v[64:67]
  s_waitcnt vmcnt(8) lgkmcnt(3)
  ds_read_b64_tr_b16 v[182:183], v17 offset:55296
  v_mfma_f32_16x16x32_bf16 v[40:43], v[168:171], a[96:99], v[40:43]
  ds_read_b64_tr_b16 v[184:185], v18 offset:49152
  buffer_load_dwordx4 a[144:147], v8, s[16:19], s39 offen offset:2048 sc1
  v_mfma_f32_16x16x32_bf16 v[40:43], v[172:175], a[104:107], v[40:43]
  ds_read_b64_tr_b16 v[186:187], v18 offset:51200
  v_lshlrev_b32 v34, 4, v34
  v_mfma_f32_16x16x32_bf16 v[44:47], v[172:175], a[108:111], v[44:47]
  ds_read_b64_tr_b16 v[188:189], v18 offset:53248
  v_mad_u32_u24 v34, v33, s36, v34
  v_mfma_f32_16x16x32_bf16 v[44:47], v[168:171], a[100:103], v[44:47]
  s_waitcnt lgkmcnt(3)
  ds_read_b64_tr_b16 v[190:191], v18 offset:55296
  v_mfma_f32_16x16x32_bf16 v[52:55], v[176:179], a[100:103], v[52:55]
  ds_read_b64_tr_b16 v[192:193], v19 offset:49152
  buffer_load_dwordx4 a[148:151], v9, s[16:19], s39 offen offset:2048 sc1
  v_mfma_f32_16x16x32_bf16 v[52:55], v[180:183], a[108:111], v[52:55]
  ds_read_b64_tr_b16 v[194:195], v19 offset:51200
  global_load_dwordx2 v[26:27], v100, s[4:5] offset:96 sc1
  v_mfma_f32_16x16x32_bf16 v[48:51], v[180:183], a[104:107], v[48:51]
  ds_read_b64_tr_b16 v[196:197], v19 offset:53248
  v_add_u32 v34, s35, v34
  v_mfma_f32_16x16x32_bf16 v[48:51], v[176:179], a[96:99], v[48:51]
  s_waitcnt vmcnt(11) lgkmcnt(3)
  ds_read_b64_tr_b16 v[198:199], v19 offset:55296
  v_mfma_f32_16x16x32_bf16 v[56:59], v[184:187], a[96:99], v[56:59]
  ds_read_b64_tr_b16 v[168:169], v16 offset:57344
  buffer_load_dwordx4 a[152:155], v8, s[16:19], s39 offen offset:3072 sc1
  v_mfma_f32_16x16x32_bf16 v[56:59], v[188:191], a[104:107], v[56:59]
  ds_read_b64_tr_b16 v[170:171], v16 offset:59392
  v_subrev_u32 v7, 3072, v34
  v_mfma_f32_16x16x32_bf16 v[60:63], v[188:191], a[108:111], v[60:63]
  ds_read_b64_tr_b16 v[172:173], v16 offset:61440
  v_add_u32 v32, 256, v1
  v_mfma_f32_16x16x32_bf16 v[60:63], v[184:187], a[100:103], v[60:63]
  s_waitcnt lgkmcnt(3)
  ds_read_b64_tr_b16 v[174:175], v16 offset:63488
  v_mfma_f32_16x16x32_bf16 v[68:71], v[192:195], a[100:103], v[68:71]
  ds_read_b64_tr_b16 v[176:177], v17 offset:57344
  buffer_load_dwordx4 a[156:159], v9, s[16:19], s39 offen offset:3072 sc1
  v_mfma_f32_16x16x32_bf16 v[68:71], v[196:199], a[108:111], v[68:71]
  ds_read_b64_tr_b16 v[178:179], v17 offset:59392
  v_mul_u32_u24 v33, s8, v32
  v_mfma_f32_16x16x32_bf16 v[64:67], v[196:199], a[104:107], v[64:67]
  ds_read_b64_tr_b16 v[180:181], v17 offset:61440
  v_lshrrev_b32 v33, 16, v33
  v_mfma_f32_16x16x32_bf16 v[64:67], v[192:195], a[96:99], v[64:67]
  s_waitcnt vmcnt(9) lgkmcnt(3)
  ds_read_b64_tr_b16 v[182:183], v17 offset:63488
  v_mfma_f32_16x16x32_bf16 v[40:43], v[168:171], a[112:115], v[40:43]
  s_mov_b32 s39, 20480
  ds_read_b64_tr_b16 v[184:185], v18 offset:57344
  buffer_load_dwordx4 a[160:163], v8, s[16:19], s39 offen offset:0 sc1
  v_mfma_f32_16x16x32_bf16 v[40:43], v[172:175], a[120:123], v[40:43]
  ds_read_b64_tr_b16 v[186:187], v18 offset:59392
  v_mul_u32_u24 v34, 14, v33
  v_mfma_f32_16x16x32_bf16 v[44:47], v[172:175], a[124:127], v[44:47]
  ds_read_b64_tr_b16 v[188:189], v18 offset:61440
  v_sub_u32 v34, v32, v34
  v_mfma_f32_16x16x32_bf16 v[44:47], v[168:171], a[116:119], v[44:47]
  s_waitcnt lgkmcnt(3)
  ds_read_b64_tr_b16 v[190:191], v18 offset:63488
  v_mfma_f32_16x16x32_bf16 v[52:55], v[176:179], a[116:119], v[52:55]
  ds_read_b64_tr_b16 v[192:193], v19 offset:57344
  buffer_load_dwordx4 a[164:167], v9, s[16:19], s39 offen offset:0 sc1
  v_mfma_f32_16x16x32_bf16 v[52:55], v[180:183], a[124:127], v[52:55]
  ds_read_b64_tr_b16 v[194:195], v19 offset:59392
  v_add_u32 v34, s34, v34
  v_mfma_f32_16x16x32_bf16 v[48:51], v[180:183], a[120:123], v[48:51]
  ds_read_b64_tr_b16 v[196:197], v19 offset:61440
  v_subrev_u32 v35, 14, v34
  v_mfma_f32_16x16x32_bf16 v[48:51], v[176:179], a[112:115], v[48:51]
  s_waitcnt vmcnt(11) lgkmcnt(3)
  ds_read_b64_tr_b16 v[198:199], v19 offset:63488
  v_mfma_f32_16x16x32_bf16 v[56:59], v[184:187], a[112:115], v[56:59]
  ds_read_b64_tr_b16 v[168:169], v20 offset:0
  buffer_load_dwordx4 a[168:171], v8, s[16:19], s39 offen offset:1024 sc1
  v_mfma_f32_16x16x32_bf16 v[56:59], v[188:191], a[120:123], v[56:59]
  ds_read_b64_tr_b16 v[170:171], v20 offset:2048
  v_min_u32 v34, v34, v35
  v_mfma_f32_16x16x32_bf16 v[60:63], v[188:191], a[124:127], v[60:63]
  ds_read_b64_tr_b16 v[172:173], v20 offset:4096
  v_lshlrev_b32 v34, 4, v34
  v_mfma_f32_16x16x32_bf16 v[60:63], v[184:187], a[116:119], v[60:63]
  s_waitcnt lgkmcnt(3)
  ds_read_b64_tr_b16 v[174:175], v20 offset:6144
  v_mfma_f32_16x16x32_bf16 v[68:71], v[192:195], a[116:119], v[68:71]
  ds_read_b64_tr_b16 v[176:177], v21 offset:0
  buffer_load_dwordx4 a[172:175], v9, s[16:19], s39 offen offset:1024 sc1
  v_mfma_f32_16x16x32_bf16 v[68:71], v[196:199], a[124:127], v[68:71]
  ds_read_b64_tr_b16 v[178:179], v21 offset:2048
  v_mad_u32_u24 v34, v33, s36, v34
  v_mfma_f32_16x16x32_bf16 v[64:67], v[196:199], a[120:123], v[64:67]
  ds_read_b64_tr_b16 v[180:181], v21 offset:4096
  v_add_u32 v34, s35, v34
  v_mfma_f32_16x16x32_bf16 v[64:67], v[192:195], a[112:115], v[64:67]
  s_waitcnt vmcnt(9) lgkmcnt(3)
  ds_read_b64_tr_b16 v[182:183], v21 offset:6144
  v_mfma_f32_16x16x32_bf16 v[40:43], v[168:171], a[128:131], v[40:43]
  ds_read_b64_tr_b16 v[184:185], v22 offset:0
  buffer_load_dwordx4 a[176:179], v8, s[16:19], s39 offen offset:2048 sc1
  v_mfma_f32_16x16x32_bf16 v[40:43], v[172:175], a[136:139], v[40:43]
  ds_read_b64_tr_b16 v[186:187], v22 offset:2048
  v_subrev_u32 v12, 0, v34
  v_mfma_f32_16x16x32_bf16 v[44:47], v[172:175], a[140:143], v[44:47]
  ds_read_b64_tr_b16 v[188:189], v22 offset:4096
  v_add_u32 v32, 320, v1
  v_mfma_f32_16x16x32_bf16 v[44:47], v[168:171], a[132:135], v[44:47]
  s_waitcnt lgkmcnt(3)
  ds_read_b64_tr_b16 v[190:191], v22 offset:6144
  v_mfma_f32_16x16x32_bf16 v[52:55], v[176:179], a[132:135], v[52:55]
  ds_read_b64_tr_b16 v[192:193], v23 offset:0
  buffer_load_dwordx4 a[180:183], v9, s[16:19], s39 offen offset:2048 sc1
  v_mfma_f32_16x16x32_bf16 v[52:55], v[180:183], a[140:143], v[52:55]
  ds_read_b64_tr_b16 v[194:195], v23 offset:2048
  v_mul_u32_u24_e64 v33, s8, v32
  v_mfma_f32_16x16x32_bf16 v[48:51], v[180:183], a[136:139], v[48:51]
  ds_read_b64_tr_b16 v[196:197], v23 offset:4096
  v_lshrrev_b32 v33, 16, v33
  v_mfma_f32_16x16x32_bf16 v[48:51], v[176:179], a[128:131], v[48:51]
  s_waitcnt vmcnt(11) lgkmcnt(3)
  ds_read_b64_tr_b16 v[198:199], v23 offset:6144
  v_mfma_f32_16x16x32_bf16 v[56:59], v[184:187], a[128:131], v[56:59]
  ds_read_b64_tr_b16 v[168:169], v20 offset:8192
  buffer_load_dwordx4 a[184:187], v8, s[16:19], s39 offen offset:3072 sc1
  v_mfma_f32_16x16x32_bf16 v[56:59], v[188:191], a[136:139], v[56:59]
  ds_read_b64_tr_b16 v[170:171], v20 offset:10240
  v_mul_u32_u24 v34, 14, v33
  v_mfma_f32_16x16x32_bf16 v[60:63], v[188:191], a[140:143], v[60:63]
  ds_read_b64_tr_b16 v[172:173], v20 offset:12288
  v_sub_u32 v34, v32, v34
  v_mfma_f32_16x16x32_bf16 v[60:63], v[184:187], a[132:135], v[60:63]
  s_waitcnt lgkmcnt(3)
  ds_read_b64_tr_b16 v[174:175], v20 offset:14336
  v_mfma_f32_16x16x32_bf16 v[68:71], v[192:195], a[132:135], v[68:71]
  ds_read_b64_tr_b16 v[176:177], v21 offset:8192
  buffer_load_dwordx4 a[188:191], v9, s[16:19], s39 offen offset:3072 sc1
  v_mfma_f32_16x16x32_bf16 v[68:71], v[196:199], a[140:143], v[68:71]
  ds_read_b64_tr_b16 v[178:179], v21 offset:10240
  v_add_u32 v34, s34, v34
  v_mfma_f32_16x16x32_bf16 v[64:67], v[196:199], a[136:139], v[64:67]
  ds_read_b64_tr_b16 v[180:181], v21 offset:12288
  v_subrev_u32_e64 v35, 14, v34
  v_mfma_f32_16x16x32_bf16 v[64:67], v[192:195], a[128:131], v[64:67]
  s_waitcnt vmcnt(8) lgkmcnt(3)
  ds_read_b64_tr_b16 v[182:183], v21 offset:14336
  v_cmp_ne_u64_e64 vcc, s[6:7], v[26:27]
  s_cbranch_vccnz L_slow_18
L_back_19:
  v_mfma_f32_16x16x32_bf16 v[40:43], v[168:171], a[144:147], v[40:43]
  s_mov_b32 s39, 24576
  ds_read_b64_tr_b16 v[184:185], v22 offset:8192
  buffer_load_dwordx4 a[192:195], v8, s[16:19], s39 offen offset:0 sc1
  v_mfma_f32_16x16x32_bf16 v[40:43], v[172:175], a[152:155], v[40:43]
  ds_read_b64_tr_b16 v[186:187], v22 offset:10240
  v_min_u32 v34, v34, v35
  v_mfma_f32_16x16x32_bf16 v[44:47], v[172:175], a[156:159], v[44:47]
  ds_read_b64_tr_b16 v[188:189], v22 offset:12288
  v_lshlrev_b32 v34, 4, v34
  v_mfma_f32_16x16x32_bf16 v[44:47], v[168:171], a[148:151], v[44:47]
  s_waitcnt lgkmcnt(3)
  ds_read_b64_tr_b16 v[190:191], v22 offset:14336
  v_mfma_f32_16x16x32_bf16 v[52:55], v[176:179], a[148:151], v[52:55]
  ds_read_b64_tr_b16 v[192:193], v23 offset:8192
  buffer_load_dwordx4 a[196:199], v9, s[16:19], s39 offen offset:0 sc1
  v_mfma_f32_16x16x32_bf16 v[52:55], v[180:183], a[156:159], v[52:55]
  ds_read_b64_tr_b16 v[194:195], v23 offset:10240
  v_mad_u32_u24 v34, v33, s36, v34
  v_mfma_f32_16x16x32_bf16 v[48:51], v[180:183], a[152:155], v[48:51]
  ds_read_b64_tr_b16 v[196:197], v23 offset:12288
  v_add_u32 v34, s35, v34
  v_mfma_f32_16x16x32_bf16 v[48:51], v[176:179], a[144:147], v[48:51]
  s_waitcnt vmcnt(10) lgkmcnt(3)
  ds_read_b64_tr_b16 v[198:199], v23 offset:14336
  v_mfma_f32_16x16x32_bf16 v[56:59], v[184:187], a[144:147], v[56:59]
  ds_read_b64_tr_b16 v[168:169], v20 offset:16384
  buffer_load_dwordx4 a[200:203], v8, s[16:19], s39 offen offset:1024 sc1
  v_mfma_f32_16x16x32_bf16 v[56:59], v[188:191], a[152:155], v[56:59]
  ds_read_b64_tr_b16 v[170:171], v20 offset:18432
  v_subrev_u32 v13, 1024, v34
  v_mfma_f32_16x16x32_bf16 v[60:63], v[188:191], a[156:159], v[60:63]
  ds_read_b64_tr_b16 v[172:173], v20 offset:20480
  v_add_u32 v32, 384, v1
  v_mfma_f32_16x16x32_bf16 v[60:63], v[184:187], a[148:151], v[60:63]
  s_waitcnt lgkmcnt(3)
  ds_read_b64_tr_b16 v[174:175], v20 offset:22528
  v_mfma_f32_16x16x32_bf16 v[68:71], v[192:195], a[148:151], v[68:71]
  ds_read_b64_tr_b16 v[176:177], v21 offset:16384
  buffer_load_dwordx4 a[204:207], v9, s[16:19], s39 offen offset:1024 sc1
  v_mfma_f32_16x16x32_bf16 v[68:71], v[196:199], a[156:159], v[68:71]
  ds_read_b64_tr_b16 v[178:179], v21 offset:18432
  v_mul_u32_u24_e64 v33, s8, v32
  v_mfma_f32_16x16x32_bf16 v[64:67], v[196:199], a[152:155], v[64:67]
  ds_read_b64_tr_b16 v[180:181], v21 offset:20480
  v_lshrrev_b32 v33, 16, v33
  v_mfma_f32_16x16x32_bf16 v[64:67], v[192:195], a[144:147], v[64:67]
  s_waitcnt vmcnt(8) lgkmcnt(3)
  ds_read_b64_tr_b16 v[182:183], v21 offset:22528
  v_mfma_f32_16x16x32_bf16 v[40:43], v[168:171], a[160:163], v[40:43]
  ds_read_b64_tr_b16 v[184:185], v22 offset:16384
  buffer_load_dwordx4 a[208:211], v8, s[16:19], s39 offen offset:2048 sc1
  v_mfma_f32_16x16x32_bf16 v[40:43], v[172:175], a[168:171], v[40:43]
  ds_read_b64_tr_b16 v[186:187], v22 offset:18432
  v_mul_u32_u24 v34, 14, v33
  v_mfma_f32_16x16x32_bf16 v[44:47], v[172:175], a[172:175], v[44:47]
  ds_read_b64_tr_b16 v[188:189], v22 offset:20480
  v_sub_u32 v34, v32, v34
  v_mfma_f32_16x16x32_bf16 v[44:47], v[168:171], a[164:167], v[44:47]
  s_waitcnt lgkmcnt(3)
  ds_read_b64_tr_b16 v[190:191], v22 offset:22528
  v_mfma_f32_16x16x32_bf16 v[52:55], v[176:179], a[164:167], v[52:55]
  ds_read_b64_tr_b16 v[192:193], v23 offset:16384
  buffer_load_dwordx4 a[212:215], v9, s[16:19], s39 offen offset:2048 sc1
  v_mfma_f32_16x16x32_bf16 v[52:55], v[180:183], a[172:175], v[52:55]
  ds_read_b64_tr_b16 v[194:195], v23 offset:18432
  v_add_u32 v34, s34, v34
  v_mfma_f32_16x16x32_bf16 v[48:51], v[180:183], a[168:171], v[48:51]
  ds_read_b64_tr_b16 v[196:197], v23 offset:20480
  v_subrev_u32_e64 v35, 14, v34
  v_mfma_f32_16x16x32_bf16 v[48:51], v[176:179], a[160:163], v[48:51]
  s_waitcnt vmcnt(10) lgkmcnt(3)
  ds_read_b64_tr_b16 v[198:199], v23 offset:22528
  v_mfma_f32_16x16x32_bf16 v[56:59], v[184:187], a[160:163], v[56:59]
  ds_read_b64_tr_b16 v[168:169], v20 offset:24576
  buffer_load_dwordx4 a[216:219], v8, s[16:19], s39 offen offset:3072 sc1
  v_mfma_f32_16x16x32_bf16 v[56:59], v[188:191], a[168:171], v[56:59]
  ds_read_b64_tr_b16 v[170:171], v20 offset:26624
  v_min_u32 v34, v34, v35
  v_mfma_f32_16x16x32_bf16 v[60:63], v[188:191], a[172:175], v[60:63]
  ds_read_b64_tr_b16 v[172:173], v20 offset:28672
  v_lshlrev_b32 v34, 4, v34
  v_mfma_f32_16x16x32_bf16 v[60:63], v[184:187], a[164:167], v[60:63]
  s_waitcnt lgkmcnt(3)
  ds_read_b64_tr_b16 v[174:175], v20 offset:30720
  v_mfma_f32_16x16x32_bf16 v[68:71], v[192:195], a[164:167], v[68:71]
  ds_read_b64_tr_b16 v[176:177], v21 offset:24576
  buffer_load_dwordx4 a[220:223], v9, s[16:19], s39 offen offset:3072 sc1
  v_mfma_f32_16x16x32_bf16 v[68:71], v[196:199], a[172:175], v[68:71]
  ds_read_b64_tr_b16 v[178:179], v21 offset:26624
  v_mad_u32_u24 v34, v33, s36, v34
  v_mfma_f32_16x16x32_bf16 v[64:67], v[196:199], a[168:171], v[64:67]
  ds_read_b64_tr_b16 v[180:181], v21 offset:28672
  v_add_u32 v34, s35, v34
  v_mfma_f32_16x16x32_bf16 v[64:67], v[192:195], a[160:163], v[64:67]
  s_waitcnt vmcnt(8) lgkmcnt(3)
  ds_read_b64_tr_b16 v[182:183], v21 offset:30720
  v_mfma_f32_16x16x32_bf16 v[40:43], v[168:171], a[176:179], v[40:43]
  s_mov_b32 s39, 28672
  ds_read_b64_tr_b16 v[184:185], v22 offset:24576
  buffer_load_dwordx4 a[224:227], v8, s[16:19], s39 offen offset:0 sc1
  v_mfma_f32_16x16x32_bf16 v[40:43], v[172:175], a[184:187], v[40:43]
  ds_read_b64_tr_b16 v[186:187], v22 offset:26624
  v_subrev_u32 v14, 2048, v34
  v_mfma_f32_16x16x32_bf16 v[44:47], v[172:175], a[188:191], v[44:47]
  s_mov_b32 s12, s62
  ds_read_b64_tr_b16 v[188:189], v22 offset:28672
  s_mov_b32 s13, s63
  v_mfma_f32_16x16x32_bf16 v[44:47], v[168:171], a[180:183], v[44:47]
  s_waitcnt lgkmcnt(3)
  ds_read_b64_tr_b16 v[190:191], v22 offset:30720
  v_mfma_f32_16x16x32_bf16 v[52:55], v[176:179], a[180:183], v[52:55]
  s_mov_b32 s14, 7340032
  ds_read_b64_tr_b16 v[192:193], v23 offset:24576
  buffer_load_dwordx4 a[228:231], v9, s[16:19], s39 offen offset:0 sc1
  v_mfma_f32_16x16x32_bf16 v[52:55], v[180:183], a[188:191], v[52:55]
  s_mov_b32 s15, 0x00020000
  ds_read_b64_tr_b16 v[194:195], v23 offset:26624
  s_mov_b32 s96, s64
  v_mfma_f32_16x16x32_bf16 v[48:51], v[180:183], a[184:187], v[48:51]
  s_mov_b32 s97, s65
  ds_read_b64_tr_b16 v[196:197], v23 offset:28672
  s_mov_b32 s98, 7340032
  v_mfma_f32_16x16x32_bf16 v[48:51], v[176:179], a[176:179], v[48:51]
  s_waitcnt vmcnt(10) lgkmcnt(3)
  ds_read_b64_tr_b16 v[198:199], v23 offset:30720
  v_mfma_f32_16x16x32_bf16 v[56:59], v[184:187], a[176:179], v[56:59]
  s_mov_b32 s99, 0x00020000
  ds_read_b64_tr_b16 v[168:169], v20 offset:32768
  buffer_load_dwordx4 a[232:235], v8, s[16:19], s39 offen offset:1024 sc1
  v_mfma_f32_16x16x32_bf16 v[56:59], v[188:191], a[184:187], v[56:59]
  ds_read_b64_tr_b16 v[170:171], v20 offset:34816
  v_mfma_f32_16x16x32_bf16 v[60:63], v[188:191], a[188:191], v[60:63]
  ds_read_b64_tr_b16 v[172:173], v20 offset:36864
  v_mfma_f32_16x16x32_bf16 v[60:63], v[184:187], a[180:183], v[60:63]
  s_waitcnt lgkmcnt(3)
  ds_read_b64_tr_b16 v[174:175], v20 offset:38912
  v_mfma_f32_16x16x32_bf16 v[68:71], v[192:195], a[180:183], v[68:71]
  ds_read_b64_tr_b16 v[176:177], v21 offset:32768
  buffer_load_dwordx4 a[236:239], v9, s[16:19], s39 offen offset:1024 sc1
  v_mfma_f32_16x16x32_bf16 v[68:71], v[196:199], a[188:191], v[68:71]
  ds_read_b64_tr_b16 v[178:179], v21 offset:34816
  v_mfma_f32_16x16x32_bf16 v[64:67], v[196:199], a[184:187], v[64:67]
  ds_read_b64_tr_b16 v[180:181], v21 offset:36864
  v_mfma_f32_16x16x32_bf16 v[64:67], v[192:195], a[176:179], v[64:67]
  s_waitcnt vmcnt(8) lgkmcnt(3)
  ds_read_b64_tr_b16 v[182:183], v21 offset:38912
  v_mfma_f32_16x16x32_bf16 v[40:43], v[168:171], a[192:195], v[40:43]
  ds_read_b64_tr_b16 v[184:185], v22 offset:32768
  buffer_load_dwordx4 a[240:243], v8, s[16:19], s39 offen offset:2048 sc1
  v_mfma_f32_16x16x32_bf16 v[40:43], v[172:175], a[200:203], v[40:43]
  ds_read_b64_tr_b16 v[186:187], v22 offset:34816
  v_mfma_f32_16x16x32_bf16 v[44:47], v[172:175], a[204:207], v[44:47]
  ds_read_b64_tr_b16 v[188:189], v22 offset:36864
  v_mfma_f32_16x16x32_bf16 v[44:47], v[168:171], a[196:199], v[44:47]
  s_waitcnt lgkmcnt(3)
  ds_read_b64_tr_b16 v[190:191], v22 offset:38912
  v_mfma_f32_16x16x32_bf16 v[52:55], v[176:179], a[196:199], v[52:55]
  ds_read_b64_tr_b16 v[192:193], v23 offset:32768
  buffer_load_dwordx4 a[244:247], v9, s[16:19], s39 offen offset:2048 sc1
  v_mfma_f32_16x16x32_bf16 v[52:55], v[180:183], a[204:207], v[52:55]
  ds_read_b64_tr_b16 v[194:195], v23 offset:34816
  v_mfma_f32_16x16x32_bf16 v[48:51], v[180:183], a[200:203], v[48:51]
  ds_read_b64_tr_b16 v[196:197], v23 offset:36864
  v_mfma_f32_16x16x32_bf16 v[48:51], v[176:179], a[192:195], v[48:51]
  s_waitcnt vmcnt(10) lgkmcnt(3)
  ds_read_b64_tr_b16 v[198:199], v23 offset:38912
  v_mfma_f32_16x16x32_bf16 v[56:59], v[184:187], a[192:195], v[56:59]
  ds_read_b64_tr_b16 v[168:169], v20 offset:40960
  buffer_load_dwordx4 a[248:251], v8, s[16:19], s39 offen offset:3072 sc1
  v_mfma_f32_16x16x32_bf16 v[56:59], v[188:191], a[200:203], v[56:59]
  ds_read_b64_tr_b16 v[170:171], v20 offset:43008
  v_mfma_f32_16x16x32_bf16 v[60:63], v[188:191], a[204:207], v[60:63]
  ds_read_b64_tr_b16 v[172:173], v20 offset:45056
  v_mfma_f32_16x16x32_bf16 v[60:63], v[184:187], a[196:199], v[60:63]
  s_waitcnt lgkmcnt(3)
  ds_read_b64_tr_b16 v[174:175], v20 offset:47104
  v_mfma_f32_16x16x32_bf16 v[68:71], v[192:195], a[196:199], v[68:71]
  ds_read_b64_tr_b16 v[176:177], v21 offset:40960
  buffer_load_dwordx4 a[252:255], v9, s[16:19], s39 offen offset:3072 sc1
  v_mfma_f32_16x16x32_bf16 v[68:71], v[196:199], a[204:207], v[68:71]
  ds_read_b64_tr_b16 v[178:179], v21 offset:43008
  v_mfma_f32_16x16x32_bf16 v[64:67], v[196:199], a[200:203], v[64:67]
  ds_read_b64_tr_b16 v[180:181], v21 offset:45056
  v_mfma_f32_16x16x32_bf16 v[64:67], v[192:195], a[192:195], v[64:67]
  s_waitcnt vmcnt(8) lgkmcnt(3)
  ds_read_b64_tr_b16 v[182:183], v21 offset:47104
  v_mfma_f32_16x16x32_bf16 v[40:43], v[168:171], a[208:211], v[40:43]
  ds_read_b64_tr_b16 v[184:185], v22 offset:40960
  global_load_dword v148, v10, s[4:5] offset:0 sc1
  v_mfma_f32_16x16x32_bf16 v[40:43], v[172:175], a[216:219], v[40:43]
  ds_read_b64_tr_b16 v[186:187], v22 offset:43008
  global_load_dword v149, v10, s[4:5] offset:256 sc1
  v_mfma_f32_16x16x32_bf16 v[44:47], v[172:175], a[220:223], v[44:47]
  ds_read_b64_tr_b16 v[188:189], v22 offset:45056
  global_load_dword v150, v10, s[4:5] offset:512 sc1
  v_mfma_f32_16x16x32_bf16 v[44:47], v[168:171], a[212:215], v[44:47]
  s_waitcnt lgkmcnt(3)
  ds_read_b64_tr_b16 v[190:191], v22 offset:47104
  global_load_dword v151, v10, s[4:5] offset:768 sc1
  v_mfma_f32_16x16x32_bf16 v[52:55], v[176:179], a[212:215], v[52:55]
  ds_read_b64_tr_b16 v[192:193], v23 offset:40960
  global_load_dword v152, v10, s[4:5] offset:1024 sc1
  v_mfma_f32_16x16x32_bf16 v[52:55], v[180:183], a[220:223], v[52:55]
  ds_read_b64_tr_b16 v[194:195], v23 offset:43008
  global_load_dword v153, v10, s[4:5] offset:1280 sc1
  v_mfma_f32_16x16x32_bf16 v[48:51], v[180:183], a[216:219], v[48:51]
  ds_read_b64_tr_b16 v[196:197], v23 offset:45056
  global_load_dword v154, v10, s[4:5] offset:1536 sc1
  v_mfma_f32_16x16x32_bf16 v[48:51], v[176:179], a[208:211], v[48:51]
  s_waitcnt vmcnt(15) lgkmcnt(3)
  ds_read_b64_tr_b16 v[198:199], v23 offset:47104
  global_load_dword v155, v10, s[4:5] offset:1792 sc1
  v_mfma_f32_16x16x32_bf16 v[56:59], v[184:187], a[208:211], v[56:59]
L_pad_0a_7:
  s_cbranch_execz L_ret_0a
  ds_read_b64_tr_b16 v[168:169], v20 offset:49152
  v_mfma_f32_16x16x32_bf16 v[56:59], v[188:191], a[216:219], v[56:59]
  ds_read_b64_tr_b16 v[170:171], v20 offset:51200
  v_mfma_f32_16x16x32_bf16 v[60:63], v[188:191], a[220:223], v[60:63]
  ds_read_b64_tr_b16 v[172:173], v20 offset:53248
  v_mfma_f32_16x16x32_bf16 v[60:63], v[184:187], a[212:215], v[60:63]
  s_waitcnt lgkmcnt(3)
  ds_read_b64_tr_b16 v[174:175], v20 offset:55296
  v_mfma_f32_16x16x32_bf16 v[68:71], v[192:195], a[212:215], v[68:71]
  ds_read_b64_tr_b16 v[176:177], v21 offset:49152
  v_mfma_f32_16x16x32_bf16 v[68:71], v[196:199], a[220:223], v[68:71]
  ds_read_b64_tr_b16 v[178:179], v21 offset:51200
  v_mfma_f32_16x16x32_bf16 v[64:67], v[196:199], a[216:219], v[64:67]
  ds_read_b64_tr_b16 v[180:181], v21 offset:53248
  v_mfma_f32_16x16x32_bf16 v[64:67], v[192:195], a[208:211], v[64:67]
  s_waitcnt vmcnt(12) lgkmcnt(3)
  ds_read_b64_tr_b16 v[182:183], v21 offset:55296
  v_mfma_f32_16x16x32_bf16 v[40:43], v[168:171], a[224:227], v[40:43]
  ds_read_b64_tr_b16 v[184:185], v22 offset:49152
  v_mfma_f32_16x16x32_bf16 v[40:43], v[172:175], a[232:235], v[40:43]
  ds_read_b64_tr_b16 v[186:187], v22 offset:51200
  v_mfma_f32_16x16x32_bf16 v[44:47], v[172:175], a[236:239], v[44:47]
  ds_read_b64_tr_b16 v[188:189], v22 offset:53248
  v_mfma_f32_16x16x32_bf16 v[44:47], v[168:171], a[228:231], v[44:47]
  s_waitcnt lgkmcnt(3)
  ds_read_b64_tr_b16 v[190:191], v22 offset:55296
  v_mfma_f32_16x16x32_bf16 v[52:55], v[176:179], a[228:231], v[52:55]
  ds_read_b64_tr_b16 v[192:193], v23 offset:49152
  v_mfma_f32_16x16x32_bf16 v[52:55], v[180:183], a[236:239], v[52:55]
  ds_read_b64_tr_b16 v[194:195], v23 offset:51200
  v_mfma_f32_16x16x32_bf16 v[48:51], v[180:183], a[232:235], v[48:51]
  ds_read_b64_tr_b16 v[196:197], v23 offset:53248
  v_mfma_f32_16x16x32_bf16 v[48:51], v[176:179], a[224:227], v[48:51]
  s_waitcnt vmcnt(12) lgkmcnt(3)
  ds_read_b64_tr_b16 v[198:199], v23 offset:55296
  v_mfma_f32_16x16x32_bf16 v[56:59], v[184:187], a[224:227], v[56:59]
  ds_read_b64_tr_b16 v[168:169], v20 offset:57344
  v_mfma_f32_16x16x32_bf16 v[56:59], v[188:191], a[232:235], v[56:59]
  ds_read_b64_tr_b16 v[170:171], v20 offset:59392
  v_mfma_f32_16x16x32_bf16 v[60:63], v[188:191], a[236:239], v[60:63]
  ds_read_b64_tr_b16 v[172:173], v20 offset:61440
  v_mfma_f32_16x16x32_bf16 v[60:63], v[184:187], a[228:231], v[60:63]
  s_waitcnt lgkmcnt(3)
  ds_read_b64_tr_b16 v[174:175], v20 offset:63488
  v_mfma_f32_16x16x32_bf16 v[68:71], v[192:195], a[228:231], v[68:71]
  ds_read_b64_tr_b16 v[176:177], v21 offset:57344
  v_mfma_f32_16x16x32_bf16 v[68:71], v[196:199], a[236:239], v[68:71]
  ds_read_b64_tr_b16 v[178:179], v21 offset:59392
  v_mfma_f32_16x16x32_bf16 v[64:67], v[196:199], a[232:235], v[64:67]
  ds_read_b64_tr_b16 v[180:181], v21 offset:61440
  v_mfma_f32_16x16x32_bf16 v[64:67], v[192:195], a[224:227], v[64:67]
  s_waitcnt vmcnt(8) lgkmcnt(3)
  ds_read_b64_tr_b16 v[182:183], v21 offset:63488
  v_mfma_f32_16x16x32_bf16 v[40:43], v[168:171], a[240:243], v[40:43]
  ds_read_b64_tr_b16 v[184:185], v22 offset:57344
  v_mfma_f32_16x16x32_bf16 v[40:43], v[172:175], a[248:251], v[40:43]
  ds_read_b64_tr_b16 v[186:187], v22 offset:59392
  v_mfma_f32_16x16x32_bf16 v[44:47], v[172:175], a[252:255], v[44:47]
  ds_read_b64_tr_b16 v[188:189], v22 offset:61440
  v_mfma_f32_16x16x32_bf16 v[44:47], v[168:171], a[244:247], v[44:47]
  s_waitcnt lgkmcnt(3)
  ds_read_b64_tr_b16 v[190:191], v22 offset:63488
  v_mfma_f32_16x16x32_bf16 v[52:55], v[176:179], a[244:247], v[52:55]
  ds_read_b64_tr_b16 v[192:193], v23 offset:57344
  v_mfma_f32_16x16x32_bf16 v[52:55], v[180:183], a[252:255], v[52:55]
  ds_read_b64_tr_b16 v[194:195], v23 offset:59392
  v_mfma_f32_16x16x32_bf16 v[48:51], v[180:183], a[248:251], v[48:51]
  ds_read_b64_tr_b16 v[196:197], v23 offset:61440
  v_mfma_f32_16x16x32_bf16 v[48:51], v[176:179], a[240:243], v[48:51]
  s_waitcnt vmcnt(8) lgkmcnt(3)
  ds_read_b64_tr_b16 v[198:199], v23 offset:63488
  v_mfma_f32_16x16x32_bf16 v[56:59], v[184:187], a[240:243], v[56:59]
  v_mfma_f32_16x16x32_bf16 v[56:59], v[188:191], a[248:251], v[56:59]
  v_mfma_f32_16x16x32_bf16 v[60:63], v[188:191], a[252:255], v[60:63]
  v_mfma_f32_16x16x32_bf16 v[60:63], v[184:187], a[244:247], v[60:63]
  s_waitcnt lgkmcnt(0)
  v_mfma_f32_16x16x32_bf16 v[68:71], v[192:195], a[244:247], v[68:71]
  v_mfma_f32_16x16x32_bf16 v[68:71], v[196:199], a[252:255], v[68:71]
  v_mfma_f32_16x16x32_bf16 v[64:67], v[196:199], a[248:251], v[64:67]
  v_mfma_f32_16x16x32_bf16 v[64:67], v[192:195], a[240:243], v[64:67]
L_p2e:
  s_waitcnt vmcnt(0)
  v_pk_add_f32 v[148:149], v[148:149], v[150:151]
  v_pk_add_f32 v[152:153], v[152:153], v[154:155]
  v_pk_add_f32 v[148:149], v[148:149], v[152:153]
  v_add_f32 v148, v148, v149
  v_mov_b32 v149, v148
  s_add_u32 s20, s4, 0x1100000
  s_addc_u32 s21, s5, 0
  s_mov_b32 s22, 0x400400
  s_mov_b32 s23, 0x00020000
  v_permlane32_swap_b32 v148, v149
  v_add_f32 v148, v148, v149
  v_mov_b32_e64 v149, v148
  s_nop 1
  v_permlane16_swap_b32 v148, v149
  v_pk_add_f32 v[160:161], v[40:41], v[148:149] op_sel_hi:[1,0] neg_lo:[0,1] neg_hi:[0,1]
  v_pk_add_f32 v[162:163], v[42:43], v[148:149] op_sel_hi:[1,0] neg_lo:[0,1] neg_hi:[0,1]
  v_cvt_pk_bf16_f32 v104, v160, v161
  v_cvt_pk_bf16_f32 v105, v162, v163
  v_pk_add_f32 v[168:169], v[48:49], v[148:149] op_sel_hi:[1,0] neg_lo:[0,1] neg_hi:[0,1]
  v_pk_add_f32 v[170:171], v[50:51], v[148:149] op_sel_hi:[1,0] neg_lo:[0,1] neg_hi:[0,1]
  v_cvt_pk_bf16_f32 v106, v168, v169
  v_cvt_pk_bf16_f32 v107, v170, v171
  buffer_store_dwordx4 v[104:107], v8, s[20:23], s85 offen offset:0 sc1
  v_pk_add_f32 v[176:177], v[56:57], v[148:149] op_sel_hi:[1,0] neg_lo:[0,1] neg_hi:[0,1]
  v_pk_add_f32 v[178:179], v[58:59], v[148:149] op_sel_hi:[1,0] neg_lo:[0,1] neg_hi:[0,1]
  v_cvt_pk_bf16_f32 v108, v176, v177
  v_cvt_pk_bf16_f32 v109, v178, v179
  v_pk_add_f32 v[184:185], v[64:65], v[148:149] op_sel_hi:[1,0] neg_lo:[0,1] neg_hi:[0,1]
  v_pk_add_f32 v[186:187], v[66:67], v[148:149] op_sel_hi:[1,0] neg_lo:[0,1] neg_hi:[0,1]
  v_cvt_pk_bf16_f32 v110, v184, v185
  v_cvt_pk_bf16_f32 v111, v186, v187
  buffer_store_dwordx4 v[108:111], v8, s[20:23], s85 offen offset:1024 sc1
  v_pk_add_f32 v[164:165], v[44:45], v[148:149] op_sel:[0,1] op_sel_hi:[1,1] neg_lo:[0,1] neg_hi:[0,1]
  v_pk_add_f32 v[166:167], v[46:47], v[148:149] op_sel:[0,1] op_sel_hi:[1,1] neg_lo:[0,1] neg_hi:[0,1]
  v_cvt_pk_bf16_f32 v112, v164, v165
  v_cvt_pk_bf16_f32 v113, v166, v167
  v_pk_add_f32 v[172:173], v[52:53], v[148:149] op_sel:[0,1] op_sel_hi:[1,1] neg_lo:[0,1] neg_hi:[0,1]
  v_pk_add_f32 v[174:175], v[54:55], v[148:149] op_sel:[0,1] op_sel_hi:[1,1] neg_lo:[0,1] neg_hi:[0,1]
  v_cvt_pk_bf16_f32 v114, v172, v173
  v_cvt_pk_bf16_f32 v115, v174, v175
  buffer_store_dwordx4 v[112:115], v9, s[20:23], s85 offen offset:0 sc1
  v_pk_add_f32 v[180:181], v[60:61], v[148:149] op_sel:[0,1] op_sel_hi:[1,1] neg_lo:[0,1] neg_hi:[0,1]
  v_pk_add_f32 v[182:183], v[62:63], v[148:149] op_sel:[0,1] op_sel_hi:[1,1] neg_lo:[0,1] neg_hi:[0,1]
  v_cvt_pk_bf16_f32 v116, v180, v181
  v_cvt_pk_bf16_f32 v117, v182, v183
  v_pk_add_f32 v[188:189], v[68:69], v[148:149] op_sel:[0,1] op_sel_hi:[1,1] neg_lo:[0,1] neg_hi:[0,1]
  v_pk_add_f32 v[190:191], v[70:71], v[148:149] op_sel:[0,1] op_sel_hi:[1,1] neg_lo:[0,1] neg_hi:[0,1]
  v_cvt_pk_bf16_f32 v118, v188, v189
  v_cvt_pk_bf16_f32 v119, v190, v191
  buffer_store_dwordx4 v[116:119], v9, s[20:23], s85 offen offset:1024 sc1
  v_pk_mul_f32 v[24:25], v[160:161], v[160:161]
  v_pk_mul_f32 v[26:27], v[162:163], v[162:163]
  v_pk_fma_f32 v[24:25], v[168:169], v[168:169], v[24:25]
  v_pk_fma_f32 v[26:27], v[170:171], v[170:171], v[26:27]
  v_pk_fma_f32 v[24:25], v[176:177], v[176:177], v[24:25]
  v_pk_fma_f32 v[26:27], v[178:179], v[178:179], v[26:27]
  v_pk_fma_f32 v[24:25], v[184:185], v[184:185], v[24:25]
  v_pk_fma_f32 v[26:27], v[186:187], v[186:187], v[26:27]
  v_pk_mul_f32 v[28:29], v[164:165], v[164:165]
  v_pk_mul_f32 v[30:31], v[166:167], v[166:167]
  v_pk_fma_f32 v[28:29], v[172:173], v[172:173], v[28:29]
  v_pk_fma_f32 v[30:31], v[174:175], v[174:175], v[30:31]
  v_pk_fma_f32 v[28:29], v[180:181], v[180:181], v[28:29]
  v_pk_fma_f32 v[30:31], v[182:183], v[182:183], v[30:31]
  v_pk_fma_f32 v[28:29], v[188:189], v[188:189], v[28:29]
  v_pk_fma_f32 v[30:31], v[190:191], v[190:191], v[30:31]
  v_pk_add_f32 v[24:25], v[24:25], v[26:27]
  v_pk_add_f32 v[28:29], v[28:29], v[30:31]
  v_add_f32 v24, v24, v25
  v_add_f32 v25, v28, v29
  s_nop 1
  v_permlane16_swap_b32 v24, v25
  v_add_f32 v24, v24, v25
  v_mov_b32 v25, v24
  s_nop 1
  v_permlane32_swap_b32 v24, v25
  v_add_f32 v24, v24, v25
  s_mov_b32 exec_hi, 0
  global_store_dword v11, v24, s[4:5] sc1
  s_mov_b64 exec, -1
  s_barrier
  s_mov_b32 s38, 0
  s_add_u32 m0, s77, 0
  s_nop 0
  buffer_load_dwordx4 v4, s[12:15], s38 offen offset:0 lds
  v_pk_add_f32 v[40:41], v[40:41], v[248:249] op_sel_hi:[1,0]
  v_pk_add_f32 v[42:43], v[42:43], v[248:249] op_sel_hi:[1,0]
  v_pk_add_f32 v[48:49], v[48:49], v[248:249] op_sel_hi:[1,0]
  v_pk_add_f32 v[50:51], v[50:51], v[248:249] op_sel_hi:[1,0]
  v_pk_add_f32 v[56:57], v[56:57], v[248:249] op_sel_hi:[1,0]
  v_pk_add_f32 v[58:59], v[58:59], v[248:249] op_sel_hi:[1,0]
  v_pk_add_f32 v[64:65], v[64:65], v[248:249] op_sel_hi:[1,0]
  v_pk_add_f32 v[66:67], v[66:67], v[248:249] op_sel_hi:[1,0]
  v_pk_add_f32 v[44:45], v[44:45], v[250:251] op_sel_hi:[1,0]
  v_pk_add_f32 v[46:47], v[46:47], v[250:251] op_sel_hi:[1,0]
  buffer_load_dwordx4 v5, s[12:15], s38 offen offset:1024 lds
  v_pk_add_f32 v[52:53], v[52:53], v[250:251] op_sel_hi:[1,0]
  v_pk_add_f32 v[54:55], v[54:55], v[250:251] op_sel_hi:[1,0]
  v_pk_add_f32 v[60:61], v[60:61], v[250:251] op_sel_hi:[1,0]
  v_pk_add_f32 v[62:63], v[62:63], v[250:251] op_sel_hi:[1,0]
  v_pk_add_f32 v[68:69], v[68:69], v[250:251] op_sel_hi:[1,0]
  v_pk_add_f32 v[70:71], v[70:71], v[250:251] op_sel_hi:[1,0]
  v_accvgpr_write_b32 a224, v40
  v_accvgpr_write_b32 a225, v41
  v_accvgpr_write_b32 a226, v42
  v_accvgpr_write_b32 a227, v43
  buffer_load_dwordx4 v6, s[12:15], s38 offen offset:2048 lds
  v_accvgpr_write_b32 a228, v44
  v_accvgpr_write_b32 a229, v45
  v_accvgpr_write_b32 a230, v46
  v_accvgpr_write_b32 a231, v47
  v_accvgpr_write_b32 a232, v48
  v_accvgpr_write_b32 a233, v49
  v_accvgpr_write_b32 a234, v50
  v_accvgpr_write_b32 a235, v51
  v_accvgpr_write_b32 a236, v52
  v_accvgpr_write_b32 a237, v53
  buffer_load_dwordx4 v7, s[12:15], s38 offen offset:3072 lds
  v_accvgpr_write_b32 a238, v54
  v_accvgpr_write_b32 a239, v55
  v_accvgpr_write_b32 a240, v56
  v_accvgpr_write_b32 a241, v57
  v_accvgpr_write_b32 a242, v58
  v_accvgpr_write_b32 a243, v59
  v_accvgpr_write_b32 a244, v60
  v_accvgpr_write_b32 a245, v61
  v_accvgpr_write_b32 a246, v62
  s_add_u32 m0, s77, 4096
  s_nop 0
  buffer_load_dwordx4 v12, s[12:15], s38 offen offset:0 lds
  v_accvgpr_write_b32 a247, v63
  v_accvgpr_write_b32 a248, v64
  v_accvgpr_write_b32 a249, v65
  v_accvgpr_write_b32 a250, v66
  v_accvgpr_write_b32 a251, v67
  v_accvgpr_write_b32 a252, v68
  v_accvgpr_write_b32 a253, v69
  v_accvgpr_write_b32 a254, v70
  v_accvgpr_write_b32 a255, v71
  s_and_b32 s34, s11, 224
  buffer_load_dwordx4 v13, s[12:15], s38 offen offset:1024 lds
  s_lshl_b32 s34, s34, 8
  s_bfe_u32 s35, s11, 0x50000
  s_lshl_b32 s35, s35, 3
  s_add_u32 s34, s34, s35
  s_add_u32 s34, s34, 0x3bd0000
  v_lshlrev_b32 v10, 8, v1
  v_add_u32 v10, s34, v10
  s_lshl_b32 s9, s32, 5
  s_add_u32 s8, s9, s33
  s_and_b32 s34, s8, 255
  buffer_load_dwordx4 v14, s[12:15], s38 offen offset:2048 lds
  s_lshl_b32 s34, s34, 8
  s_add_u32 s34, s34, 0x3bd0000
  v_and_b32 v11, 31, v1
  v_lshl_add_u32 v11, v11, 3, s34
  s_add_u32 s86, s4, s34
  s_addc_u32 s87, s5, 0
  v_mov_b32 v16, v11
  v_and_b32 v11, 17, v1
  v_lshl_add_u32 v11, v11, 3, s34
  s_waitcnt vmcnt(7)
  s_barrier
  s_cmp_eq_u32 s24, 0
  s_cbranch_scc0 L_nosig_20
  v_mov_b32 v28, s6
  v_mov_b32 v29, s7
  s_mov_b32 exec_lo, 0xffffffff
  s_mov_b32 exec_hi, 0
  global_store_dwordx2 v10, v[28:29], s[4:5] sc1
  s_mov_b64 exec, -1
L_nosig_20:
  s_mov_b32 s38, 0
  s_add_u32 m0, s77, 32768
  s_nop 0
  buffer_load_dwordx4 v4, s[96:99], s38 offen offset:0 lds
  buffer_load_dwordx4 v5, s[96:99], s38 offen offset:1024 lds
  buffer_load_dwordx4 v6, s[96:99], s38 offen offset:2048 lds
  buffer_load_dwordx4 v7, s[96:99], s38 offen offset:3072 lds
  s_add_u32 m0, s77, 36864
  s_nop 0
  buffer_load_dwordx4 v12, s[96:99], s38 offen offset:0 lds
  buffer_load_dwordx4 v13, s[96:99], s38 offen offset:1024 lds
  buffer_load_dwordx4 v14, s[96:99], s38 offen offset:2048 lds
  s_lshl_b32 s44, s32, 4
  s_lshl_b32 s34, s24, 2
  s_add_u32 s44, s44, s34
  s_mul_i32 s45, s44, 32768
  s_mov_b32 s39, 0
  v_add_u32 v8, s45, v3
  v_lshrrev_b32 v9, 2, v1
  v_mul_u32_u24 v9, 224, v9
  v_and_b32 v15, 3, v1
  v_lshl_add_u32 v24, v15, 3, v9
  v_add_u32 v25, 0x10000, v24
  v_add_u32 v9, 0x20000, v24
  s_add_u32 s16, s4, 0x1100000
  s_addc_u32 s17, s5, 0
  s_mov_b32 s18, 0x400400
  s_mov_b32 s19, 0x00020000
  s_and_b32 s34, s26, 0
  s_mul_i32 s34, s34, 32
  s_lshr_b32 s35, s26, 0
  s_add_u32 s34, s34, s35
  s_lshl_b32 s34, s34, 1
  s_lshr_b32 s35, s24, 1
  s_add_u32 s34, s34, s35
  s_mul_i32 s34, s34, 14
  s_add_u32 s34, s34, 1792
  v_min_u32 v26, 13, v1
  v_add_u32_e64 v26, s34, v26
  v_mul_u32_u24 v15, 9363, v26
  v_lshrrev_b32 v15, 16, v15
  v_mul_u32_u24 v15, 6272, v15
  v_lshl_add_u32 v26, v26, 7, v15
  s_lshr_b32 s34, s33, 2
  s_mul_i32 s34, s34, 896
  v_add_u32 v26, s34, v26
  s_lshl_b32 s34, s2, 2
  s_add_u32 s34, s34, s24
  s_mul_i32 s34, s34, 1792
  v_min_u32 v27, 13, v1
  v_lshl_add_u32 v27, v27, 7, s34
  s_mov_b32 s40, 0
  s_mov_b32 s82, 917504
  s_lshl_b32 s34, s26, 2
  s_add_u32 s34, s34, s24
  s_mul_i32 s34, s34, 14336
  s_and_b32 s35, s31, 1
  s_mul_i32 s35, s35, 4587520
  s_add_u32 s34, s34, s35
  s_add_u32 s83, s34, 384
  s_mov_b32 s20, s80
  s_mov_b32 s21, s81
  s_mov_b32 s22, 0x700000
  s_mov_b32 s23, 0x00020000
  s_cmp_eq_u32 s24, 1
  s_cbranch_scc0 L_nopoll_21
  s_mov_b32 s34, 0
L_poll_22:
  s_load_dwordx4 s[88:91], s[86:87], 0 glc
  s_load_dwordx4 s[92:95], s[86:87], 128 glc
  s_add_u32 s34, s34, 1
  s_waitcnt lgkmcnt(0)
  s_xor_b64 s[88:89], s[88:89], s[6:7]
  s_xor_b64 s[90:91], s[90:91], s[6:7]
  s_xor_b64 s[92:93], s[92:93], s[6:7]
  s_xor_b64 s[94:95], s[94:95], s[6:7]
  s_or_b64 s[88:89], s[88:89], s[90:91]
  s_or_b64 s[92:93], s[92:93], s[94:95]
  s_or_b64 s[88:89], s[88:89], s[92:93]
  s_cbranch_scc0 L_go_23
  s_cmp_lt_u32 s34, 0x40000
  s_cbranch_scc1 L_poll_22
L_go_23:
  s_branch L_polled_24
L_nopoll_21:
  s_mov_b64 exec, 0
  s_cmp_eq_u32 s24, 0
  s_cbranch_scc1 L_pad_3b_0
  s_cmp_eq_u32 s24, 2
  s_cbranch_scc1 L_pad_3b_1
  s_branch L_pad_3b_2
L_ret_3b:
  s_mov_b64 exec, -1
L_polled_24:
  s_waitcnt vmcnt(8)
  s_cmp_eq_u32 s24, 0
  s_cbranch_scc1 L_w0_25
  s_waitcnt vmcnt(7)
L_w0_25:
  s_barrier
  s_mov_b32 s39, 0
  buffer_load_dwordx4 a[0:3], v8, s[16:19], s39 offen offset:0 sc1
  s_mov_b32 s39, 32768
  buffer_load_dwordx4 a[4:7], v8, s[16:19], s39 offen offset:0 sc1
  s_mov_b32 s39, 65536
  buffer_load_dwordx4 a[8:11], v8, s[16:19], s39 offen offset:0 sc1
  s_mov_b32 s39, 98304
  buffer_load_dwordx4 a[12:15], v8, s[16:19], s39 offen offset:0 sc1
  ds_read_b64_tr_b16 a[128:129], v24 offset:192
  ds_read_b64_tr_b16 a[130:131], v24 offset:3776
  ds_read_b64_tr_b16 a[132:133], v24 offset:0
  ds_read_b64_tr_b16 a[134:135], v24 offset:3584
  ds_read_b64_tr_b16 a[136:137], v24 offset:32
  ds_read_b64_tr_b16 a[138:139], v24 offset:3616
  ds_read_b64_tr_b16 a[140:141], v24 offset:64
  ds_read_b64_tr_b16 a[142:143], v24 offset:3648
  ds_read_b64_tr_b16 a[144:145], v24 offset:96
  ds_read_b64_tr_b16 a[146:147], v24 offset:3680
  ds_read_b64_tr_b16 a[148:149], v24 offset:128
  ds_read_b64_tr_b16 a[150:151], v24 offset:3712
  s_mov_b32 s39, 0
  buffer_load_dwordx4 a[16:19], v8, s[16:19], s39 offen offset:1024 sc1
  s_mov_b32 s39, 32768
  buffer_load_dwordx4 a[20:23], v8, s[16:19], s39 offen offset:1024 sc1
  s_mov_b32 s39, 65536
  buffer_load_dwordx4 a[24:27], v8, s[16:19], s39 offen offset:1024 sc1
  s_mov_b32 s39, 98304
  buffer_load_dwordx4 a[28:31], v8, s[16:19], s39 offen offset:1024 sc1
  s_mov_b32 s39, 0
  buffer_load_dwordx4 a[32:35], v8, s[16:19], s39 offen offset:2048 sc1
  s_mov_b32 s39, 32768
  buffer_load_dwordx4 a[36:39], v8, s[16:19], s39 offen offset:2048 sc1
  s_mov_b32 s39, 65536
  buffer_load_dwordx4 a[40:43], v8, s[16:19], s39 offen offset:2048 sc1
  s_mov_b32 s39, 98304
  buffer_load_dwordx4 a[44:47], v8, s[16:19], s39 offen offset:2048 sc1
  s_mov_b32 s39, 0
  buffer_load_dwordx4 a[48:51], v8, s[16:19], s39 offen offset:3072 sc1
  s_mov_b32 s39, 32768
  buffer_load_dwordx4 a[52:55], v8, s[16:19], s39 offen offset:3072 sc1
  s_mov_b32 s39, 65536
  buffer_load_dwordx4 a[56:59], v8, s[16:19], s39 offen offset:3072 sc1
  s_mov_b32 s39, 98304
  buffer_load_dwordx4 a[60:63], v8, s[16:19], s39 offen offset:3072 sc1
  s_waitcnt vmcnt(12) lgkmcnt(10)
L_p3:
  v_mfma_f32_16x16x32_bf16 v[224:227], a[128:131], a[0:3], 0
  s_mov_b32 s38, 917504
  ds_read_b64_tr_b16 a[152:153], v24 offset:160
  s_add_u32 m0, s77, 65536
  v_mfma_f32_16x16x32_bf16 v[228:231], a[128:131], a[4:7], 0
  buffer_load_dwordx4 v4, s[12:15], s38 offen offset:0 lds
  v_mfma_f32_16x16x32_bf16 v[232:235], a[128:131], a[8:11], 0
  ds_read_b64_tr_b16 a[154:155], v24 offset:3744
  v_mfma_f32_16x16x32_bf16 v[236:239], a[128:131], a[12:15], 0
  s_waitcnt lgkmcnt(10)
  v_mfma_f32_16x16x32_bf16 v[44:47], a[132:135], a[12:15], 0
  ds_read_b64_tr_b16 a[156:157], v24 offset:7360
  v_mfma_f32_16x16x32_bf16 v[40:43], a[132:135], a[8:11], 0
  buffer_load_dwordx4 v5, s[12:15], s38 offen offset:1024 lds
  v_mfma_f32_16x16x32_bf16 v[36:39], a[132:135], a[4:7], 0
  ds_read_b64_tr_b16 a[158:159], v24 offset:10944
  v_mfma_f32_16x16x32_bf16 v[32:35], a[132:135], a[0:3], 0
  s_waitcnt lgkmcnt(10)
  v_mfma_f32_16x16x32_bf16 v[64:67], a[136:139], a[0:3], 0
  ds_read_b64_tr_b16 a[160:161], v24 offset:7168
  v_mfma_f32_16x16x32_bf16 v[68:71], a[136:139], a[4:7], 0
  v_mfma_f32_16x16x32_bf16 v[72:75], a[136:139], a[8:11], 0
  ds_read_b64_tr_b16 a[162:163], v24 offset:10752
  v_mfma_f32_16x16x32_bf16 v[76:79], a[136:139], a[12:15], 0
  s_waitcnt lgkmcnt(10)
  buffer_load_dwordx4 v6, s[12:15], s38 offen offset:2048 lds
  v_mfma_f32_16x16x32_bf16 v[108:111], a[140:143], a[12:15], 0
  ds_read_b64_tr_b16 a[164:165], v24 offset:7200
  v_mfma_f32_16x16x32_bf16 v[104:107], a[140:143], a[8:11], 0
  v_mfma_f32_16x16x32_bf16 v[100:103], a[140:143], a[4:7], 0
  ds_read_b64_tr_b16 a[166:167], v24 offset:10784
  v_mfma_f32_16x16x32_bf16 v[96:99], a[140:143], a[0:3], 0
  s_waitcnt lgkmcnt(10)
  v_mfma_f32_16x16x32_bf16 v[128:131], a[144:147], a[0:3], 0
  ds_read_b64_tr_b16 a[128:129], v24 offset:7232
  v_mfma_f32_16x16x32_bf16 v[132:135], a[144:147], a[4:7], 0
  buffer_load_dwordx4 v7, s[12:15], s38 offen offset:3072 lds
  s_add_u32 m0, s77, 69632
  v_mfma_f32_16x16x32_bf16 v[136:139], a[144:147], a[8:11], 0
  ds_read_b64_tr_b16 a[130:131], v24 offset:10816
  v_mfma_f32_16x16x32_bf16 v[140:143], a[144:147], a[12:15], 0
  s_waitcnt lgkmcnt(10)
  v_mfma_f32_16x16x32_bf16 v[172:175], a[148:151], a[12:15], 0
  ds_read_b64_tr_b16 a[132:133], v24 offset:7264
  v_mfma_f32_16x16x32_bf16 v[168:171], a[148:151], a[8:11], 0
  v_mfma_f32_16x16x32_bf16 v[164:167], a[148:151], a[4:7], 0
  ds_read_b64_tr_b16 a[134:135], v24 offset:10848
  v_mfma_f32_16x16x32_bf16 v[160:163], a[148:151], a[0:3], 0
  s_waitcnt lgkmcnt(10)
  buffer_load_dwordx4 v12, s[12:15], s38 offen offset:0 lds
  v_mfma_f32_16x16x32_bf16 v[192:195], a[152:155], a[0:3], 0
  ds_read_b64_tr_b16 a[136:137], v24 offset:7296
  v_mfma_f32_16x16x32_bf16 v[196:199], a[152:155], a[4:7], 0
  v_mfma_f32_16x16x32_bf16 v[200:203], a[152:155], a[8:11], 0
  ds_read_b64_tr_b16 a[138:139], v24 offset:10880
  v_mfma_f32_16x16x32_bf16 v[204:207], a[152:155], a[12:15], 0
  s_waitcnt vmcnt(13) lgkmcnt(10)
  buffer_load_dwordx4 v13, s[12:15], s38 offen offset:1024 lds
  v_mfma_f32_16x16x32_bf16 v[236:239], a[156:159], a[28:31], v[236:239]
  ds_read_b64_tr_b16 a[140:141], v24 offset:7328
  v_mfma_f32_16x16x32_bf16 v[232:235], a[156:159], a[24:27], v[232:235]
  v_mfma_f32_16x16x32_bf16 v[228:231], a[156:159], a[20:23], v[228:231]
  ds_read_b64_tr_b16 a[142:143], v24 offset:10912
  v_mfma_f32_16x16x32_bf16 v[224:227], a[156:159], a[16:19], v[224:227]
  s_waitcnt lgkmcnt(10)
  v_mfma_f32_16x16x32_bf16 v[32:35], a[160:163], a[16:19], v[32:35]
  ds_read_b64_tr_b16 a[144:145], v24 offset:14528
  v_mfma_f32_16x16x32_bf16 v[36:39], a[160:163], a[20:23], v[36:39]
  buffer_load_dwordx4 v14, s[12:15], s38 offen offset:2048 lds
  v_mfma_f32_16x16x32_bf16 v[40:43], a[160:163], a[24:27], v[40:43]
  ds_read_b64_tr_b16 a[146:147], v24 offset:18112
  v_mfma_f32_16x16x32_bf16 v[44:47], a[160:163], a[28:31], v[44:47]
  s_waitcnt lgkmcnt(10)
  v_mfma_f32_16x16x32_bf16 v[76:79], a[164:167], a[28:31], v[76:79]
  ds_read_b64_tr_b16 a[148:149], v24 offset:14336
  v_mfma_f32_16x16x32_bf16 v[72:75], a[164:167], a[24:27], v[72:75]
  v_mfma_f32_16x16x32_bf16 v[68:71], a[164:167], a[20:23], v[68:71]
  ds_read_b64_tr_b16 a[150:151], v24 offset:17920
  v_mfma_f32_16x16x32_bf16 v[64:67], a[164:167], a[16:19], v[64:67]
  s_waitcnt lgkmcnt(10)
  v_mfma_f32_16x16x32_bf16 v[96:99], a[128:131], a[16:19], v[96:99]
  ds_read_b64_tr_b16 a[152:153], v24 offset:14368
  v_mfma_f32_16x16x32_bf16 v[100:103], a[128:131], a[20:23], v[100:103]
  v_mfma_f32_16x16x32_bf16 v[104:107], a[128:131], a[24:27], v[104:107]
  ds_read_b64_tr_b16 a[154:155], v24 offset:17952
  v_mfma_f32_16x16x32_bf16 v[108:111], a[128:131], a[28:31], v[108:111]
  s_waitcnt lgkmcnt(10)
  v_mfma_f32_16x16x32_bf16 v[140:143], a[132:135], a[28:31], v[140:143]
  ds_read_b64_tr_b16 a[156:157], v24 offset:14400
  v_mfma_f32_16x16x32_bf16 v[136:139], a[132:135], a[24:27], v[136:139]
  v_mfma_f32_16x16x32_bf16 v[132:135], a[132:135], a[20:23], v[132:135]
  ds_read_b64_tr_b16 a[158:159], v24 offset:17984
  v_mfma_f32_16x16x32_bf16 v[128:131], a[132:135], a[16:19], v[128:131]
  s_waitcnt lgkmcnt(10)
  v_mfma_f32_16x16x32_bf16 v[160:163], a[136:139], a[16:19], v[160:163]
  ds_read_b64_tr_b16 a[160:161], v24 offset:14432
  global_load_dwordx2 v[18:19], v16, s[4:5] sc1
  v_mfma_f32_16x16x32_bf16 v[164:167], a[136:139], a[20:23], v[164:167]
  v_mfma_f32_16x16x32_bf16 v[168:171], a[136:139], a[24:27], v[168:171]
  ds_read_b64_tr_b16 a[162:163], v24 offset:18016
  v_mfma_f32_16x16x32_bf16 v[172:175], a[136:139], a[28:31], v[172:175]
  s_waitcnt lgkmcnt(10)
  v_mfma_f32_16x16x32_bf16 v[204:207], a[140:143], a[28:31], v[204:207]
  ds_read_b64_tr_b16 a[164:165], v24 offset:14464
  v_mfma_f32_16x16x32_bf16 v[200:203], a[140:143], a[24:27], v[200:203]
  v_mfma_f32_16x16x32_bf16 v[196:199], a[140:143], a[20:23], v[196:199]
  ds_read_b64_tr_b16 a[166:167], v24 offset:18048
  v_mfma_f32_16x16x32_bf16 v[192:195], a[140:143], a[16:19], v[192:195]
  s_waitcnt vmcnt(12) lgkmcnt(10)
  v_mfma_f32_16x16x32_bf16 v[224:227], a[144:147], a[32:35], v[224:227]
  ds_read_b64_tr_b16 a[128:129], v24 offset:14496
  v_mfma_f32_16x16x32_bf16 v[228:231], a[144:147], a[36:39], v[228:231]
  v_mfma_f32_16x16x32_bf16 v[232:235], a[144:147], a[40:43], v[232:235]
  ds_read_b64_tr_b16 a[130:131], v24 offset:18080
  v_mfma_f32_16x16x32_bf16 v[236:239], a[144:147], a[44:47], v[236:239]
  s_waitcnt lgkmcnt(10)
  v_mfma_f32_16x16x32_bf16 v[44:47], a[148:151], a[44:47], v[44:47]
  ds_read_b64_tr_b16 a[132:133], v24 offset:21696
  v_mfma_f32_16x16x32_bf16 v[40:43], a[148:151], a[40:43], v[40:43]
  v_mfma_f32_16x16x32_bf16 v[36:39], a[148:151], a[36:39], v[36:39]
  ds_read_b64_tr_b16 a[134:135], v24 offset:25280
  v_mfma_f32_16x16x32_bf16 v[32:35], a[148:151], a[32:35], v[32:35]
  s_waitcnt lgkmcnt(10)
  v_mfma_f32_16x16x32_bf16 v[64:67], a[152:155], a[32:35], v[64:67]
  ds_read_b64_tr_b16 a[136:137], v24 offset:21504
  v_mfma_f32_16x16x32_bf16 v[68:71], a[152:155], a[36:39], v[68:71]
  v_mfma_f32_16x16x32_bf16 v[72:75], a[152:155], a[40:43], v[72:75]
  ds_read_b64_tr_b16 a[138:139], v24 offset:25088
  v_mfma_f32_16x16x32_bf16 v[76:79], a[152:155], a[44:47], v[76:79]
  s_waitcnt lgkmcnt(10)
  v_mfma_f32_16x16x32_bf16 v[108:111], a[156:159], a[44:47], v[108:111]
  ds_read_b64_tr_b16 a[140:141], v24 offset:21536
  v_mfma_f32_16x16x32_bf16 v[104:107], a[156:159], a[40:43], v[104:107]
  v_mfma_f32_16x16x32_bf16 v[100:103], a[156:159], a[36:39], v[100:103]
  ds_read_b64_tr_b16 a[142:143], v24 offset:25120
  v_mfma_f32_16x16x32_bf16 v[96:99], a[156:159], a[32:35], v[96:99]
  s_waitcnt lgkmcnt(10)
  v_mfma_f32_16x16x32_bf16 v[128:131], a[160:163], a[32:35], v[128:131]
  ds_read_b64_tr_b16 a[144:145], v24 offset:21568
  v_mfma_f32_16x16x32_bf16 v[132:135], a[160:163], a[36:39], v[132:135]
  v_mfma_f32_16x16x32_bf16 v[136:139], a[160:163], a[40:43], v[136:139]
  ds_read_b64_tr_b16 a[146:147], v24 offset:25152
  v_mfma_f32_16x16x32_bf16 v[140:143], a[160:163], a[44:47], v[140:143]
  s_waitcnt lgkmcnt(10)
  v_mfma_f32_16x16x32_bf16 v[172:175], a[164:167], a[44:47], v[172:175]
  ds_read_b64_tr_b16 a[148:149], v24 offset:21600
  v_mfma_f32_16x16x32_bf16 v[168:171], a[164:167], a[40:43], v[168:171]
  v_mfma_f32_16x16x32_bf16 v[164:167], a[164:167], a[36:39], v[164:167]
  ds_read_b64_tr_b16 a[150:151], v24 offset:25184
  v_mfma_f32_16x16x32_bf16 v[160:163], a[164:167], a[32:35], v[160:163]
  s_waitcnt vmcnt(0) lgkmcnt(10)
  v_cmp_ne_u64_e64 vcc, s[6:7], v[18:19]
  s_cbranch_vccnz L_slow_26
L_back_27:
  v_mfma_f32_16x16x32_bf16 v[192:195], a[128:131], a[32:35], v[192:195]
  s_mov_b32 s39, 4096
  ds_read_b64_tr_b16 a[152:153], v24 offset:21632
  v_mfma_f32_16x16x32_bf16 v[196:199], a[128:131], a[36:39], v[196:199]
  buffer_load_dwordx4 a[64:67], v8, s[16:19], s39 offen offset:0 sc1
  s_mov_b32 s39, 36864
  v_mfma_f32_16x16x32_bf16 v[200:203], a[128:131], a[40:43], v[200:203]
  ds_read_b64_tr_b16 a[154:155], v24 offset:25216
  v_mfma_f32_16x16x32_bf16 v[204:207], a[128:131], a[44:47], v[204:207]
  s_waitcnt vmcnt(9) lgkmcnt(10)
  v_mfma_f32_16x16x32_bf16 v[236:239], a[132:135], a[60:63], v[236:239]
  ds_read_b64_tr_b16 a[156:157], v24 offset:21664
  v_mfma_f32_16x16x32_bf16 v[232:235], a[132:135], a[56:59], v[232:235]
  buffer_load_dwordx4 a[68:71], v8, s[16:19], s39 offen offset:0 sc1
  s_mov_b32 s39, 69632
  v_mfma_f32_16x16x32_bf16 v[228:231], a[132:135], a[52:55], v[228:231]
  ds_read_b64_tr_b16 a[158:159], v24 offset:25248
  v_mfma_f32_16x16x32_bf16 v[224:227], a[132:135], a[48:51], v[224:227]
  s_waitcnt vmcnt(26) lgkmcnt(10)
  v_mfma_f32_16x16x32_bf16 v[32:35], a[136:139], a[48:51], v[32:35]
  s_barrier
  ds_read_b64_tr_b16 a[160:161], v24 offset:32960
  v_mfma_f32_16x16x32_bf16 v[36:39], a[136:139], a[52:55], v[36:39]
  v_mfma_f32_16x16x32_bf16 v[40:43], a[136:139], a[56:59], v[40:43]
  ds_read_b64_tr_b16 a[162:163], v24 offset:36544
  v_mfma_f32_16x16x32_bf16 v[44:47], a[136:139], a[60:63], v[44:47]
  s_waitcnt lgkmcnt(10)
  buffer_load_dwordx4 a[72:75], v8, s[16:19], s39 offen offset:0 sc1
  s_mov_b32 s39, 102400
  v_mfma_f32_16x16x32_bf16 v[76:79], a[140:143], a[60:63], v[76:79]
  ds_read_b64_tr_b16 a[164:165], v24 offset:40128
  v_mfma_f32_16x16x32_bf16 v[72:75], a[140:143], a[56:59], v[72:75]
  v_mfma_f32_16x16x32_bf16 v[68:71], a[140:143], a[52:55], v[68:71]
  ds_read_b64_tr_b16 a[166:167], v24 offset:43712
  v_mfma_f32_16x16x32_bf16 v[64:67], a[140:143], a[48:51], v[64:67]
  s_waitcnt lgkmcnt(10)
  v_mfma_f32_16x16x32_bf16 v[96:99], a[144:147], a[48:51], v[96:99]
L_pad_2b_0:
  s_cbranch_execz L_pad_2b_3
  ds_read_b64_tr_b16 a[128:129], v24 offset:47296
  v_mfma_f32_16x16x32_bf16 v[100:103], a[144:147], a[52:55], v[100:103]
  buffer_load_dwordx4 a[76:79], v8, s[16:19], s39 offen offset:0 sc1
  v_mfma_f32_16x16x32_bf16 v[104:107], a[144:147], a[56:59], v[104:107]
  ds_read_b64_tr_b16 a[130:131], v24 offset:50880
  v_mfma_f32_16x16x32_bf16 v[108:111], a[144:147], a[60:63], v[108:111]
  s_waitcnt lgkmcnt(10)
  v_mfma_f32_16x16x32_bf16 v[140:143], a[148:151], a[60:63], v[140:143]
  ds_read_b64_tr_b16 a[132:133], v24 offset:54464
  v_mfma_f32_16x16x32_bf16 v[136:139], a[148:151], a[56:59], v[136:139]
  v_mfma_f32_16x16x32_bf16 v[132:135], a[148:151], a[52:55], v[132:135]
  ds_read_b64_tr_b16 a[134:135], v24 offset:58048
  v_mfma_f32_16x16x32_bf16 v[128:131], a[148:151], a[48:51], v[128:131]
  s_waitcnt lgkmcnt(10)
  v_mfma_f32_16x16x32_bf16 v[160:163], a[152:155], a[48:51], v[160:163]
  ds_read_b64_tr_b16 a[136:137], v24 offset:32768
  v_mfma_f32_16x16x32_bf16 v[164:167], a[152:155], a[52:55], v[164:167]
  v_mfma_f32_16x16x32_bf16 v[168:171], a[152:155], a[56:59], v[168:171]
  ds_read_b64_tr_b16 a[138:139], v24 offset:36352
  v_mfma_f32_16x16x32_bf16 v[172:175], a[152:155], a[60:63], v[172:175]
  s_waitcnt lgkmcnt(10)
  v_mfma_f32_16x16x32_bf16 v[204:207], a[156:159], a[60:63], v[204:207]
  ds_read_b64_tr_b16 a[140:141], v24 offset:39936
  v_mfma_f32_16x16x32_bf16 v[200:203], a[156:159], a[56:59], v[200:203]
  v_mfma_f32_16x16x32_bf16 v[196:199], a[156:159], a[52:55], v[196:199]
  ds_read_b64_tr_b16 a[142:143], v24 offset:43520
  v_mfma_f32_16x16x32_bf16 v[192:195], a[156:159], a[48:51], v[192:195]
  s_waitcnt lgkmcnt(4)
  v_mfma_f32_16x16x32_bf16 v[240:243], a[160:163], a[0:3], 0
  s_mov_b32 s39, 4096
  ds_read_b64_tr_b16 a[144:145], v24 offset:47104
  v_mfma_f32_16x16x32_bf16 v[240:243], a[164:167], a[16:19], v[240:243]
  buffer_load_dwordx4 a[80:83], v8, s[16:19], s39 offen offset:1024 sc1
  v_mfma_f32_16x16x32_bf16 v[240:243], a[128:131], a[32:35], v[240:243]
  ds_read_b64_tr_b16 a[146:147], v24 offset:50688
  v_mfma_f32_16x16x32_bf16 v[240:243], a[132:135], a[48:51], v[240:243]
  v_mfma_f32_16x16x32_bf16 v[244:247], a[132:135], a[52:55], 0
  ds_read_b64_tr_b16 a[148:149], v24 offset:54272
  v_mfma_f32_16x16x32_bf16 v[244:247], a[128:131], a[36:39], v[244:247]
  buffer_load_dwordx4 a[96:99], v8, s[16:19], s39 offen offset:2048 sc1
  v_mfma_f32_16x16x32_bf16 v[244:247], a[164:167], a[20:23], v[244:247]
  ds_read_b64_tr_b16 a[150:151], v24 offset:57856
  v_mfma_f32_16x16x32_bf16 v[244:247], a[160:163], a[4:7], v[244:247]
  v_mfma_f32_16x16x32_bf16 v[248:251], a[160:163], a[8:11], 0
  ds_read_b64_tr_b16 a[152:153], v24 offset:32800
  v_mfma_f32_16x16x32_bf16 v[248:251], a[164:167], a[24:27], v[248:251]
  buffer_load_dwordx4 a[112:115], v8, s[16:19], s39 offen offset:3072 sc1
  s_mov_b32 s39, 36864
  v_mfma_f32_16x16x32_bf16 v[248:251], a[128:131], a[40:43], v[248:251]
  ds_read_b64_tr_b16 a[154:155], v24 offset:36384
  v_mfma_f32_16x16x32_bf16 v[248:251], a[132:135], a[56:59], v[248:251]
  v_mfma_f32_16x16x32_bf16 v[252:255], a[132:135], a[60:63], 0
  ds_read_b64_tr_b16 a[156:157], v24 offset:39968
  v_mfma_f32_16x16x32_bf16 v[252:255], a[128:131], a[44:47], v[252:255]
  buffer_load_dwordx4 a[84:87], v8, s[16:19], s39 offen offset:1024 sc1
  v_mfma_f32_16x16x32_bf16 v[252:255], a[164:167], a[28:31], v[252:255]
  ds_read_b64_tr_b16 a[158:159], v24 offset:43552
  v_mfma_f32_16x16x32_bf16 v[252:255], a[160:163], a[12:15], v[252:255]
  s_waitcnt lgkmcnt(4)
  v_mfma_f32_16x16x32_bf16 v[60:63], a[136:139], a[12:15], 0
  ds_read_b64_tr_b16 a[160:161], v24 offset:47136
  v_mfma_f32_16x16x32_bf16 v[60:63], a[140:143], a[28:31], v[60:63]
  v_mfma_f32_16x16x32_bf16 v[60:63], a[144:147], a[44:47], v[60:63]
  ds_read_b64_tr_b16 a[162:163], v24 offset:50720
  v_mfma_f32_16x16x32_bf16 v[60:63], a[148:151], a[60:63], v[60:63]
  buffer_load_dwordx4 a[100:103], v8, s[16:19], s39 offen offset:2048 sc1
  v_mfma_f32_16x16x32_bf16 v[56:59], a[148:151], a[56:59], 0
  ds_read_b64_tr_b16 a[164:165], v24 offset:54304
  v_mfma_f32_16x16x32_bf16 v[56:59], a[144:147], a[40:43], v[56:59]
  v_mfma_f32_16x16x32_bf16 v[56:59], a[140:143], a[24:27], v[56:59]
  ds_read_b64_tr_b16 a[166:167], v24 offset:57888
  v_mfma_f32_16x16x32_bf16 v[56:59], a[136:139], a[8:11], v[56:59]
  buffer_load_dwordx4 a[116:119], v8, s[16:19], s39 offen offset:3072 sc1
  s_mov_b32 s39, 69632
  v_mfma_f32_16x16x32_bf16 v[52:55], a[136:139], a[4:7], 0
  ds_read_b64_tr_b16 a[128:129], v24 offset:32832
  v_mfma_f32_16x16x32_bf16 v[52:55], a[140:143], a[20:23], v[52:55]
  v_mfma_f32_16x16x32_bf16 v[52:55], a[144:147], a[36:39], v[52:55]
  ds_read_b64_tr_b16 a[130:131], v24 offset:36416
  v_mfma_f32_16x16x32_bf16 v[52:55], a[148:151], a[52:55], v[52:55]
  buffer_load_dwordx4 a[88:91], v8, s[16:19], s39 offen offset:1024 sc1
  v_mfma_f32_16x16x32_bf16 v[48:51], a[148:151], a[48:51], 0
  ds_read_b64_tr_b16 a[132:133], v24 offset:40000
  v_mfma_f32_16x16x32_bf16 v[48:51], a[144:147], a[32:35], v[48:51]
  v_mfma_f32_16x16x32_bf16 v[48:51], a[140:143], a[16:19], v[48:51]
  ds_read_b64_tr_b16 a[134:135], v24 offset:43584
  v_mfma_f32_16x16x32_bf16 v[48:51], a[136:139], a[0:3], v[48:51]
  s_waitcnt lgkmcnt(4)
  v_mfma_f32_16x16x32_bf16 v[80:83], a[152:155], a[0:3], 0
  ds_read_b64_tr_b16 a[136:137], v24 offset:47168
  v_mfma_f32_16x16x32_bf16 v[80:83], a[156:159], a[16:19], v[80:83]
  buffer_load_dwordx4 a[104:107], v8, s[16:19], s39 offen offset:2048 sc1
  v_mfma_f32_16x16x32_bf16 v[80:83], a[160:163], a[32:35], v[80:83]
  ds_read_b64_tr_b16 a[138:139], v24 offset:50752
  v_mfma_f32_16x16x32_bf16 v[80:83], a[164:167], a[48:51], v[80:83]
  v_mfma_f32_16x16x32_bf16 v[84:87], a[164:167], a[52:55], 0
  ds_read_b64_tr_b16 a[140:141], v24 offset:54336
  v_mfma_f32_16x16x32_bf16 v[84:87], a[160:163], a[36:39], v[84:87]
  buffer_load_dwordx4 a[120:123], v8, s[16:19], s39 offen offset:3072 sc1
  s_mov_b32 s39, 102400
  v_mfma_f32_16x16x32_bf16 v[84:87], a[156:159], a[20:23], v[84:87]
  ds_read_b64_tr_b16 a[142:143], v24 offset:57920
  v_mfma_f32_16x16x32_bf16 v[84:87], a[152:155], a[4:7], v[84:87]
  v_mfma_f32_16x16x32_bf16 v[88:91], a[152:155], a[8:11], 0
  ds_read_b64_tr_b16 a[144:145], v24 offset:32864
  v_mfma_f32_16x16x32_bf16 v[88:91], a[156:159], a[24:27], v[88:91]
  buffer_load_dwordx4 a[92:95], v8, s[16:19], s39 offen offset:1024 sc1
  v_mfma_f32_16x16x32_bf16 v[88:91], a[160:163], a[40:43], v[88:91]
  ds_read_b64_tr_b16 a[146:147], v24 offset:36448
  v_mfma_f32_16x16x32_bf16 v[88:91], a[164:167], a[56:59], v[88:91]
  v_mfma_f32_16x16x32_bf16 v[92:95], a[164:167], a[60:63], 0
  ds_read_b64_tr_b16 a[148:149], v24 offset:40032
  v_mfma_f32_16x16x32_bf16 v[92:95], a[160:163], a[44:47], v[92:95]
  buffer_load_dwordx4 a[108:111], v8, s[16:19], s39 offen offset:2048 sc1
  v_mfma_f32_16x16x32_bf16 v[92:95], a[156:159], a[28:31], v[92:95]
  ds_read_b64_tr_b16 a[150:151], v24 offset:43616
  v_mfma_f32_16x16x32_bf16 v[92:95], a[152:155], a[12:15], v[92:95]
  s_waitcnt lgkmcnt(4)
  v_mfma_f32_16x16x32_bf16 v[124:127], a[128:131], a[12:15], 0
  ds_read_b64_tr_b16 a[152:153], v24 offset:47200
  v_mfma_f32_16x16x32_bf16 v[124:127], a[132:135], a[28:31], v[124:127]
  v_mfma_f32_16x16x32_bf16 v[124:127], a[136:139], a[44:47], v[124:127]
  ds_read_b64_tr_b16 a[154:155], v24 offset:50784
  v_mfma_f32_16x16x32_bf16 v[124:127], a[140:143], a[60:63], v[124:127]
  buffer_load_dwordx4 a[124:127], v8, s[16:19], s39 offen offset:3072 sc1
  s_mov_b32 s38, 917504
  v_mfma_f32_16x16x32_bf16 v[120:123], a[140:143], a[56:59], 0
  s_add_u32 m0, s77, 98304
  ds_read_b64_tr_b16 a[156:157], v24 offset:54368
  v_mfma_f32_16x16x32_bf16 v[120:123], a[136:139], a[40:43], v[120:123]
  v_mfma_f32_16x16x32_bf16 v[120:123], a[132:135], a[24:27], v[120:123]
  ds_read_b64_tr_b16 a[158:159], v24 offset:57952
  v_mfma_f32_16x16x32_bf16 v[120:123], a[128:131], a[8:11], v[120:123]
  buffer_load_dwordx4 v4, s[96:99], s38 offen offset:0 lds
  v_mfma_f32_16x16x32_bf16 v[116:119], a[128:131], a[4:7], 0
  ds_read_b64_tr_b16 a[160:161], v24 offset:32896
  v_mfma_f32_16x16x32_bf16 v[116:119], a[132:135], a[20:23], v[116:119]
  v_mfma_f32_16x16x32_bf16 v[116:119], a[136:139], a[36:39], v[116:119]
  ds_read_b64_tr_b16 a[162:163], v24 offset:36480
  v_mfma_f32_16x16x32_bf16 v[116:119], a[140:143], a[52:55], v[116:119]
  buffer_load_dwordx4 v5, s[96:99], s38 offen offset:1024 lds
  v_mfma_f32_16x16x32_bf16 v[112:115], a[140:143], a[48:51], 0
  ds_read_b64_tr_b16 a[164:165], v24 offset:40064
  v_mfma_f32_16x16x32_bf16 v[112:115], a[136:139], a[32:35], v[112:115]
  v_mfma_f32_16x16x32_bf16 v[112:115], a[132:135], a[16:19], v[112:115]
  ds_read_b64_tr_b16 a[166:167], v24 offset:43648
  v_mfma_f32_16x16x32_bf16 v[112:115], a[128:131], a[0:3], v[112:115]
  s_waitcnt lgkmcnt(4)
  v_mfma_f32_16x16x32_bf16 v[144:147], a[144:147], a[0:3], 0
  ds_read_b64_tr_b16 a[128:129], v24 offset:47232
  v_mfma_f32_16x16x32_bf16 v[144:147], a[148:151], a[16:19], v[144:147]
  buffer_load_dwordx4 v6, s[96:99], s38 offen offset:2048 lds
  v_mfma_f32_16x16x32_bf16 v[144:147], a[152:155], a[32:35], v[144:147]
  ds_read_b64_tr_b16 a[130:131], v24 offset:50816
  v_mfma_f32_16x16x32_bf16 v[144:147], a[156:159], a[48:51], v[144:147]
  v_mfma_f32_16x16x32_bf16 v[148:151], a[156:159], a[52:55], 0
  ds_read_b64_tr_b16 a[132:133], v24 offset:54400
  v_mfma_f32_16x16x32_bf16 v[148:151], a[152:155], a[36:39], v[148:151]
  buffer_load_dwordx4 v7, s[96:99], s38 offen offset:3072 lds
  s_add_u32 m0, s77, 102400
  v_mfma_f32_16x16x32_bf16 v[148:151], a[148:151], a[20:23], v[148:151]
  ds_read_b64_tr_b16 a[134:135], v24 offset:57984
  v_mfma_f32_16x16x32_bf16 v[148:151], a[144:147], a[4:7], v[148:151]
  v_mfma_f32_16x16x32_bf16 v[152:155], a[144:147], a[8:11], 0
  ds_read_b64_tr_b16 a[136:137], v24 offset:32928
  v_mfma_f32_16x16x32_bf16 v[152:155], a[148:151], a[24:27], v[152:155]
  buffer_load_dwordx4 v12, s[96:99], s38 offen offset:0 lds
  v_mfma_f32_16x16x32_bf16 v[152:155], a[152:155], a[40:43], v[152:155]
  ds_read_b64_tr_b16 a[138:139], v24 offset:36512
  v_mfma_f32_16x16x32_bf16 v[152:155], a[156:159], a[56:59], v[152:155]
  v_mfma_f32_16x16x32_bf16 v[156:159], a[156:159], a[60:63], 0
  ds_read_b64_tr_b16 a[140:141], v24 offset:40096
  v_mfma_f32_16x16x32_bf16 v[156:159], a[152:155], a[44:47], v[156:159]
  v_mfma_f32_16x16x32_bf16 v[156:159], a[148:151], a[28:31], v[156:159]
  ds_read_b64_tr_b16 a[142:143], v24 offset:43680
  v_mfma_f32_16x16x32_bf16 v[156:159], a[144:147], a[12:15], v[156:159]
  s_waitcnt lgkmcnt(4)
  buffer_load_dwordx4 v13, s[96:99], s38 offen offset:1024 lds
  v_mfma_f32_16x16x32_bf16 v[188:191], a[160:163], a[12:15], 0
  ds_read_b64_tr_b16 a[144:145], v24 offset:47264
  v_mfma_f32_16x16x32_bf16 v[188:191], a[164:167], a[28:31], v[188:191]
  v_mfma_f32_16x16x32_bf16 v[188:191], a[128:131], a[44:47], v[188:191]
  ds_read_b64_tr_b16 a[146:147], v24 offset:50848
  v_mfma_f32_16x16x32_bf16 v[188:191], a[132:135], a[60:63], v[188:191]
  buffer_load_dwordx4 v14, s[96:99], s38 offen offset:2048 lds
  v_mfma_f32_16x16x32_bf16 v[184:187], a[132:135], a[56:59], 0
  ds_read_b64_tr_b16 a[148:149], v24 offset:54432
  v_mfma_f32_16x16x32_bf16 v[184:187], a[128:131], a[40:43], v[184:187]
  v_mfma_f32_16x16x32_bf16 v[184:187], a[164:167], a[24:27], v[184:187]
  ds_read_b64_tr_b16 a[150:151], v24 offset:58016
  v_mfma_f32_16x16x32_bf16 v[184:187], a[160:163], a[8:11], v[184:187]
  s_waitcnt vmcnt(24)
  buffer_load_dword v0, v26, s[20:23], 0 offen
  v_add_u32 v26, 917504, v26
  v_mfma_f32_16x16x32_bf16 v[180:183], a[160:163], a[4:7], 0
  s_barrier
  ds_read_b64_tr_b16 a[152:153], v25 offset:192
  v_mfma_f32_16x16x32_bf16 v[180:183], a[164:167], a[20:23], v[180:183]
  v_mfma_f32_16x16x32_bf16 v[180:183], a[128:131], a[36:39], v[180:183]
  ds_read_b64_tr_b16 a[154:155], v25 offset:3776
  v_mfma_f32_16x16x32_bf16 v[180:183], a[132:135], a[52:55], v[180:183]
  v_mfma_f32_16x16x32_bf16 v[176:179], a[132:135], a[48:51], 0
  ds_read_b64_tr_b16 a[156:157], v25 offset:7360
  v_mfma_f32_16x16x32_bf16 v[176:179], a[128:131], a[32:35], v[176:179]
  v_mfma_f32_16x16x32_bf16 v[176:179], a[164:167], a[16:19], v[176:179]
  ds_read_b64_tr_b16 a[158:159], v25 offset:10944
  v_mfma_f32_16x16x32_bf16 v[176:179], a[160:163], a[0:3], v[176:179]
  s_waitcnt lgkmcnt(4)
  v_mfma_f32_16x16x32_bf16 v[208:211], a[136:139], a[0:3], 0
  ds_read_b64_tr_b16 a[160:161], v25 offset:14528
  v_mfma_f32_16x16x32_bf16 v[208:211], a[140:143], a[16:19], v[208:211]
  v_mfma_f32_16x16x32_bf16 v[208:211], a[144:147], a[32:35], v[208:211]
  ds_read_b64_tr_b16 a[162:163], v25 offset:18112
  v_mfma_f32_16x16x32_bf16 v[208:211], a[148:151], a[48:51], v[208:211]
  v_mfma_f32_16x16x32_bf16 v[212:215], a[148:151], a[52:55], 0
  ds_read_b64_tr_b16 a[164:165], v25 offset:21696
  v_mfma_f32_16x16x32_bf16 v[212:215], a[144:147], a[36:39], v[212:215]
  v_mfma_f32_16x16x32_bf16 v[212:215], a[140:143], a[20:23], v[212:215]
  ds_read_b64_tr_b16 a[166:167], v25 offset:25280
  v_mfma_f32_16x16x32_bf16 v[212:215], a[136:139], a[4:7], v[212:215]
  v_mfma_f32_16x16x32_bf16 v[216:219], a[136:139], a[8:11], 0
  ds_read_b64_tr_b16 a[128:129], v25 offset:0
  v_mfma_f32_16x16x32_bf16 v[216:219], a[140:143], a[24:27], v[216:219]
  v_mfma_f32_16x16x32_bf16 v[216:219], a[144:147], a[40:43], v[216:219]
  ds_read_b64_tr_b16 a[130:131], v25 offset:3584
  v_mfma_f32_16x16x32_bf16 v[216:219], a[148:151], a[56:59], v[216:219]
  v_mfma_f32_16x16x32_bf16 v[220:223], a[148:151], a[60:63], 0
  ds_read_b64_tr_b16 a[132:133], v25 offset:7168
  v_mfma_f32_16x16x32_bf16 v[220:223], a[144:147], a[44:47], v[220:223]
  v_mfma_f32_16x16x32_bf16 v[220:223], a[140:143], a[28:31], v[220:223]
  ds_read_b64_tr_b16 a[134:135], v25 offset:10752
  v_mfma_f32_16x16x32_bf16 v[220:223], a[136:139], a[12:15], v[220:223]
  s_waitcnt vmcnt(8) lgkmcnt(4)
  v_mfma_f32_16x16x32_bf16 v[236:239], a[152:155], a[76:79], v[236:239]
  s_mov_b32 s39, 8192
  ds_read_b64_tr_b16 a[136:137], v25 offset:14336
  v_mfma_f32_16x16x32_bf16 v[236:239], a[156:159], a[92:95], v[236:239]
  buffer_load_dwordx4 a[0:3], v8, s[16:19], s39 offen offset:0 sc1
  s_mov_b32 s38, 1835008
  v_mfma_f32_16x16x32_bf16 v[236:239], a[160:163], a[108:111], v[236:239]
  s_add_u32 m0, s77, 0
  ds_read_b64_tr_b16 a[138:139], v25 offset:17920
  v_mfma_f32_16x16x32_bf16 v[236:239], a[164:167], a[124:127], v[236:239]
  v_mfma_f32_16x16x32_bf16 v[232:235], a[164:167], a[120:123], v[232:235]
  ds_read_b64_tr_b16 a[140:141], v25 offset:21504
  v_mfma_f32_16x16x32_bf16 v[232:235], a[160:163], a[104:107], v[232:235]
  buffer_load_dwordx4 v4, s[12:15], s38 offen offset:0 lds
  v_mfma_f32_16x16x32_bf16 v[232:235], a[156:159], a[88:91], v[232:235]
  ds_read_b64_tr_b16 a[142:143], v25 offset:25088
  v_mfma_f32_16x16x32_bf16 v[232:235], a[152:155], a[72:75], v[232:235]
  v_mfma_f32_16x16x32_bf16 v[228:231], a[152:155], a[68:71], v[228:231]
  ds_read_b64_tr_b16 a[144:145], v25 offset:32
  v_mfma_f32_16x16x32_bf16 v[228:231], a[156:159], a[84:87], v[228:231]
  v_mfma_f32_16x16x32_bf16 v[228:231], a[160:163], a[100:103], v[228:231]
  ds_read_b64_tr_b16 a[146:147], v25 offset:3616
  v_mfma_f32_16x16x32_bf16 v[228:231], a[164:167], a[116:119], v[228:231]
  buffer_load_dwordx4 a[16:19], v8, s[16:19], s39 offen offset:1024 sc1
  v_mfma_f32_16x16x32_bf16 v[224:227], a[164:167], a[112:115], v[224:227]
  ds_read_b64_tr_b16 a[148:149], v25 offset:7200
  v_mfma_f32_16x16x32_bf16 v[224:227], a[160:163], a[96:99], v[224:227]
  v_mfma_f32_16x16x32_bf16 v[224:227], a[156:159], a[80:83], v[224:227]
  ds_read_b64_tr_b16 a[150:151], v25 offset:10784
  v_mfma_f32_16x16x32_bf16 v[224:227], a[152:155], a[64:67], v[224:227]
  s_waitcnt lgkmcnt(4)
  v_mfma_f32_16x16x32_bf16 v[32:35], a[128:131], a[64:67], v[32:35]
  ds_read_b64_tr_b16 a[152:153], v25 offset:14368
  v_mfma_f32_16x16x32_bf16 v[32:35], a[132:135], a[80:83], v[32:35]
  buffer_load_dwordx4 v5, s[12:15], s38 offen offset:1024 lds
  s_mov_b32 s39, 40960
  v_mfma_f32_16x16x32_bf16 v[32:35], a[136:139], a[96:99], v[32:35]
  ds_read_b64_tr_b16 a[154:155], v25 offset:17952
  v_mfma_f32_16x16x32_bf16 v[32:35], a[140:143], a[112:115], v[32:35]
  v_mfma_f32_16x16x32_bf16 v[36:39], a[140:143], a[116:119], v[36:39]
  ds_read_b64_tr_b16 a[156:157], v25 offset:21536
  v_mfma_f32_16x16x32_bf16 v[36:39], a[136:139], a[100:103], v[36:39]
  v_mfma_f32_16x16x32_bf16 v[36:39], a[132:135], a[84:87], v[36:39]
  ds_read_b64_tr_b16 a[158:159], v25 offset:25120
  v_mfma_f32_16x16x32_bf16 v[36:39], a[128:131], a[68:71], v[36:39]
  buffer_load_dwordx4 a[4:7], v8, s[16:19], s39 offen offset:0 sc1
  v_mfma_f32_16x16x32_bf16 v[40:43], a[128:131], a[72:75], v[40:43]
  ds_read_b64_tr_b16 a[160:161], v25 offset:64
  v_mfma_f32_16x16x32_bf16 v[40:43], a[132:135], a[88:91], v[40:43]
  v_mfma_f32_16x16x32_bf16 v[40:43], a[136:139], a[104:107], v[40:43]
  ds_read_b64_tr_b16 a[162:163], v25 offset:3648
  v_mfma_f32_16x16x32_bf16 v[40:43], a[140:143], a[120:123], v[40:43]
  buffer_load_dwordx4 v6, s[12:15], s38 offen offset:2048 lds
  v_mfma_f32_16x16x32_bf16 v[44:47], a[140:143], a[124:127], v[44:47]
  ds_read_b64_tr_b16 a[164:165], v25 offset:7232
  v_mfma_f32_16x16x32_bf16 v[44:47], a[136:139], a[108:111], v[44:47]
  v_mfma_f32_16x16x32_bf16 v[44:47], a[132:135], a[92:95], v[44:47]
  ds_read_b64_tr_b16 a[166:167], v25 offset:10816
  v_mfma_f32_16x16x32_bf16 v[44:47], a[128:131], a[76:79], v[44:47]
  s_waitcnt lgkmcnt(4)
  v_mfma_f32_16x16x32_bf16 v[76:79], a[144:147], a[76:79], v[76:79]
  ds_read_b64_tr_b16 a[128:129], v25 offset:14400
  v_mfma_f32_16x16x32_bf16 v[76:79], a[148:151], a[92:95], v[76:79]
  buffer_load_dwordx4 a[20:23], v8, s[16:19], s39 offen offset:1024 sc1
  v_mfma_f32_16x16x32_bf16 v[76:79], a[152:155], a[108:111], v[76:79]
  ds_read_b64_tr_b16 a[130:131], v25 offset:17984
  v_mfma_f32_16x16x32_bf16 v[76:79], a[156:159], a[124:127], v[76:79]
  v_mfma_f32_16x16x32_bf16 v[72:75], a[156:159], a[120:123], v[72:75]
  ds_read_b64_tr_b16 a[132:133], v25 offset:21568
  v_mfma_f32_16x16x32_bf16 v[72:75], a[152:155], a[104:107], v[72:75]
  v_mfma_f32_16x16x32_bf16 v[72:75], a[148:151], a[88:91], v[72:75]
  ds_read_b64_tr_b16 a[134:135], v25 offset:25152
  v_mfma_f32_16x16x32_bf16 v[72:75], a[144:147], a[72:75], v[72:75]
  buffer_load_dwordx4 v7, s[12:15], s38 offen offset:3072 lds
  s_mov_b32 s39, 73728
  v_mfma_f32_16x16x32_bf16 v[68:71], a[144:147], a[68:71], v[68:71]
  ds_read_b64_tr_b16 a[136:137], v25 offset:96
  v_mfma_f32_16x16x32_bf16 v[68:71], a[148:151], a[84:87], v[68:71]
  v_mfma_f32_16x16x32_bf16 v[68:71], a[152:155], a[100:103], v[68:71]
  ds_read_b64_tr_b16 a[138:139], v25 offset:3680
  v_mfma_f32_16x16x32_bf16 v[68:71], a[156:159], a[116:119], v[68:71]
  v_mfma_f32_16x16x32_bf16 v[64:67], a[156:159], a[112:115], v[64:67]
  ds_read_b64_tr_b16 a[140:141], v25 offset:7264
  v_mfma_f32_16x16x32_bf16 v[64:67], a[152:155], a[96:99], v[64:67]
  buffer_load_dwordx4 a[8:11], v8, s[16:19], s39 offen offset:0 sc1
  s_add_u32 m0, s77, 4096
  v_mfma_f32_16x16x32_bf16 v[64:67], a[148:151], a[80:83], v[64:67]
  ds_read_b64_tr_b16 a[142:143], v25 offset:10848
  v_mfma_f32_16x16x32_bf16 v[64:67], a[144:147], a[64:67], v[64:67]
  s_waitcnt lgkmcnt(4)
  v_mfma_f32_16x16x32_bf16 v[96:99], a[160:163], a[64:67], v[96:99]
  ds_read_b64_tr_b16 a[144:145], v25 offset:14432
  v_mfma_f32_16x16x32_bf16 v[96:99], a[164:167], a[80:83], v[96:99]
  buffer_load_dwordx4 v12, s[12:15], s38 offen offset:0 lds
  v_mfma_f32_16x16x32_bf16 v[96:99], a[128:131], a[96:99], v[96:99]
  ds_read_b64_tr_b16 a[146:147], v25 offset:18016
  v_mfma_f32_16x16x32_bf16 v[96:99], a[132:135], a[112:115], v[96:99]
  v_mfma_f32_16x16x32_bf16 v[100:103], a[132:135], a[116:119], v[100:103]
  ds_read_b64_tr_b16 a[148:149], v25 offset:21600
  v_mfma_f32_16x16x32_bf16 v[100:103], a[128:131], a[100:103], v[100:103]
  v_mfma_f32_16x16x32_bf16 v[100:103], a[164:167], a[84:87], v[100:103]
  ds_read_b64_tr_b16 a[150:151], v25 offset:25184
  v_mfma_f32_16x16x32_bf16 v[100:103], a[160:163], a[68:71], v[100:103]
  buffer_load_dwordx4 a[24:27], v8, s[16:19], s39 offen offset:1024 sc1
  v_mfma_f32_16x16x32_bf16 v[104:107], a[160:163], a[72:75], v[104:107]
  ds_read_b64_tr_b16 a[152:153], v25 offset:128
  v_mfma_f32_16x16x32_bf16 v[104:107], a[164:167], a[88:91], v[104:107]
  v_mfma_f32_16x16x32_bf16 v[104:107], a[128:131], a[104:107], v[104:107]
  ds_read_b64_tr_b16 a[154:155], v25 offset:3712
  v_mfma_f32_16x16x32_bf16 v[104:107], a[132:135], a[120:123], v[104:107]
  v_mfma_f32_16x16x32_bf16 v[108:111], a[132:135], a[124:127], v[108:111]
  ds_read_b64_tr_b16 a[156:157], v25 offset:7296
  v_mfma_f32_16x16x32_bf16 v[108:111], a[128:131], a[108:111], v[108:111]
  buffer_load_dwordx4 v13, s[12:15], s38 offen offset:1024 lds
  s_mov_b32 s39, 106496
  v_mfma_f32_16x16x32_bf16 v[108:111], a[164:167], a[92:95], v[108:111]
  ds_read_b64_tr_b16 a[158:159], v25 offset:10880
  v_mfma_f32_16x16x32_bf16 v[108:111], a[160:163], a[76:79], v[108:111]
  s_waitcnt lgkmcnt(4)
  v_mfma_f32_16x16x32_bf16 v[140:143], a[136:139], a[76:79], v[140:143]
  ds_read_b64_tr_b16 a[160:161], v25 offset:14464
  v_mfma_f32_16x16x32_bf16 v[140:143], a[140:143], a[92:95], v[140:143]
  v_mfma_f32_16x16x32_bf16 v[140:143], a[144:147], a[108:111], v[140:143]
  ds_read_b64_tr_b16 a[162:163], v25 offset:18048
  v_mfma_f32_16x16x32_bf16 v[140:143], a[148:151], a[124:127], v[140:143]
  buffer_load_dwordx4 a[12:15], v8, s[16:19], s39 offen offset:0 sc1
  v_mfma_f32_16x16x32_bf16 v[136:139], a[148:151], a[120:123], v[136:139]
  ds_read_b64_tr_b16 a[164:165], v25 offset:21632
  v_mfma_f32_16x16x32_bf16 v[136:139], a[144:147], a[104:107], v[136:139]
  v_mfma_f32_16x16x32_bf16 v[136:139], a[140:143], a[88:91], v[136:139]
  ds_read_b64_tr_b16 a[166:167], v25 offset:25216
  v_mfma_f32_16x16x32_bf16 v[136:139], a[136:139], a[72:75], v[136:139]
  buffer_load_dwordx4 v14, s[12:15], s38 offen offset:2048 lds
  v_mfma_f32_16x16x32_bf16 v[132:135], a[136:139], a[68:71], v[132:135]
  ds_read_b64_tr_b16 a[128:129], v25 offset:160
  v_mfma_f32_16x16x32_bf16 v[132:135], a[140:143], a[84:87], v[132:135]
  v_mfma_f32_16x16x32_bf16 v[132:135], a[144:147], a[100:103], v[132:135]
  ds_read_b64_tr_b16 a[130:131], v25 offset:3744
  v_mfma_f32_16x16x32_bf16 v[132:135], a[148:151], a[116:119], v[132:135]
  v_mfma_f32_16x16x32_bf16 v[128:131], a[148:151], a[112:115], v[128:131]
  ds_read_b64_tr_b16 a[132:133], v25 offset:7328
  v_mfma_f32_16x16x32_bf16 v[128:131], a[144:147], a[96:99], v[128:131]
  buffer_load_dwordx4 a[28:31], v8, s[16:19], s39 offen offset:1024 sc1
  v_mfma_f32_16x16x32_bf16 v[128:131], a[140:143], a[80:83], v[128:131]
  ds_read_b64_tr_b16 a[134:135], v25 offset:10912
  v_mfma_f32_16x16x32_bf16 v[128:131], a[136:139], a[64:67], v[128:131]
  s_waitcnt lgkmcnt(4)
  v_mfma_f32_16x16x32_bf16 v[160:163], a[152:155], a[64:67], v[160:163]
  ds_read_b64_tr_b16 a[136:137], v25 offset:14496
  v_mfma_f32_16x16x32_bf16 v[160:163], a[156:159], a[80:83], v[160:163]
  v_mfma_f32_16x16x32_bf16 v[160:163], a[160:163], a[96:99], v[160:163]
  ds_read_b64_tr_b16 a[138:139], v25 offset:18080
  v_mfma_f32_16x16x32_bf16 v[160:163], a[164:167], a[112:115], v[160:163]
  buffer_load_dword v0, v26, s[20:23], 0 offen
  v_add_u32 v26, 917504, v26
  v_mfma_f32_16x16x32_bf16 v[164:167], a[164:167], a[116:119], v[164:167]
  ds_read_b64_tr_b16 a[140:141], v25 offset:21664
  v_mfma_f32_16x16x32_bf16 v[164:167], a[160:163], a[100:103], v[164:167]
  v_mfma_f32_16x16x32_bf16 v[164:167], a[156:159], a[84:87], v[164:167]
  ds_read_b64_tr_b16 a[142:143], v25 offset:25248
  v_mfma_f32_16x16x32_bf16 v[164:167], a[152:155], a[68:71], v[164:167]
  s_waitcnt vmcnt(17)
  v_mfma_f32_16x16x32_bf16 v[168:171], a[152:155], a[72:75], v[168:171]
  s_barrier
  ds_read_b64_tr_b16 a[144:145], v25 offset:32960
  v_mfma_f32_16x16x32_bf16 v[168:171], a[156:159], a[88:91], v[168:171]
  v_mfma_f32_16x16x32_bf16 v[168:171], a[160:163], a[104:107], v[168:171]
  ds_read_b64_tr_b16 a[146:147], v25 offset:36544
  v_mfma_f32_16x16x32_bf16 v[168:171], a[164:167], a[120:123], v[168:171]
  v_mfma_f32_16x16x32_bf16 v[172:175], a[164:167], a[124:127], v[172:175]
  ds_read_b64_tr_b16 a[148:149], v25 offset:40128
  v_mfma_f32_16x16x32_bf16 v[172:175], a[160:163], a[108:111], v[172:175]
  v_mfma_f32_16x16x32_bf16 v[172:175], a[156:159], a[92:95], v[172:175]
  ds_read_b64_tr_b16 a[150:151], v25 offset:43712
  v_mfma_f32_16x16x32_bf16 v[172:175], a[152:155], a[76:79], v[172:175]
  s_waitcnt lgkmcnt(4)
  v_mfma_f32_16x16x32_bf16 v[204:207], a[128:131], a[76:79], v[204:207]
  ds_read_b64_tr_b16 a[152:153], v25 offset:47296
  v_mfma_f32_16x16x32_bf16 v[204:207], a[132:135], a[92:95], v[204:207]
  v_mfma_f32_16x16x32_bf16 v[204:207], a[136:139], a[108:111], v[204:207]
  ds_read_b64_tr_b16 a[154:155], v25 offset:50880
  v_mfma_f32_16x16x32_bf16 v[204:207], a[140:143], a[124:127], v[204:207]
  v_mfma_f32_16x16x32_bf16 v[200:203], a[140:143], a[120:123], v[200:203]
  ds_read_b64_tr_b16 a[156:157], v25 offset:54464
  v_mfma_f32_16x16x32_bf16 v[200:203], a[136:139], a[104:107], v[200:203]
  v_mfma_f32_16x16x32_bf16 v[200:203], a[132:135], a[88:91], v[200:203]
  ds_read_b64_tr_b16 a[158:159], v25 offset:58048
  v_mfma_f32_16x16x32_bf16 v[200:203], a[128:131], a[72:75], v[200:203]
  v_mfma_f32_16x16x32_bf16 v[196:199], a[128:131], a[68:71], v[196:199]
  ds_read_b64_tr_b16 a[160:161], v25 offset:32768
  v_mfma_f32_16x16x32_bf16 v[196:199], a[132:135], a[84:87], v[196:199]
  v_mfma_f32_16x16x32_bf16 v[196:199], a[136:139], a[100:103], v[196:199]
  ds_read_b64_tr_b16 a[162:163], v25 offset:36352
  v_mfma_f32_16x16x32_bf16 v[196:199], a[140:143], a[116:119], v[196:199]
  v_mfma_f32_16x16x32_bf16 v[192:195], a[140:143], a[112:115], v[192:195]
  ds_read_b64_tr_b16 a[164:165], v25 offset:39936
  v_mfma_f32_16x16x32_bf16 v[192:195], a[136:139], a[96:99], v[192:195]
  v_mfma_f32_16x16x32_bf16 v[192:195], a[132:135], a[80:83], v[192:195]
  ds_read_b64_tr_b16 a[166:167], v25 offset:43520
  v_mfma_f32_16x16x32_bf16 v[192:195], a[128:131], a[64:67], v[192:195]
  s_waitcnt lgkmcnt(4)
  v_mfma_f32_16x16x32_bf16 v[240:243], a[144:147], a[64:67], v[240:243]
  s_mov_b32 s39, 8192
  ds_read_b64_tr_b16 a[128:129], v25 offset:47104
  v_mfma_f32_16x16x32_bf16 v[240:243], a[148:151], a[80:83], v[240:243]
  buffer_load_dwordx4 a[32:35], v8, s[16:19], s39 offen offset:2048 sc1
  v_mfma_f32_16x16x32_bf16 v[240:243], a[152:155], a[96:99], v[240:243]
  ds_read_b64_tr_b16 a[130:131], v25 offset:50688
  v_mfma_f32_16x16x32_bf16 v[240:243], a[156:159], a[112:115], v[240:243]
  v_mfma_f32_16x16x32_bf16 v[244:247], a[156:159], a[116:119], v[244:247]
  ds_read_b64_tr_b16 a[132:133], v25 offset:54272
  v_mfma_f32_16x16x32_bf16 v[244:247], a[152:155], a[100:103], v[244:247]
  buffer_load_dwordx4 a[48:51], v8, s[16:19], s39 offen offset:3072 sc1
  s_mov_b32 s39, 40960
  v_mfma_f32_16x16x32_bf16 v[244:247], a[148:151], a[84:87], v[244:247]
  ds_read_b64_tr_b16 a[134:135], v25 offset:57856
  v_mfma_f32_16x16x32_bf16 v[244:247], a[144:147], a[68:71], v[244:247]
  v_mfma_f32_16x16x32_bf16 v[248:251], a[144:147], a[72:75], v[248:251]
  ds_read_b64_tr_b16 a[136:137], v25 offset:32800
  v_mfma_f32_16x16x32_bf16 v[248:251], a[148:151], a[88:91], v[248:251]
  v_mfma_f32_16x16x32_bf16 v[248:251], a[152:155], a[104:107], v[248:251]
  ds_read_b64_tr_b16 a[138:139], v25 offset:36384
  v_mfma_f32_16x16x32_bf16 v[248:251], a[156:159], a[120:123], v[248:251]
  buffer_load_dwordx4 a[36:39], v8, s[16:19], s39 offen offset:2048 sc1
  v_mfma_f32_16x16x32_bf16 v[252:255], a[156:159], a[124:127], v[252:255]
  ds_read_b64_tr_b16 a[140:141], v25 offset:39968
  v_mfma_f32_16x16x32_bf16 v[252:255], a[152:155], a[108:111], v[252:255]
  v_mfma_f32_16x16x32_bf16 v[252:255], a[148:151], a[92:95], v[252:255]
  ds_read_b64_tr_b16 a[142:143], v25 offset:43552
  v_mfma_f32_16x16x32_bf16 v[252:255], a[144:147], a[76:79], v[252:255]
  s_waitcnt lgkmcnt(4)
  v_mfma_f32_16x16x32_bf16 v[60:63], a[160:163], a[76:79], v[60:63]
  ds_read_b64_tr_b16 a[144:145], v25 offset:47136
  v_mfma_f32_16x16x32_bf16 v[60:63], a[164:167], a[92:95], v[60:63]
  buffer_load_dwordx4 a[52:55], v8, s[16:19], s39 offen offset:3072 sc1
  s_mov_b32 s39, 73728
  v_mfma_f32_16x16x32_bf16 v[60:63], a[128:131], a[108:111], v[60:63]
  ds_read_b64_tr_b16 a[146:147], v25 offset:50720
  v_mfma_f32_16x16x32_bf16 v[60:63], a[132:135], a[124:127], v[60:63]
  v_mfma_f32_16x16x32_bf16 v[56:59], a[132:135], a[120:123], v[56:59]
  ds_read_b64_tr_b16 a[148:149], v25 offset:54304
  v_mfma_f32_16x16x32_bf16 v[56:59], a[128:131], a[104:107], v[56:59]
  v_mfma_f32_16x16x32_bf16 v[56:59], a[164:167], a[88:91], v[56:59]
  ds_read_b64_tr_b16 a[150:151], v25 offset:57888
  v_mfma_f32_16x16x32_bf16 v[56:59], a[160:163], a[72:75], v[56:59]
  buffer_load_dwordx4 a[40:43], v8, s[16:19], s39 offen offset:2048 sc1
  v_mfma_f32_16x16x32_bf16 v[52:55], a[160:163], a[68:71], v[52:55]
  ds_read_b64_tr_b16 a[152:153], v25 offset:32832
  v_mfma_f32_16x16x32_bf16 v[52:55], a[164:167], a[84:87], v[52:55]
  v_mfma_f32_16x16x32_bf16 v[52:55], a[128:131], a[100:103], v[52:55]
  ds_read_b64_tr_b16 a[154:155], v25 offset:36416
  v_mfma_f32_16x16x32_bf16 v[52:55], a[132:135], a[116:119], v[52:55]
  buffer_load_dwordx4 a[56:59], v8, s[16:19], s39 offen offset:3072 sc1
  s_mov_b32 s39, 106496
  v_mfma_f32_16x16x32_bf16 v[48:51], a[132:135], a[112:115], v[48:51]
  ds_read_b64_tr_b16 a[156:157], v25 offset:40000
  v_mfma_f32_16x16x32_bf16 v[48:51], a[128:131], a[96:99], v[48:51]
  v_mfma_f32_16x16x32_bf16 v[48:51], a[164:167], a[80:83], v[48:51]
  ds_read_b64_tr_b16 a[158:159], v25 offset:43584
  v_mfma_f32_16x16x32_bf16 v[48:51], a[160:163], a[64:67], v[48:51]
  s_waitcnt lgkmcnt(4)
  v_mfma_f32_16x16x32_bf16 v[80:83], a[136:139], a[64:67], v[80:83]
  ds_read_b64_tr_b16 a[160:161], v25 offset:47168
  v_mfma_f32_16x16x32_bf16 v[80:83], a[140:143], a[80:83], v[80:83]
  buffer_load_dwordx4 a[44:47], v8, s[16:19], s39 offen offset:2048 sc1
  v_mfma_f32_16x16x32_bf16 v[80:83], a[144:147], a[96:99], v[80:83]
  ds_read_b64_tr_b16 a[162:163], v25 offset:50752
  v_mfma_f32_16x16x32_bf16 v[80:83], a[148:151], a[112:115], v[80:83]
  v_mfma_f32_16x16x32_bf16 v[84:87], a[148:151], a[116:119], v[84:87]
  ds_read_b64_tr_b16 a[164:165], v25 offset:54336
  v_mfma_f32_16x16x32_bf16 v[84:87], a[144:147], a[100:103], v[84:87]
  v_mfma_f32_16x16x32_bf16 v[84:87], a[140:143], a[84:87], v[84:87]
  ds_read_b64_tr_b16 a[166:167], v25 offset:57920
  v_mfma_f32_16x16x32_bf16 v[84:87], a[136:139], a[68:71], v[84:87]
  buffer_load_dwordx4 a[60:63], v8, s[16:19], s39 offen offset:3072 sc1
  s_mov_b32 s38, 1835008
  v_mfma_f32_16x16x32_bf16 v[88:91], a[136:139], a[72:75], v[88:91]
  s_add_u32 m0, s77, 32768
  ds_read_b64_tr_b16 a[128:129], v25 offset:32864
  v_mfma_f32_16x16x32_bf16 v[88:91], a[140:143], a[88:91], v[88:91]
  v_mfma_f32_16x16x32_bf16 v[88:91], a[144:147], a[104:107], v[88:91]
  ds_read_b64_tr_b16 a[130:131], v25 offset:36448
  v_mfma_f32_16x16x32_bf16 v[88:91], a[148:151], a[120:123], v[88:91]
  v_mfma_f32_16x16x32_bf16 v[92:95], a[148:151], a[124:127], v[92:95]
  ds_read_b64_tr_b16 a[132:133], v25 offset:40032
  v_mfma_f32_16x16x32_bf16 v[92:95], a[144:147], a[108:111], v[92:95]
  buffer_load_dwordx4 v4, s[96:99], s38 offen offset:0 lds
  v_mfma_f32_16x16x32_bf16 v[92:95], a[140:143], a[92:95], v[92:95]
  ds_read_b64_tr_b16 a[134:135], v25 offset:43616
  v_mfma_f32_16x16x32_bf16 v[92:95], a[136:139], a[76:79], v[92:95]
  s_waitcnt lgkmcnt(4)
  v_mfma_f32_16x16x32_bf16 v[124:127], a[152:155], a[76:79], v[124:127]
L_pad_2b_1:
  s_cbranch_execz L_pad_2b_4
  ds_read_b64_tr_b16 a[136:137], v25 offset:47200
  v_mfma_f32_16x16x32_bf16 v[124:127], a[156:159], a[92:95], v[124:127]
  buffer_load_dwordx4 v5, s[96:99], s38 offen offset:1024 lds
  v_mfma_f32_16x16x32_bf16 v[124:127], a[160:163], a[108:111], v[124:127]
  ds_read_b64_tr_b16 a[138:139], v25 offset:50784
  v_mfma_f32_16x16x32_bf16 v[124:127], a[164:167], a[124:127], v[124:127]
  v_mfma_f32_16x16x32_bf16 v[120:123], a[164:167], a[120:123], v[120:123]
  ds_read_b64_tr_b16 a[140:141], v25 offset:54368
  v_mfma_f32_16x16x32_bf16 v[120:123], a[160:163], a[104:107], v[120:123]
  v_mfma_f32_16x16x32_bf16 v[120:123], a[156:159], a[88:91], v[120:123]
  ds_read_b64_tr_b16 a[142:143], v25 offset:57952
  v_mfma_f32_16x16x32_bf16 v[120:123], a[152:155], a[72:75], v[120:123]
  buffer_load_dwordx4 v6, s[96:99], s38 offen offset:2048 lds
  v_mfma_f32_16x16x32_bf16 v[116:119], a[152:155], a[68:71], v[116:119]
  ds_read_b64_tr_b16 a[144:145], v25 offset:32896
  v_mfma_f32_16x16x32_bf16 v[116:119], a[156:159], a[84:87], v[116:119]
  v_mfma_f32_16x16x32_bf16 v[116:119], a[160:163], a[100:103], v[116:119]
  ds_read_b64_tr_b16 a[146:147], v25 offset:36480
  v_mfma_f32_16x16x32_bf16 v[116:119], a[164:167], a[116:119], v[116:119]
  v_mfma_f32_16x16x32_bf16 v[112:115], a[164:167], a[112:115], v[112:115]
  ds_read_b64_tr_b16 a[148:149], v25 offset:40064
  v_mfma_f32_16x16x32_bf16 v[112:115], a[160:163], a[96:99], v[112:115]
  buffer_load_dwordx4 v7, s[96:99], s38 offen offset:3072 lds
  s_add_u32 m0, s77, 36864
  v_mfma_f32_16x16x32_bf16 v[112:115], a[156:159], a[80:83], v[112:115]
  ds_read_b64_tr_b16 a[150:151], v25 offset:43648
  v_mfma_f32_16x16x32_bf16 v[112:115], a[152:155], a[64:67], v[112:115]
  s_waitcnt lgkmcnt(4)
  v_mfma_f32_16x16x32_bf16 v[144:147], a[128:131], a[64:67], v[144:147]
  ds_read_b64_tr_b16 a[152:153], v25 offset:47232
  v_mfma_f32_16x16x32_bf16 v[144:147], a[132:135], a[80:83], v[144:147]
  v_mfma_f32_16x16x32_bf16 v[144:147], a[136:139], a[96:99], v[144:147]
  ds_read_b64_tr_b16 a[154:155], v25 offset:50816
  v_mfma_f32_16x16x32_bf16 v[144:147], a[140:143], a[112:115], v[144:147]
  buffer_load_dwordx4 v12, s[96:99], s38 offen offset:0 lds
  v_mfma_f32_16x16x32_bf16 v[148:151], a[140:143], a[116:119], v[148:151]
  ds_read_b64_tr_b16 a[156:157], v25 offset:54400
  v_mfma_f32_16x16x32_bf16 v[148:151], a[136:139], a[100:103], v[148:151]
  v_mfma_f32_16x16x32_bf16 v[148:151], a[132:135], a[84:87], v[148:151]
  ds_read_b64_tr_b16 a[158:159], v25 offset:57984
  v_mfma_f32_16x16x32_bf16 v[148:151], a[128:131], a[68:71], v[148:151]
  buffer_load_dwordx4 v13, s[96:99], s38 offen offset:1024 lds
  v_mfma_f32_16x16x32_bf16 v[152:155], a[128:131], a[72:75], v[152:155]
  ds_read_b64_tr_b16 a[160:161], v25 offset:32928
  v_mfma_f32_16x16x32_bf16 v[152:155], a[132:135], a[88:91], v[152:155]
  v_mfma_f32_16x16x32_bf16 v[152:155], a[136:139], a[104:107], v[152:155]
  ds_read_b64_tr_b16 a[162:163], v25 offset:36512
  v_mfma_f32_16x16x32_bf16 v[152:155], a[140:143], a[120:123], v[152:155]
  v_mfma_f32_16x16x32_bf16 v[156:159], a[140:143], a[124:127], v[156:159]
  ds_read_b64_tr_b16 a[164:165], v25 offset:40096
  v_mfma_f32_16x16x32_bf16 v[156:159], a[136:139], a[108:111], v[156:159]
  buffer_load_dwordx4 v14, s[96:99], s38 offen offset:2048 lds
  v_mfma_f32_16x16x32_bf16 v[156:159], a[132:135], a[92:95], v[156:159]
  ds_read_b64_tr_b16 a[166:167], v25 offset:43680
  v_mfma_f32_16x16x32_bf16 v[156:159], a[128:131], a[76:79], v[156:159]
  s_waitcnt lgkmcnt(4)
  v_mfma_f32_16x16x32_bf16 v[188:191], a[144:147], a[76:79], v[188:191]
  ds_read_b64_tr_b16 a[128:129], v25 offset:47264
  v_mfma_f32_16x16x32_bf16 v[188:191], a[148:151], a[92:95], v[188:191]
  v_mfma_f32_16x16x32_bf16 v[188:191], a[152:155], a[108:111], v[188:191]
  ds_read_b64_tr_b16 a[130:131], v25 offset:50848
  v_mfma_f32_16x16x32_bf16 v[188:191], a[156:159], a[124:127], v[188:191]
  buffer_load_dword v0, v26, s[20:23], 0 offen
  v_add_u32 v26, 917504, v26
  v_mfma_f32_16x16x32_bf16 v[184:187], a[156:159], a[120:123], v[184:187]
  ds_read_b64_tr_b16 a[132:133], v25 offset:54432
  v_mfma_f32_16x16x32_bf16 v[184:187], a[152:155], a[104:107], v[184:187]
  v_mfma_f32_16x16x32_bf16 v[184:187], a[148:151], a[88:91], v[184:187]
  ds_read_b64_tr_b16 a[134:135], v25 offset:58016
  v_mfma_f32_16x16x32_bf16 v[184:187], a[144:147], a[72:75], v[184:187]
  s_waitcnt vmcnt(18)
  v_mfma_f32_16x16x32_bf16 v[180:183], a[144:147], a[68:71], v[180:183]
  s_barrier
  ds_read_b64_tr_b16 a[136:137], v24 offset:192
  v_mfma_f32_16x16x32_bf16 v[180:183], a[148:151], a[84:87], v[180:183]
  v_mfma_f32_16x16x32_bf16 v[180:183], a[152:155], a[100:103], v[180:183]
  ds_read_b64_tr_b16 a[138:139], v24 offset:3776
  v_mfma_f32_16x16x32_bf16 v[180:183], a[156:159], a[116:119], v[180:183]
  v_mfma_f32_16x16x32_bf16 v[176:179], a[156:159], a[112:115], v[176:179]
  ds_read_b64_tr_b16 a[140:141], v24 offset:7360
  v_mfma_f32_16x16x32_bf16 v[176:179], a[152:155], a[96:99], v[176:179]
  v_mfma_f32_16x16x32_bf16 v[176:179], a[148:151], a[80:83], v[176:179]
  ds_read_b64_tr_b16 a[142:143], v24 offset:10944
  v_mfma_f32_16x16x32_bf16 v[176:179], a[144:147], a[64:67], v[176:179]
  s_waitcnt lgkmcnt(4)
  v_mfma_f32_16x16x32_bf16 v[208:211], a[160:163], a[64:67], v[208:211]
  ds_read_b64_tr_b16 a[144:145], v24 offset:14528
  v_mfma_f32_16x16x32_bf16 v[208:211], a[164:167], a[80:83], v[208:211]
  v_mfma_f32_16x16x32_bf16 v[208:211], a[128:131], a[96:99], v[208:211]
  ds_read_b64_tr_b16 a[146:147], v24 offset:18112
  v_mfma_f32_16x16x32_bf16 v[208:211], a[132:135], a[112:115], v[208:211]
  v_mfma_f32_16x16x32_bf16 v[212:215], a[132:135], a[116:119], v[212:215]
  ds_read_b64_tr_b16 a[148:149], v24 offset:21696
  v_mfma_f32_16x16x32_bf16 v[212:215], a[128:131], a[100:103], v[212:215]
  v_mfma_f32_16x16x32_bf16 v[212:215], a[164:167], a[84:87], v[212:215]
  ds_read_b64_tr_b16 a[150:151], v24 offset:25280
  v_mfma_f32_16x16x32_bf16 v[212:215], a[160:163], a[68:71], v[212:215]
  v_mfma_f32_16x16x32_bf16 v[216:219], a[160:163], a[72:75], v[216:219]
  ds_read_b64_tr_b16 a[152:153], v24 offset:0
  v_mfma_f32_16x16x32_bf16 v[216:219], a[164:167], a[88:91], v[216:219]
  v_mfma_f32_16x16x32_bf16 v[216:219], a[128:131], a[104:107], v[216:219]
  ds_read_b64_tr_b16 a[154:155], v24 offset:3584
  v_mfma_f32_16x16x32_bf16 v[216:219], a[132:135], a[120:123], v[216:219]
  v_mfma_f32_16x16x32_bf16 v[220:223], a[132:135], a[124:127], v[220:223]
  ds_read_b64_tr_b16 a[156:157], v24 offset:7168
  v_mfma_f32_16x16x32_bf16 v[220:223], a[128:131], a[108:111], v[220:223]
  v_mfma_f32_16x16x32_bf16 v[220:223], a[164:167], a[92:95], v[220:223]
  ds_read_b64_tr_b16 a[158:159], v24 offset:10752
  v_mfma_f32_16x16x32_bf16 v[220:223], a[160:163], a[76:79], v[220:223]
  s_waitcnt vmcnt(8) lgkmcnt(4)
  v_mfma_f32_16x16x32_bf16 v[236:239], a[136:139], a[12:15], v[236:239]
  s_mov_b32 s39, 12288
  ds_read_b64_tr_b16 a[160:161], v24 offset:14336
  v_mfma_f32_16x16x32_bf16 v[236:239], a[140:143], a[28:31], v[236:239]
  buffer_load_dwordx4 a[64:67], v8, s[16:19], s39 offen offset:0 sc1
  s_mov_b32 s38, 2752512
  v_mfma_f32_16x16x32_bf16 v[236:239], a[144:147], a[44:47], v[236:239]
  s_add_u32 m0, s77, 65536
  ds_read_b64_tr_b16 a[162:163], v24 offset:17920
  v_mfma_f32_16x16x32_bf16 v[236:239], a[148:151], a[60:63], v[236:239]
  v_mfma_f32_16x16x32_bf16 v[232:235], a[148:151], a[56:59], v[232:235]
  ds_read_b64_tr_b16 a[164:165], v24 offset:21504
  v_mfma_f32_16x16x32_bf16 v[232:235], a[144:147], a[40:43], v[232:235]
  buffer_load_dwordx4 v4, s[12:15], s38 offen offset:0 lds
  v_mfma_f32_16x16x32_bf16 v[232:235], a[140:143], a[24:27], v[232:235]
  ds_read_b64_tr_b16 a[166:167], v24 offset:25088
  v_mfma_f32_16x16x32_bf16 v[232:235], a[136:139], a[8:11], v[232:235]
  v_mfma_f32_16x16x32_bf16 v[228:231], a[136:139], a[4:7], v[228:231]
  ds_read_b64_tr_b16 a[128:129], v24 offset:32
  v_mfma_f32_16x16x32_bf16 v[228:231], a[140:143], a[20:23], v[228:231]
  v_mfma_f32_16x16x32_bf16 v[228:231], a[144:147], a[36:39], v[228:231]
  ds_read_b64_tr_b16 a[130:131], v24 offset:3616
  v_mfma_f32_16x16x32_bf16 v[228:231], a[148:151], a[52:55], v[228:231]
  buffer_load_dwordx4 a[80:83], v8, s[16:19], s39 offen offset:1024 sc1
  v_mfma_f32_16x16x32_bf16 v[224:227], a[148:151], a[48:51], v[224:227]
  ds_read_b64_tr_b16 a[132:133], v24 offset:7200
  v_mfma_f32_16x16x32_bf16 v[224:227], a[144:147], a[32:35], v[224:227]
  v_mfma_f32_16x16x32_bf16 v[224:227], a[140:143], a[16:19], v[224:227]
  ds_read_b64_tr_b16 a[134:135], v24 offset:10784
  v_mfma_f32_16x16x32_bf16 v[224:227], a[136:139], a[0:3], v[224:227]
  s_waitcnt lgkmcnt(4)
  v_mfma_f32_16x16x32_bf16 v[32:35], a[152:155], a[0:3], v[32:35]
  ds_read_b64_tr_b16 a[136:137], v24 offset:14368
  v_mfma_f32_16x16x32_bf16 v[32:35], a[156:159], a[16:19], v[32:35]
  buffer_load_dwordx4 v5, s[12:15], s38 offen offset:1024 lds
  s_mov_b32 s39, 45056
  v_mfma_f32_16x16x32_bf16 v[32:35], a[160:163], a[32:35], v[32:35]
  ds_read_b64_tr_b16 a[138:139], v24 offset:17952
  v_mfma_f32_16x16x32_bf16 v[32:35], a[164:167], a[48:51], v[32:35]
  v_mfma_f32_16x16x32_bf16 v[36:39], a[164:167], a[52:55], v[36:39]
  ds_read_b64_tr_b16 a[140:141], v24 offset:21536
  v_mfma_f32_16x16x32_bf16 v[36:39], a[160:163], a[36:39], v[36:39]
  buffer_load_dwordx4 a[68:71], v8, s[16:19], s39 offen offset:0 sc1
  v_mfma_f32_16x16x32_bf16 v[36:39], a[156:159], a[20:23], v[36:39]
  ds_read_b64_tr_b16 a[142:143], v24 offset:25120
  v_mfma_f32_16x16x32_bf16 v[36:39], a[152:155], a[4:7], v[36:39]
  v_mfma_f32_16x16x32_bf16 v[40:43], a[152:155], a[8:11], v[40:43]
  ds_read_b64_tr_b16 a[144:145], v24 offset:64
  v_mfma_f32_16x16x32_bf16 v[40:43], a[156:159], a[24:27], v[40:43]
  v_mfma_f32_16x16x32_bf16 v[40:43], a[160:163], a[40:43], v[40:43]
  ds_read_b64_tr_b16 a[146:147], v24 offset:3648
  v_mfma_f32_16x16x32_bf16 v[40:43], a[164:167], a[56:59], v[40:43]
  buffer_load_dwordx4 v6, s[12:15], s38 offen offset:2048 lds
  v_mfma_f32_16x16x32_bf16 v[44:47], a[164:167], a[60:63], v[44:47]
  ds_read_b64_tr_b16 a[148:149], v24 offset:7232
  v_mfma_f32_16x16x32_bf16 v[44:47], a[160:163], a[44:47], v[44:47]
  v_mfma_f32_16x16x32_bf16 v[44:47], a[156:159], a[28:31], v[44:47]
  ds_read_b64_tr_b16 a[150:151], v24 offset:10816
  v_mfma_f32_16x16x32_bf16 v[44:47], a[152:155], a[12:15], v[44:47]
  s_waitcnt lgkmcnt(4)
  v_mfma_f32_16x16x32_bf16 v[76:79], a[128:131], a[12:15], v[76:79]
  ds_read_b64_tr_b16 a[152:153], v24 offset:14400
  v_mfma_f32_16x16x32_bf16 v[76:79], a[132:135], a[28:31], v[76:79]
  buffer_load_dwordx4 a[84:87], v8, s[16:19], s39 offen offset:1024 sc1
  v_mfma_f32_16x16x32_bf16 v[76:79], a[136:139], a[44:47], v[76:79]
  ds_read_b64_tr_b16 a[154:155], v24 offset:17984
  v_mfma_f32_16x16x32_bf16 v[76:79], a[140:143], a[60:63], v[76:79]
  v_mfma_f32_16x16x32_bf16 v[72:75], a[140:143], a[56:59], v[72:75]
  ds_read_b64_tr_b16 a[156:157], v24 offset:21568
  v_mfma_f32_16x16x32_bf16 v[72:75], a[136:139], a[40:43], v[72:75]
  buffer_load_dwordx4 v7, s[12:15], s38 offen offset:3072 lds
  s_mov_b32 s39, 77824
  v_mfma_f32_16x16x32_bf16 v[72:75], a[132:135], a[24:27], v[72:75]
  ds_read_b64_tr_b16 a[158:159], v24 offset:25152
  v_mfma_f32_16x16x32_bf16 v[72:75], a[128:131], a[8:11], v[72:75]
  v_mfma_f32_16x16x32_bf16 v[68:71], a[128:131], a[4:7], v[68:71]
  ds_read_b64_tr_b16 a[160:161], v24 offset:96
  v_mfma_f32_16x16x32_bf16 v[68:71], a[132:135], a[20:23], v[68:71]
  v_mfma_f32_16x16x32_bf16 v[68:71], a[136:139], a[36:39], v[68:71]
  ds_read_b64_tr_b16 a[162:163], v24 offset:3680
  v_mfma_f32_16x16x32_bf16 v[68:71], a[140:143], a[52:55], v[68:71]
  buffer_load_dwordx4 a[72:75], v8, s[16:19], s39 offen offset:0 sc1
  s_add_u32 m0, s77, 69632
  v_mfma_f32_16x16x32_bf16 v[64:67], a[140:143], a[48:51], v[64:67]
  ds_read_b64_tr_b16 a[164:165], v24 offset:7264
  v_mfma_f32_16x16x32_bf16 v[64:67], a[136:139], a[32:35], v[64:67]
  v_mfma_f32_16x16x32_bf16 v[64:67], a[132:135], a[16:19], v[64:67]
  ds_read_b64_tr_b16 a[166:167], v24 offset:10848
  v_mfma_f32_16x16x32_bf16 v[64:67], a[128:131], a[0:3], v[64:67]
  s_waitcnt lgkmcnt(4)
  v_mfma_f32_16x16x32_bf16 v[96:99], a[144:147], a[0:3], v[96:99]
  ds_read_b64_tr_b16 a[128:129], v24 offset:14432
  v_mfma_f32_16x16x32_bf16 v[96:99], a[148:151], a[16:19], v[96:99]
  buffer_load_dwordx4 v12, s[12:15], s38 offen offset:0 lds
  v_mfma_f32_16x16x32_bf16 v[96:99], a[152:155], a[32:35], v[96:99]
  ds_read_b64_tr_b16 a[130:131], v24 offset:18016
  v_mfma_f32_16x16x32_bf16 v[96:99], a[156:159], a[48:51], v[96:99]
  v_mfma_f32_16x16x32_bf16 v[100:103], a[156:159], a[52:55], v[100:103]
  ds_read_b64_tr_b16 a[132:133], v24 offset:21600
  v_mfma_f32_16x16x32_bf16 v[100:103], a[152:155], a[36:39], v[100:103]
  v_mfma_f32_16x16x32_bf16 v[100:103], a[148:151], a[20:23], v[100:103]
  ds_read_b64_tr_b16 a[134:135], v24 offset:25184
  v_mfma_f32_16x16x32_bf16 v[100:103], a[144:147], a[4:7], v[100:103]
  buffer_load_dwordx4 a[88:91], v8, s[16:19], s39 offen offset:1024 sc1
  v_mfma_f32_16x16x32_bf16 v[104:107], a[144:147], a[8:11], v[104:107]
  ds_read_b64_tr_b16 a[136:137], v24 offset:128
  v_mfma_f32_16x16x32_bf16 v[104:107], a[148:151], a[24:27], v[104:107]
  v_mfma_f32_16x16x32_bf16 v[104:107], a[152:155], a[40:43], v[104:107]
  ds_read_b64_tr_b16 a[138:139], v24 offset:3712
  v_mfma_f32_16x16x32_bf16 v[104:107], a[156:159], a[56:59], v[104:107]
  buffer_load_dwordx4 v13, s[12:15], s38 offen offset:1024 lds
  s_mov_b32 s39, 110592
  v_mfma_f32_16x16x32_bf16 v[108:111], a[156:159], a[60:63], v[108:111]
  ds_read_b64_tr_b16 a[140:141], v24 offset:7296
  v_mfma_f32_16x16x32_bf16 v[108:111], a[152:155], a[44:47], v[108:111]
  v_mfma_f32_16x16x32_bf16 v[108:111], a[148:151], a[28:31], v[108:111]
  ds_read_b64_tr_b16 a[142:143], v24 offset:10880
  v_mfma_f32_16x16x32_bf16 v[108:111], a[144:147], a[12:15], v[108:111]
  s_waitcnt lgkmcnt(4)
  v_mfma_f32_16x16x32_bf16 v[140:143], a[160:163], a[12:15], v[140:143]
  ds_read_b64_tr_b16 a[144:145], v24 offset:14464
  v_mfma_f32_16x16x32_bf16 v[140:143], a[164:167], a[28:31], v[140:143]
  buffer_load_dwordx4 a[76:79], v8, s[16:19], s39 offen offset:0 sc1
  v_mfma_f32_16x16x32_bf16 v[140:143], a[128:131], a[44:47], v[140:143]
  ds_read_b64_tr_b16 a[146:147], v24 offset:18048
  v_mfma_f32_16x16x32_bf16 v[140:143], a[132:135], a[60:63], v[140:143]
  v_mfma_f32_16x16x32_bf16 v[136:139], a[132:135], a[56:59], v[136:139]
  ds_read_b64_tr_b16 a[148:149], v24 offset:21632
  v_mfma_f32_16x16x32_bf16 v[136:139], a[128:131], a[40:43], v[136:139]
  v_mfma_f32_16x16x32_bf16 v[136:139], a[164:167], a[24:27], v[136:139]
  ds_read_b64_tr_b16 a[150:151], v24 offset:25216
  v_mfma_f32_16x16x32_bf16 v[136:139], a[160:163], a[8:11], v[136:139]
  buffer_load_dwordx4 v14, s[12:15], s38 offen offset:2048 lds
  v_mfma_f32_16x16x32_bf16 v[132:135], a[160:163], a[4:7], v[132:135]
  ds_read_b64_tr_b16 a[152:153], v24 offset:160
  v_mfma_f32_16x16x32_bf16 v[132:135], a[164:167], a[20:23], v[132:135]
  v_mfma_f32_16x16x32_bf16 v[132:135], a[128:131], a[36:39], v[132:135]
  ds_read_b64_tr_b16 a[154:155], v24 offset:3744
  v_mfma_f32_16x16x32_bf16 v[132:135], a[132:135], a[52:55], v[132:135]
  buffer_load_dwordx4 a[92:95], v8, s[16:19], s39 offen offset:1024 sc1
  v_mfma_f32_16x16x32_bf16 v[128:131], a[132:135], a[48:51], v[128:131]
  ds_read_b64_tr_b16 a[156:157], v24 offset:7328
  v_mfma_f32_16x16x32_bf16 v[128:131], a[128:131], a[32:35], v[128:131]
  v_mfma_f32_16x16x32_bf16 v[128:131], a[164:167], a[16:19], v[128:131]
  ds_read_b64_tr_b16 a[158:159], v24 offset:10912
  v_mfma_f32_16x16x32_bf16 v[128:131], a[160:163], a[0:3], v[128:131]
  s_waitcnt lgkmcnt(4)
  v_mfma_f32_16x16x32_bf16 v[160:163], a[136:139], a[0:3], v[160:163]
  ds_read_b64_tr_b16 a[160:161], v24 offset:14496
  v_mfma_f32_16x16x32_bf16 v[160:163], a[140:143], a[16:19], v[160:163]
  buffer_load_dword v0, v26, s[20:23], 0 offen
  v_add_u32 v26, 917504, v26
  v_mfma_f32_16x16x32_bf16 v[160:163], a[144:147], a[32:35], v[160:163]
  s_lshl_b32 s101, s26, 2
  ds_read_b64_tr_b16 a[162:163], v24 offset:18080
  s_add_u32 s101, s101, s24
  v_mfma_f32_16x16x32_bf16 v[160:163], a[148:151], a[48:51], v[160:163]
  s_mul_i32 s101, s101, 384
  s_add_u32 s101, s101, L_p3t-L_pc
  v_min_u32 v15, 2, v1
  v_mfma_f32_16x16x32_bf16 v[164:167], a[148:151], a[52:55], v[164:167]
  ds_read_b64_tr_b16 a[164:165], v24 offset:21664
  v_lshl_add_u32 v15, v15, 7, s101
  v_mfma_f32_16x16x32_bf16 v[164:167], a[144:147], a[36:39], v[164:167]
  v_min_u32 v15, L_end-L_pc, v15
  v_mfma_f32_16x16x32_bf16 v[164:167], a[140:143], a[20:23], v[164:167]
  ds_read_b64_tr_b16 a[166:167], v24 offset:25248
  v_mfma_f32_16x16x32_bf16 v[164:167], a[136:139], a[4:7], v[164:167]
  s_waitcnt vmcnt(17)
  global_load_dword v0, v15, s[78:79]
  v_mfma_f32_16x16x32_bf16 v[168:171], a[136:139], a[8:11], v[168:171]
  s_barrier
  ds_read_b64_tr_b16 a[128:129], v24 offset:32960
  v_mfma_f32_16x16x32_bf16 v[168:171], a[140:143], a[24:27], v[168:171]
  v_mfma_f32_16x16x32_bf16 v[168:171], a[144:147], a[40:43], v[168:171]
  ds_read_b64_tr_b16 a[130:131], v24 offset:36544
  v_mfma_f32_16x16x32_bf16 v[168:171], a[148:151], a[56:59], v[168:171]
  v_mfma_f32_16x16x32_bf16 v[172:175], a[148:151], a[60:63], v[172:175]
  ds_read_b64_tr_b16 a[132:133], v24 offset:40128
  v_mfma_f32_16x16x32_bf16 v[172:175], a[144:147], a[44:47], v[172:175]
  v_mfma_f32_16x16x32_bf16 v[172:175], a[140:143], a[28:31], v[172:175]
  ds_read_b64_tr_b16 a[134:135], v24 offset:43712
  v_mfma_f32_16x16x32_bf16 v[172:175], a[136:139], a[12:15], v[172:175]
  s_waitcnt lgkmcnt(4)
  v_mfma_f32_16x16x32_bf16 v[204:207], a[152:155], a[12:15], v[204:207]
  ds_read_b64_tr_b16 a[136:137], v24 offset:47296
  v_mfma_f32_16x16x32_bf16 v[204:207], a[156:159], a[28:31], v[204:207]
  v_mfma_f32_16x16x32_bf16 v[204:207], a[160:163], a[44:47], v[204:207]
  ds_read_b64_tr_b16 a[138:139], v24 offset:50880
  v_mfma_f32_16x16x32_bf16 v[204:207], a[164:167], a[60:63], v[204:207]
  v_mfma_f32_16x16x32_bf16 v[200:203], a[164:167], a[56:59], v[200:203]
  ds_read_b64_tr_b16 a[140:141], v24 offset:54464
  v_mfma_f32_16x16x32_bf16 v[200:203], a[160:163], a[40:43], v[200:203]
  v_mfma_f32_16x16x32_bf16 v[200:203], a[156:159], a[24:27], v[200:203]
  ds_read_b64_tr_b16 a[142:143], v24 offset:58048
  v_mfma_f32_16x16x32_bf16 v[200:203], a[152:155], a[8:11], v[200:203]
  v_mfma_f32_16x16x32_bf16 v[196:199], a[152:155], a[4:7], v[196:199]
  ds_read_b64_tr_b16 a[144:145], v24 offset:32768
  v_mfma_f32_16x16x32_bf16 v[196:199], a[156:159], a[20:23], v[196:199]
  v_mfma_f32_16x16x32_bf16 v[196:199], a[160:163], a[36:39], v[196:199]
  ds_read_b64_tr_b16 a[146:147], v24 offset:36352
  v_mfma_f32_16x16x32_bf16 v[196:199], a[164:167], a[52:55], v[196:199]
  v_mfma_f32_16x16x32_bf16 v[192:195], a[164:167], a[48:51], v[192:195]
  ds_read_b64_tr_b16 a[148:149], v24 offset:39936
  v_mfma_f32_16x16x32_bf16 v[192:195], a[160:163], a[32:35], v[192:195]
  v_mfma_f32_16x16x32_bf16 v[192:195], a[156:159], a[16:19], v[192:195]
  ds_read_b64_tr_b16 a[150:151], v24 offset:43520
  v_mfma_f32_16x16x32_bf16 v[192:195], a[152:155], a[0:3], v[192:195]
  s_waitcnt lgkmcnt(4)
  v_mfma_f32_16x16x32_bf16 v[240:243], a[128:131], a[0:3], v[240:243]
  s_mov_b32 s39, 12288
  ds_read_b64_tr_b16 a[152:153], v24 offset:47104
  v_mfma_f32_16x16x32_bf16 v[240:243], a[132:135], a[16:19], v[240:243]
  buffer_load_dwordx4 a[96:99], v8, s[16:19], s39 offen offset:2048 sc1
  v_mfma_f32_16x16x32_bf16 v[240:243], a[136:139], a[32:35], v[240:243]
  ds_read_b64_tr_b16 a[154:155], v24 offset:50688
  v_mfma_f32_16x16x32_bf16 v[240:243], a[140:143], a[48:51], v[240:243]
  v_mfma_f32_16x16x32_bf16 v[244:247], a[140:143], a[52:55], v[244:247]
  ds_read_b64_tr_b16 a[156:157], v24 offset:54272
  v_mfma_f32_16x16x32_bf16 v[244:247], a[136:139], a[36:39], v[244:247]
  buffer_load_dwordx4 a[112:115], v8, s[16:19], s39 offen offset:3072 sc1
  s_mov_b32 s39, 45056
  v_mfma_f32_16x16x32_bf16 v[244:247], a[132:135], a[20:23], v[244:247]
  ds_read_b64_tr_b16 a[158:159], v24 offset:57856
  v_mfma_f32_16x16x32_bf16 v[244:247], a[128:131], a[4:7], v[244:247]
  v_mfma_f32_16x16x32_bf16 v[248:251], a[128:131], a[8:11], v[248:251]
  ds_read_b64_tr_b16 a[160:161], v24 offset:32800
  v_mfma_f32_16x16x32_bf16 v[248:251], a[132:135], a[24:27], v[248:251]
  v_mfma_f32_16x16x32_bf16 v[248:251], a[136:139], a[40:43], v[248:251]
  ds_read_b64_tr_b16 a[162:163], v24 offset:36384
  v_mfma_f32_16x16x32_bf16 v[248:251], a[140:143], a[56:59], v[248:251]
  buffer_load_dwordx4 a[100:103], v8, s[16:19], s39 offen offset:2048 sc1
  v_mfma_f32_16x16x32_bf16 v[252:255], a[140:143], a[60:63], v[252:255]
  ds_read_b64_tr_b16 a[164:165], v24 offset:39968
  v_mfma_f32_16x16x32_bf16 v[252:255], a[136:139], a[44:47], v[252:255]
  v_mfma_f32_16x16x32_bf16 v[252:255], a[132:135], a[28:31], v[252:255]
  ds_read_b64_tr_b16 a[166:167], v24 offset:43552
  v_mfma_f32_16x16x32_bf16 v[252:255], a[128:131], a[12:15], v[252:255]
  s_waitcnt lgkmcnt(4)
  v_mfma_f32_16x16x32_bf16 v[60:63], a[144:147], a[12:15], v[60:63]
  ds_read_b64_tr_b16 a[128:129], v24 offset:47136
  v_mfma_f32_16x16x32_bf16 v[60:63], a[148:151], a[28:31], v[60:63]
  buffer_load_dwordx4 a[116:119], v8, s[16:19], s39 offen offset:3072 sc1
  s_mov_b32 s39, 77824
  v_mfma_f32_16x16x32_bf16 v[60:63], a[152:155], a[44:47], v[60:63]
  ds_read_b64_tr_b16 a[130:131], v24 offset:50720
  v_mfma_f32_16x16x32_bf16 v[60:63], a[156:159], a[60:63], v[60:63]
  v_mfma_f32_16x16x32_bf16 v[56:59], a[156:159], a[56:59], v[56:59]
  ds_read_b64_tr_b16 a[132:133], v24 offset:54304
  v_mfma_f32_16x16x32_bf16 v[56:59], a[152:155], a[40:43], v[56:59]
  v_mfma_f32_16x16x32_bf16 v[56:59], a[148:151], a[24:27], v[56:59]
  ds_read_b64_tr_b16 a[134:135], v24 offset:57888
  v_mfma_f32_16x16x32_bf16 v[56:59], a[144:147], a[8:11], v[56:59]
  buffer_load_dwordx4 a[104:107], v8, s[16:19], s39 offen offset:2048 sc1
  v_mfma_f32_16x16x32_bf16 v[52:55], a[144:147], a[4:7], v[52:55]
  ds_read_b64_tr_b16 a[136:137], v24 offset:32832
  v_mfma_f32_16x16x32_bf16 v[52:55], a[148:151], a[20:23], v[52:55]
  v_mfma_f32_16x16x32_bf16 v[52:55], a[152:155], a[36:39], v[52:55]
  ds_read_b64_tr_b16 a[138:139], v24 offset:36416
  v_mfma_f32_16x16x32_bf16 v[52:55], a[156:159], a[52:55], v[52:55]
  buffer_load_dwordx4 a[120:123], v8, s[16:19], s39 offen offset:3072 sc1
  s_mov_b32 s39, 110592
  v_mfma_f32_16x16x32_bf16 v[48:51], a[156:159], a[48:51], v[48:51]
  ds_read_b64_tr_b16 a[140:141], v24 offset:40000
  v_mfma_f32_16x16x32_bf16 v[48:51], a[152:155], a[32:35], v[48:51]
  v_mfma_f32_16x16x32_bf16 v[48:51], a[148:151], a[16:19], v[48:51]
  ds_read_b64_tr_b16 a[142:143], v24 offset:43584
  v_mfma_f32_16x16x32_bf16 v[48:51], a[144:147], a[0:3], v[48:51]
  s_waitcnt lgkmcnt(4)
  v_mfma_f32_16x16x32_bf16 v[80:83], a[160:163], a[0:3], v[80:83]
  ds_read_b64_tr_b16 a[144:145], v24 offset:47168
  v_mfma_f32_16x16x32_bf16 v[80:83], a[164:167], a[16:19], v[80:83]
  buffer_load_dwordx4 a[108:111], v8, s[16:19], s39 offen offset:2048 sc1
  v_mfma_f32_16x16x32_bf16 v[80:83], a[128:131], a[32:35], v[80:83]
  ds_read_b64_tr_b16 a[146:147], v24 offset:50752
  v_mfma_f32_16x16x32_bf16 v[80:83], a[132:135], a[48:51], v[80:83]
  v_mfma_f32_16x16x32_bf16 v[84:87], a[132:135], a[52:55], v[84:87]
  ds_read_b64_tr_b16 a[148:149], v24 offset:54336
  v_mfma_f32_16x16x32_bf16 v[84:87], a[128:131], a[36:39], v[84:87]
  v_mfma_f32_16x16x32_bf16 v[84:87], a[164:167], a[20:23], v[84:87]
  ds_read_b64_tr_b16 a[150:151], v24 offset:57920
  v_mfma_f32_16x16x32_bf16 v[84:87], a[160:163], a[4:7], v[84:87]
  buffer_load_dwordx4 a[124:127], v8, s[16:19], s39 offen offset:3072 sc1
  s_mov_b32 s38, 2752512
  v_mfma_f32_16x16x32_bf16 v[88:91], a[160:163], a[8:11], v[88:91]
  s_add_u32 m0, s77, 98304
  ds_read_b64_tr_b16 a[152:153], v24 offset:32864
  v_mfma_f32_16x16x32_bf16 v[88:91], a[164:167], a[24:27], v[88:91]
  v_mfma_f32_16x16x32_bf16 v[88:91], a[128:131], a[40:43], v[88:91]
  ds_read_b64_tr_b16 a[154:155], v24 offset:36448
  v_mfma_f32_16x16x32_bf16 v[88:91], a[132:135], a[56:59], v[88:91]
  v_mfma_f32_16x16x32_bf16 v[92:95], a[132:135], a[60:63], v[92:95]
  ds_read_b64_tr_b16 a[156:157], v24 offset:40032
  v_mfma_f32_16x16x32_bf16 v[92:95], a[128:131], a[44:47], v[92:95]
  buffer_load_dwordx4 v4, s[96:99], s38 offen offset:0 lds
  v_mfma_f32_16x16x32_bf16 v[92:95], a[164:167], a[28:31], v[92:95]
  ds_read_b64_tr_b16 a[158:159], v24 offset:43616
  v_mfma_f32_16x16x32_bf16 v[92:95], a[160:163], a[12:15], v[92:95]
  s_waitcnt lgkmcnt(4)
  v_mfma_f32_16x16x32_bf16 v[124:127], a[136:139], a[12:15], v[124:127]
  ds_read_b64_tr_b16 a[160:161], v24 offset:47200
  v_mfma_f32_16x16x32_bf16 v[124:127], a[140:143], a[28:31], v[124:127]
  buffer_load_dwordx4 v5, s[96:99], s38 offen offset:1024 lds
  v_mfma_f32_16x16x32_bf16 v[124:127], a[144:147], a[44:47], v[124:127]
  ds_read_b64_tr_b16 a[162:163], v24 offset:50784
  v_mfma_f32_16x16x32_bf16 v[124:127], a[148:151], a[60:63], v[124:127]
  v_mfma_f32_16x16x32_bf16 v[120:123], a[148:151], a[56:59], v[120:123]
  ds_read_b64_tr_b16 a[164:165], v24 offset:54368
  v_mfma_f32_16x16x32_bf16 v[120:123], a[144:147], a[40:43], v[120:123]
  v_mfma_f32_16x16x32_bf16 v[120:123], a[140:143], a[24:27], v[120:123]
  ds_read_b64_tr_b16 a[166:167], v24 offset:57952
  v_mfma_f32_16x16x32_bf16 v[120:123], a[136:139], a[8:11], v[120:123]
  buffer_load_dwordx4 v6, s[96:99], s38 offen offset:2048 lds
  v_mfma_f32_16x16x32_bf16 v[116:119], a[136:139], a[4:7], v[116:119]
  ds_read_b64_tr_b16 a[128:129], v24 offset:32896
  v_mfma_f32_16x16x32_bf16 v[116:119], a[140:143], a[20:23], v[116:119]
  v_mfma_f32_16x16x32_bf16 v[116:119], a[144:147], a[36:39], v[116:119]
  ds_read_b64_tr_b16 a[130:131], v24 offset:36480
  v_mfma_f32_16x16x32_bf16 v[116:119], a[148:151], a[52:55], v[116:119]
  v_mfma_f32_16x16x32_bf16 v[112:115], a[148:151], a[48:51], v[112:115]
  ds_read_b64_tr_b16 a[132:133], v24 offset:40064
  v_mfma_f32_16x16x32_bf16 v[112:115], a[144:147], a[32:35], v[112:115]
  buffer_load_dwordx4 v7, s[96:99], s38 offen offset:3072 lds
  s_add_u32 m0, s77, 102400
  v_mfma_f32_16x16x32_bf16 v[112:115], a[140:143], a[16:19], v[112:115]
  ds_read_b64_tr_b16 a[134:135], v24 offset:43648
  v_mfma_f32_16x16x32_bf16 v[112:115], a[136:139], a[0:3], v[112:115]
  s_waitcnt lgkmcnt(4)
  v_mfma_f32_16x16x32_bf16 v[144:147], a[152:155], a[0:3], v[144:147]
  ds_read_b64_tr_b16 a[136:137], v24 offset:47232
  v_mfma_f32_16x16x32_bf16 v[144:147], a[156:159], a[16:19], v[144:147]
  v_mfma_f32_16x16x32_bf16 v[144:147], a[160:163], a[32:35], v[144:147]
  ds_read_b64_tr_b16 a[138:139], v24 offset:50816
  v_mfma_f32_16x16x32_bf16 v[144:147], a[164:167], a[48:51], v[144:147]
  buffer_load_dwordx4 v12, s[96:99], s38 offen offset:0 lds
  v_mfma_f32_16x16x32_bf16 v[148:151], a[164:167], a[52:55], v[148:151]
  ds_read_b64_tr_b16 a[140:141], v24 offset:54400
  v_mfma_f32_16x16x32_bf16 v[148:151], a[160:163], a[36:39], v[148:151]
  v_mfma_f32_16x16x32_bf16 v[148:151], a[156:159], a[20:23], v[148:151]
  ds_read_b64_tr_b16 a[142:143], v24 offset:57984
  v_mfma_f32_16x16x32_bf16 v[148:151], a[152:155], a[4:7], v[148:151]
  buffer_load_dwordx4 v13, s[96:99], s38 offen offset:1024 lds
  v_mfma_f32_16x16x32_bf16 v[152:155], a[152:155], a[8:11], v[152:155]
  ds_read_b64_tr_b16 a[144:145], v24 offset:32928
  v_mfma_f32_16x16x32_bf16 v[152:155], a[156:159], a[24:27], v[152:155]
  v_mfma_f32_16x16x32_bf16 v[152:155], a[160:163], a[40:43], v[152:155]
  ds_read_b64_tr_b16 a[146:147], v24 offset:36512
  v_mfma_f32_16x16x32_bf16 v[152:155], a[164:167], a[56:59], v[152:155]
  v_mfma_f32_16x16x32_bf16 v[156:159], a[164:167], a[60:63], v[156:159]
  ds_read_b64_tr_b16 a[148:149], v24 offset:40096
  v_mfma_f32_16x16x32_bf16 v[156:159], a[160:163], a[44:47], v[156:159]
  buffer_load_dwordx4 v14, s[96:99], s38 offen offset:2048 lds
  v_mfma_f32_16x16x32_bf16 v[156:159], a[156:159], a[28:31], v[156:159]
  ds_read_b64_tr_b16 a[150:151], v24 offset:43680
  v_mfma_f32_16x16x32_bf16 v[156:159], a[152:155], a[12:15], v[156:159]
  s_waitcnt lgkmcnt(4)
  v_mfma_f32_16x16x32_bf16 v[188:191], a[128:131], a[12:15], v[188:191]
  ds_read_b64_tr_b16 a[152:153], v24 offset:47264
  v_mfma_f32_16x16x32_bf16 v[188:191], a[132:135], a[28:31], v[188:191]
  v_mfma_f32_16x16x32_bf16 v[188:191], a[136:139], a[44:47], v[188:191]
  ds_read_b64_tr_b16 a[154:155], v24 offset:50848
  v_mfma_f32_16x16x32_bf16 v[188:191], a[140:143], a[60:63], v[188:191]
  buffer_load_dword v0, v26, s[20:23], 0 offen
  v_add_u32 v26, 917504, v26
  v_mfma_f32_16x16x32_bf16 v[184:187], a[140:143], a[56:59], v[184:187]
  ds_read_b64_tr_b16 a[156:157], v24 offset:54432
  v_mfma_f32_16x16x32_bf16 v[184:187], a[136:139], a[40:43], v[184:187]
  v_mfma_f32_16x16x32_bf16 v[184:187], a[132:135], a[24:27], v[184:187]
  ds_read_b64_tr_b16 a[158:159], v24 offset:58016
  v_mfma_f32_16x16x32_bf16 v[184:187], a[128:131], a[8:11], v[184:187]
  s_waitcnt vmcnt(19)
  v_mfma_f32_16x16x32_bf16 v[180:183], a[128:131], a[4:7], v[180:183]
  s_barrier
  ds_read_b64_tr_b16 a[160:161], v25 offset:192
  v_mfma_f32_16x16x32_bf16 v[180:183], a[132:135], a[20:23], v[180:183]
  v_mfma_f32_16x16x32_bf16 v[180:183], a[136:139], a[36:39], v[180:183]
  ds_read_b64_tr_b16 a[162:163], v25 offset:3776
  v_mfma_f32_16x16x32_bf16 v[180:183], a[140:143], a[52:55], v[180:183]
  v_mfma_f32_16x16x32_bf16 v[176:179], a[140:143], a[48:51], v[176:179]
  ds_read_b64_tr_b16 a[164:165], v25 offset:7360
  v_mfma_f32_16x16x32_bf16 v[176:179], a[136:139], a[32:35], v[176:179]
  v_mfma_f32_16x16x32_bf16 v[176:179], a[132:135], a[16:19], v[176:179]
  ds_read_b64_tr_b16 a[166:167], v25 offset:10944
  v_mfma_f32_16x16x32_bf16 v[176:179], a[128:131], a[0:3], v[176:179]
  s_waitcnt lgkmcnt(4)
  v_mfma_f32_16x16x32_bf16 v[208:211], a[144:147], a[0:3], v[208:211]
  ds_read_b64_tr_b16 a[128:129], v25 offset:14528
  v_mfma_f32_16x16x32_bf16 v[208:211], a[148:151], a[16:19], v[208:211]
  v_mfma_f32_16x16x32_bf16 v[208:211], a[152:155], a[32:35], v[208:211]
  ds_read_b64_tr_b16 a[130:131], v25 offset:18112
  v_mfma_f32_16x16x32_bf16 v[208:211], a[156:159], a[48:51], v[208:211]
  v_mfma_f32_16x16x32_bf16 v[212:215], a[156:159], a[52:55], v[212:215]
  ds_read_b64_tr_b16 a[132:133], v25 offset:21696
  v_mfma_f32_16x16x32_bf16 v[212:215], a[152:155], a[36:39], v[212:215]
  v_mfma_f32_16x16x32_bf16 v[212:215], a[148:151], a[20:23], v[212:215]
  ds_read_b64_tr_b16 a[134:135], v25 offset:25280
  v_mfma_f32_16x16x32_bf16 v[212:215], a[144:147], a[4:7], v[212:215]
  v_mfma_f32_16x16x32_bf16 v[216:219], a[144:147], a[8:11], v[216:219]
  ds_read_b64_tr_b16 a[136:137], v25 offset:0
  v_mfma_f32_16x16x32_bf16 v[216:219], a[148:151], a[24:27], v[216:219]
  v_mfma_f32_16x16x32_bf16 v[216:219], a[152:155], a[40:43], v[216:219]
  ds_read_b64_tr_b16 a[138:139], v25 offset:3584
  v_mfma_f32_16x16x32_bf16 v[216:219], a[156:159], a[56:59], v[216:219]
  v_mfma_f32_16x16x32_bf16 v[220:223], a[156:159], a[60:63], v[220:223]
  ds_read_b64_tr_b16 a[140:141], v25 offset:7168
  v_mfma_f32_16x16x32_bf16 v[220:223], a[152:155], a[44:47], v[220:223]
  v_mfma_f32_16x16x32_bf16 v[220:223], a[148:151], a[28:31], v[220:223]
  ds_read_b64_tr_b16 a[142:143], v25 offset:10752
  v_mfma_f32_16x16x32_bf16 v[220:223], a[144:147], a[12:15], v[220:223]
  s_waitcnt vmcnt(8) lgkmcnt(4)
L_p3t:
  v_mfma_f32_16x16x32_bf16 v[236:239], a[160:163], a[76:79], v[236:239]
  s_mov_b32 s39, 16384
  ds_read_b64_tr_b16 a[144:145], v25 offset:14336
  v_mfma_f32_16x16x32_bf16 v[236:239], a[164:167], a[92:95], v[236:239]
L_pad_2b_2:
  s_cbranch_execz L_pad_2b_5
  buffer_load_dwordx4 a[0:3], v8, s[16:19], s39 offen offset:0 sc1
  s_mov_b32 s38, 3670016
  v_mfma_f32_16x16x32_bf16 v[236:239], a[128:131], a[108:111], v[236:239]
  s_add_u32 m0, s77, 0
  ds_read_b64_tr_b16 a[146:147], v25 offset:17920
  v_mfma_f32_16x16x32_bf16 v[236:239], a[132:135], a[124:127], v[236:239]
  v_mfma_f32_16x16x32_bf16 v[232:235], a[132:135], a[120:123], v[232:235]
  ds_read_b64_tr_b16 a[148:149], v25 offset:21504
  v_mfma_f32_16x16x32_bf16 v[232:235], a[128:131], a[104:107], v[232:235]
  buffer_load_dwordx4 v4, s[12:15], s38 offen offset:0 lds
  v_mfma_f32_16x16x32_bf16 v[232:235], a[164:167], a[88:91], v[232:235]
  ds_read_b64_tr_b16 a[150:151], v25 offset:25088
  v_mfma_f32_16x16x32_bf16 v[232:235], a[160:163], a[72:75], v[232:235]
  v_mfma_f32_16x16x32_bf16 v[228:231], a[160:163], a[68:71], v[228:231]
  ds_read_b64_tr_b16 a[152:153], v25 offset:32
  v_mfma_f32_16x16x32_bf16 v[228:231], a[164:167], a[84:87], v[228:231]
  v_mfma_f32_16x16x32_bf16 v[228:231], a[128:131], a[100:103], v[228:231]
  ds_read_b64_tr_b16 a[154:155], v25 offset:3616
  v_mfma_f32_16x16x32_bf16 v[228:231], a[132:135], a[116:119], v[228:231]
  buffer_load_dwordx4 a[16:19], v8, s[16:19], s39 offen offset:1024 sc1
  v_mfma_f32_16x16x32_bf16 v[224:227], a[132:135], a[112:115], v[224:227]
  ds_read_b64_tr_b16 a[156:157], v25 offset:7200
  v_mfma_f32_16x16x32_bf16 v[224:227], a[128:131], a[96:99], v[224:227]
  v_mfma_f32_16x16x32_bf16 v[224:227], a[164:167], a[80:83], v[224:227]
  ds_read_b64_tr_b16 a[158:159], v25 offset:10784
  v_mfma_f32_16x16x32_bf16 v[224:227], a[160:163], a[64:67], v[224:227]
  s_waitcnt lgkmcnt(4)
  v_mfma_f32_16x16x32_bf16 v[32:35], a[136:139], a[64:67], v[32:35]
  ds_read_b64_tr_b16 a[160:161], v25 offset:14368
  v_mfma_f32_16x16x32_bf16 v[32:35], a[140:143], a[80:83], v[32:35]
  buffer_load_dwordx4 v5, s[12:15], s38 offen offset:1024 lds
  s_mov_b32 s39, 49152
  v_mfma_f32_16x16x32_bf16 v[32:35], a[144:147], a[96:99], v[32:35]
  ds_read_b64_tr_b16 a[162:163], v25 offset:17952
  v_mfma_f32_16x16x32_bf16 v[32:35], a[148:151], a[112:115], v[32:35]
  v_mfma_f32_16x16x32_bf16 v[36:39], a[148:151], a[116:119], v[36:39]
  ds_read_b64_tr_b16 a[164:165], v25 offset:21536
  v_mfma_f32_16x16x32_bf16 v[36:39], a[144:147], a[100:103], v[36:39]
  v_mfma_f32_16x16x32_bf16 v[36:39], a[140:143], a[84:87], v[36:39]
  ds_read_b64_tr_b16 a[166:167], v25 offset:25120
  v_mfma_f32_16x16x32_bf16 v[36:39], a[136:139], a[68:71], v[36:39]
  buffer_load_dwordx4 a[4:7], v8, s[16:19], s39 offen offset:0 sc1
  v_mfma_f32_16x16x32_bf16 v[40:43], a[136:139], a[72:75], v[40:43]
  ds_read_b64_tr_b16 a[128:129], v25 offset:64
  v_mfma_f32_16x16x32_bf16 v[40:43], a[140:143], a[88:91], v[40:43]
  v_mfma_f32_16x16x32_bf16 v[40:43], a[144:147], a[104:107], v[40:43]
  ds_read_b64_tr_b16 a[130:131], v25 offset:3648
  v_mfma_f32_16x16x32_bf16 v[40:43], a[148:151], a[120:123], v[40:43]
  buffer_load_dwordx4 v6, s[12:15], s38 offen offset:2048 lds
  v_mfma_f32_16x16x32_bf16 v[44:47], a[148:151], a[124:127], v[44:47]
  ds_read_b64_tr_b16 a[132:133], v25 offset:7232
  v_mfma_f32_16x16x32_bf16 v[44:47], a[144:147], a[108:111], v[44:47]
  v_mfma_f32_16x16x32_bf16 v[44:47], a[140:143], a[92:95], v[44:47]
  ds_read_b64_tr_b16 a[134:135], v25 offset:10816
  v_mfma_f32_16x16x32_bf16 v[44:47], a[136:139], a[76:79], v[44:47]
  s_waitcnt lgkmcnt(4)
  v_mfma_f32_16x16x32_bf16 v[76:79], a[152:155], a[76:79], v[76:79]
  ds_read_b64_tr_b16 a[136:137], v25 offset:14400
  v_mfma_f32_16x16x32_bf16 v[76:79], a[156:159], a[92:95], v[76:79]
  buffer_load_dwordx4 a[20:23], v8, s[16:19], s39 offen offset:1024 sc1
  v_mfma_f32_16x16x32_bf16 v[76:79], a[160:163], a[108:111], v[76:79]
  ds_read_b64_tr_b16 a[138:139], v25 offset:17984
  v_mfma_f32_16x16x32_bf16 v[76:79], a[164:167], a[124:127], v[76:79]
  v_mfma_f32_16x16x32_bf16 v[72:75], a[164:167], a[120:123], v[72:75]
  ds_read_b64_tr_b16 a[140:141], v25 offset:21568
  v_mfma_f32_16x16x32_bf16 v[72:75], a[160:163], a[104:107], v[72:75]
  v_mfma_f32_16x16x32_bf16 v[72:75], a[156:159], a[88:91], v[72:75]
  ds_read_b64_tr_b16 a[142:143], v25 offset:25152
  v_mfma_f32_16x16x32_bf16 v[72:75], a[152:155], a[72:75], v[72:75]
  buffer_load_dwordx4 v7, s[12:15], s38 offen offset:3072 lds
  s_mov_b32 s39, 81920
  v_mfma_f32_16x16x32_bf16 v[68:71], a[152:155], a[68:71], v[68:71]
  ds_read_b64_tr_b16 a[144:145], v25 offset:96
  v_mfma_f32_16x16x32_bf16 v[68:71], a[156:159], a[84:87], v[68:71]
  v_mfma_f32_16x16x32_bf16 v[68:71], a[160:163], a[100:103], v[68:71]
  ds_read_b64_tr_b16 a[146:147], v25 offset:3680
  v_mfma_f32_16x16x32_bf16 v[68:71], a[164:167], a[116:119], v[68:71]
  v_mfma_f32_16x16x32_bf16 v[64:67], a[164:167], a[112:115], v[64:67]
  ds_read_b64_tr_b16 a[148:149], v25 offset:7264
  v_mfma_f32_16x16x32_bf16 v[64:67], a[160:163], a[96:99], v[64:67]
  buffer_load_dwordx4 a[8:11], v8, s[16:19], s39 offen offset:0 sc1
  s_add_u32 m0, s77, 4096
  v_mfma_f32_16x16x32_bf16 v[64:67], a[156:159], a[80:83], v[64:67]
  ds_read_b64_tr_b16 a[150:151], v25 offset:10848
  v_mfma_f32_16x16x32_bf16 v[64:67], a[152:155], a[64:67], v[64:67]
  s_waitcnt lgkmcnt(4)
  v_mfma_f32_16x16x32_bf16 v[96:99], a[128:131], a[64:67], v[96:99]
  ds_read_b64_tr_b16 a[152:153], v25 offset:14432
  v_mfma_f32_16x16x32_bf16 v[96:99], a[132:135], a[80:83], v[96:99]
  buffer_load_dwordx4 v12, s[12:15], s38 offen offset:0 lds
  v_mfma_f32_16x16x32_bf16 v[96:99], a[136:139], a[96:99], v[96:99]
  ds_read_b64_tr_b16 a[154:155], v25 offset:18016
  v_mfma_f32_16x16x32_bf16 v[96:99], a[140:143], a[112:115], v[96:99]
  v_mfma_f32_16x16x32_bf16 v[100:103], a[140:143], a[116:119], v[100:103]
  ds_read_b64_tr_b16 a[156:157], v25 offset:21600
  v_mfma_f32_16x16x32_bf16 v[100:103], a[136:139], a[100:103], v[100:103]
  v_mfma_f32_16x16x32_bf16 v[100:103], a[132:135], a[84:87], v[100:103]
  ds_read_b64_tr_b16 a[158:159], v25 offset:25184
  v_mfma_f32_16x16x32_bf16 v[100:103], a[128:131], a[68:71], v[100:103]
  buffer_load_dwordx4 a[24:27], v8, s[16:19], s39 offen offset:1024 sc1
  v_mfma_f32_16x16x32_bf16 v[104:107], a[128:131], a[72:75], v[104:107]
  ds_read_b64_tr_b16 a[160:161], v25 offset:128
  v_mfma_f32_16x16x32_bf16 v[104:107], a[132:135], a[88:91], v[104:107]
  v_mfma_f32_16x16x32_bf16 v[104:107], a[136:139], a[104:107], v[104:107]
  ds_read_b64_tr_b16 a[162:163], v25 offset:3712
  v_mfma_f32_16x16x32_bf16 v[104:107], a[140:143], a[120:123], v[104:107]
  v_mfma_f32_16x16x32_bf16 v[108:111], a[140:143], a[124:127], v[108:111]
  ds_read_b64_tr_b16 a[164:165], v25 offset:7296
  v_mfma_f32_16x16x32_bf16 v[108:111], a[136:139], a[108:111], v[108:111]
  buffer_load_dwordx4 v13, s[12:15], s38 offen offset:1024 lds
  s_mov_b32 s39, 114688
  v_mfma_f32_16x16x32_bf16 v[108:111], a[132:135], a[92:95], v[108:111]
  ds_read_b64_tr_b16 a[166:167], v25 offset:10880
  v_mfma_f32_16x16x32_bf16 v[108:111], a[128:131], a[76:79], v[108:111]
  s_waitcnt lgkmcnt(4)
  v_mfma_f32_16x16x32_bf16 v[140:143], a[144:147], a[76:79], v[140:143]
  ds_read_b64_tr_b16 a[128:129], v25 offset:14464
  v_mfma_f32_16x16x32_bf16 v[140:143], a[148:151], a[92:95], v[140:143]
  v_mfma_f32_16x16x32_bf16 v[140:143], a[152:155], a[108:111], v[140:143]
  ds_read_b64_tr_b16 a[130:131], v25 offset:18048
  v_mfma_f32_16x16x32_bf16 v[140:143], a[156:159], a[124:127], v[140:143]
  buffer_load_dwordx4 a[12:15], v8, s[16:19], s39 offen offset:0 sc1
  v_mfma_f32_16x16x32_bf16 v[136:139], a[156:159], a[120:123], v[136:139]
  ds_read_b64_tr_b16 a[132:133], v25 offset:21632
  v_mfma_f32_16x16x32_bf16 v[136:139], a[152:155], a[104:107], v[136:139]
  v_mfma_f32_16x16x32_bf16 v[136:139], a[148:151], a[88:91], v[136:139]
  ds_read_b64_tr_b16 a[134:135], v25 offset:25216
  v_mfma_f32_16x16x32_bf16 v[136:139], a[144:147], a[72:75], v[136:139]
  buffer_load_dwordx4 v14, s[12:15], s38 offen offset:2048 lds
  v_mfma_f32_16x16x32_bf16 v[132:135], a[144:147], a[68:71], v[132:135]
  ds_read_b64_tr_b16 a[136:137], v25 offset:160
  v_mfma_f32_16x16x32_bf16 v[132:135], a[148:151], a[84:87], v[132:135]
  v_mfma_f32_16x16x32_bf16 v[132:135], a[152:155], a[100:103], v[132:135]
  ds_read_b64_tr_b16 a[138:139], v25 offset:3744
  v_mfma_f32_16x16x32_bf16 v[132:135], a[156:159], a[116:119], v[132:135]
  v_mfma_f32_16x16x32_bf16 v[128:131], a[156:159], a[112:115], v[128:131]
  ds_read_b64_tr_b16 a[140:141], v25 offset:7328
  v_mfma_f32_16x16x32_bf16 v[128:131], a[152:155], a[96:99], v[128:131]
  buffer_load_dwordx4 a[28:31], v8, s[16:19], s39 offen offset:1024 sc1
  v_mfma_f32_16x16x32_bf16 v[128:131], a[148:151], a[80:83], v[128:131]
  ds_read_b64_tr_b16 a[142:143], v25 offset:10912
  v_mfma_f32_16x16x32_bf16 v[128:131], a[144:147], a[64:67], v[128:131]
  s_waitcnt lgkmcnt(4)
  v_mfma_f32_16x16x32_bf16 v[160:163], a[160:163], a[64:67], v[160:163]
  ds_read_b64_tr_b16 a[144:145], v25 offset:14496
  v_mfma_f32_16x16x32_bf16 v[160:163], a[164:167], a[80:83], v[160:163]
  v_mfma_f32_16x16x32_bf16 v[160:163], a[128:131], a[96:99], v[160:163]
  ds_read_b64_tr_b16 a[146:147], v25 offset:18080
  v_mfma_f32_16x16x32_bf16 v[160:163], a[132:135], a[112:115], v[160:163]
  buffer_load_dword v0, v26, s[20:23], 0 offen
  v_add_u32 v26, 917504, v26
  v_mfma_f32_16x16x32_bf16 v[164:167], a[132:135], a[116:119], v[164:167]
  ds_read_b64_tr_b16 a[148:149], v25 offset:21664
  v_mfma_f32_16x16x32_bf16 v[164:167], a[128:131], a[100:103], v[164:167]
  v_mfma_f32_16x16x32_bf16 v[164:167], a[164:167], a[84:87], v[164:167]
  ds_read_b64_tr_b16 a[150:151], v25 offset:25248
  v_mfma_f32_16x16x32_bf16 v[164:167], a[160:163], a[68:71], v[164:167]
  s_waitcnt vmcnt(17)
  v_mfma_f32_16x16x32_bf16 v[168:171], a[160:163], a[72:75], v[168:171]
  s_barrier
  ds_read_b64_tr_b16 a[152:153], v25 offset:32960
  v_mfma_f32_16x16x32_bf16 v[168:171], a[164:167], a[88:91], v[168:171]
  v_mfma_f32_16x16x32_bf16 v[168:171], a[128:131], a[104:107], v[168:171]
  ds_read_b64_tr_b16 a[154:155], v25 offset:36544
  v_mfma_f32_16x16x32_bf16 v[168:171], a[132:135], a[120:123], v[168:171]
  v_mfma_f32_16x16x32_bf16 v[172:175], a[132:135], a[124:127], v[172:175]
  ds_read_b64_tr_b16 a[156:157], v25 offset:40128
  v_mfma_f32_16x16x32_bf16 v[172:175], a[128:131], a[108:111], v[172:175]
  v_mfma_f32_16x16x32_bf16 v[172:175], a[164:167], a[92:95], v[172:175]
  ds_read_b64_tr_b16 a[158:159], v25 offset:43712
  v_mfma_f32_16x16x32_bf16 v[172:175], a[160:163], a[76:79], v[172:175]
  s_waitcnt lgkmcnt(4)
  v_mfma_f32_16x16x32_bf16 v[204:207], a[136:139], a[76:79], v[204:207]
  ds_read_b64_tr_b16 a[160:161], v25 offset:47296
  v_mfma_f32_16x16x32_bf16 v[204:207], a[140:143], a[92:95], v[204:207]
  v_mfma_f32_16x16x32_bf16 v[204:207], a[144:147], a[108:111], v[204:207]
  ds_read_b64_tr_b16 a[162:163], v25 offset:50880
  v_mfma_f32_16x16x32_bf16 v[204:207], a[148:151], a[124:127], v[204:207]
  v_mfma_f32_16x16x32_bf16 v[200:203], a[148:151], a[120:123], v[200:203]
  ds_read_b64_tr_b16 a[164:165], v25 offset:54464
  v_mfma_f32_16x16x32_bf16 v[200:203], a[144:147], a[104:107], v[200:203]
  v_mfma_f32_16x16x32_bf16 v[200:203], a[140:143], a[88:91], v[200:203]
  ds_read_b64_tr_b16 a[166:167], v25 offset:58048
  v_mfma_f32_16x16x32_bf16 v[200:203], a[136:139], a[72:75], v[200:203]
  v_mfma_f32_16x16x32_bf16 v[196:199], a[136:139], a[68:71], v[196:199]
  ds_read_b64_tr_b16 a[128:129], v25 offset:32768
  v_mfma_f32_16x16x32_bf16 v[196:199], a[140:143], a[84:87], v[196:199]
  v_mfma_f32_16x16x32_bf16 v[196:199], a[144:147], a[100:103], v[196:199]
  ds_read_b64_tr_b16 a[130:131], v25 offset:36352
  v_mfma_f32_16x16x32_bf16 v[196:199], a[148:151], a[116:119], v[196:199]
  v_mfma_f32_16x16x32_bf16 v[192:195], a[148:151], a[112:115], v[192:195]
  ds_read_b64_tr_b16 a[132:133], v25 offset:39936
  v_mfma_f32_16x16x32_bf16 v[192:195], a[144:147], a[96:99], v[192:195]
  v_mfma_f32_16x16x32_bf16 v[192:195], a[140:143], a[80:83], v[192:195]
  ds_read_b64_tr_b16 a[134:135], v25 offset:43520
  v_mfma_f32_16x16x32_bf16 v[192:195], a[136:139], a[64:67], v[192:195]
  s_waitcnt lgkmcnt(4)
  v_mfma_f32_16x16x32_bf16 v[240:243], a[152:155], a[64:67], v[240:243]
  s_mov_b32 s39, 16384
  ds_read_b64_tr_b16 a[136:137], v25 offset:47104
  v_mfma_f32_16x16x32_bf16 v[240:243], a[156:159], a[80:83], v[240:243]
  buffer_load_dwordx4 a[32:35], v8, s[16:19], s39 offen offset:2048 sc1
  v_mfma_f32_16x16x32_bf16 v[240:243], a[160:163], a[96:99], v[240:243]
  ds_read_b64_tr_b16 a[138:139], v25 offset:50688
  v_mfma_f32_16x16x32_bf16 v[240:243], a[164:167], a[112:115], v[240:243]
  v_mfma_f32_16x16x32_bf16 v[244:247], a[164:167], a[116:119], v[244:247]
  ds_read_b64_tr_b16 a[140:141], v25 offset:54272
  v_mfma_f32_16x16x32_bf16 v[244:247], a[160:163], a[100:103], v[244:247]
  buffer_load_dwordx4 a[48:51], v8, s[16:19], s39 offen offset:3072 sc1
  s_mov_b32 s39, 49152
  v_mfma_f32_16x16x32_bf16 v[244:247], a[156:159], a[84:87], v[244:247]
  ds_read_b64_tr_b16 a[142:143], v25 offset:57856
  v_mfma_f32_16x16x32_bf16 v[244:247], a[152:155], a[68:71], v[244:247]
  v_mfma_f32_16x16x32_bf16 v[248:251], a[152:155], a[72:75], v[248:251]
  ds_read_b64_tr_b16 a[144:145], v25 offset:32800
  v_mfma_f32_16x16x32_bf16 v[248:251], a[156:159], a[88:91], v[248:251]
  v_mfma_f32_16x16x32_bf16 v[248:251], a[160:163], a[104:107], v[248:251]
  ds_read_b64_tr_b16 a[146:147], v25 offset:36384
  v_mfma_f32_16x16x32_bf16 v[248:251], a[164:167], a[120:123], v[248:251]
  buffer_load_dwordx4 a[36:39], v8, s[16:19], s39 offen offset:2048 sc1
  v_mfma_f32_16x16x32_bf16 v[252:255], a[164:167], a[124:127], v[252:255]
  ds_read_b64_tr_b16 a[148:149], v25 offset:39968
  v_mfma_f32_16x16x32_bf16 v[252:255], a[160:163], a[108:111], v[252:255]
  v_mfma_f32_16x16x32_bf16 v[252:255], a[156:159], a[92:95], v[252:255]
  ds_read_b64_tr_b16 a[150:151], v25 offset:43552
  v_mfma_f32_16x16x32_bf16 v[252:255], a[152:155], a[76:79], v[252:255]
  s_waitcnt lgkmcnt(4)
  v_mfma_f32_16x16x32_bf16 v[60:63], a[128:131], a[76:79], v[60:63]
  ds_read_b64_tr_b16 a[152:153], v25 offset:47136
  v_mfma_f32_16x16x32_bf16 v[60:63], a[132:135], a[92:95], v[60:63]
  buffer_load_dwordx4 a[52:55], v8, s[16:19], s39 offen offset:3072 sc1
  s_mov_b32 s39, 81920
  v_mfma_f32_16x16x32_bf16 v[60:63], a[136:139], a[108:111], v[60:63]
  ds_read_b64_tr_b16 a[154:155], v25 offset:50720
  v_mfma_f32_16x16x32_bf16 v[60:63], a[140:143], a[124:127], v[60:63]
  v_mfma_f32_16x16x32_bf16 v[56:59], a[140:143], a[120:123], v[56:59]
  ds_read_b64_tr_b16 a[156:157], v25 offset:54304
  v_mfma_f32_16x16x32_bf16 v[56:59], a[136:139], a[104:107], v[56:59]
  v_mfma_f32_16x16x32_bf16 v[56:59], a[132:135], a[88:91], v[56:59]
  ds_read_b64_tr_b16 a[158:159], v25 offset:57888
  v_mfma_f32_16x16x32_bf16 v[56:59], a[128:131], a[72:75], v[56:59]
  buffer_load_dwordx4 a[40:43], v8, s[16:19], s39 offen offset:2048 sc1
  v_mfma_f32_16x16x32_bf16 v[52:55], a[128:131], a[68:71], v[52:55]
  ds_read_b64_tr_b16 a[160:161], v25 offset:32832
  v_mfma_f32_16x16x32_bf16 v[52:55], a[132:135], a[84:87], v[52:55]
  v_mfma_f32_16x16x32_bf16 v[52:55], a[136:139], a[100:103], v[52:55]
  ds_read_b64_tr_b16 a[162:163], v25 offset:36416
  v_mfma_f32_16x16x32_bf16 v[52:55], a[140:143], a[116:119], v[52:55]
  buffer_load_dwordx4 a[56:59], v8, s[16:19], s39 offen offset:3072 sc1
  s_mov_b32 s39, 114688
  v_mfma_f32_16x16x32_bf16 v[48:51], a[140:143], a[112:115], v[48:51]
  ds_read_b64_tr_b16 a[164:165], v25 offset:40000
  v_mfma_f32_16x16x32_bf16 v[48:51], a[136:139], a[96:99], v[48:51]
  v_mfma_f32_16x16x32_bf16 v[48:51], a[132:135], a[80:83], v[48:51]
  ds_read_b64_tr_b16 a[166:167], v25 offset:43584
  v_mfma_f32_16x16x32_bf16 v[48:51], a[128:131], a[64:67], v[48:51]
  s_waitcnt lgkmcnt(4)
  v_mfma_f32_16x16x32_bf16 v[80:83], a[144:147], a[64:67], v[80:83]
  ds_read_b64_tr_b16 a[128:129], v25 offset:47168
  v_mfma_f32_16x16x32_bf16 v[80:83], a[148:151], a[80:83], v[80:83]
  buffer_load_dwordx4 a[44:47], v8, s[16:19], s39 offen offset:2048 sc1
  v_mfma_f32_16x16x32_bf16 v[80:83], a[152:155], a[96:99], v[80:83]
  ds_read_b64_tr_b16 a[130:131], v25 offset:50752
  v_mfma_f32_16x16x32_bf16 v[80:83], a[156:159], a[112:115], v[80:83]
  v_mfma_f32_16x16x32_bf16 v[84:87], a[156:159], a[116:119], v[84:87]
  ds_read_b64_tr_b16 a[132:133], v25 offset:54336
  v_mfma_f32_16x16x32_bf16 v[84:87], a[152:155], a[100:103], v[84:87]
  v_mfma_f32_16x16x32_bf16 v[84:87], a[148:151], a[84:87], v[84:87]
  ds_read_b64_tr_b16 a[134:135], v25 offset:57920
  v_mfma_f32_16x16x32_bf16 v[84:87], a[144:147], a[68:71], v[84:87]
  buffer_load_dwordx4 a[60:63], v8, s[16:19], s39 offen offset:3072 sc1
  s_mov_b32 s38, 3670016
  v_mfma_f32_16x16x32_bf16 v[88:91], a[144:147], a[72:75], v[88:91]
  s_add_u32 m0, s77, 32768
  ds_read_b64_tr_b16 a[136:137], v25 offset:32864
  v_mfma_f32_16x16x32_bf16 v[88:91], a[148:151], a[88:91], v[88:91]
  v_mfma_f32_16x16x32_bf16 v[88:91], a[152:155], a[104:107], v[88:91]
  ds_read_b64_tr_b16 a[138:139], v25 offset:36448
  v_mfma_f32_16x16x32_bf16 v[88:91], a[156:159], a[120:123], v[88:91]
  v_mfma_f32_16x16x32_bf16 v[92:95], a[156:159], a[124:127], v[92:95]
  ds_read_b64_tr_b16 a[140:141], v25 offset:40032
  v_mfma_f32_16x16x32_bf16 v[92:95], a[152:155], a[108:111], v[92:95]
  buffer_load_dwordx4 v4, s[96:99], s38 offen offset:0 lds
  v_mfma_f32_16x16x32_bf16 v[92:95], a[148:151], a[92:95], v[92:95]
  ds_read_b64_tr_b16 a[142:143], v25 offset:43616
  v_mfma_f32_16x16x32_bf16 v[92:95], a[144:147], a[76:79], v[92:95]
  s_waitcnt lgkmcnt(4)
  v_mfma_f32_16x16x32_bf16 v[124:127], a[160:163], a[76:79], v[124:127]
  ds_read_b64_tr_b16 a[144:145], v25 offset:47200
  v_mfma_f32_16x16x32_bf16 v[124:127], a[164:167], a[92:95], v[124:127]
  buffer_load_dwordx4 v5, s[96:99], s38 offen offset:1024 lds
  v_mfma_f32_16x16x32_bf16 v[124:127], a[128:131], a[108:111], v[124:127]
  ds_read_b64_tr_b16 a[146:147], v25 offset:50784
  v_mfma_f32_16x16x32_bf16 v[124:127], a[132:135], a[124:127], v[124:127]
  v_mfma_f32_16x16x32_bf16 v[120:123], a[132:135], a[120:123], v[120:123]
  ds_read_b64_tr_b16 a[148:149], v25 offset:54368
  v_mfma_f32_16x16x32_bf16 v[120:123], a[128:131], a[104:107], v[120:123]
  v_mfma_f32_16x16x32_bf16 v[120:123], a[164:167], a[88:91], v[120:123]
  ds_read_b64_tr_b16 a[150:151], v25 offset:57952
  v_mfma_f32_16x16x32_bf16 v[120:123], a[160:163], a[72:75], v[120:123]
  buffer_load_dwordx4 v6, s[96:99], s38 offen offset:2048 lds
  v_mfma_f32_16x16x32_bf16 v[116:119], a[160:163], a[68:71], v[116:119]
  ds_read_b64_tr_b16 a[152:153], v25 offset:32896
  v_mfma_f32_16x16x32_bf16 v[116:119], a[164:167], a[84:87], v[116:119]
  v_mfma_f32_16x16x32_bf16 v[116:119], a[128:131], a[100:103], v[116:119]
  ds_read_b64_tr_b16 a[154:155], v25 offset:36480
  v_mfma_f32_16x16x32_bf16 v[116:119], a[132:135], a[116:119], v[116:119]
  v_mfma_f32_16x16x32_bf16 v[112:115], a[132:135], a[112:115], v[112:115]
  ds_read_b64_tr_b16 a[156:157], v25 offset:40064
  v_mfma_f32_16x16x32_bf16 v[112:115], a[128:131], a[96:99], v[112:115]
  buffer_load_dwordx4 v7, s[96:99], s38 offen offset:3072 lds
  s_add_u32 m0, s77, 36864
  v_mfma_f32_16x16x32_bf16 v[112:115], a[164:167], a[80:83], v[112:115]
  ds_read_b64_tr_b16 a[158:159], v25 offset:43648
  v_mfma_f32_16x16x32_bf16 v[112:115], a[160:163], a[64:67], v[112:115]
  s_waitcnt lgkmcnt(4)
  v_mfma_f32_16x16x32_bf16 v[144:147], a[136:139], a[64:67], v[144:147]
  ds_read_b64_tr_b16 a[160:161], v25 offset:47232
  v_mfma_f32_16x16x32_bf16 v[144:147], a[140:143], a[80:83], v[144:147]
  v_mfma_f32_16x16x32_bf16 v[144:147], a[144:147], a[96:99], v[144:147]
  ds_read_b64_tr_b16 a[162:163], v25 offset:50816
  v_mfma_f32_16x16x32_bf16 v[144:147], a[148:151], a[112:115], v[144:147]
  buffer_load_dwordx4 v12, s[96:99], s38 offen offset:0 lds
  v_mfma_f32_16x16x32_bf16 v[148:151], a[148:151], a[116:119], v[148:151]
  ds_read_b64_tr_b16 a[164:165], v25 offset:54400
  v_mfma_f32_16x16x32_bf16 v[148:151], a[144:147], a[100:103], v[148:151]
  v_mfma_f32_16x16x32_bf16 v[148:151], a[140:143], a[84:87], v[148:151]
  ds_read_b64_tr_b16 a[166:167], v25 offset:57984
  v_mfma_f32_16x16x32_bf16 v[148:151], a[136:139], a[68:71], v[148:151]
  buffer_load_dwordx4 v13, s[96:99], s38 offen offset:1024 lds
  v_mfma_f32_16x16x32_bf16 v[152:155], a[136:139], a[72:75], v[152:155]
  ds_read_b64_tr_b16 a[128:129], v25 offset:32928
  v_mfma_f32_16x16x32_bf16 v[152:155], a[140:143], a[88:91], v[152:155]
  v_mfma_f32_16x16x32_bf16 v[152:155], a[144:147], a[104:107], v[152:155]
  ds_read_b64_tr_b16 a[130:131], v25 offset:36512
  v_mfma_f32_16x16x32_bf16 v[152:155], a[148:151], a[120:123], v[152:155]
  v_mfma_f32_16x16x32_bf16 v[156:159], a[148:151], a[124:127], v[156:159]
  ds_read_b64_tr_b16 a[132:133], v25 offset:40096
  v_mfma_f32_16x16x32_bf16 v[156:159], a[144:147], a[108:111], v[156:159]
  buffer_load_dwordx4 v14, s[96:99], s38 offen offset:2048 lds
  s_mov_b32 s20, s66
  v_mfma_f32_16x16x32_bf16 v[156:159], a[140:143], a[92:95], v[156:159]
  s_mov_b32 s21, s67
  ds_read_b64_tr_b16 a[134:135], v25 offset:43680
  v_mfma_f32_16x16x32_bf16 v[156:159], a[136:139], a[76:79], v[156:159]
  s_waitcnt lgkmcnt(4)
  v_mfma_f32_16x16x32_bf16 v[188:191], a[152:155], a[76:79], v[188:191]
  ds_read_b64_tr_b16 a[136:137], v25 offset:47264
  v_mfma_f32_16x16x32_bf16 v[188:191], a[156:159], a[92:95], v[188:191]
  v_mfma_f32_16x16x32_bf16 v[188:191], a[160:163], a[108:111], v[188:191]
  ds_read_b64_tr_b16 a[138:139], v25 offset:50848
  v_mfma_f32_16x16x32_bf16 v[188:191], a[164:167], a[124:127], v[188:191]
  buffer_load_dword v0, v27, s[20:23], 0 offen
  v_add_u32 v27, 1835008, v27
  v_mfma_f32_16x16x32_bf16 v[184:187], a[164:167], a[120:123], v[184:187]
  ds_read_b64_tr_b16 a[140:141], v25 offset:54432
  v_mfma_f32_16x16x32_bf16 v[184:187], a[160:163], a[104:107], v[184:187]
  v_mfma_f32_16x16x32_bf16 v[184:187], a[156:159], a[88:91], v[184:187]
  ds_read_b64_tr_b16 a[142:143], v25 offset:58016
  v_mfma_f32_16x16x32_bf16 v[184:187], a[152:155], a[72:75], v[184:187]
  s_waitcnt vmcnt(18)
  v_mfma_f32_16x16x32_bf16 v[180:183], a[152:155], a[68:71], v[180:183]
  s_barrier
  ds_read_b64_tr_b16 a[144:145], v24 offset:192
  v_mfma_f32_16x16x32_bf16 v[180:183], a[156:159], a[84:87], v[180:183]
  v_mfma_f32_16x16x32_bf16 v[180:183], a[160:163], a[100:103], v[180:183]
  ds_read_b64_tr_b16 a[146:147], v24 offset:3776
  v_mfma_f32_16x16x32_bf16 v[180:183], a[164:167], a[116:119], v[180:183]
  v_mfma_f32_16x16x32_bf16 v[176:179], a[164:167], a[112:115], v[176:179]
  ds_read_b64_tr_b16 a[148:149], v24 offset:7360
  v_mfma_f32_16x16x32_bf16 v[176:179], a[160:163], a[96:99], v[176:179]
  v_mfma_f32_16x16x32_bf16 v[176:179], a[156:159], a[80:83], v[176:179]
  ds_read_b64_tr_b16 a[150:151], v24 offset:10944
  v_mfma_f32_16x16x32_bf16 v[176:179], a[152:155], a[64:67], v[176:179]
  s_waitcnt lgkmcnt(4)
  v_mfma_f32_16x16x32_bf16 v[208:211], a[128:131], a[64:67], v[208:211]
  ds_read_b64_tr_b16 a[152:153], v24 offset:14528
  v_mfma_f32_16x16x32_bf16 v[208:211], a[132:135], a[80:83], v[208:211]
  v_mfma_f32_16x16x32_bf16 v[208:211], a[136:139], a[96:99], v[208:211]
  ds_read_b64_tr_b16 a[154:155], v24 offset:18112
  v_mfma_f32_16x16x32_bf16 v[208:211], a[140:143], a[112:115], v[208:211]
  v_mfma_f32_16x16x32_bf16 v[212:215], a[140:143], a[116:119], v[212:215]
  ds_read_b64_tr_b16 a[156:157], v24 offset:21696
  v_mfma_f32_16x16x32_bf16 v[212:215], a[136:139], a[100:103], v[212:215]
  v_mfma_f32_16x16x32_bf16 v[212:215], a[132:135], a[84:87], v[212:215]
  ds_read_b64_tr_b16 a[158:159], v24 offset:25280
  v_mfma_f32_16x16x32_bf16 v[212:215], a[128:131], a[68:71], v[212:215]
  v_mfma_f32_16x16x32_bf16 v[216:219], a[128:131], a[72:75], v[216:219]
  ds_read_b64_tr_b16 a[160:161], v24 offset:0
  v_mfma_f32_16x16x32_bf16 v[216:219], a[132:135], a[88:91], v[216:219]
  v_mfma_f32_16x16x32_bf16 v[216:219], a[136:139], a[104:107], v[216:219]
  ds_read_b64_tr_b16 a[162:163], v24 offset:3584
  v_mfma_f32_16x16x32_bf16 v[216:219], a[140:143], a[120:123], v[216:219]
  v_mfma_f32_16x16x32_bf16 v[220:223], a[140:143], a[124:127], v[220:223]
  ds_read_b64_tr_b16 a[164:165], v24 offset:7168
  v_mfma_f32_16x16x32_bf16 v[220:223], a[136:139], a[108:111], v[220:223]
  v_mfma_f32_16x16x32_bf16 v[220:223], a[132:135], a[92:95], v[220:223]
  ds_read_b64_tr_b16 a[166:167], v24 offset:10752
  v_mfma_f32_16x16x32_bf16 v[220:223], a[128:131], a[76:79], v[220:223]
  s_waitcnt vmcnt(8) lgkmcnt(4)
  v_mfma_f32_16x16x32_bf16 v[236:239], a[144:147], a[12:15], v[236:239]
  s_mov_b32 s39, 20480
  ds_read_b64_tr_b16 a[128:129], v24 offset:14336
  v_mfma_f32_16x16x32_bf16 v[236:239], a[148:151], a[28:31], v[236:239]
  buffer_load_dwordx4 a[64:67], v8, s[16:19], s39 offen offset:0 sc1
  s_mov_b32 s38, 4587520
  v_mfma_f32_16x16x32_bf16 v[236:239], a[152:155], a[44:47], v[236:239]
  s_add_u32 m0, s77, 65536
  ds_read_b64_tr_b16 a[130:131], v24 offset:17920
  v_mfma_f32_16x16x32_bf16 v[236:239], a[156:159], a[60:63], v[236:239]
  v_mfma_f32_16x16x32_bf16 v[232:235], a[156:159], a[56:59], v[232:235]
  ds_read_b64_tr_b16 a[132:133], v24 offset:21504
  v_mfma_f32_16x16x32_bf16 v[232:235], a[152:155], a[40:43], v[232:235]
  buffer_load_dwordx4 v4, s[12:15], s38 offen offset:0 lds
  v_mfma_f32_16x16x32_bf16 v[232:235], a[148:151], a[24:27], v[232:235]
  ds_read_b64_tr_b16 a[134:135], v24 offset:25088
  v_mfma_f32_16x16x32_bf16 v[232:235], a[144:147], a[8:11], v[232:235]
  v_mfma_f32_16x16x32_bf16 v[228:231], a[144:147], a[4:7], v[228:231]
  ds_read_b64_tr_b16 a[136:137], v24 offset:32
  v_mfma_f32_16x16x32_bf16 v[228:231], a[148:151], a[20:23], v[228:231]
  v_mfma_f32_16x16x32_bf16 v[228:231], a[152:155], a[36:39], v[228:231]
  ds_read_b64_tr_b16 a[138:139], v24 offset:3616
  v_mfma_f32_16x16x32_bf16 v[228:231], a[156:159], a[52:55], v[228:231]
  buffer_load_dwordx4 a[80:83], v8, s[16:19], s39 offen offset:1024 sc1
  v_mfma_f32_16x16x32_bf16 v[224:227], a[156:159], a[48:51], v[224:227]
  ds_read_b64_tr_b16 a[140:141], v24 offset:7200
  v_mfma_f32_16x16x32_bf16 v[224:227], a[152:155], a[32:35], v[224:227]
  v_mfma_f32_16x16x32_bf16 v[224:227], a[148:151], a[16:19], v[224:227]
  ds_read_b64_tr_b16 a[142:143], v24 offset:10784
  v_mfma_f32_16x16x32_bf16 v[224:227], a[144:147], a[0:3], v[224:227]
  s_waitcnt lgkmcnt(4)
  v_mfma_f32_16x16x32_bf16 v[32:35], a[160:163], a[0:3], v[32:35]
  ds_read_b64_tr_b16 a[144:145], v24 offset:14368
  v_mfma_f32_16x16x32_bf16 v[32:35], a[164:167], a[16:19], v[32:35]
  buffer_load_dwordx4 v5, s[12:15], s38 offen offset:1024 lds
  s_mov_b32 s39, 53248
  v_mfma_f32_16x16x32_bf16 v[32:35], a[128:131], a[32:35], v[32:35]
  ds_read_b64_tr_b16 a[146:147], v24 offset:17952
  v_mfma_f32_16x16x32_bf16 v[32:35], a[132:135], a[48:51], v[32:35]
  v_mfma_f32_16x16x32_bf16 v[36:39], a[132:135], a[52:55], v[36:39]
  ds_read_b64_tr_b16 a[148:149], v24 offset:21536
  v_mfma_f32_16x16x32_bf16 v[36:39], a[128:131], a[36:39], v[36:39]
  v_mfma_f32_16x16x32_bf16 v[36:39], a[164:167], a[20:23], v[36:39]
  ds_read_b64_tr_b16 a[150:151], v24 offset:25120
  v_mfma_f32_16x16x32_bf16 v[36:39], a[160:163], a[4:7], v[36:39]
  buffer_load_dwordx4 a[68:71], v8, s[16:19], s39 offen offset:0 sc1
  v_mfma_f32_16x16x32_bf16 v[40:43], a[160:163], a[8:11], v[40:43]
  ds_read_b64_tr_b16 a[152:153], v24 offset:64
  v_mfma_f32_16x16x32_bf16 v[40:43], a[164:167], a[24:27], v[40:43]
  v_mfma_f32_16x16x32_bf16 v[40:43], a[128:131], a[40:43], v[40:43]
  ds_read_b64_tr_b16 a[154:155], v24 offset:3648
  v_mfma_f32_16x16x32_bf16 v[40:43], a[132:135], a[56:59], v[40:43]
  buffer_load_dwordx4 v6, s[12:15], s38 offen offset:2048 lds
  v_mfma_f32_16x16x32_bf16 v[44:47], a[132:135], a[60:63], v[44:47]
  ds_read_b64_tr_b16 a[156:157], v24 offset:7232
  v_mfma_f32_16x16x32_bf16 v[44:47], a[128:131], a[44:47], v[44:47]
  v_mfma_f32_16x16x32_bf16 v[44:47], a[164:167], a[28:31], v[44:47]
  ds_read_b64_tr_b16 a[158:159], v24 offset:10816
  v_mfma_f32_16x16x32_bf16 v[44:47], a[160:163], a[12:15], v[44:47]
  s_waitcnt lgkmcnt(4)
  v_mfma_f32_16x16x32_bf16 v[76:79], a[136:139], a[12:15], v[76:79]
  ds_read_b64_tr_b16 a[160:161], v24 offset:14400
  v_mfma_f32_16x16x32_bf16 v[76:79], a[140:143], a[28:31], v[76:79]
  buffer_load_dwordx4 a[84:87], v8, s[16:19], s39 offen offset:1024 sc1
  v_mfma_f32_16x16x32_bf16 v[76:79], a[144:147], a[44:47], v[76:79]
  ds_read_b64_tr_b16 a[162:163], v24 offset:17984
  v_mfma_f32_16x16x32_bf16 v[76:79], a[148:151], a[60:63], v[76:79]
  v_mfma_f32_16x16x32_bf16 v[72:75], a[148:151], a[56:59], v[72:75]
  ds_read_b64_tr_b16 a[164:165], v24 offset:21568
  v_mfma_f32_16x16x32_bf16 v[72:75], a[144:147], a[40:43], v[72:75]
  v_mfma_f32_16x16x32_bf16 v[72:75], a[140:143], a[24:27], v[72:75]
  ds_read_b64_tr_b16 a[166:167], v24 offset:25152
  v_mfma_f32_16x16x32_bf16 v[72:75], a[136:139], a[8:11], v[72:75]
  buffer_load_dwordx4 v7, s[12:15], s38 offen offset:3072 lds
  s_mov_b32 s39, 86016
  v_mfma_f32_16x16x32_bf16 v[68:71], a[136:139], a[4:7], v[68:71]
  ds_read_b64_tr_b16 a[128:129], v24 offset:96
  v_mfma_f32_16x16x32_bf16 v[68:71], a[140:143], a[20:23], v[68:71]
  v_mfma_f32_16x16x32_bf16 v[68:71], a[144:147], a[36:39], v[68:71]
  ds_read_b64_tr_b16 a[130:131], v24 offset:3680
  v_mfma_f32_16x16x32_bf16 v[68:71], a[148:151], a[52:55], v[68:71]
  v_mfma_f32_16x16x32_bf16 v[64:67], a[148:151], a[48:51], v[64:67]
  ds_read_b64_tr_b16 a[132:133], v24 offset:7264
  v_mfma_f32_16x16x32_bf16 v[64:67], a[144:147], a[32:35], v[64:67]
  buffer_load_dwordx4 a[72:75], v8, s[16:19], s39 offen offset:0 sc1
  s_add_u32 m0, s77, 69632
  v_mfma_f32_16x16x32_bf16 v[64:67], a[140:143], a[16:19], v[64:67]
  ds_read_b64_tr_b16 a[134:135], v24 offset:10848
  v_mfma_f32_16x16x32_bf16 v[64:67], a[136:139], a[0:3], v[64:67]
  s_waitcnt lgkmcnt(4)
  v_mfma_f32_16x16x32_bf16 v[96:99], a[152:155], a[0:3], v[96:99]
  ds_read_b64_tr_b16 a[136:137], v24 offset:14432
  v_mfma_f32_16x16x32_bf16 v[96:99], a[156:159], a[16:19], v[96:99]
  buffer_load_dwordx4 v12, s[12:15], s38 offen offset:0 lds
  v_mfma_f32_16x16x32_bf16 v[96:99], a[160:163], a[32:35], v[96:99]
  ds_read_b64_tr_b16 a[138:139], v24 offset:18016
  v_mfma_f32_16x16x32_bf16 v[96:99], a[164:167], a[48:51], v[96:99]
  v_mfma_f32_16x16x32_bf16 v[100:103], a[164:167], a[52:55], v[100:103]
  ds_read_b64_tr_b16 a[140:141], v24 offset:21600
  v_mfma_f32_16x16x32_bf16 v[100:103], a[160:163], a[36:39], v[100:103]
  v_mfma_f32_16x16x32_bf16 v[100:103], a[156:159], a[20:23], v[100:103]
  ds_read_b64_tr_b16 a[142:143], v24 offset:25184
  v_mfma_f32_16x16x32_bf16 v[100:103], a[152:155], a[4:7], v[100:103]
  buffer_load_dwordx4 a[88:91], v8, s[16:19], s39 offen offset:1024 sc1
  v_mfma_f32_16x16x32_bf16 v[104:107], a[152:155], a[8:11], v[104:107]
  ds_read_b64_tr_b16 a[144:145], v24 offset:128
  v_mfma_f32_16x16x32_bf16 v[104:107], a[156:159], a[24:27], v[104:107]
  v_mfma_f32_16x16x32_bf16 v[104:107], a[160:163], a[40:43], v[104:107]
  ds_read_b64_tr_b16 a[146:147], v24 offset:3712
  v_mfma_f32_16x16x32_bf16 v[104:107], a[164:167], a[56:59], v[104:107]
  v_mfma_f32_16x16x32_bf16 v[108:111], a[164:167], a[60:63], v[108:111]
  ds_read_b64_tr_b16 a[148:149], v24 offset:7296
  v_mfma_f32_16x16x32_bf16 v[108:111], a[160:163], a[44:47], v[108:111]
  buffer_load_dwordx4 v13, s[12:15], s38 offen offset:1024 lds
  s_mov_b32 s39, 118784
  v_mfma_f32_16x16x32_bf16 v[108:111], a[156:159], a[28:31], v[108:111]
  ds_read_b64_tr_b16 a[150:151], v24 offset:10880
  v_mfma_f32_16x16x32_bf16 v[108:111], a[152:155], a[12:15], v[108:111]
  s_waitcnt lgkmcnt(4)
  v_mfma_f32_16x16x32_bf16 v[140:143], a[128:131], a[12:15], v[140:143]
  ds_read_b64_tr_b16 a[152:153], v24 offset:14464
  v_mfma_f32_16x16x32_bf16 v[140:143], a[132:135], a[28:31], v[140:143]
L_pad_2b_3:
  s_cbranch_execz L_pad_2b_6
  v_mfma_f32_16x16x32_bf16 v[140:143], a[136:139], a[44:47], v[140:143]
  ds_read_b64_tr_b16 a[154:155], v24 offset:18048
  v_mfma_f32_16x16x32_bf16 v[140:143], a[140:143], a[60:63], v[140:143]
  buffer_load_dwordx4 a[76:79], v8, s[16:19], s39 offen offset:0 sc1
  v_mfma_f32_16x16x32_bf16 v[136:139], a[140:143], a[56:59], v[136:139]
  ds_read_b64_tr_b16 a[156:157], v24 offset:21632
  v_mfma_f32_16x16x32_bf16 v[136:139], a[136:139], a[40:43], v[136:139]
  v_mfma_f32_16x16x32_bf16 v[136:139], a[132:135], a[24:27], v[136:139]
  ds_read_b64_tr_b16 a[158:159], v24 offset:25216
  v_mfma_f32_16x16x32_bf16 v[136:139], a[128:131], a[8:11], v[136:139]
  buffer_load_dwordx4 v14, s[12:15], s38 offen offset:2048 lds
  v_mfma_f32_16x16x32_bf16 v[132:135], a[128:131], a[4:7], v[132:135]
  ds_read_b64_tr_b16 a[160:161], v24 offset:160
  v_mfma_f32_16x16x32_bf16 v[132:135], a[132:135], a[20:23], v[132:135]
  v_mfma_f32_16x16x32_bf16 v[132:135], a[136:139], a[36:39], v[132:135]
  ds_read_b64_tr_b16 a[162:163], v24 offset:3744
  v_mfma_f32_16x16x32_bf16 v[132:135], a[140:143], a[52:55], v[132:135]
  v_mfma_f32_16x16x32_bf16 v[128:131], a[140:143], a[48:51], v[128:131]
  ds_read_b64_tr_b16 a[164:165], v24 offset:7328
  v_mfma_f32_16x16x32_bf16 v[128:131], a[136:139], a[32:35], v[128:131]
  buffer_load_dwordx4 a[92:95], v8, s[16:19], s39 offen offset:1024 sc1
  v_mfma_f32_16x16x32_bf16 v[128:131], a[132:135], a[16:19], v[128:131]
  ds_read_b64_tr_b16 a[166:167], v24 offset:10912
  v_mfma_f32_16x16x32_bf16 v[128:131], a[128:131], a[0:3], v[128:131]
  s_waitcnt lgkmcnt(4)
  v_mfma_f32_16x16x32_bf16 v[160:163], a[144:147], a[0:3], v[160:163]
  ds_read_b64_tr_b16 a[128:129], v24 offset:14496
  v_mfma_f32_16x16x32_bf16 v[160:163], a[148:151], a[16:19], v[160:163]
  v_mfma_f32_16x16x32_bf16 v[160:163], a[152:155], a[32:35], v[160:163]
  ds_read_b64_tr_b16 a[130:131], v24 offset:18080
  v_mfma_f32_16x16x32_bf16 v[160:163], a[156:159], a[48:51], v[160:163]
  buffer_load_dword v0, v27, s[20:23], 0 offen
  v_add_u32 v27, 1835008, v27
  v_mfma_f32_16x16x32_bf16 v[164:167], a[156:159], a[52:55], v[164:167]
  ds_read_b64_tr_b16 a[132:133], v24 offset:21664
  v_mfma_f32_16x16x32_bf16 v[164:167], a[152:155], a[36:39], v[164:167]
  v_mfma_f32_16x16x32_bf16 v[164:167], a[148:151], a[20:23], v[164:167]
  ds_read_b64_tr_b16 a[134:135], v24 offset:25248
  v_mfma_f32_16x16x32_bf16 v[164:167], a[144:147], a[4:7], v[164:167]
  s_waitcnt vmcnt(17)
  v_mfma_f32_16x16x32_bf16 v[168:171], a[144:147], a[8:11], v[168:171]
  s_barrier
  ds_read_b64_tr_b16 a[136:137], v24 offset:32960
  v_mfma_f32_16x16x32_bf16 v[168:171], a[148:151], a[24:27], v[168:171]
  v_mfma_f32_16x16x32_bf16 v[168:171], a[152:155], a[40:43], v[168:171]
  ds_read_b64_tr_b16 a[138:139], v24 offset:36544
  v_mfma_f32_16x16x32_bf16 v[168:171], a[156:159], a[56:59], v[168:171]
  v_mfma_f32_16x16x32_bf16 v[172:175], a[156:159], a[60:63], v[172:175]
  ds_read_b64_tr_b16 a[140:141], v24 offset:40128
  v_mfma_f32_16x16x32_bf16 v[172:175], a[152:155], a[44:47], v[172:175]
  v_mfma_f32_16x16x32_bf16 v[172:175], a[148:151], a[28:31], v[172:175]
  ds_read_b64_tr_b16 a[142:143], v24 offset:43712
  v_mfma_f32_16x16x32_bf16 v[172:175], a[144:147], a[12:15], v[172:175]
  s_waitcnt lgkmcnt(4)
  v_mfma_f32_16x16x32_bf16 v[204:207], a[160:163], a[12:15], v[204:207]
  ds_read_b64_tr_b16 a[144:145], v24 offset:47296
  v_mfma_f32_16x16x32_bf16 v[204:207], a[164:167], a[28:31], v[204:207]
  v_mfma_f32_16x16x32_bf16 v[204:207], a[128:131], a[44:47], v[204:207]
  ds_read_b64_tr_b16 a[146:147], v24 offset:50880
  v_mfma_f32_16x16x32_bf16 v[204:207], a[132:135], a[60:63], v[204:207]
  v_mfma_f32_16x16x32_bf16 v[200:203], a[132:135], a[56:59], v[200:203]
  ds_read_b64_tr_b16 a[148:149], v24 offset:54464
  v_mfma_f32_16x16x32_bf16 v[200:203], a[128:131], a[40:43], v[200:203]
  v_mfma_f32_16x16x32_bf16 v[200:203], a[164:167], a[24:27], v[200:203]
  ds_read_b64_tr_b16 a[150:151], v24 offset:58048
  v_mfma_f32_16x16x32_bf16 v[200:203], a[160:163], a[8:11], v[200:203]
  v_mfma_f32_16x16x32_bf16 v[196:199], a[160:163], a[4:7], v[196:199]
  ds_read_b64_tr_b16 a[152:153], v24 offset:32768
  v_mfma_f32_16x16x32_bf16 v[196:199], a[164:167], a[20:23], v[196:199]
  v_mfma_f32_16x16x32_bf16 v[196:199], a[128:131], a[36:39], v[196:199]
  ds_read_b64_tr_b16 a[154:155], v24 offset:36352
  v_mfma_f32_16x16x32_bf16 v[196:199], a[132:135], a[52:55], v[196:199]
  v_mfma_f32_16x16x32_bf16 v[192:195], a[132:135], a[48:51], v[192:195]
  ds_read_b64_tr_b16 a[156:157], v24 offset:39936
  v_mfma_f32_16x16x32_bf16 v[192:195], a[128:131], a[32:35], v[192:195]
  v_mfma_f32_16x16x32_bf16 v[192:195], a[164:167], a[16:19], v[192:195]
  ds_read_b64_tr_b16 a[158:159], v24 offset:43520
  v_mfma_f32_16x16x32_bf16 v[192:195], a[160:163], a[0:3], v[192:195]
  s_waitcnt lgkmcnt(4)
  v_mfma_f32_16x16x32_bf16 v[240:243], a[136:139], a[0:3], v[240:243]
  s_mov_b32 s39, 20480
  ds_read_b64_tr_b16 a[160:161], v24 offset:47104
  v_mfma_f32_16x16x32_bf16 v[240:243], a[140:143], a[16:19], v[240:243]
  buffer_load_dwordx4 a[96:99], v8, s[16:19], s39 offen offset:2048 sc1
  v_mfma_f32_16x16x32_bf16 v[240:243], a[144:147], a[32:35], v[240:243]
  ds_read_b64_tr_b16 a[162:163], v24 offset:50688
  v_mfma_f32_16x16x32_bf16 v[240:243], a[148:151], a[48:51], v[240:243]
  v_mfma_f32_16x16x32_bf16 v[244:247], a[148:151], a[52:55], v[244:247]
  ds_read_b64_tr_b16 a[164:165], v24 offset:54272
  v_mfma_f32_16x16x32_bf16 v[244:247], a[144:147], a[36:39], v[244:247]
  buffer_load_dwordx4 a[112:115], v8, s[16:19], s39 offen offset:3072 sc1
  s_mov_b32 s39, 53248
  v_mfma_f32_16x16x32_bf16 v[244:247], a[140:143], a[20:23], v[244:247]
  ds_read_b64_tr_b16 a[166:167], v24 offset:57856
  v_mfma_f32_16x16x32_bf16 v[244:247], a[136:139], a[4:7], v[244:247]
  v_mfma_f32_16x16x32_bf16 v[248:251], a[136:139], a[8:11], v[248:251]
  ds_read_b64_tr_b16 a[128:129], v24 offset:32800
  v_mfma_f32_16x16x32_bf16 v[248:251], a[140:143], a[24:27], v[248:251]
  v_mfma_f32_16x16x32_bf16 v[248:251], a[144:147], a[40:43], v[248:251]
  ds_read_b64_tr_b16 a[130:131], v24 offset:36384
  v_mfma_f32_16x16x32_bf16 v[248:251], a[148:151], a[56:59], v[248:251]
  buffer_load_dwordx4 a[100:103], v8, s[16:19], s39 offen offset:2048 sc1
  v_mfma_f32_16x16x32_bf16 v[252:255], a[148:151], a[60:63], v[252:255]
  ds_read_b64_tr_b16 a[132:133], v24 offset:39968
  v_mfma_f32_16x16x32_bf16 v[252:255], a[144:147], a[44:47], v[252:255]
  v_mfma_f32_16x16x32_bf16 v[252:255], a[140:143], a[28:31], v[252:255]
  ds_read_b64_tr_b16 a[134:135], v24 offset:43552
  v_mfma_f32_16x16x32_bf16 v[252:255], a[136:139], a[12:15], v[252:255]
  s_waitcnt lgkmcnt(4)
  v_mfma_f32_16x16x32_bf16 v[60:63], a[152:155], a[12:15], v[60:63]
  ds_read_b64_tr_b16 a[136:137], v24 offset:47136
  v_mfma_f32_16x16x32_bf16 v[60:63], a[156:159], a[28:31], v[60:63]
  buffer_load_dwordx4 a[116:119], v8, s[16:19], s39 offen offset:3072 sc1
  s_mov_b32 s39, 86016
  v_mfma_f32_16x16x32_bf16 v[60:63], a[160:163], a[44:47], v[60:63]
  ds_read_b64_tr_b16 a[138:139], v24 offset:50720
  v_mfma_f32_16x16x32_bf16 v[60:63], a[164:167], a[60:63], v[60:63]
  v_mfma_f32_16x16x32_bf16 v[56:59], a[164:167], a[56:59], v[56:59]
  ds_read_b64_tr_b16 a[140:141], v24 offset:54304
  v_mfma_f32_16x16x32_bf16 v[56:59], a[160:163], a[40:43], v[56:59]
  v_mfma_f32_16x16x32_bf16 v[56:59], a[156:159], a[24:27], v[56:59]
  ds_read_b64_tr_b16 a[142:143], v24 offset:57888
  v_mfma_f32_16x16x32_bf16 v[56:59], a[152:155], a[8:11], v[56:59]
  buffer_load_dwordx4 a[104:107], v8, s[16:19], s39 offen offset:2048 sc1
  v_mfma_f32_16x16x32_bf16 v[52:55], a[152:155], a[4:7], v[52:55]
  ds_read_b64_tr_b16 a[144:145], v24 offset:32832
  v_mfma_f32_16x16x32_bf16 v[52:55], a[156:159], a[20:23], v[52:55]
  v_mfma_f32_16x16x32_bf16 v[52:55], a[160:163], a[36:39], v[52:55]
  ds_read_b64_tr_b16 a[146:147], v24 offset:36416
  v_mfma_f32_16x16x32_bf16 v[52:55], a[164:167], a[52:55], v[52:55]
  buffer_load_dwordx4 a[120:123], v8, s[16:19], s39 offen offset:3072 sc1
  s_mov_b32 s39, 118784
  v_mfma_f32_16x16x32_bf16 v[48:51], a[164:167], a[48:51], v[48:51]
  ds_read_b64_tr_b16 a[148:149], v24 offset:40000
  v_mfma_f32_16x16x32_bf16 v[48:51], a[160:163], a[32:35], v[48:51]
  v_mfma_f32_16x16x32_bf16 v[48:51], a[156:159], a[16:19], v[48:51]
  ds_read_b64_tr_b16 a[150:151], v24 offset:43584
  v_mfma_f32_16x16x32_bf16 v[48:51], a[152:155], a[0:3], v[48:51]
  s_waitcnt lgkmcnt(4)
  v_mfma_f32_16x16x32_bf16 v[80:83], a[128:131], a[0:3], v[80:83]
  ds_read_b64_tr_b16 a[152:153], v24 offset:47168
  v_mfma_f32_16x16x32_bf16 v[80:83], a[132:135], a[16:19], v[80:83]
  buffer_load_dwordx4 a[108:111], v8, s[16:19], s39 offen offset:2048 sc1
  v_mfma_f32_16x16x32_bf16 v[80:83], a[136:139], a[32:35], v[80:83]
  ds_read_b64_tr_b16 a[154:155], v24 offset:50752
  v_mfma_f32_16x16x32_bf16 v[80:83], a[140:143], a[48:51], v[80:83]
  v_mfma_f32_16x16x32_bf16 v[84:87], a[140:143], a[52:55], v[84:87]
  ds_read_b64_tr_b16 a[156:157], v24 offset:54336
  v_mfma_f32_16x16x32_bf16 v[84:87], a[136:139], a[36:39], v[84:87]
  v_mfma_f32_16x16x32_bf16 v[84:87], a[132:135], a[20:23], v[84:87]
  ds_read_b64_tr_b16 a[158:159], v24 offset:57920
  v_mfma_f32_16x16x32_bf16 v[84:87], a[128:131], a[4:7], v[84:87]
  buffer_load_dwordx4 a[124:127], v8, s[16:19], s39 offen offset:3072 sc1
  s_mov_b32 s38, 4587520
  v_mfma_f32_16x16x32_bf16 v[88:91], a[128:131], a[8:11], v[88:91]
  s_add_u32 m0, s77, 98304
  ds_read_b64_tr_b16 a[160:161], v24 offset:32864
  v_mfma_f32_16x16x32_bf16 v[88:91], a[132:135], a[24:27], v[88:91]
  v_mfma_f32_16x16x32_bf16 v[88:91], a[136:139], a[40:43], v[88:91]
  ds_read_b64_tr_b16 a[162:163], v24 offset:36448
  v_mfma_f32_16x16x32_bf16 v[88:91], a[140:143], a[56:59], v[88:91]
  v_mfma_f32_16x16x32_bf16 v[92:95], a[140:143], a[60:63], v[92:95]
  ds_read_b64_tr_b16 a[164:165], v24 offset:40032
  v_mfma_f32_16x16x32_bf16 v[92:95], a[136:139], a[44:47], v[92:95]
  buffer_load_dwordx4 v4, s[96:99], s38 offen offset:0 lds
  v_mfma_f32_16x16x32_bf16 v[92:95], a[132:135], a[28:31], v[92:95]
  ds_read_b64_tr_b16 a[166:167], v24 offset:43616
  v_mfma_f32_16x16x32_bf16 v[92:95], a[128:131], a[12:15], v[92:95]
  s_waitcnt lgkmcnt(4)
  v_mfma_f32_16x16x32_bf16 v[124:127], a[144:147], a[12:15], v[124:127]
  ds_read_b64_tr_b16 a[128:129], v24 offset:47200
  v_mfma_f32_16x16x32_bf16 v[124:127], a[148:151], a[28:31], v[124:127]
  buffer_load_dwordx4 v5, s[96:99], s38 offen offset:1024 lds
  v_mfma_f32_16x16x32_bf16 v[124:127], a[152:155], a[44:47], v[124:127]
  ds_read_b64_tr_b16 a[130:131], v24 offset:50784
  v_mfma_f32_16x16x32_bf16 v[124:127], a[156:159], a[60:63], v[124:127]
  v_mfma_f32_16x16x32_bf16 v[120:123], a[156:159], a[56:59], v[120:123]
  ds_read_b64_tr_b16 a[132:133], v24 offset:54368
  v_mfma_f32_16x16x32_bf16 v[120:123], a[152:155], a[40:43], v[120:123]
  v_mfma_f32_16x16x32_bf16 v[120:123], a[148:151], a[24:27], v[120:123]
  ds_read_b64_tr_b16 a[134:135], v24 offset:57952
  v_mfma_f32_16x16x32_bf16 v[120:123], a[144:147], a[8:11], v[120:123]
  buffer_load_dwordx4 v6, s[96:99], s38 offen offset:2048 lds
  v_mfma_f32_16x16x32_bf16 v[116:119], a[144:147], a[4:7], v[116:119]
  ds_read_b64_tr_b16 a[136:137], v24 offset:32896
  v_mfma_f32_16x16x32_bf16 v[116:119], a[148:151], a[20:23], v[116:119]
  v_mfma_f32_16x16x32_bf16 v[116:119], a[152:155], a[36:39], v[116:119]
  ds_read_b64_tr_b16 a[138:139], v24 offset:36480
  v_mfma_f32_16x16x32_bf16 v[116:119], a[156:159], a[52:55], v[116:119]
  v_mfma_f32_16x16x32_bf16 v[112:115], a[156:159], a[48:51], v[112:115]
  ds_read_b64_tr_b16 a[140:141], v24 offset:40064
  v_mfma_f32_16x16x32_bf16 v[112:115], a[152:155], a[32:35], v[112:115]
  buffer_load_dwordx4 v7, s[96:99], s38 offen offset:3072 lds
  s_add_u32 m0, s77, 102400
  v_mfma_f32_16x16x32_bf16 v[112:115], a[148:151], a[16:19], v[112:115]
  ds_read_b64_tr_b16 a[142:143], v24 offset:43648
  v_mfma_f32_16x16x32_bf16 v[112:115], a[144:147], a[0:3], v[112:115]
  s_waitcnt lgkmcnt(4)
  v_mfma_f32_16x16x32_bf16 v[144:147], a[160:163], a[0:3], v[144:147]
  ds_read_b64_tr_b16 a[144:145], v24 offset:47232
  v_mfma_f32_16x16x32_bf16 v[144:147], a[164:167], a[16:19], v[144:147]
  v_mfma_f32_16x16x32_bf16 v[144:147], a[128:131], a[32:35], v[144:147]
  ds_read_b64_tr_b16 a[146:147], v24 offset:50816
  v_mfma_f32_16x16x32_bf16 v[144:147], a[132:135], a[48:51], v[144:147]
  buffer_load_dwordx4 v12, s[96:99], s38 offen offset:0 lds
  v_mfma_f32_16x16x32_bf16 v[148:151], a[132:135], a[52:55], v[148:151]
  ds_read_b64_tr_b16 a[148:149], v24 offset:54400
  v_mfma_f32_16x16x32_bf16 v[148:151], a[128:131], a[36:39], v[148:151]
  v_mfma_f32_16x16x32_bf16 v[148:151], a[164:167], a[20:23], v[148:151]
  ds_read_b64_tr_b16 a[150:151], v24 offset:57984
  v_mfma_f32_16x16x32_bf16 v[148:151], a[160:163], a[4:7], v[148:151]
  buffer_load_dwordx4 v13, s[96:99], s38 offen offset:1024 lds
  v_mfma_f32_16x16x32_bf16 v[152:155], a[160:163], a[8:11], v[152:155]
  ds_read_b64_tr_b16 a[152:153], v24 offset:32928
  v_mfma_f32_16x16x32_bf16 v[152:155], a[164:167], a[24:27], v[152:155]
  v_mfma_f32_16x16x32_bf16 v[152:155], a[128:131], a[40:43], v[152:155]
  ds_read_b64_tr_b16 a[154:155], v24 offset:36512
  v_mfma_f32_16x16x32_bf16 v[152:155], a[132:135], a[56:59], v[152:155]
  v_mfma_f32_16x16x32_bf16 v[156:159], a[132:135], a[60:63], v[156:159]
  ds_read_b64_tr_b16 a[156:157], v24 offset:40096
  v_mfma_f32_16x16x32_bf16 v[156:159], a[128:131], a[44:47], v[156:159]
  buffer_load_dwordx4 v14, s[96:99], s38 offen offset:2048 lds
  v_mfma_f32_16x16x32_bf16 v[156:159], a[164:167], a[28:31], v[156:159]
  ds_read_b64_tr_b16 a[158:159], v24 offset:43680
  v_mfma_f32_16x16x32_bf16 v[156:159], a[160:163], a[12:15], v[156:159]
  s_waitcnt lgkmcnt(4)
  v_mfma_f32_16x16x32_bf16 v[188:191], a[136:139], a[12:15], v[188:191]
  ds_read_b64_tr_b16 a[160:161], v24 offset:47264
  v_mfma_f32_16x16x32_bf16 v[188:191], a[140:143], a[28:31], v[188:191]
  v_mfma_f32_16x16x32_bf16 v[188:191], a[144:147], a[44:47], v[188:191]
  ds_read_b64_tr_b16 a[162:163], v24 offset:50848
  v_mfma_f32_16x16x32_bf16 v[188:191], a[148:151], a[60:63], v[188:191]
  buffer_load_dword v0, v27, s[20:23], 0 offen
  v_add_u32 v27, 1835008, v27
  v_mfma_f32_16x16x32_bf16 v[184:187], a[148:151], a[56:59], v[184:187]
  ds_read_b64_tr_b16 a[164:165], v24 offset:54432
  v_mfma_f32_16x16x32_bf16 v[184:187], a[144:147], a[40:43], v[184:187]
  v_mfma_f32_16x16x32_bf16 v[184:187], a[140:143], a[24:27], v[184:187]
  ds_read_b64_tr_b16 a[166:167], v24 offset:58016
  v_mfma_f32_16x16x32_bf16 v[184:187], a[136:139], a[8:11], v[184:187]
  s_waitcnt vmcnt(18)
  v_mfma_f32_16x16x32_bf16 v[180:183], a[136:139], a[4:7], v[180:183]
  s_barrier
  ds_read_b64_tr_b16 a[128:129], v25 offset:192
  v_mfma_f32_16x16x32_bf16 v[180:183], a[140:143], a[20:23], v[180:183]
  v_mfma_f32_16x16x32_bf16 v[180:183], a[144:147], a[36:39], v[180:183]
  ds_read_b64_tr_b16 a[130:131], v25 offset:3776
  v_mfma_f32_16x16x32_bf16 v[180:183], a[148:151], a[52:55], v[180:183]
  v_mfma_f32_16x16x32_bf16 v[176:179], a[148:151], a[48:51], v[176:179]
  ds_read_b64_tr_b16 a[132:133], v25 offset:7360
  v_mfma_f32_16x16x32_bf16 v[176:179], a[144:147], a[32:35], v[176:179]
  v_mfma_f32_16x16x32_bf16 v[176:179], a[140:143], a[16:19], v[176:179]
  ds_read_b64_tr_b16 a[134:135], v25 offset:10944
  v_mfma_f32_16x16x32_bf16 v[176:179], a[136:139], a[0:3], v[176:179]
  s_waitcnt lgkmcnt(4)
  v_mfma_f32_16x16x32_bf16 v[208:211], a[152:155], a[0:3], v[208:211]
  ds_read_b64_tr_b16 a[136:137], v25 offset:14528
  v_mfma_f32_16x16x32_bf16 v[208:211], a[156:159], a[16:19], v[208:211]
  v_mfma_f32_16x16x32_bf16 v[208:211], a[160:163], a[32:35], v[208:211]
  ds_read_b64_tr_b16 a[138:139], v25 offset:18112
  v_mfma_f32_16x16x32_bf16 v[208:211], a[164:167], a[48:51], v[208:211]
  v_mfma_f32_16x16x32_bf16 v[212:215], a[164:167], a[52:55], v[212:215]
  ds_read_b64_tr_b16 a[140:141], v25 offset:21696
  v_mfma_f32_16x16x32_bf16 v[212:215], a[160:163], a[36:39], v[212:215]
  v_mfma_f32_16x16x32_bf16 v[212:215], a[156:159], a[20:23], v[212:215]
  ds_read_b64_tr_b16 a[142:143], v25 offset:25280
  v_mfma_f32_16x16x32_bf16 v[212:215], a[152:155], a[4:7], v[212:215]
  v_mfma_f32_16x16x32_bf16 v[216:219], a[152:155], a[8:11], v[216:219]
  ds_read_b64_tr_b16 a[144:145], v25 offset:0
  v_mfma_f32_16x16x32_bf16 v[216:219], a[156:159], a[24:27], v[216:219]
  v_mfma_f32_16x16x32_bf16 v[216:219], a[160:163], a[40:43], v[216:219]
  ds_read_b64_tr_b16 a[146:147], v25 offset:3584
  v_mfma_f32_16x16x32_bf16 v[216:219], a[164:167], a[56:59], v[216:219]
  v_mfma_f32_16x16x32_bf16 v[220:223], a[164:167], a[60:63], v[220:223]
  ds_read_b64_tr_b16 a[148:149], v25 offset:7168
  v_mfma_f32_16x16x32_bf16 v[220:223], a[160:163], a[44:47], v[220:223]
  v_mfma_f32_16x16x32_bf16 v[220:223], a[156:159], a[28:31], v[220:223]
  ds_read_b64_tr_b16 a[150:151], v25 offset:10752
  v_mfma_f32_16x16x32_bf16 v[220:223], a[152:155], a[12:15], v[220:223]
  s_waitcnt vmcnt(8) lgkmcnt(4)
  v_mfma_f32_16x16x32_bf16 v[236:239], a[128:131], a[76:79], v[236:239]
  s_mov_b32 s39, 24576
  ds_read_b64_tr_b16 a[152:153], v25 offset:14336
  v_mfma_f32_16x16x32_bf16 v[236:239], a[132:135], a[92:95], v[236:239]
  buffer_load_dwordx4 a[0:3], v8, s[16:19], s39 offen offset:0 sc1
  s_mov_b32 s38, 5505024
  v_mfma_f32_16x16x32_bf16 v[236:239], a[136:139], a[108:111], v[236:239]
  s_add_u32 m0, s77, 0
  ds_read_b64_tr_b16 a[154:155], v25 offset:17920
  v_mfma_f32_16x16x32_bf16 v[236:239], a[140:143], a[124:127], v[236:239]
  v_mfma_f32_16x16x32_bf16 v[232:235], a[140:143], a[120:123], v[232:235]
  ds_read_b64_tr_b16 a[156:157], v25 offset:21504
  v_mfma_f32_16x16x32_bf16 v[232:235], a[136:139], a[104:107], v[232:235]
  buffer_load_dwordx4 v4, s[12:15], s38 offen offset:0 lds
  v_mfma_f32_16x16x32_bf16 v[232:235], a[132:135], a[88:91], v[232:235]
  ds_read_b64_tr_b16 a[158:159], v25 offset:25088
  v_mfma_f32_16x16x32_bf16 v[232:235], a[128:131], a[72:75], v[232:235]
  v_mfma_f32_16x16x32_bf16 v[228:231], a[128:131], a[68:71], v[228:231]
  ds_read_b64_tr_b16 a[160:161], v25 offset:32
  v_mfma_f32_16x16x32_bf16 v[228:231], a[132:135], a[84:87], v[228:231]
  v_mfma_f32_16x16x32_bf16 v[228:231], a[136:139], a[100:103], v[228:231]
  ds_read_b64_tr_b16 a[162:163], v25 offset:3616
  v_mfma_f32_16x16x32_bf16 v[228:231], a[140:143], a[116:119], v[228:231]
  buffer_load_dwordx4 a[16:19], v8, s[16:19], s39 offen offset:1024 sc1
  v_mfma_f32_16x16x32_bf16 v[224:227], a[140:143], a[112:115], v[224:227]
  ds_read_b64_tr_b16 a[164:165], v25 offset:7200
  v_mfma_f32_16x16x32_bf16 v[224:227], a[136:139], a[96:99], v[224:227]
  v_mfma_f32_16x16x32_bf16 v[224:227], a[132:135], a[80:83], v[224:227]
  ds_read_b64_tr_b16 a[166:167], v25 offset:10784
  v_mfma_f32_16x16x32_bf16 v[224:227], a[128:131], a[64:67], v[224:227]
  s_waitcnt lgkmcnt(4)
  v_mfma_f32_16x16x32_bf16 v[32:35], a[144:147], a[64:67], v[32:35]
  ds_read_b64_tr_b16 a[128:129], v25 offset:14368
  v_mfma_f32_16x16x32_bf16 v[32:35], a[148:151], a[80:83], v[32:35]
  buffer_load_dwordx4 v5, s[12:15], s38 offen offset:1024 lds
  s_mov_b32 s39, 57344
  v_mfma_f32_16x16x32_bf16 v[32:35], a[152:155], a[96:99], v[32:35]
  ds_read_b64_tr_b16 a[130:131], v25 offset:17952
  v_mfma_f32_16x16x32_bf16 v[32:35], a[156:159], a[112:115], v[32:35]
  v_mfma_f32_16x16x32_bf16 v[36:39], a[156:159], a[116:119], v[36:39]
  ds_read_b64_tr_b16 a[132:133], v25 offset:21536
  v_mfma_f32_16x16x32_bf16 v[36:39], a[152:155], a[100:103], v[36:39]
  v_mfma_f32_16x16x32_bf16 v[36:39], a[148:151], a[84:87], v[36:39]
  ds_read_b64_tr_b16 a[134:135], v25 offset:25120
  v_mfma_f32_16x16x32_bf16 v[36:39], a[144:147], a[68:71], v[36:39]
  buffer_load_dwordx4 a[4:7], v8, s[16:19], s39 offen offset:0 sc1
  v_mfma_f32_16x16x32_bf16 v[40:43], a[144:147], a[72:75], v[40:43]
  ds_read_b64_tr_b16 a[136:137], v25 offset:64
  v_mfma_f32_16x16x32_bf16 v[40:43], a[148:151], a[88:91], v[40:43]
  v_mfma_f32_16x16x32_bf16 v[40:43], a[152:155], a[104:107], v[40:43]
  ds_read_b64_tr_b16 a[138:139], v25 offset:3648
  v_mfma_f32_16x16x32_bf16 v[40:43], a[156:159], a[120:123], v[40:43]
  buffer_load_dwordx4 v6, s[12:15], s38 offen offset:2048 lds
  v_mfma_f32_16x16x32_bf16 v[44:47], a[156:159], a[124:127], v[44:47]
  ds_read_b64_tr_b16 a[140:141], v25 offset:7232
  v_mfma_f32_16x16x32_bf16 v[44:47], a[152:155], a[108:111], v[44:47]
  v_mfma_f32_16x16x32_bf16 v[44:47], a[148:151], a[92:95], v[44:47]
  ds_read_b64_tr_b16 a[142:143], v25 offset:10816
  v_mfma_f32_16x16x32_bf16 v[44:47], a[144:147], a[76:79], v[44:47]
  s_waitcnt lgkmcnt(4)
  v_mfma_f32_16x16x32_bf16 v[76:79], a[160:163], a[76:79], v[76:79]
  ds_read_b64_tr_b16 a[144:145], v25 offset:14400
  v_mfma_f32_16x16x32_bf16 v[76:79], a[164:167], a[92:95], v[76:79]
  buffer_load_dwordx4 a[20:23], v8, s[16:19], s39 offen offset:1024 sc1
  v_mfma_f32_16x16x32_bf16 v[76:79], a[128:131], a[108:111], v[76:79]
  ds_read_b64_tr_b16 a[146:147], v25 offset:17984
  v_mfma_f32_16x16x32_bf16 v[76:79], a[132:135], a[124:127], v[76:79]
  v_mfma_f32_16x16x32_bf16 v[72:75], a[132:135], a[120:123], v[72:75]
  ds_read_b64_tr_b16 a[148:149], v25 offset:21568
  v_mfma_f32_16x16x32_bf16 v[72:75], a[128:131], a[104:107], v[72:75]
  v_mfma_f32_16x16x32_bf16 v[72:75], a[164:167], a[88:91], v[72:75]
  ds_read_b64_tr_b16 a[150:151], v25 offset:25152
  v_mfma_f32_16x16x32_bf16 v[72:75], a[160:163], a[72:75], v[72:75]
  buffer_load_dwordx4 v7, s[12:15], s38 offen offset:3072 lds
  s_mov_b32 s39, 90112
  v_mfma_f32_16x16x32_bf16 v[68:71], a[160:163], a[68:71], v[68:71]
  ds_read_b64_tr_b16 a[152:153], v25 offset:96
  v_mfma_f32_16x16x32_bf16 v[68:71], a[164:167], a[84:87], v[68:71]
  v_mfma_f32_16x16x32_bf16 v[68:71], a[128:131], a[100:103], v[68:71]
  ds_read_b64_tr_b16 a[154:155], v25 offset:3680
  v_mfma_f32_16x16x32_bf16 v[68:71], a[132:135], a[116:119], v[68:71]
  v_mfma_f32_16x16x32_bf16 v[64:67], a[132:135], a[112:115], v[64:67]
  ds_read_b64_tr_b16 a[156:157], v25 offset:7264
  v_mfma_f32_16x16x32_bf16 v[64:67], a[128:131], a[96:99], v[64:67]
  buffer_load_dwordx4 a[8:11], v8, s[16:19], s39 offen offset:0 sc1
  s_add_u32 m0, s77, 4096
  v_mfma_f32_16x16x32_bf16 v[64:67], a[164:167], a[80:83], v[64:67]
  ds_read_b64_tr_b16 a[158:159], v25 offset:10848
  v_mfma_f32_16x16x32_bf16 v[64:67], a[160:163], a[64:67], v[64:67]
  s_waitcnt lgkmcnt(4)
  v_mfma_f32_16x16x32_bf16 v[96:99], a[136:139], a[64:67], v[96:99]
  ds_read_b64_tr_b16 a[160:161], v25 offset:14432
  v_mfma_f32_16x16x32_bf16 v[96:99], a[140:143], a[80:83], v[96:99]
  buffer_load_dwordx4 v12, s[12:15], s38 offen offset:0 lds
  v_mfma_f32_16x16x32_bf16 v[96:99], a[144:147], a[96:99], v[96:99]
  ds_read_b64_tr_b16 a[162:163], v25 offset:18016
  v_mfma_f32_16x16x32_bf16 v[96:99], a[148:151], a[112:115], v[96:99]
  v_mfma_f32_16x16x32_bf16 v[100:103], a[148:151], a[116:119], v[100:103]
  ds_read_b64_tr_b16 a[164:165], v25 offset:21600
  v_mfma_f32_16x16x32_bf16 v[100:103], a[144:147], a[100:103], v[100:103]
  v_mfma_f32_16x16x32_bf16 v[100:103], a[140:143], a[84:87], v[100:103]
  ds_read_b64_tr_b16 a[166:167], v25 offset:25184
  v_mfma_f32_16x16x32_bf16 v[100:103], a[136:139], a[68:71], v[100:103]
  buffer_load_dwordx4 a[24:27], v8, s[16:19], s39 offen offset:1024 sc1
  v_mfma_f32_16x16x32_bf16 v[104:107], a[136:139], a[72:75], v[104:107]
  ds_read_b64_tr_b16 a[128:129], v25 offset:128
  v_mfma_f32_16x16x32_bf16 v[104:107], a[140:143], a[88:91], v[104:107]
  v_mfma_f32_16x16x32_bf16 v[104:107], a[144:147], a[104:107], v[104:107]
  ds_read_b64_tr_b16 a[130:131], v25 offset:3712
  v_mfma_f32_16x16x32_bf16 v[104:107], a[148:151], a[120:123], v[104:107]
  v_mfma_f32_16x16x32_bf16 v[108:111], a[148:151], a[124:127], v[108:111]
  ds_read_b64_tr_b16 a[132:133], v25 offset:7296
  v_mfma_f32_16x16x32_bf16 v[108:111], a[144:147], a[108:111], v[108:111]
  buffer_load_dwordx4 v13, s[12:15], s38 offen offset:1024 lds
  s_mov_b32 s39, 122880
  v_mfma_f32_16x16x32_bf16 v[108:111], a[140:143], a[92:95], v[108:111]
  ds_read_b64_tr_b16 a[134:135], v25 offset:10880
  v_mfma_f32_16x16x32_bf16 v[108:111], a[136:139], a[76:79], v[108:111]
  s_waitcnt lgkmcnt(4)
  v_mfma_f32_16x16x32_bf16 v[140:143], a[152:155], a[76:79], v[140:143]
  ds_read_b64_tr_b16 a[136:137], v25 offset:14464
  v_mfma_f32_16x16x32_bf16 v[140:143], a[156:159], a[92:95], v[140:143]
  v_mfma_f32_16x16x32_bf16 v[140:143], a[160:163], a[108:111], v[140:143]
  ds_read_b64_tr_b16 a[138:139], v25 offset:18048
  v_mfma_f32_16x16x32_bf16 v[140:143], a[164:167], a[124:127], v[140:143]
  buffer_load_dwordx4 a[12:15], v8, s[16:19], s39 offen offset:0 sc1
  v_mfma_f32_16x16x32_bf16 v[136:139], a[164:167], a[120:123], v[136:139]
  ds_read_b64_tr_b16 a[140:141], v25 offset:21632
  v_mfma_f32_16x16x32_bf16 v[136:139], a[160:163], a[104:107], v[136:139]
  v_mfma_f32_16x16x32_bf16 v[136:139], a[156:159], a[88:91], v[136:139]
  ds_read_b64_tr_b16 a[142:143], v25 offset:25216
  v_mfma_f32_16x16x32_bf16 v[136:139], a[152:155], a[72:75], v[136:139]
  buffer_load_dwordx4 v14, s[12:15], s38 offen offset:2048 lds
  v_mfma_f32_16x16x32_bf16 v[132:135], a[152:155], a[68:71], v[132:135]
  ds_read_b64_tr_b16 a[144:145], v25 offset:160
  v_mfma_f32_16x16x32_bf16 v[132:135], a[156:159], a[84:87], v[132:135]
  v_mfma_f32_16x16x32_bf16 v[132:135], a[160:163], a[100:103], v[132:135]
  ds_read_b64_tr_b16 a[146:147], v25 offset:3744
  v_mfma_f32_16x16x32_bf16 v[132:135], a[164:167], a[116:119], v[132:135]
  v_mfma_f32_16x16x32_bf16 v[128:131], a[164:167], a[112:115], v[128:131]
  ds_read_b64_tr_b16 a[148:149], v25 offset:7328
  v_mfma_f32_16x16x32_bf16 v[128:131], a[160:163], a[96:99], v[128:131]
  buffer_load_dwordx4 a[28:31], v8, s[16:19], s39 offen offset:1024 sc1
  v_mfma_f32_16x16x32_bf16 v[128:131], a[156:159], a[80:83], v[128:131]
  ds_read_b64_tr_b16 a[150:151], v25 offset:10912
  v_mfma_f32_16x16x32_bf16 v[128:131], a[152:155], a[64:67], v[128:131]
  s_waitcnt lgkmcnt(4)
  v_mfma_f32_16x16x32_bf16 v[160:163], a[128:131], a[64:67], v[160:163]
  ds_read_b64_tr_b16 a[152:153], v25 offset:14496
  v_mfma_f32_16x16x32_bf16 v[160:163], a[132:135], a[80:83], v[160:163]
  v_mfma_f32_16x16x32_bf16 v[160:163], a[136:139], a[96:99], v[160:163]
  ds_read_b64_tr_b16 a[154:155], v25 offset:18080
  v_mfma_f32_16x16x32_bf16 v[160:163], a[140:143], a[112:115], v[160:163]
  buffer_load_dword v0, v27, s[20:23], 0 offen
  v_add_u32 v27, 1835008, v27
  v_mfma_f32_16x16x32_bf16 v[164:167], a[140:143], a[116:119], v[164:167]
  s_lshl_b32 s34, s44, 10
  ds_read_b64_tr_b16 a[156:157], v25 offset:21664
  s_add_u32 s34, s34, 0x3b60000
  v_mfma_f32_16x16x32_bf16 v[164:167], a[136:139], a[100:103], v[164:167]
  v_lshl_add_u32 v10, v1, 2, s34
  global_load_dword a168, v10, s[4:5] offset:0 sc1
  v_mfma_f32_16x16x32_bf16 v[164:167], a[132:135], a[84:87], v[164:167]
  ds_read_b64_tr_b16 a[158:159], v25 offset:25248
  global_load_dword a169, v10, s[4:5] offset:256 sc1
  v_mfma_f32_16x16x32_bf16 v[164:167], a[128:131], a[68:71], v[164:167]
  s_waitcnt vmcnt(19)
  global_load_dword a170, v10, s[4:5] offset:512 sc1
  global_load_dword a171, v10, s[4:5] offset:768 sc1
  v_mfma_f32_16x16x32_bf16 v[168:171], a[128:131], a[72:75], v[168:171]
  s_barrier
  ds_read_b64_tr_b16 a[160:161], v25 offset:32960
  global_load_dword a172, v10, s[4:5] offset:1024 sc1
  v_mfma_f32_16x16x32_bf16 v[168:171], a[132:135], a[88:91], v[168:171]
  global_load_dword a173, v10, s[4:5] offset:1280 sc1
  global_load_dword a174, v10, s[4:5] offset:1536 sc1
  v_mfma_f32_16x16x32_bf16 v[168:171], a[136:139], a[104:107], v[168:171]
  ds_read_b64_tr_b16 a[162:163], v25 offset:36544
  global_load_dword a175, v10, s[4:5] offset:1792 sc1
  v_mfma_f32_16x16x32_bf16 v[168:171], a[140:143], a[120:123], v[168:171]
  global_load_dword a176, v10, s[4:5] offset:2048 sc1
  global_load_dword a177, v10, s[4:5] offset:2304 sc1
  v_mfma_f32_16x16x32_bf16 v[172:175], a[140:143], a[124:127], v[172:175]
  ds_read_b64_tr_b16 a[164:165], v25 offset:40128
  global_load_dword a178, v10, s[4:5] offset:2560 sc1
  v_mfma_f32_16x16x32_bf16 v[172:175], a[136:139], a[108:111], v[172:175]
  global_load_dword a179, v10, s[4:5] offset:2816 sc1
  global_load_dword a180, v10, s[4:5] offset:3072 sc1
  v_mfma_f32_16x16x32_bf16 v[172:175], a[132:135], a[92:95], v[172:175]
  ds_read_b64_tr_b16 a[166:167], v25 offset:43712
  global_load_dword a181, v10, s[4:5] offset:3328 sc1
  v_mfma_f32_16x16x32_bf16 v[172:175], a[128:131], a[76:79], v[172:175]
  s_waitcnt lgkmcnt(4)
  global_load_dword a182, v10, s[4:5] offset:3584 sc1
  global_load_dword a183, v10, s[4:5] offset:3840 sc1
  v_mfma_f32_16x16x32_bf16 v[204:207], a[144:147], a[76:79], v[204:207]
  ds_read_b64_tr_b16 a[128:129], v25 offset:47296
  v_mfma_f32_16x16x32_bf16 v[204:207], a[148:151], a[92:95], v[204:207]
  v_mfma_f32_16x16x32_bf16 v[204:207], a[152:155], a[108:111], v[204:207]
  ds_read_b64_tr_b16 a[130:131], v25 offset:50880
  v_mfma_f32_16x16x32_bf16 v[204:207], a[156:159], a[124:127], v[204:207]
  v_mfma_f32_16x16x32_bf16 v[200:203], a[156:159], a[120:123], v[200:203]
  ds_read_b64_tr_b16 a[132:133], v25 offset:54464
  v_mfma_f32_16x16x32_bf16 v[200:203], a[152:155], a[104:107], v[200:203]
  v_mfma_f32_16x16x32_bf16 v[200:203], a[148:151], a[88:91], v[200:203]
  ds_read_b64_tr_b16 a[134:135], v25 offset:58048
  v_mfma_f32_16x16x32_bf16 v[200:203], a[144:147], a[72:75], v[200:203]
  v_mfma_f32_16x16x32_bf16 v[196:199], a[144:147], a[68:71], v[196:199]
  ds_read_b64_tr_b16 a[136:137], v25 offset:32768
  v_mfma_f32_16x16x32_bf16 v[196:199], a[148:151], a[84:87], v[196:199]
  v_mfma_f32_16x16x32_bf16 v[196:199], a[152:155], a[100:103], v[196:199]
  ds_read_b64_tr_b16 a[138:139], v25 offset:36352
  v_mfma_f32_16x16x32_bf16 v[196:199], a[156:159], a[116:119], v[196:199]
  v_mfma_f32_16x16x32_bf16 v[192:195], a[156:159], a[112:115], v[192:195]
  ds_read_b64_tr_b16 a[140:141], v25 offset:39936
  v_mfma_f32_16x16x32_bf16 v[192:195], a[152:155], a[96:99], v[192:195]
  v_mfma_f32_16x16x32_bf16 v[192:195], a[148:151], a[80:83], v[192:195]
  ds_read_b64_tr_b16 a[142:143], v25 offset:43520
  v_mfma_f32_16x16x32_bf16 v[192:195], a[144:147], a[64:67], v[192:195]
  s_waitcnt lgkmcnt(4)
  v_mfma_f32_16x16x32_bf16 v[240:243], a[160:163], a[64:67], v[240:243]
  s_mov_b32 s39, 24576
  ds_read_b64_tr_b16 a[144:145], v25 offset:47104
  v_mfma_f32_16x16x32_bf16 v[240:243], a[164:167], a[80:83], v[240:243]
  buffer_load_dwordx4 a[32:35], v8, s[16:19], s39 offen offset:2048 sc1
  v_mfma_f32_16x16x32_bf16 v[240:243], a[128:131], a[96:99], v[240:243]
  ds_read_b64_tr_b16 a[146:147], v25 offset:50688
  v_mfma_f32_16x16x32_bf16 v[240:243], a[132:135], a[112:115], v[240:243]
  v_mfma_f32_16x16x32_bf16 v[244:247], a[132:135], a[116:119], v[244:247]
  ds_read_b64_tr_b16 a[148:149], v25 offset:54272
  v_mfma_f32_16x16x32_bf16 v[244:247], a[128:131], a[100:103], v[244:247]
  buffer_load_dwordx4 a[48:51], v8, s[16:19], s39 offen offset:3072 sc1
  s_mov_b32 s39, 57344
  v_mfma_f32_16x16x32_bf16 v[244:247], a[164:167], a[84:87], v[244:247]
  ds_read_b64_tr_b16 a[150:151], v25 offset:57856
  v_mfma_f32_16x16x32_bf16 v[244:247], a[160:163], a[68:71], v[244:247]
  v_mfma_f32_16x16x32_bf16 v[248:251], a[160:163], a[72:75], v[248:251]
  ds_read_b64_tr_b16 a[152:153], v25 offset:32800
  v_mfma_f32_16x16x32_bf16 v[248:251], a[164:167], a[88:91], v[248:251]
  buffer_load_dwordx4 a[36:39], v8, s[16:19], s39 offen offset:2048 sc1
  v_mfma_f32_16x16x32_bf16 v[248:251], a[128:131], a[104:107], v[248:251]
  ds_read_b64_tr_b16 a[154:155], v25 offset:36384
  v_mfma_f32_16x16x32_bf16 v[248:251], a[132:135], a[120:123], v[248:251]
  v_mfma_f32_16x16x32_bf16 v[252:255], a[132:135], a[124:127], v[252:255]
L_pad_2b_4:
  s_cbranch_execz L_ret_2b
  ds_read_b64_tr_b16 a[156:157], v25 offset:39968
  v_mfma_f32_16x16x32_bf16 v[252:255], a[128:131], a[108:111], v[252:255]
  v_mfma_f32_16x16x32_bf16 v[252:255], a[164:167], a[92:95], v[252:255]
  ds_read_b64_tr_b16 a[158:159], v25 offset:43552
  v_mfma_f32_16x16x32_bf16 v[252:255], a[160:163], a[76:79], v[252:255]
  s_waitcnt lgkmcnt(4)
  buffer_load_dwordx4 a[52:55], v8, s[16:19], s39 offen offset:3072 sc1
  s_mov_b32 s39, 90112
  v_mfma_f32_16x16x32_bf16 v[60:63], a[136:139], a[76:79], v[60:63]
  ds_read_b64_tr_b16 a[160:161], v25 offset:47136
  v_mfma_f32_16x16x32_bf16 v[60:63], a[140:143], a[92:95], v[60:63]
  v_mfma_f32_16x16x32_bf16 v[60:63], a[144:147], a[108:111], v[60:63]
  ds_read_b64_tr_b16 a[162:163], v25 offset:50720
  v_mfma_f32_16x16x32_bf16 v[60:63], a[148:151], a[124:127], v[60:63]
  buffer_load_dwordx4 a[40:43], v8, s[16:19], s39 offen offset:2048 sc1
  v_mfma_f32_16x16x32_bf16 v[56:59], a[148:151], a[120:123], v[56:59]
  ds_read_b64_tr_b16 a[164:165], v25 offset:54304
  v_mfma_f32_16x16x32_bf16 v[56:59], a[144:147], a[104:107], v[56:59]
  v_mfma_f32_16x16x32_bf16 v[56:59], a[140:143], a[88:91], v[56:59]
  ds_read_b64_tr_b16 a[166:167], v25 offset:57888
  v_mfma_f32_16x16x32_bf16 v[56:59], a[136:139], a[72:75], v[56:59]
  v_mfma_f32_16x16x32_bf16 v[52:55], a[136:139], a[68:71], v[52:55]
  ds_read_b64_tr_b16 a[128:129], v25 offset:32832
  v_mfma_f32_16x16x32_bf16 v[52:55], a[140:143], a[84:87], v[52:55]
  buffer_load_dwordx4 a[56:59], v8, s[16:19], s39 offen offset:3072 sc1
  s_mov_b32 s39, 122880
  v_mfma_f32_16x16x32_bf16 v[52:55], a[144:147], a[100:103], v[52:55]
  ds_read_b64_tr_b16 a[130:131], v25 offset:36416
  v_mfma_f32_16x16x32_bf16 v[52:55], a[148:151], a[116:119], v[52:55]
  v_mfma_f32_16x16x32_bf16 v[48:51], a[148:151], a[112:115], v[48:51]
  ds_read_b64_tr_b16 a[132:133], v25 offset:40000
  v_mfma_f32_16x16x32_bf16 v[48:51], a[144:147], a[96:99], v[48:51]
  buffer_load_dwordx4 a[44:47], v8, s[16:19], s39 offen offset:2048 sc1
  v_mfma_f32_16x16x32_bf16 v[48:51], a[140:143], a[80:83], v[48:51]
  ds_read_b64_tr_b16 a[134:135], v25 offset:43584
  v_mfma_f32_16x16x32_bf16 v[48:51], a[136:139], a[64:67], v[48:51]
  s_waitcnt lgkmcnt(4)
  v_mfma_f32_16x16x32_bf16 v[80:83], a[152:155], a[64:67], v[80:83]
  ds_read_b64_tr_b16 a[136:137], v25 offset:47168
  v_mfma_f32_16x16x32_bf16 v[80:83], a[156:159], a[80:83], v[80:83]
  buffer_load_dwordx4 a[60:63], v8, s[16:19], s39 offen offset:3072 sc1
  s_mov_b32 s39, 28672
  v_mfma_f32_16x16x32_bf16 v[80:83], a[160:163], a[96:99], v[80:83]
  ds_read_b64_tr_b16 a[138:139], v25 offset:50752
  v_mfma_f32_16x16x32_bf16 v[80:83], a[164:167], a[112:115], v[80:83]
  v_mfma_f32_16x16x32_bf16 v[84:87], a[164:167], a[116:119], v[84:87]
  ds_read_b64_tr_b16 a[140:141], v25 offset:54336
  v_mfma_f32_16x16x32_bf16 v[84:87], a[160:163], a[100:103], v[84:87]
  v_mfma_f32_16x16x32_bf16 v[84:87], a[156:159], a[84:87], v[84:87]
  ds_read_b64_tr_b16 a[142:143], v25 offset:57920
  v_mfma_f32_16x16x32_bf16 v[84:87], a[152:155], a[68:71], v[84:87]
  buffer_load_dwordx4 a[184:187], v8, s[16:19], s39 offen offset:0 sc1
  s_mov_b32 s39, 61440
  v_mfma_f32_16x16x32_bf16 v[88:91], a[152:155], a[72:75], v[88:91]
  ds_read_b64_tr_b16 a[144:145], v25 offset:32864
  v_mfma_f32_16x16x32_bf16 v[88:91], a[156:159], a[88:91], v[88:91]
  v_mfma_f32_16x16x32_bf16 v[88:91], a[160:163], a[104:107], v[88:91]
  ds_read_b64_tr_b16 a[146:147], v25 offset:36448
  v_mfma_f32_16x16x32_bf16 v[88:91], a[164:167], a[120:123], v[88:91]
  buffer_load_dwordx4 a[188:191], v8, s[16:19], s39 offen offset:0 sc1
  s_mov_b32 s39, 94208
  v_mfma_f32_16x16x32_bf16 v[92:95], a[164:167], a[124:127], v[92:95]
  ds_read_b64_tr_b16 a[148:149], v25 offset:40032
  v_mfma_f32_16x16x32_bf16 v[92:95], a[160:163], a[108:111], v[92:95]
  v_mfma_f32_16x16x32_bf16 v[92:95], a[156:159], a[92:95], v[92:95]
  ds_read_b64_tr_b16 a[150:151], v25 offset:43616
  v_mfma_f32_16x16x32_bf16 v[92:95], a[152:155], a[76:79], v[92:95]
  s_waitcnt lgkmcnt(4)
  v_mfma_f32_16x16x32_bf16 v[124:127], a[128:131], a[76:79], v[124:127]
  ds_read_b64_tr_b16 a[152:153], v25 offset:47200
  v_mfma_f32_16x16x32_bf16 v[124:127], a[132:135], a[92:95], v[124:127]
  buffer_load_dwordx4 a[192:195], v8, s[16:19], s39 offen offset:0 sc1
  s_mov_b32 s39, 126976
  v_mfma_f32_16x16x32_bf16 v[124:127], a[136:139], a[108:111], v[124:127]
  ds_read_b64_tr_b16 a[154:155], v25 offset:50784
  v_mfma_f32_16x16x32_bf16 v[124:127], a[140:143], a[124:127], v[124:127]
  v_mfma_f32_16x16x32_bf16 v[120:123], a[140:143], a[120:123], v[120:123]
  ds_read_b64_tr_b16 a[156:157], v25 offset:54368
  v_mfma_f32_16x16x32_bf16 v[120:123], a[136:139], a[104:107], v[120:123]
  buffer_load_dwordx4 a[196:199], v8, s[16:19], s39 offen offset:0 sc1
  s_mov_b32 s38, 6422528
  v_mfma_f32_16x16x32_bf16 v[120:123], a[132:135], a[88:91], v[120:123]
  s_add_u32 m0, s77, 32768
  ds_read_b64_tr_b16 a[158:159], v25 offset:57952
  v_mfma_f32_16x16x32_bf16 v[120:123], a[128:131], a[72:75], v[120:123]
  v_mfma_f32_16x16x32_bf16 v[116:119], a[128:131], a[68:71], v[116:119]
  ds_read_b64_tr_b16 a[160:161], v25 offset:32896
  v_mfma_f32_16x16x32_bf16 v[116:119], a[132:135], a[84:87], v[116:119]
  v_mfma_f32_16x16x32_bf16 v[116:119], a[136:139], a[100:103], v[116:119]
  ds_read_b64_tr_b16 a[162:163], v25 offset:36480
  v_mfma_f32_16x16x32_bf16 v[116:119], a[140:143], a[116:119], v[116:119]
  buffer_load_dwordx4 v4, s[12:15], s38 offen offset:0 lds
  v_mfma_f32_16x16x32_bf16 v[112:115], a[140:143], a[112:115], v[112:115]
  ds_read_b64_tr_b16 a[164:165], v25 offset:40064
  v_mfma_f32_16x16x32_bf16 v[112:115], a[136:139], a[96:99], v[112:115]
  v_mfma_f32_16x16x32_bf16 v[112:115], a[132:135], a[80:83], v[112:115]
  ds_read_b64_tr_b16 a[166:167], v25 offset:43648
  v_mfma_f32_16x16x32_bf16 v[112:115], a[128:131], a[64:67], v[112:115]
  s_waitcnt lgkmcnt(4)
  buffer_load_dwordx4 v5, s[12:15], s38 offen offset:1024 lds
  v_mfma_f32_16x16x32_bf16 v[144:147], a[144:147], a[64:67], v[144:147]
  ds_read_b64_tr_b16 a[128:129], v25 offset:47232
  v_mfma_f32_16x16x32_bf16 v[144:147], a[148:151], a[80:83], v[144:147]
  v_mfma_f32_16x16x32_bf16 v[144:147], a[152:155], a[96:99], v[144:147]
  ds_read_b64_tr_b16 a[130:131], v25 offset:50816
  v_mfma_f32_16x16x32_bf16 v[144:147], a[156:159], a[112:115], v[144:147]
  buffer_load_dwordx4 v6, s[12:15], s38 offen offset:2048 lds
  v_mfma_f32_16x16x32_bf16 v[148:151], a[156:159], a[116:119], v[148:151]
  ds_read_b64_tr_b16 a[132:133], v25 offset:54400
  v_mfma_f32_16x16x32_bf16 v[148:151], a[152:155], a[100:103], v[148:151]
  v_mfma_f32_16x16x32_bf16 v[148:151], a[148:151], a[84:87], v[148:151]
  ds_read_b64_tr_b16 a[134:135], v25 offset:57984
  v_mfma_f32_16x16x32_bf16 v[148:151], a[144:147], a[68:71], v[148:151]
  v_mfma_f32_16x16x32_bf16 v[152:155], a[144:147], a[72:75], v[152:155]
  ds_read_b64_tr_b16 a[136:137], v25 offset:32928
  v_mfma_f32_16x16x32_bf16 v[152:155], a[148:151], a[88:91], v[152:155]
  buffer_load_dwordx4 v7, s[12:15], s38 offen offset:3072 lds
  s_add_u32 m0, s77, 36864
  v_mfma_f32_16x16x32_bf16 v[152:155], a[152:155], a[104:107], v[152:155]
  ds_read_b64_tr_b16 a[138:139], v25 offset:36512
  v_mfma_f32_16x16x32_bf16 v[152:155], a[156:159], a[120:123], v[152:155]
  v_mfma_f32_16x16x32_bf16 v[156:159], a[156:159], a[124:127], v[156:159]
  ds_read_b64_tr_b16 a[140:141], v25 offset:40096
  v_mfma_f32_16x16x32_bf16 v[156:159], a[152:155], a[108:111], v[156:159]
  buffer_load_dwordx4 v12, s[12:15], s38 offen offset:0 lds
  v_mfma_f32_16x16x32_bf16 v[156:159], a[148:151], a[92:95], v[156:159]
  ds_read_b64_tr_b16 a[142:143], v25 offset:43680
  v_mfma_f32_16x16x32_bf16 v[156:159], a[144:147], a[76:79], v[156:159]
  s_waitcnt lgkmcnt(4)
  v_mfma_f32_16x16x32_bf16 v[188:191], a[160:163], a[76:79], v[188:191]
  ds_read_b64_tr_b16 a[144:145], v25 offset:47264
  v_mfma_f32_16x16x32_bf16 v[188:191], a[164:167], a[92:95], v[188:191]
  v_mfma_f32_16x16x32_bf16 v[188:191], a[128:131], a[108:111], v[188:191]
  ds_read_b64_tr_b16 a[146:147], v25 offset:50848
  v_mfma_f32_16x16x32_bf16 v[188:191], a[132:135], a[124:127], v[188:191]
  buffer_load_dwordx4 v13, s[12:15], s38 offen offset:1024 lds
  v_mfma_f32_16x16x32_bf16 v[184:187], a[132:135], a[120:123], v[184:187]
  ds_read_b64_tr_b16 a[148:149], v25 offset:54432
  v_mfma_f32_16x16x32_bf16 v[184:187], a[128:131], a[104:107], v[184:187]
  v_mfma_f32_16x16x32_bf16 v[184:187], a[164:167], a[88:91], v[184:187]
  ds_read_b64_tr_b16 a[150:151], v25 offset:58016
  v_mfma_f32_16x16x32_bf16 v[184:187], a[160:163], a[72:75], v[184:187]
  s_waitcnt vmcnt(36)
  buffer_load_dwordx4 v14, s[12:15], s38 offen offset:2048 lds
  v_mfma_f32_16x16x32_bf16 v[180:183], a[160:163], a[68:71], v[180:183]
  s_barrier
  ds_read_b64_tr_b16 a[152:153], v24 offset:192
  v_mfma_f32_16x16x32_bf16 v[180:183], a[164:167], a[84:87], v[180:183]
  v_mfma_f32_16x16x32_bf16 v[180:183], a[128:131], a[100:103], v[180:183]
  ds_read_b64_tr_b16 a[154:155], v24 offset:3776
  v_mfma_f32_16x16x32_bf16 v[180:183], a[132:135], a[116:119], v[180:183]
  v_mfma_f32_16x16x32_bf16 v[176:179], a[132:135], a[112:115], v[176:179]
  ds_read_b64_tr_b16 a[156:157], v24 offset:7360
  v_mfma_f32_16x16x32_bf16 v[176:179], a[128:131], a[96:99], v[176:179]
  v_mfma_f32_16x16x32_bf16 v[176:179], a[164:167], a[80:83], v[176:179]
  ds_read_b64_tr_b16 a[158:159], v24 offset:10944
  v_mfma_f32_16x16x32_bf16 v[176:179], a[160:163], a[64:67], v[176:179]
  s_waitcnt lgkmcnt(4)
  v_mfma_f32_16x16x32_bf16 v[208:211], a[136:139], a[64:67], v[208:211]
  ds_read_b64_tr_b16 a[160:161], v24 offset:14528
  v_mfma_f32_16x16x32_bf16 v[208:211], a[140:143], a[80:83], v[208:211]
  v_mfma_f32_16x16x32_bf16 v[208:211], a[144:147], a[96:99], v[208:211]
  ds_read_b64_tr_b16 a[162:163], v24 offset:18112
  v_mfma_f32_16x16x32_bf16 v[208:211], a[148:151], a[112:115], v[208:211]
  v_mfma_f32_16x16x32_bf16 v[212:215], a[148:151], a[116:119], v[212:215]
  ds_read_b64_tr_b16 a[164:165], v24 offset:21696
  v_mfma_f32_16x16x32_bf16 v[212:215], a[144:147], a[100:103], v[212:215]
  v_mfma_f32_16x16x32_bf16 v[212:215], a[140:143], a[84:87], v[212:215]
  ds_read_b64_tr_b16 a[166:167], v24 offset:25280
  v_mfma_f32_16x16x32_bf16 v[212:215], a[136:139], a[68:71], v[212:215]
  v_mfma_f32_16x16x32_bf16 v[216:219], a[136:139], a[72:75], v[216:219]
  ds_read_b64_tr_b16 a[128:129], v24 offset:0
  v_mfma_f32_16x16x32_bf16 v[216:219], a[140:143], a[88:91], v[216:219]
  v_mfma_f32_16x16x32_bf16 v[216:219], a[144:147], a[104:107], v[216:219]
  ds_read_b64_tr_b16 a[130:131], v24 offset:3584
  v_mfma_f32_16x16x32_bf16 v[216:219], a[148:151], a[120:123], v[216:219]
  v_mfma_f32_16x16x32_bf16 v[220:223], a[148:151], a[124:127], v[220:223]
  ds_read_b64_tr_b16 a[132:133], v24 offset:7168
  v_mfma_f32_16x16x32_bf16 v[220:223], a[144:147], a[108:111], v[220:223]
  v_mfma_f32_16x16x32_bf16 v[220:223], a[140:143], a[92:95], v[220:223]
  ds_read_b64_tr_b16 a[134:135], v24 offset:10752
  v_mfma_f32_16x16x32_bf16 v[220:223], a[136:139], a[76:79], v[220:223]
  s_waitcnt vmcnt(11) lgkmcnt(4)
  v_mfma_f32_16x16x32_bf16 v[236:239], a[152:155], a[12:15], v[236:239]
  s_mov_b32 s39, 28672
  ds_read_b64_tr_b16 a[136:137], v24 offset:14336
  v_accvgpr_read_b32 v26, a168
  v_mfma_f32_16x16x32_bf16 v[236:239], a[156:159], a[28:31], v[236:239]
  buffer_load_dwordx4 a[200:203], v8, s[16:19], s39 offen offset:1024 sc1
  v_mfma_f32_16x16x32_bf16 v[236:239], a[160:163], a[44:47], v[236:239]
  ds_read_b64_tr_b16 a[138:139], v24 offset:17920
  v_accvgpr_read_b32 v27, a169
  v_mfma_f32_16x16x32_bf16 v[236:239], a[164:167], a[60:63], v[236:239]
  v_accvgpr_read_b32 v28, a170
  v_mfma_f32_16x16x32_bf16 v[232:235], a[164:167], a[56:59], v[232:235]
  ds_read_b64_tr_b16 a[140:141], v24 offset:21504
  v_accvgpr_read_b32 v29, a171
  v_mfma_f32_16x16x32_bf16 v[232:235], a[160:163], a[40:43], v[232:235]
  buffer_load_dwordx4 a[96:99], v8, s[16:19], s39 offen offset:2048 sc1
  v_mfma_f32_16x16x32_bf16 v[232:235], a[156:159], a[24:27], v[232:235]
  ds_read_b64_tr_b16 a[142:143], v24 offset:25088
  v_add_f32 v26, v26, v27
  v_mfma_f32_16x16x32_bf16 v[232:235], a[152:155], a[8:11], v[232:235]
  v_add_f32 v28, v28, v29
  v_mfma_f32_16x16x32_bf16 v[228:231], a[152:155], a[4:7], v[228:231]
  ds_read_b64_tr_b16 a[144:145], v24 offset:32
  v_add_f32 v30, v26, v28
  v_mfma_f32_16x16x32_bf16 v[228:231], a[156:159], a[20:23], v[228:231]
  buffer_load_dwordx4 a[112:115], v8, s[16:19], s39 offen offset:3072 sc1
  s_mov_b32 s39, 61440
  v_mfma_f32_16x16x32_bf16 v[228:231], a[160:163], a[36:39], v[228:231]
  ds_read_b64_tr_b16 a[146:147], v24 offset:3616
  v_accvgpr_read_b32 v26, a172
  v_mfma_f32_16x16x32_bf16 v[228:231], a[164:167], a[52:55], v[228:231]
  v_accvgpr_read_b32 v27, a173
  v_mfma_f32_16x16x32_bf16 v[224:227], a[164:167], a[48:51], v[224:227]
  ds_read_b64_tr_b16 a[148:149], v24 offset:7200
  v_accvgpr_read_b32 v28, a174
  v_mfma_f32_16x16x32_bf16 v[224:227], a[160:163], a[32:35], v[224:227]
  v_accvgpr_read_b32 v29, a175
  v_mfma_f32_16x16x32_bf16 v[224:227], a[156:159], a[16:19], v[224:227]
  ds_read_b64_tr_b16 a[150:151], v24 offset:10784
  v_add_f32 v26, v26, v27
  v_mfma_f32_16x16x32_bf16 v[224:227], a[152:155], a[0:3], v[224:227]
  s_waitcnt lgkmcnt(4)
  buffer_load_dwordx4 a[204:207], v8, s[16:19], s39 offen offset:1024 sc1
  v_mfma_f32_16x16x32_bf16 v[32:35], a[128:131], a[0:3], v[32:35]
  ds_read_b64_tr_b16 a[152:153], v24 offset:14368
  v_add_f32 v28, v28, v29
  v_mfma_f32_16x16x32_bf16 v[32:35], a[132:135], a[16:19], v[32:35]
  v_add_f32 v31, v26, v28
  v_mfma_f32_16x16x32_bf16 v[32:35], a[136:139], a[32:35], v[32:35]
  ds_read_b64_tr_b16 a[154:155], v24 offset:17952
  v_add_f32 v30, v30, v31
  v_mfma_f32_16x16x32_bf16 v[32:35], a[140:143], a[48:51], v[32:35]
  buffer_load_dwordx4 a[100:103], v8, s[16:19], s39 offen offset:2048 sc1
  v_mfma_f32_16x16x32_bf16 v[36:39], a[140:143], a[52:55], v[36:39]
  ds_read_b64_tr_b16 a[156:157], v24 offset:21536
  v_mov_b32 v31, v30
  v_mfma_f32_16x16x32_bf16 v[36:39], a[136:139], a[36:39], v[36:39]
  s_nop 0
  v_permlane32_swap_b32 v30, v31
  v_mfma_f32_16x16x32_bf16 v[36:39], a[132:135], a[20:23], v[36:39]
  ds_read_b64_tr_b16 a[158:159], v24 offset:25120
  v_add_f32 v30, v30, v31
  v_mfma_f32_16x16x32_bf16 v[36:39], a[128:131], a[4:7], v[36:39]
  v_mov_b32 v26, 0x3727c5ac
  v_mfma_f32_16x16x32_bf16 v[40:43], a[128:131], a[8:11], v[40:43]
  ds_read_b64_tr_b16 a[160:161], v24 offset:64
  v_fmac_f32 v26, 0x3a800000, v30
  v_mfma_f32_16x16x32_bf16 v[40:43], a[132:135], a[24:27], v[40:43]
  buffer_load_dwordx4 a[116:119], v8, s[16:19], s39 offen offset:3072 sc1
  s_mov_b32 s39, 94208
  v_mfma_f32_16x16x32_bf16 v[40:43], a[136:139], a[40:43], v[40:43]
  ds_read_b64_tr_b16 a[162:163], v24 offset:3648
  v_mfma_f32_16x16x32_bf16 v[40:43], a[140:143], a[56:59], v[40:43]
  v_rsq_f32 v30, v26
  v_mfma_f32_16x16x32_bf16 v[44:47], a[140:143], a[60:63], v[44:47]
  ds_read_b64_tr_b16 a[164:165], v24 offset:7232
  v_mul_f32 v17, v30, v26
  v_mfma_f32_16x16x32_bf16 v[44:47], a[136:139], a[44:47], v[44:47]
  buffer_load_dwordx4 a[208:211], v8, s[16:19], s39 offen offset:1024 sc1
  v_mfma_f32_16x16x32_bf16 v[44:47], a[132:135], a[28:31], v[44:47]
  ds_read_b64_tr_b16 a[166:167], v24 offset:10816
  v_mul_f32 v16, s49, v30
  v_mfma_f32_16x16x32_bf16 v[44:47], a[128:131], a[12:15], v[44:47]
  s_waitcnt lgkmcnt(4)
  v_mov_b32 v19, v17
  v_mfma_f32_16x16x32_bf16 v[76:79], a[144:147], a[12:15], v[76:79]
  ds_read_b64_tr_b16 a[128:129], v24 offset:14400
  v_mov_b32 v18, v16
  v_mfma_f32_16x16x32_bf16 v[76:79], a[148:151], a[28:31], v[76:79]
  buffer_load_dwordx4 a[104:107], v8, s[16:19], s39 offen offset:2048 sc1
  v_mfma_f32_16x16x32_bf16 v[76:79], a[152:155], a[44:47], v[76:79]
  ds_read_b64_tr_b16 a[130:131], v24 offset:17984
  v_mfma_f32_16x16x32_bf16 v[76:79], a[156:159], a[60:63], v[76:79]
  v_permlane16_swap_b32 v17, v19
  v_mfma_f32_16x16x32_bf16 v[72:75], a[156:159], a[56:59], v[72:75]
  ds_read_b64_tr_b16 a[132:133], v24 offset:21568
  v_mfma_f32_16x16x32_bf16 v[72:75], a[152:155], a[40:43], v[72:75]
  v_permlane16_swap_b32 v16, v18
  v_mfma_f32_16x16x32_bf16 v[72:75], a[148:151], a[24:27], v[72:75]
  ds_read_b64_tr_b16 a[134:135], v24 offset:25152
  v_accvgpr_read_b32 v26, a176
  v_mfma_f32_16x16x32_bf16 v[72:75], a[144:147], a[8:11], v[72:75]
  buffer_load_dwordx4 a[120:123], v8, s[16:19], s39 offen offset:3072 sc1
  s_mov_b32 s39, 126976
  v_mfma_f32_16x16x32_bf16 v[68:71], a[144:147], a[4:7], v[68:71]
  ds_read_b64_tr_b16 a[136:137], v24 offset:96
  v_accvgpr_read_b32 v27, a177
  v_mfma_f32_16x16x32_bf16 v[68:71], a[148:151], a[20:23], v[68:71]
  v_accvgpr_read_b32 v28, a178
  v_mfma_f32_16x16x32_bf16 v[68:71], a[152:155], a[36:39], v[68:71]
  ds_read_b64_tr_b16 a[138:139], v24 offset:3680
  v_accvgpr_read_b32 v29, a179
  v_mfma_f32_16x16x32_bf16 v[68:71], a[156:159], a[52:55], v[68:71]
  buffer_load_dwordx4 a[212:215], v8, s[16:19], s39 offen offset:1024 sc1
  v_mfma_f32_16x16x32_bf16 v[64:67], a[156:159], a[48:51], v[64:67]
  ds_read_b64_tr_b16 a[140:141], v24 offset:7264
  v_add_f32 v26, v26, v27
  v_mfma_f32_16x16x32_bf16 v[64:67], a[152:155], a[32:35], v[64:67]
  v_add_f32 v28, v28, v29
  v_mfma_f32_16x16x32_bf16 v[64:67], a[148:151], a[16:19], v[64:67]
  ds_read_b64_tr_b16 a[142:143], v24 offset:10848
  v_add_f32 v30, v26, v28
  v_mfma_f32_16x16x32_bf16 v[64:67], a[144:147], a[0:3], v[64:67]
  s_waitcnt lgkmcnt(4)
  v_accvgpr_read_b32 v26, a180
  v_mfma_f32_16x16x32_bf16 v[96:99], a[160:163], a[0:3], v[96:99]
  ds_read_b64_tr_b16 a[144:145], v24 offset:14432
  v_accvgpr_read_b32 v27, a181
  v_mfma_f32_16x16x32_bf16 v[96:99], a[164:167], a[16:19], v[96:99]
  buffer_load_dwordx4 a[108:111], v8, s[16:19], s39 offen offset:2048 sc1
  v_mfma_f32_16x16x32_bf16 v[96:99], a[128:131], a[32:35], v[96:99]
  ds_read_b64_tr_b16 a[146:147], v24 offset:18016
  v_accvgpr_read_b32 v28, a182
  v_mfma_f32_16x16x32_bf16 v[96:99], a[132:135], a[48:51], v[96:99]
  v_accvgpr_read_b32 v29, a183
  v_mfma_f32_16x16x32_bf16 v[100:103], a[132:135], a[52:55], v[100:103]
  ds_read_b64_tr_b16 a[148:149], v24 offset:21600
  v_add_f32 v26, v26, v27
  v_mfma_f32_16x16x32_bf16 v[100:103], a[128:131], a[36:39], v[100:103]
  buffer_load_dwordx4 a[124:127], v8, s[16:19], s39 offen offset:3072 sc1
  s_mov_b32 s38, 5505024
  v_mfma_f32_16x16x32_bf16 v[100:103], a[164:167], a[20:23], v[100:103]
  s_add_u32 m0, s77, 65536
  ds_read_b64_tr_b16 a[150:151], v24 offset:25184
  v_add_f32 v28, v28, v29
  v_mfma_f32_16x16x32_bf16 v[100:103], a[160:163], a[4:7], v[100:103]
  v_add_f32 v31, v26, v28
  v_mfma_f32_16x16x32_bf16 v[104:107], a[160:163], a[8:11], v[104:107]
  ds_read_b64_tr_b16 a[152:153], v24 offset:128
  v_add_f32 v30, v30, v31
  v_mfma_f32_16x16x32_bf16 v[104:107], a[164:167], a[24:27], v[104:107]
  v_mov_b32 v31, v30
  v_mfma_f32_16x16x32_bf16 v[104:107], a[128:131], a[40:43], v[104:107]
  ds_read_b64_tr_b16 a[154:155], v24 offset:3712
  v_mfma_f32_16x16x32_bf16 v[104:107], a[132:135], a[56:59], v[104:107]
  buffer_load_dwordx4 v4, s[96:99], s38 offen offset:0 lds
  v_mfma_f32_16x16x32_bf16 v[108:111], a[132:135], a[60:63], v[108:111]
  ds_read_b64_tr_b16 a[156:157], v24 offset:7296
  v_mfma_f32_16x16x32_bf16 v[108:111], a[128:131], a[44:47], v[108:111]
  v_permlane32_swap_b32 v30, v31
  v_mfma_f32_16x16x32_bf16 v[108:111], a[164:167], a[28:31], v[108:111]
  ds_read_b64_tr_b16 a[158:159], v24 offset:10880
  v_add_f32 v30, v30, v31
  v_mfma_f32_16x16x32_bf16 v[108:111], a[160:163], a[12:15], v[108:111]
  s_waitcnt lgkmcnt(4)
  buffer_load_dwordx4 v5, s[96:99], s38 offen offset:1024 lds
  v_mfma_f32_16x16x32_bf16 v[140:143], a[136:139], a[12:15], v[140:143]
  ds_read_b64_tr_b16 a[160:161], v24 offset:14464
  v_mov_b32 v26, 0x3727c5ac
  v_mfma_f32_16x16x32_bf16 v[140:143], a[140:143], a[28:31], v[140:143]
  v_fmac_f32 v26, 0x3a800000, v30
  v_mfma_f32_16x16x32_bf16 v[140:143], a[144:147], a[44:47], v[140:143]
  ds_read_b64_tr_b16 a[162:163], v24 offset:18048
  v_mfma_f32_16x16x32_bf16 v[140:143], a[148:151], a[60:63], v[140:143]
  buffer_load_dwordx4 v6, s[96:99], s38 offen offset:2048 lds
  v_mfma_f32_16x16x32_bf16 v[136:139], a[148:151], a[56:59], v[136:139]
  ds_read_b64_tr_b16 a[164:165], v24 offset:21632
  v_mfma_f32_16x16x32_bf16 v[136:139], a[144:147], a[40:43], v[136:139]
  v_rsq_f32 v30, v26
  v_mfma_f32_16x16x32_bf16 v[136:139], a[140:143], a[24:27], v[136:139]
  ds_read_b64_tr_b16 a[166:167], v24 offset:25216
  v_mul_f32 v21, v30, v26
  v_mfma_f32_16x16x32_bf16 v[136:139], a[136:139], a[8:11], v[136:139]
  v_mul_f32 v20, s49, v30
  v_mfma_f32_16x16x32_bf16 v[132:135], a[136:139], a[4:7], v[132:135]
  ds_read_b64_tr_b16 a[128:129], v24 offset:160
  v_mov_b32 v23, v21
  v_mfma_f32_16x16x32_bf16 v[132:135], a[140:143], a[20:23], v[132:135]
  buffer_load_dwordx4 v7, s[96:99], s38 offen offset:3072 lds
  s_add_u32 m0, s77, 69632
  v_mfma_f32_16x16x32_bf16 v[132:135], a[144:147], a[36:39], v[132:135]
  ds_read_b64_tr_b16 a[130:131], v24 offset:3744
  v_mov_b32 v22, v20
  v_mfma_f32_16x16x32_bf16 v[132:135], a[148:151], a[52:55], v[132:135]
  v_permlane16_swap_b32 v21, v23
  v_mfma_f32_16x16x32_bf16 v[128:131], a[148:151], a[48:51], v[128:131]
  ds_read_b64_tr_b16 a[132:133], v24 offset:7328
  v_mfma_f32_16x16x32_bf16 v[128:131], a[144:147], a[32:35], v[128:131]
  buffer_load_dwordx4 v12, s[96:99], s38 offen offset:0 lds
  v_mfma_f32_16x16x32_bf16 v[128:131], a[140:143], a[16:19], v[128:131]
  ds_read_b64_tr_b16 a[134:135], v24 offset:10912
  v_mfma_f32_16x16x32_bf16 v[128:131], a[136:139], a[0:3], v[128:131]
  s_waitcnt lgkmcnt(4)
  v_permlane16_swap_b32 v20, v22
  v_mfma_f32_16x16x32_bf16 v[160:163], a[152:155], a[0:3], v[160:163]
  ds_read_b64_tr_b16 a[136:137], v24 offset:14496
  v_mfma_f32_16x16x32_bf16 v[160:163], a[156:159], a[16:19], v[160:163]
  v_mfma_f32_16x16x32_bf16 v[160:163], a[160:163], a[32:35], v[160:163]
  ds_read_b64_tr_b16 a[138:139], v24 offset:18080
  v_mfma_f32_16x16x32_bf16 v[160:163], a[164:167], a[48:51], v[160:163]
  buffer_load_dwordx4 v13, s[96:99], s38 offen offset:1024 lds
  v_mfma_f32_16x16x32_bf16 v[164:167], a[164:167], a[52:55], v[164:167]
  ds_read_b64_tr_b16 a[140:141], v24 offset:21664
  v_mfma_f32_16x16x32_bf16 v[164:167], a[160:163], a[36:39], v[164:167]
  v_mfma_f32_16x16x32_bf16 v[164:167], a[156:159], a[20:23], v[164:167]
  ds_read_b64_tr_b16 a[142:143], v24 offset:25248
  v_mfma_f32_16x16x32_bf16 v[164:167], a[152:155], a[4:7], v[164:167]
  s_waitcnt vmcnt(18)
  buffer_load_dwordx4 v14, s[96:99], s38 offen offset:2048 lds
  s_mov_b32 s74, 230400
  v_mfma_f32_16x16x32_bf16 v[168:171], a[152:155], a[8:11], v[168:171]
  s_barrier
  ds_read_b64_tr_b16 a[144:145], v24 offset:32960
  s_mov_b32 s75, 460800
  v_mfma_f32_16x16x32_bf16 v[168:171], a[156:159], a[24:27], v[168:171]
  s_mov_b32 s76, 691200
  s_add_u32 s20, s4, 0x1980000
  s_addc_u32 s21, s5, 0
  v_mfma_f32_16x16x32_bf16 v[168:171], a[160:163], a[40:43], v[168:171]
  s_mov_b32 s22, 0x1c20400
  ds_read_b64_tr_b16 a[146:147], v24 offset:36544
  s_mov_b32 s23, 0x00020000
  v_mfma_f32_16x16x32_bf16 v[168:171], a[164:167], a[56:59], v[168:171]
  s_and_b32 s10, s33, 1
  s_mul_i32 s34, s33, 7
  s_add_u32 s34, s34, s10
  v_mfma_f32_16x16x32_bf16 v[172:175], a[164:167], a[60:63], v[172:175]
  s_lshr_b32 s34, s34, 1
  ds_read_b64_tr_b16 a[148:149], v24 offset:40128
  s_add_u32 s35, s34, 3
  v_mfma_f32_16x16x32_bf16 v[172:175], a[160:163], a[44:47], v[172:175]
  s_lshl_b32 s36, s10, 2
  s_sub_u32 s35, s35, s36
  s_lshl_b32 s34, s34, 11
  v_mfma_f32_16x16x32_bf16 v[172:175], a[156:159], a[28:31], v[172:175]
  s_lshl_b32 s35, s35, 11
  ds_read_b64_tr_b16 a[150:151], v24 offset:43712
  s_mul_i32 s36, s10, 230400
  v_mfma_f32_16x16x32_bf16 v[172:175], a[152:155], a[12:15], v[172:175]
  s_waitcnt lgkmcnt(4)
  s_add_u32 s35, s35, s36
  s_sub_u32 s35, s35, s34
  v_mfma_f32_16x16x32_bf16 v[204:207], a[128:131], a[12:15], v[204:207]
  s_mul_i32 s36, s44, 230400
  ds_read_b64_tr_b16 a[152:153], v24 offset:47296
  s_add_u32 s34, s34, s36
  v_mfma_f32_16x16x32_bf16 v[204:207], a[132:135], a[28:31], v[204:207]
  v_add_u32 v11, 40, v1
  v_lshrrev_b32 v11, 6, v11
  v_mfma_f32_16x16x32_bf16 v[204:207], a[136:139], a[44:47], v[204:207]
  ds_read_b64_tr_b16 a[154:155], v24 offset:50880
  v_lshl_add_u32 v11, v11, 7, v3
  v_mfma_f32_16x16x32_bf16 v[204:207], a[140:143], a[60:63], v[204:207]
  v_add_u32 v11, s34, v11
  v_add_u32 v9, s35, v11
  v_mfma_f32_16x16x32_bf16 v[200:203], a[140:143], a[56:59], v[200:203]
  ds_read_b64_tr_b16 a[156:157], v24 offset:54464
  v_add_u32 v10, 4096, v11
  v_mfma_f32_16x16x32_bf16 v[200:203], a[136:139], a[40:43], v[200:203]
  v_mfma_f32_16x16x32_bf16 v[200:203], a[132:135], a[24:27], v[200:203]
  ds_read_b64_tr_b16 a[158:159], v24 offset:58048
  v_mfma_f32_16x16x32_bf16 v[200:203], a[128:131], a[8:11], v[200:203]
  v_mfma_f32_16x16x32_bf16 v[196:199], a[128:131], a[4:7], v[196:199]
  ds_read_b64_tr_b16 a[160:161], v24 offset:32768
  v_mfma_f32_16x16x32_bf16 v[196:199], a[132:135], a[20:23], v[196:199]
  v_mfma_f32_16x16x32_bf16 v[196:199], a[136:139], a[36:39], v[196:199]
  ds_read_b64_tr_b16 a[162:163], v24 offset:36352
  v_mfma_f32_16x16x32_bf16 v[196:199], a[140:143], a[52:55], v[196:199]
  v_mfma_f32_16x16x32_bf16 v[192:195], a[140:143], a[48:51], v[192:195]
  ds_read_b64_tr_b16 a[164:165], v24 offset:39936
  v_mfma_f32_16x16x32_bf16 v[192:195], a[136:139], a[32:35], v[192:195]
  v_mfma_f32_16x16x32_bf16 v[192:195], a[132:135], a[16:19], v[192:195]
  ds_read_b64_tr_b16 a[166:167], v24 offset:43520
  v_mfma_f32_16x16x32_bf16 v[192:195], a[128:131], a[0:3], v[192:195]
  s_waitcnt vmcnt(7) lgkmcnt(4)
  v_mfma_f32_16x16x32_bf16 v[224:227], a[144:147], a[184:187], v[224:227]
  s_mov_b32 s38, 6422528
  ds_read_b64_tr_b16 a[128:129], v24 offset:47104
  s_add_u32 m0, s77, 98304
  v_mfma_f32_16x16x32_bf16 v[224:227], a[148:151], a[200:203], v[224:227]
  buffer_load_dwordx4 v4, s[96:99], s38 offen offset:0 lds
  v_mfma_f32_16x16x32_bf16 v[224:227], a[152:155], a[96:99], v[224:227]
  ds_read_b64_tr_b16 a[130:131], v24 offset:50688
  v_mfma_f32_16x16x32_bf16 v[224:227], a[156:159], a[112:115], v[224:227]
  v_mfma_f32_16x16x32_bf16 v[228:231], a[156:159], a[116:119], v[228:231]
  ds_read_b64_tr_b16 a[132:133], v24 offset:54272
  v_mfma_f32_16x16x32_bf16 v[228:231], a[152:155], a[100:103], v[228:231]
  buffer_load_dwordx4 v5, s[96:99], s38 offen offset:1024 lds
  v_mfma_f32_16x16x32_bf16 v[228:231], a[148:151], a[204:207], v[228:231]
  ds_read_b64_tr_b16 a[134:135], v24 offset:57856
  v_mfma_f32_16x16x32_bf16 v[228:231], a[144:147], a[188:191], v[228:231]
  v_mfma_f32_16x16x32_bf16 v[232:235], a[144:147], a[192:195], v[232:235]
  ds_read_b64_tr_b16 a[136:137], v24 offset:32800
  v_mfma_f32_16x16x32_bf16 v[232:235], a[148:151], a[208:211], v[232:235]
  buffer_load_dwordx4 v6, s[96:99], s38 offen offset:2048 lds
  v_mfma_f32_16x16x32_bf16 v[232:235], a[152:155], a[104:107], v[232:235]
  ds_read_b64_tr_b16 a[138:139], v24 offset:36384
  v_mfma_f32_16x16x32_bf16 v[232:235], a[156:159], a[120:123], v[232:235]
  v_mfma_f32_16x16x32_bf16 v[236:239], a[156:159], a[124:127], v[236:239]
  ds_read_b64_tr_b16 a[140:141], v24 offset:39968
  v_mfma_f32_16x16x32_bf16 v[236:239], a[152:155], a[108:111], v[236:239]
  buffer_load_dwordx4 v7, s[96:99], s38 offen offset:3072 lds
  s_add_u32 m0, s77, 102400
  v_mfma_f32_16x16x32_bf16 v[236:239], a[148:151], a[212:215], v[236:239]
  ds_read_b64_tr_b16 a[142:143], v24 offset:43552
  v_mfma_f32_16x16x32_bf16 v[236:239], a[144:147], a[196:199], v[236:239]
  s_waitcnt lgkmcnt(4)
  v_mfma_f32_16x16x32_bf16 v[44:47], a[160:163], a[196:199], v[44:47]
  ds_read_b64_tr_b16 a[144:145], v24 offset:47136
  buffer_load_dwordx4 v12, s[96:99], s38 offen offset:0 lds
  v_mfma_f32_16x16x32_bf16 v[44:47], a[164:167], a[212:215], v[44:47]
  v_mfma_f32_16x16x32_bf16 v[44:47], a[128:131], a[108:111], v[44:47]
  ds_read_b64_tr_b16 a[146:147], v24 offset:50720
  v_mfma_f32_16x16x32_bf16 v[44:47], a[132:135], a[124:127], v[44:47]
  v_mfma_f32_16x16x32_bf16 v[40:43], a[132:135], a[120:123], v[40:43]
  ds_read_b64_tr_b16 a[148:149], v24 offset:54304
  buffer_load_dwordx4 v13, s[96:99], s38 offen offset:1024 lds
  v_mfma_f32_16x16x32_bf16 v[40:43], a[128:131], a[104:107], v[40:43]
  v_mul_f32 v224, v16, v224
  v_mul_f32 v225, v16, v225
  v_mfma_f32_16x16x32_bf16 v[40:43], a[164:167], a[208:211], v[40:43]
  ds_read_b64_tr_b16 a[150:151], v24 offset:57888
  v_mul_f32_e64 v226, v16, v226
  v_mfma_f32_16x16x32_bf16 v[40:43], a[160:163], a[192:195], v[40:43]
  v_exp_f32 v224, v224
  v_mfma_f32_16x16x32_bf16 v[36:39], a[160:163], a[188:191], v[36:39]
  ds_read_b64_tr_b16 a[152:153], v24 offset:32832
  buffer_load_dwordx4 v14, s[96:99], s38 offen offset:2048 lds
  v_mfma_f32_16x16x32_bf16 v[36:39], a[164:167], a[204:207], v[36:39]
  v_exp_f32 v225, v225
  v_mfma_f32_16x16x32_bf16 v[36:39], a[128:131], a[100:103], v[36:39]
  ds_read_b64_tr_b16 a[154:155], v24 offset:36416
  v_fma_f32 v224, v224, v17, v17
  v_mfma_f32_16x16x32_bf16 v[36:39], a[132:135], a[116:119], v[36:39]
  v_rcp_f32 v224, v224
  v_mfma_f32_16x16x32_bf16 v[32:35], a[132:135], a[112:115], v[32:35]
  ds_read_b64_tr_b16 a[156:157], v24 offset:40000
  v_fma_f32 v225, v225, v17, v17
  v_mfma_f32_16x16x32_bf16 v[32:35], a[128:131], a[96:99], v[32:35]
  v_rcp_f32 v225, v225
  v_mfma_f32_16x16x32_bf16 v[32:35], a[164:167], a[200:203], v[32:35]
  ds_read_b64_tr_b16 a[158:159], v24 offset:43584
  v_mul_f32 v227, v16, v227
  v_mfma_f32_16x16x32_bf16 v[32:35], a[160:163], a[184:187], v[32:35]
  s_waitcnt lgkmcnt(4)
  v_exp_f32_e64 v226, v226
  v_mfma_f32_16x16x32_bf16 v[64:67], a[136:139], a[184:187], v[64:67]
  ds_read_b64_tr_b16 a[160:161], v24 offset:47168
  v_fma_f32 v226, v226, v17, v17
  v_mfma_f32_16x16x32_bf16 v[64:67], a[140:143], a[200:203], v[64:67]
  v_rcp_f32 v226, v226
  v_mfma_f32_16x16x32_bf16 v[64:67], a[144:147], a[96:99], v[64:67]
  ds_read_b64_tr_b16 a[162:163], v24 offset:50752
  v_mul_f32 v228, v18, v228
  v_mfma_f32_16x16x32_bf16 v[64:67], a[148:151], a[112:115], v[64:67]
  v_exp_f32 v227, v227
  v_mfma_f32_16x16x32_bf16 v[68:71], a[148:151], a[116:119], v[68:71]
  ds_read_b64_tr_b16 a[164:165], v24 offset:54336
  v_fma_f32 v227, v227, v17, v17
  v_mfma_f32_16x16x32_bf16 v[68:71], a[144:147], a[100:103], v[68:71]
L_pad_2b_5:
  s_cbranch_execz L_ret_2b
  v_rcp_f32 v227, v227
  v_mfma_f32_16x16x32_bf16 v[68:71], a[140:143], a[204:207], v[68:71]
  ds_read_b64_tr_b16 a[166:167], v24 offset:57920
  v_mul_f32 v229, v18, v229
  v_mfma_f32_16x16x32_bf16 v[68:71], a[136:139], a[188:191], v[68:71]
  v_exp_f32 v228, v228
  v_mfma_f32_16x16x32_bf16 v[72:75], a[136:139], a[192:195], v[72:75]
  ds_read_b64_tr_b16 a[128:129], v24 offset:32864
  v_fma_f32 v228, v228, v19, v19
  v_mfma_f32_16x16x32_bf16 v[72:75], a[140:143], a[208:211], v[72:75]
  v_rcp_f32 v228, v228
  v_mfma_f32_16x16x32_bf16 v[72:75], a[144:147], a[104:107], v[72:75]
  ds_read_b64_tr_b16 a[130:131], v24 offset:36448
  v_mul_f32 v230, v18, v230
  v_mfma_f32_16x16x32_bf16 v[72:75], a[148:151], a[120:123], v[72:75]
  v_exp_f32 v229, v229
  v_mfma_f32_16x16x32_bf16 v[76:79], a[148:151], a[124:127], v[76:79]
  ds_read_b64_tr_b16 a[132:133], v24 offset:40032
  v_fma_f32 v229, v229, v19, v19
  v_mfma_f32_16x16x32_bf16 v[76:79], a[144:147], a[108:111], v[76:79]
  v_rcp_f32 v229, v229
  v_mfma_f32_16x16x32_bf16 v[76:79], a[140:143], a[212:215], v[76:79]
  ds_read_b64_tr_b16 a[134:135], v24 offset:43616
  v_mul_f32 v231, v18, v231
  v_mfma_f32_16x16x32_bf16 v[76:79], a[136:139], a[196:199], v[76:79]
  s_waitcnt lgkmcnt(4)
  v_exp_f32 v230, v230
  v_mfma_f32_16x16x32_bf16 v[108:111], a[152:155], a[196:199], v[108:111]
  s_mov_b32 s42, 0
  ds_read_b64_tr_b16 a[136:137], v24 offset:47200
  v_lshrrev_b32 v12, 3, v1
  v_mfma_f32_16x16x32_bf16 v[108:111], a[156:159], a[212:215], v[108:111]
  v_bfe_u32 v13, v1, 1, 2
  v_lshrrev_b32 v14, 1, v12
  v_mfma_f32_16x16x32_bf16 v[108:111], a[160:163], a[108:111], v[108:111]
  ds_read_b64_tr_b16 a[138:139], v24 offset:50784
  v_xor_b32 v13, v13, v14
  v_mfma_f32_16x16x32_bf16 v[108:111], a[164:167], a[124:127], v[108:111]
  v_and_b32 v14, 1, v1
  v_lshlrev_b32 v14, 4, v14
  v_mfma_f32_16x16x32_bf16 v[104:107], a[164:167], a[120:123], v[104:107]
  ds_read_b64_tr_b16 a[140:141], v24 offset:54368
  v_lshl_add_u32 v13, v13, 5, v14
  v_mfma_f32_16x16x32_bf16 v[104:107], a[160:163], a[104:107], v[104:107]
  v_mul_u32_u24 v12, 2048, v12
  v_add3_u32 v4, v12, v13, s42
  v_mfma_f32_16x16x32_bf16 v[104:107], a[156:159], a[208:211], v[104:107]
  ds_read_b64_tr_b16 a[142:143], v24 offset:57952
  v_add_u32 v5, 15360, v4
  v_mfma_f32_16x16x32_bf16 v[104:107], a[152:155], a[192:195], v[104:107]
  v_add_u32 v6, 30720, v4
  v_add_u32 v7, 46080, v4
  v_mfma_f32_16x16x32_bf16 v[100:103], a[152:155], a[188:191], v[100:103]
  s_mov_b32 s12, s66
  ds_read_b64_tr_b16 a[144:145], v24 offset:32896
  v_fma_f32 v230, v230, v19, v19
  v_mfma_f32_16x16x32_bf16 v[100:103], a[156:159], a[204:207], v[100:103]
  s_mov_b32 s13, s67
  v_rcp_f32 v230, v230
  v_mfma_f32_16x16x32_bf16 v[100:103], a[160:163], a[100:103], v[100:103]
  s_mov_b32 s14, 0x700000
  ds_read_b64_tr_b16 a[146:147], v24 offset:36480
  v_mul_f32 v232, v20, v232
  v_mfma_f32_16x16x32_bf16 v[100:103], a[164:167], a[116:119], v[100:103]
  s_mov_b32 s15, 0x00020000
  v_exp_f32 v231, v231
  v_mfma_f32_16x16x32_bf16 v[96:99], a[164:167], a[112:115], v[96:99]
  s_and_b32 s36, s31, 1
  ds_read_b64_tr_b16 a[148:149], v24 offset:40064
  v_fma_f32 v231, v231, v19, v19
  v_mfma_f32_16x16x32_bf16 v[96:99], a[160:163], a[96:99], v[96:99]
  s_mul_i32 s100, s36, 111
  v_rcp_f32 v231, v231
  v_mfma_f32_16x16x32_bf16 v[96:99], a[156:159], a[200:203], v[96:99]
  s_lshl_b32 s36, s36, 1
  ds_read_b64_tr_b16 a[150:151], v24 offset:43648
  v_mul_f32 v233, v20, v233
  v_mfma_f32_16x16x32_bf16 v[96:99], a[152:155], a[184:187], v[96:99]
  s_waitcnt lgkmcnt(4)
  v_exp_f32_e64 v232, v232
  v_mfma_f32_16x16x32_bf16 v[128:131], a[128:131], a[184:187], v[128:131]
  s_sub_u32 s99, 1, s36
  ds_read_b64_tr_b16 a[152:153], v24 offset:47232
  v_fma_f32 v232, v232, v21, v21
  v_mfma_f32_16x16x32_bf16 v[128:131], a[132:135], a[200:203], v[128:131]
  s_lshl_b32 s96, s99, 17
  v_rcp_f32 v232, v232
  v_mfma_f32_16x16x32_bf16 v[128:131], a[136:139], a[96:99], v[128:131]
  s_add_u32 s34, s24, 48
  ds_read_b64_tr_b16 a[154:155], v24 offset:50816
  v_mul_f32 v234, v20, v234
  v_mfma_f32_16x16x32_bf16 v[128:131], a[140:143], a[112:115], v[128:131]
  s_mul_i32 s34, s34, s99
  v_exp_f32 v233, v233
  v_mfma_f32_16x16x32_bf16 v[132:135], a[140:143], a[116:119], v[132:135]
  s_add_u32 s34, s34, s100
  ds_read_b64_tr_b16 a[156:157], v24 offset:54400
  v_fma_f32 v233, v233, v21, v21
  v_mfma_f32_16x16x32_bf16 v[132:135], a[136:139], a[100:103], v[132:135]
  s_lshl_b32 s34, s34, 16
  v_rcp_f32 v233, v233
  v_mfma_f32_16x16x32_bf16 v[132:135], a[132:135], a[204:207], v[132:135]
  s_lshl_b32 s35, s31, 7
  ds_read_b64_tr_b16 a[158:159], v24 offset:57984
  v_mul_f32 v235, v20, v235
  v_mfma_f32_16x16x32_bf16 v[132:135], a[128:131], a[188:191], v[132:135]
  s_add_u32 s98, s34, s35
  v_exp_f32 v234, v234
  v_mfma_f32_16x16x32_bf16 v[136:139], a[128:131], a[192:195], v[136:139]
  s_and_b32 s34, s24, 1
  ds_read_b64_tr_b16 a[160:161], v24 offset:32928
  v_fma_f32 v234, v234, v21, v21
  v_mfma_f32_16x16x32_bf16 v[136:139], a[132:135], a[208:211], v[136:139]
  s_mul_i32 s34, s34, s99
  v_rcp_f32 v234, v234
  v_mfma_f32_16x16x32_bf16 v[136:139], a[136:139], a[104:107], v[136:139]
  s_add_u32 s34, s34, s100
  ds_read_b64_tr_b16 a[162:163], v24 offset:36512
  v_mul_f32 v236, v22, v236
  v_mfma_f32_16x16x32_bf16 v[136:139], a[140:143], a[120:123], v[136:139]
  s_lshl_b32 s34, s34, 16
  v_exp_f32_e64 v235, v235
  v_mfma_f32_16x16x32_bf16 v[140:143], a[140:143], a[124:127], v[140:143]
  s_lshr_b32 s35, s24, 1
  ds_read_b64_tr_b16 a[164:165], v24 offset:40096
  v_fma_f32 v235, v235, v21, v21
  v_mfma_f32_16x16x32_bf16 v[140:143], a[136:139], a[108:111], v[140:143]
  s_xor_b32 s35, s35, s31
  v_rcp_f32 v235, v235
  v_mfma_f32_16x16x32_bf16 v[140:143], a[132:135], a[212:215], v[140:143]
  s_lshl_b32 s35, s35, 7
  ds_read_b64_tr_b16 a[166:167], v24 offset:43680
  v_mul_f32 v237, v22, v237
  v_mfma_f32_16x16x32_bf16 v[140:143], a[128:131], a[196:199], v[140:143]
  s_waitcnt lgkmcnt(4)
  v_exp_f32 v236, v236
  v_mfma_f32_16x16x32_bf16 v[172:175], a[144:147], a[196:199], v[172:175]
  s_add_u32 s38, s34, s35
  ds_read_b64_tr_b16 a[128:129], v24 offset:47264
  v_fma_f32 v236, v236, v23, v23
  v_mfma_f32_16x16x32_bf16 v[172:175], a[148:151], a[212:215], v[172:175]
  s_add_u32 s8, s4, 0x47ffe80
  v_rcp_f32 v236, v236
  v_mfma_f32_16x16x32_bf16 v[172:175], a[152:155], a[108:111], v[172:175]
  s_addc_u32 s9, s5, 0
  ds_read_b64_tr_b16 a[130:131], v24 offset:50848
  v_mul_f32_e64 v238, v22, v238
  v_mfma_f32_16x16x32_bf16 v[172:175], a[156:159], a[124:127], v[172:175]
  s_and_b32 s35, s35, 0x380
  v_exp_f32 v237, v237
  v_mfma_f32_16x16x32_bf16 v[168:171], a[156:159], a[120:123], v[168:171]
  s_cmp_eq_u32 s35, 0x180
  ds_read_b64_tr_b16 a[132:133], v24 offset:54432
  v_fma_f32 v237, v237, v23, v23
  v_mfma_f32_16x16x32_bf16 v[168:171], a[152:155], a[104:107], v[168:171]
  s_cselect_b32 s12, s8, s12
  v_rcp_f32 v237, v237
  v_mfma_f32_16x16x32_bf16 v[168:171], a[148:151], a[208:211], v[168:171]
  s_cselect_b32 s13, s9, s13
  ds_read_b64_tr_b16 a[134:135], v24 offset:58016
  v_mul_f32_e64 v239, v22, v239
  v_mfma_f32_16x16x32_bf16 v[168:171], a[144:147], a[192:195], v[168:171]
  s_waitcnt vmcnt(0)
  v_exp_f32 v238, v238
  v_mfma_f32_16x16x32_bf16 v[164:167], a[144:147], a[188:191], v[164:167]
  s_barrier
  ds_read_b64_tr_b16 a[136:137], v25 offset:192
  v_mfma_f32_16x16x32_bf16 v[164:167], a[148:151], a[204:207], v[164:167]
  s_and_b32 s35, s31, 7
  v_exp_f32 v239, v239
  v_mfma_f32_16x16x32_bf16 v[164:167], a[152:155], a[100:103], v[164:167]
  s_cmp_eq_u32 s35, 3
  ds_read_b64_tr_b16 a[138:139], v25 offset:3776
  v_fma_f32 v238, v238, v23, v23
  v_mfma_f32_16x16x32_bf16 v[164:167], a[156:159], a[116:119], v[164:167]
  s_cselect_b32 s80, s8, s66
  v_rcp_f32 v238, v238
  v_mfma_f32_16x16x32_bf16 v[160:163], a[156:159], a[112:115], v[160:163]
  s_cselect_b32 s81, s9, s67
  ds_read_b64_tr_b16 a[140:141], v25 offset:7360
  v_fma_f32 v239, v239, v23, v23
  v_mfma_f32_16x16x32_bf16 v[160:163], a[152:155], a[96:99], v[160:163]
  v_rcp_f32 v239, v239
  v_mfma_f32_16x16x32_bf16 v[160:163], a[148:151], a[200:203], v[160:163]
  ds_read_b64_tr_b16 a[142:143], v25 offset:10944
  v_mul_f32_e64 v32, v16, v32
  v_mfma_f32_16x16x32_bf16 v[160:163], a[144:147], a[184:187], v[160:163]
  s_waitcnt lgkmcnt(4)
  v_exp_f32 v32, v32
  v_mfma_f32_16x16x32_bf16 v[192:195], a[160:163], a[184:187], v[192:195]
  ds_read_b64_tr_b16 a[144:145], v25 offset:14528
  v_fma_f32 v32, v32, v17, v17
  v_mfma_f32_16x16x32_bf16 v[192:195], a[164:167], a[200:203], v[192:195]
  v_rcp_f32 v32, v32
  v_mfma_f32_16x16x32_bf16 v[192:195], a[128:131], a[96:99], v[192:195]
  ds_read_b64_tr_b16 a[146:147], v25 offset:18112
  v_mul_f32 v33, v16, v33
  v_mfma_f32_16x16x32_bf16 v[192:195], a[132:135], a[112:115], v[192:195]
  v_exp_f32 v33, v33
  v_mfma_f32_16x16x32_bf16 v[196:199], a[132:135], a[116:119], v[196:199]
  ds_read_b64_tr_b16 a[148:149], v25 offset:21696
  v_fma_f32 v33, v33, v17, v17
  v_mfma_f32_16x16x32_bf16 v[196:199], a[128:131], a[100:103], v[196:199]
  v_rcp_f32 v33, v33
  v_mfma_f32_16x16x32_bf16 v[196:199], a[164:167], a[204:207], v[196:199]
  ds_read_b64_tr_b16 a[150:151], v25 offset:25280
  v_mul_f32 v34, v16, v34
  v_mfma_f32_16x16x32_bf16 v[196:199], a[160:163], a[188:191], v[196:199]
  v_exp_f32 v34, v34
  v_mfma_f32_16x16x32_bf16 v[200:203], a[160:163], a[192:195], v[200:203]
  ds_read_b64_tr_b16 a[152:153], v25 offset:32960
  v_fma_f32 v34, v34, v17, v17
  v_mfma_f32_16x16x32_bf16 v[200:203], a[164:167], a[208:211], v[200:203]
  v_rcp_f32_e64 v34, v34
  v_mfma_f32_16x16x32_bf16 v[200:203], a[128:131], a[104:107], v[200:203]
  ds_read_b64_tr_b16 a[154:155], v25 offset:36544
  v_mul_f32 v35, v16, v35
  v_mfma_f32_16x16x32_bf16 v[200:203], a[132:135], a[120:123], v[200:203]
  v_exp_f32 v35, v35
  v_mfma_f32_16x16x32_bf16 v[204:207], a[132:135], a[124:127], v[204:207]
  ds_read_b64_tr_b16 a[156:157], v25 offset:40128
  v_fma_f32 v35, v35, v17, v17
  v_mfma_f32_16x16x32_bf16 v[204:207], a[128:131], a[108:111], v[204:207]
  v_rcp_f32 v35, v35
  v_mfma_f32_16x16x32_bf16 v[204:207], a[164:167], a[212:215], v[204:207]
  ds_read_b64_tr_b16 a[158:159], v25 offset:43712
  v_mul_f32 v64, v16, v64
  v_mfma_f32_16x16x32_bf16 v[204:207], a[160:163], a[196:199], v[204:207]
  s_waitcnt lgkmcnt(4)
  v_exp_f32 v64, v64
  v_mfma_f32_16x16x32_bf16 v[252:255], a[136:139], a[12:15], v[252:255]
  ds_read_b64_tr_b16 a[160:161], v25 offset:47296
  v_fma_f32 v64, v64, v17, v17
  v_mfma_f32_16x16x32_bf16 v[252:255], a[140:143], a[28:31], v[252:255]
  v_rcp_f32 v64, v64
  v_mfma_f32_16x16x32_bf16 v[252:255], a[144:147], a[44:47], v[252:255]
  ds_read_b64_tr_b16 a[162:163], v25 offset:50880
  v_mul_f32 v65, v16, v65
  v_mfma_f32_16x16x32_bf16 v[252:255], a[148:151], a[60:63], v[252:255]
  v_exp_f32 v65, v65
  v_mfma_f32_16x16x32_bf16 v[248:251], a[148:151], a[56:59], v[248:251]
  ds_read_b64_tr_b16 a[164:165], v25 offset:54464
  v_fma_f32 v65, v65, v17, v17
  v_mfma_f32_16x16x32_bf16 v[248:251], a[144:147], a[40:43], v[248:251]
  v_rcp_f32 v65, v65
  v_mfma_f32_16x16x32_bf16 v[248:251], a[140:143], a[24:27], v[248:251]
  ds_read_b64_tr_b16 a[166:167], v25 offset:58048
  v_mul_f32 v66, v16, v66
  v_mfma_f32_16x16x32_bf16 v[248:251], a[136:139], a[8:11], v[248:251]
  s_waitcnt vmcnt(0)
  v_exp_f32 v66, v66
  v_mfma_f32_16x16x32_bf16 v[244:247], a[136:139], a[4:7], v[244:247]
  s_barrier
  ds_read_b64_tr_b16 a[128:129], v25 offset:0
  v_mfma_f32_16x16x32_bf16 v[244:247], a[140:143], a[20:23], v[244:247]
  v_fma_f32 v66, v66, v17, v17
  v_mul_f32_e64 v67, v16, v67
  v_mfma_f32_16x16x32_bf16 v[244:247], a[144:147], a[36:39], v[244:247]
  ds_read_b64_tr_b16 a[130:131], v25 offset:3584
  v_mul_f32 v36, v18, v36
  v_mfma_f32_16x16x32_bf16 v[244:247], a[148:151], a[52:55], v[244:247]
  v_rcp_f32 v66, v66
  v_mfma_f32_16x16x32_bf16 v[240:243], a[148:151], a[48:51], v[240:243]
  ds_read_b64_tr_b16 a[132:133], v25 offset:7168
  v_mul_f32 v37, v18, v37
  v_mfma_f32_16x16x32_bf16 v[240:243], a[144:147], a[32:35], v[240:243]
  v_exp_f32 v67, v67
  v_mfma_f32_16x16x32_bf16 v[240:243], a[140:143], a[16:19], v[240:243]
  ds_read_b64_tr_b16 a[134:135], v25 offset:10752
  v_fma_f32 v67, v67, v17, v17
  v_mfma_f32_16x16x32_bf16 v[240:243], a[136:139], a[0:3], v[240:243]
  s_waitcnt lgkmcnt(4)
  v_rcp_f32 v67, v67
  v_mfma_f32_16x16x32_bf16 v[240:243], a[152:155], a[184:187], v[240:243]
  s_add_u32 m0, s37, 0
  ds_read_b64_tr_b16 a[136:137], v25 offset:14336
  buffer_load_dwordx4 v4, s[12:15], s38 offen offset:0 lds
  v_mfma_f32_16x16x32_bf16 v[240:243], a[156:159], a[200:203], v[240:243]
  v_exp_f32 v36, v36
  v_mfma_f32_16x16x32_bf16 v[240:243], a[160:163], a[96:99], v[240:243]
  ds_read_b64_tr_b16 a[138:139], v25 offset:17920
  v_fma_f32 v36, v36, v19, v19
  v_mfma_f32_16x16x32_bf16 v[240:243], a[164:167], a[112:115], v[240:243]
  v_rcp_f32 v36, v36
  v_mfma_f32_16x16x32_bf16 v[244:247], a[164:167], a[116:119], v[244:247]
  ds_read_b64_tr_b16 a[140:141], v25 offset:21504
  buffer_load_dwordx4 v5, s[12:15], s38 offen offset:1024 lds
  v_mfma_f32_16x16x32_bf16 v[244:247], a[160:163], a[100:103], v[244:247]
  v_exp_f32 v37, v37
  v_mfma_f32_16x16x32_bf16 v[244:247], a[156:159], a[204:207], v[244:247]
  ds_read_b64_tr_b16 a[142:143], v25 offset:25088
  v_fma_f32 v37, v37, v19, v19
  v_mfma_f32_16x16x32_bf16 v[244:247], a[152:155], a[188:191], v[244:247]
  v_rcp_f32_e64 v37, v37
  v_mfma_f32_16x16x32_bf16 v[248:251], a[152:155], a[192:195], v[248:251]
  ds_read_b64_tr_b16 a[144:145], v25 offset:32768
  buffer_load_dwordx4 v6, s[12:15], s38 offen offset:2048 lds
  v_mfma_f32_16x16x32_bf16 v[248:251], a[156:159], a[208:211], v[248:251]
  v_mul_f32 v38, v18, v38
  v_mul_f32 v39, v18, v39
  v_mfma_f32_16x16x32_bf16 v[248:251], a[160:163], a[104:107], v[248:251]
  ds_read_b64_tr_b16 a[146:147], v25 offset:36352
  v_mul_f32_e64 v68, v18, v68
  v_mfma_f32_16x16x32_bf16 v[248:251], a[164:167], a[120:123], v[248:251]
  v_exp_f32 v38, v38
  v_mfma_f32_16x16x32_bf16 v[252:255], a[164:167], a[124:127], v[252:255]
  ds_read_b64_tr_b16 a[148:149], v25 offset:39936
  buffer_load_dwordx4 v7, s[12:15], s38 offen offset:3072 lds
  v_mfma_f32_16x16x32_bf16 v[252:255], a[160:163], a[108:111], v[252:255]
  s_add_u32 s38, s38, s96
  v_exp_f32 v39, v39
  v_mfma_f32_16x16x32_bf16 v[252:255], a[156:159], a[212:215], v[252:255]
  s_add_u32 m0, s37, 16384
  ds_read_b64_tr_b16 a[150:151], v25 offset:43520
  v_fma_f32 v38, v38, v19, v19
  v_mfma_f32_16x16x32_bf16 v[252:255], a[152:155], a[196:199], v[252:255]
  s_waitcnt lgkmcnt(4)
  v_rcp_f32 v38, v38
  v_mfma_f32_16x16x32_bf16 v[60:63], a[128:131], a[12:15], v[60:63]
  ds_read_b64_tr_b16 a[152:153], v25 offset:47104
  buffer_load_dwordx4 v4, s[12:15], s38 offen offset:0 lds
  v_mfma_f32_16x16x32_bf16 v[60:63], a[132:135], a[28:31], v[60:63]
  v_exp_f32 v68, v68
  v_mfma_f32_16x16x32_bf16 v[60:63], a[136:139], a[44:47], v[60:63]
  ds_read_b64_tr_b16 a[154:155], v25 offset:50688
  v_fma_f32 v39, v39, v19, v19
  v_mfma_f32_16x16x32_bf16 v[60:63], a[140:143], a[60:63], v[60:63]
  v_rcp_f32 v39, v39
  v_mfma_f32_16x16x32_bf16 v[56:59], a[140:143], a[56:59], v[56:59]
  ds_read_b64_tr_b16 a[156:157], v25 offset:54272
  buffer_load_dwordx4 v5, s[12:15], s38 offen offset:1024 lds
  v_mfma_f32_16x16x32_bf16 v[56:59], a[136:139], a[40:43], v[56:59]
  v_mul_f32 v240, v224, v240
  v_mul_f32 v241, v225, v241
  v_mfma_f32_16x16x32_bf16 v[56:59], a[132:135], a[24:27], v[56:59]
  ds_read_b64_tr_b16 a[158:159], v25 offset:57856
  v_mul_f32 v242, v226, v242
  v_mfma_f32_16x16x32_bf16 v[56:59], a[128:131], a[8:11], v[56:59]
  v_mul_f32 v243, v227, v243
  v_mul_f32 v244, v228, v244
  v_mfma_f32_16x16x32_bf16 v[52:55], a[128:131], a[4:7], v[52:55]
  ds_read_b64_tr_b16 a[160:161], v25 offset:32
  buffer_load_dwordx4 v6, s[12:15], s38 offen offset:2048 lds
  v_mfma_f32_16x16x32_bf16 v[52:55], a[132:135], a[20:23], v[52:55]
  v_mul_f32 v245, v229, v245
  v_mul_f32 v246, v230, v246
  v_mfma_f32_16x16x32_bf16 v[52:55], a[136:139], a[36:39], v[52:55]
  ds_read_b64_tr_b16 a[162:163], v25 offset:3616
  v_mul_f32 v247, v231, v247
  v_mfma_f32_16x16x32_bf16 v[52:55], a[140:143], a[52:55], v[52:55]
  v_cvt_pk_bf16_f32 v224, v240, v241
  v_cvt_pk_bf16_f32 v225, v242, v243
  v_mfma_f32_16x16x32_bf16 v[48:51], a[140:143], a[48:51], v[48:51]
  ds_read_b64_tr_b16 a[164:165], v25 offset:7200
  buffer_load_dwordx4 v7, s[12:15], s38 offen offset:3072 lds
  v_mfma_f32_16x16x32_bf16 v[48:51], a[136:139], a[32:35], v[48:51]
  s_add_u32 s38, s38, s96
  v_cvt_pk_bf16_f32 v226, v244, v245
  v_cvt_pk_bf16_f32 v227, v246, v247
  v_mfma_f32_16x16x32_bf16 v[48:51], a[132:135], a[16:19], v[48:51]
  s_add_u32 m0, s37, 32768
  ds_read_b64_tr_b16 a[166:167], v25 offset:10784
  buffer_store_dwordx4 v[224:227], v9, s[20:23], 0 offen sc1
  v_mfma_f32_16x16x32_bf16 v[48:51], a[128:131], a[0:3], v[48:51]
  s_waitcnt lgkmcnt(4)
  v_mul_f32 v248, v232, v248
  v_mul_f32 v249, v233, v249
  v_mfma_f32_16x16x32_bf16 v[48:51], a[144:147], a[184:187], v[48:51]
  ds_read_b64_tr_b16 a[128:129], v25 offset:14368
  buffer_load_dwordx4 v4, s[12:15], s38 offen offset:0 lds
  v_mfma_f32_16x16x32_bf16 v[48:51], a[148:151], a[200:203], v[48:51]
  v_mul_f32_e64 v250, v234, v250
  v_mul_f32 v251, v235, v251
  v_mfma_f32_16x16x32_bf16 v[48:51], a[152:155], a[96:99], v[48:51]
  ds_read_b64_tr_b16 a[130:131], v25 offset:17952
  v_mul_f32 v252, v236, v252
  v_mfma_f32_16x16x32_bf16 v[48:51], a[156:159], a[112:115], v[48:51]
  v_mul_f32 v253, v237, v253
  v_mul_f32 v254, v238, v254
  v_mfma_f32_16x16x32_bf16 v[52:55], a[156:159], a[116:119], v[52:55]
  ds_read_b64_tr_b16 a[132:133], v25 offset:21536
  buffer_load_dwordx4 v5, s[12:15], s38 offen offset:1024 lds
  v_mfma_f32_16x16x32_bf16 v[52:55], a[152:155], a[100:103], v[52:55]
  v_mul_f32 v255, v239, v255
  v_cvt_pk_bf16_f32 v232, v248, v249
  v_mfma_f32_16x16x32_bf16 v[52:55], a[148:151], a[204:207], v[52:55]
  ds_read_b64_tr_b16 a[134:135], v25 offset:25120
  v_cvt_pk_bf16_f32 v233, v250, v251
  v_mfma_f32_16x16x32_bf16 v[52:55], a[144:147], a[188:191], v[52:55]
  v_cvt_pk_bf16_f32 v234, v252, v253
  v_cvt_pk_bf16_f32 v235, v254, v255
  v_mfma_f32_16x16x32_bf16 v[56:59], a[144:147], a[192:195], v[56:59]
  ds_read_b64_tr_b16 a[136:137], v25 offset:32800
  buffer_load_dwordx4 v6, s[12:15], s38 offen offset:2048 lds
  v_mfma_f32_16x16x32_bf16 v[56:59], a[148:151], a[208:211], v[56:59]
  buffer_store_dwordx4 v[232:235], v9, s[20:23], s75 offen sc1
  v_fma_f32 v68, v68, v19, v19
  v_mfma_f32_16x16x32_bf16 v[56:59], a[152:155], a[104:107], v[56:59]
  ds_read_b64_tr_b16 a[138:139], v25 offset:36384
  v_mul_f32 v69, v18, v69
  v_mfma_f32_16x16x32_bf16 v[56:59], a[156:159], a[120:123], v[56:59]
  v_rcp_f32 v68, v68
  v_mfma_f32_16x16x32_bf16 v[60:63], a[156:159], a[124:127], v[60:63]
  ds_read_b64_tr_b16 a[140:141], v25 offset:39968
  buffer_load_dwordx4 v7, s[12:15], s38 offen offset:3072 lds
  v_mfma_f32_16x16x32_bf16 v[60:63], a[152:155], a[108:111], v[60:63]
  s_add_u32 s38, s38, s96
  v_exp_f32 v69, v69
  v_mfma_f32_16x16x32_bf16 v[60:63], a[148:151], a[212:215], v[60:63]
  s_add_u32 m0, s37, 49152
  ds_read_b64_tr_b16 a[142:143], v25 offset:43552
  v_fma_f32 v69, v69, v19, v19
  v_mfma_f32_16x16x32_bf16 v[60:63], a[144:147], a[196:199], v[60:63]
  s_waitcnt lgkmcnt(4)
  v_rcp_f32 v69, v69
  v_mfma_f32_16x16x32_bf16 v[92:95], a[160:163], a[12:15], v[92:95]
  ds_read_b64_tr_b16 a[144:145], v25 offset:47136
  buffer_load_dwordx4 v4, s[12:15], s38 offen offset:0 lds
  v_mfma_f32_16x16x32_bf16 v[92:95], a[164:167], a[28:31], v[92:95]
  v_mul_f32 v70, v18, v70
  v_mul_f32 v71, v18, v71
  v_mfma_f32_16x16x32_bf16 v[92:95], a[128:131], a[44:47], v[92:95]
  ds_read_b64_tr_b16 a[146:147], v25 offset:50720
  v_mul_f32 v40, v20, v40
  v_mfma_f32_16x16x32_bf16 v[92:95], a[132:135], a[60:63], v[92:95]
  v_exp_f32 v70, v70
  v_mfma_f32_16x16x32_bf16 v[88:91], a[132:135], a[56:59], v[88:91]
  ds_read_b64_tr_b16 a[148:149], v25 offset:54304
  buffer_load_dwordx4 v5, s[12:15], s38 offen offset:1024 lds
  v_mfma_f32_16x16x32_bf16 v[88:91], a[128:131], a[40:43], v[88:91]
  v_exp_f32 v71, v71
  v_mfma_f32_16x16x32_bf16 v[88:91], a[164:167], a[24:27], v[88:91]
  ds_read_b64_tr_b16 a[150:151], v25 offset:57888
  v_mul_f32 v48, v32, v48
  v_mfma_f32_16x16x32_bf16 v[88:91], a[160:163], a[8:11], v[88:91]
  v_exp_f32 v40, v40
  v_mfma_f32_16x16x32_bf16 v[84:87], a[160:163], a[4:7], v[84:87]
  ds_read_b64_tr_b16 a[152:153], v25 offset:64
  buffer_load_dwordx4 v6, s[12:15], s38 offen offset:2048 lds
  v_mfma_f32_16x16x32_bf16 v[84:87], a[164:167], a[20:23], v[84:87]
  v_mul_f32_e64 v49, v33, v49
  v_mul_f32 v50, v34, v50
  v_mfma_f32_16x16x32_bf16 v[84:87], a[128:131], a[36:39], v[84:87]
  ds_read_b64_tr_b16 a[154:155], v25 offset:3648
  v_mul_f32 v51, v35, v51
  v_mfma_f32_16x16x32_bf16 v[84:87], a[132:135], a[52:55], v[84:87]
  v_mul_f32 v52, v36, v52
  v_mul_f32 v53, v37, v53
  v_mfma_f32_16x16x32_bf16 v[80:83], a[132:135], a[48:51], v[80:83]
  ds_read_b64_tr_b16 a[156:157], v25 offset:7232
  buffer_load_dwordx4 v7, s[12:15], s38 offen offset:3072 lds
  v_mfma_f32_16x16x32_bf16 v[80:83], a[128:131], a[32:35], v[80:83]
  s_add_u32 s38, s38, s96
  v_mul_f32 v54, v38, v54
  v_mul_f32 v55, v39, v55
  v_mfma_f32_16x16x32_bf16 v[80:83], a[164:167], a[16:19], v[80:83]
  s_add_u32 m0, s37, 131072
  ds_read_b64_tr_b16 a[158:159], v25 offset:10816
  v_fma_f32 v70, v70, v19, v19
  v_mfma_f32_16x16x32_bf16 v[80:83], a[160:163], a[0:3], v[80:83]
  s_waitcnt lgkmcnt(4)
  v_rcp_f32 v70, v70
  v_mfma_f32_16x16x32_bf16 v[80:83], a[136:139], a[184:187], v[80:83]
  ds_read_b64_tr_b16 a[160:161], v25 offset:14400
  buffer_load_dwordx4 v4, s[12:15], s38 offen offset:0 lds
  v_mfma_f32_16x16x32_bf16 v[80:83], a[140:143], a[200:203], v[80:83]
  v_fma_f32 v71, v71, v19, v19
  v_fma_f32 v40, v40, v21, v21
  v_mfma_f32_16x16x32_bf16 v[80:83], a[144:147], a[96:99], v[80:83]
  ds_read_b64_tr_b16 a[162:163], v25 offset:17984
  v_mul_f32 v41, v20, v41
  v_mfma_f32_16x16x32_bf16 v[80:83], a[148:151], a[112:115], v[80:83]
  v_rcp_f32 v71, v71
  v_mfma_f32_16x16x32_bf16 v[84:87], a[148:151], a[116:119], v[84:87]
  ds_read_b64_tr_b16 a[164:165], v25 offset:21568
  buffer_load_dwordx4 v5, s[12:15], s38 offen offset:1024 lds
  v_mfma_f32_16x16x32_bf16 v[84:87], a[144:147], a[100:103], v[84:87]
  v_rcp_f32 v40, v40
  v_mfma_f32_16x16x32_bf16 v[84:87], a[140:143], a[204:207], v[84:87]
  ds_read_b64_tr_b16 a[166:167], v25 offset:25152
  v_mul_f32 v56, v40, v56
  v_mfma_f32_16x16x32_bf16 v[84:87], a[136:139], a[188:191], v[84:87]
  v_exp_f32 v41, v41
  v_mfma_f32_16x16x32_bf16 v[88:91], a[136:139], a[192:195], v[88:91]
  ds_read_b64_tr_b16 a[128:129], v25 offset:32832
  buffer_load_dwordx4 v6, s[12:15], s38 offen offset:2048 lds
  v_mfma_f32_16x16x32_bf16 v[88:91], a[140:143], a[208:211], v[88:91]
  v_fma_f32 v41, v41, v21, v21
  v_mul_f32 v42, v20, v42
  v_mfma_f32_16x16x32_bf16 v[88:91], a[144:147], a[104:107], v[88:91]
  ds_read_b64_tr_b16 a[130:131], v25 offset:36416
  v_mul_f32 v43, v20, v43
  v_mfma_f32_16x16x32_bf16 v[88:91], a[148:151], a[120:123], v[88:91]
  v_rcp_f32 v41, v41
  v_mfma_f32_16x16x32_bf16 v[92:95], a[148:151], a[124:127], v[92:95]
  ds_read_b64_tr_b16 a[132:133], v25 offset:40000
  buffer_load_dwordx4 v7, s[12:15], s38 offen offset:3072 lds
  v_mfma_f32_16x16x32_bf16 v[92:95], a[144:147], a[108:111], v[92:95]
  s_add_u32 s38, s38, s96
  v_exp_f32 v42, v42
  v_mfma_f32_16x16x32_bf16 v[92:95], a[140:143], a[212:215], v[92:95]
  s_add_u32 m0, s37, 147456
  ds_read_b64_tr_b16 a[134:135], v25 offset:43584
  v_mul_f32 v57, v41, v57
  v_mfma_f32_16x16x32_bf16 v[92:95], a[136:139], a[196:199], v[92:95]
  s_waitcnt lgkmcnt(4)
  v_exp_f32 v43, v43
  v_mfma_f32_16x16x32_bf16 v[124:127], a[152:155], a[12:15], v[124:127]
  ds_read_b64_tr_b16 a[136:137], v25 offset:47168
  buffer_load_dwordx4 v4, s[12:15], s38 offen offset:0 lds
  v_mfma_f32_16x16x32_bf16 v[124:127], a[156:159], a[28:31], v[124:127]
  v_fma_f32 v42, v42, v21, v21
  v_fma_f32 v43, v43, v21, v21
  v_mfma_f32_16x16x32_bf16 v[124:127], a[160:163], a[44:47], v[124:127]
  ds_read_b64_tr_b16 a[138:139], v25 offset:50752
  v_mul_f32 v72, v20, v72
  v_mfma_f32_16x16x32_bf16 v[124:127], a[164:167], a[60:63], v[124:127]
  v_rcp_f32 v42, v42
  v_mfma_f32_16x16x32_bf16 v[120:123], a[164:167], a[56:59], v[120:123]
  ds_read_b64_tr_b16 a[140:141], v25 offset:54336
  buffer_load_dwordx4 v5, s[12:15], s38 offen offset:1024 lds
  v_mfma_f32_16x16x32_bf16 v[120:123], a[160:163], a[40:43], v[120:123]
  v_rcp_f32 v43, v43
  v_mfma_f32_16x16x32_bf16 v[120:123], a[156:159], a[24:27], v[120:123]
  ds_read_b64_tr_b16 a[142:143], v25 offset:57920
  v_mul_f32_e64 v80, v64, v80
  v_mfma_f32_16x16x32_bf16 v[120:123], a[152:155], a[8:11], v[120:123]
  v_exp_f32 v72, v72
  v_mfma_f32_16x16x32_bf16 v[116:119], a[152:155], a[4:7], v[116:119]
  ds_read_b64_tr_b16 a[144:145], v25 offset:96
  buffer_load_dwordx4 v6, s[12:15], s38 offen offset:2048 lds
  v_mfma_f32_16x16x32_bf16 v[116:119], a[156:159], a[20:23], v[116:119]
  v_mul_f32 v81, v65, v81
  v_mul_f32 v82, v66, v82
  v_mfma_f32_16x16x32_bf16 v[116:119], a[160:163], a[36:39], v[116:119]
  ds_read_b64_tr_b16 a[146:147], v25 offset:3680
  v_mul_f32 v83, v67, v83
  v_mfma_f32_16x16x32_bf16 v[116:119], a[164:167], a[52:55], v[116:119]
  v_cvt_pk_bf16_f32 v32, v48, v49
  v_cvt_pk_bf16_f32 v33, v50, v51
  v_mfma_f32_16x16x32_bf16 v[112:115], a[164:167], a[48:51], v[112:115]
  ds_read_b64_tr_b16 a[148:149], v25 offset:7264
  buffer_load_dwordx4 v7, s[12:15], s38 offen offset:3072 lds
  v_mfma_f32_16x16x32_bf16 v[112:115], a[160:163], a[32:35], v[112:115]
  s_add_u32 s38, s38, s96
  v_cvt_pk_bf16_f32 v34, v80, v81
  v_cvt_pk_bf16_f32 v35, v82, v83
  v_mfma_f32_16x16x32_bf16 v[112:115], a[156:159], a[16:19], v[112:115]
  ds_read_b64_tr_b16 a[150:151], v25 offset:10848
  buffer_store_dwordx4 v[32:35], v11, s[20:23], 0 offen offset:0 sc1
  v_mfma_f32_16x16x32_bf16 v[112:115], a[152:155], a[0:3], v[112:115]
  s_waitcnt lgkmcnt(4)
  v_mul_f32 v84, v68, v84
  v_mul_f32 v85, v69, v85
  v_mfma_f32_16x16x32_bf16 v[112:115], a[128:131], a[184:187], v[112:115]
  ds_read_b64_tr_b16 a[152:153], v25 offset:14432
  v_mul_f32 v86, v70, v86
  v_mfma_f32_16x16x32_bf16 v[112:115], a[132:135], a[200:203], v[112:115]
  v_mul_f32 v87, v71, v87
  v_cvt_pk_bf16_f32 v36, v52, v53
  v_mfma_f32_16x16x32_bf16 v[112:115], a[136:139], a[96:99], v[112:115]
  ds_read_b64_tr_b16 a[154:155], v25 offset:18016
  v_cvt_pk_bf16_f32 v37, v54, v55
  v_mfma_f32_16x16x32_bf16 v[112:115], a[140:143], a[112:115], v[112:115]
  v_cvt_pk_bf16_f32 v38, v84, v85
  v_cvt_pk_bf16_f32 v39, v86, v87
  v_mfma_f32_16x16x32_bf16 v[116:119], a[140:143], a[116:119], v[116:119]
  ds_read_b64_tr_b16 a[156:157], v25 offset:21600
  buffer_store_dwordx4 v[36:39], v11, s[20:23], s74 offen offset:0 sc1
  v_mfma_f32_16x16x32_bf16 v[116:119], a[136:139], a[100:103], v[116:119]
  v_mul_f32 v58, v42, v58
  v_mul_f32 v59, v43, v59
  v_mfma_f32_16x16x32_bf16 v[116:119], a[132:135], a[204:207], v[116:119]
  ds_read_b64_tr_b16 a[158:159], v25 offset:25184
  v_fma_f32 v72, v72, v21, v21
  v_mfma_f32_16x16x32_bf16 v[116:119], a[128:131], a[188:191], v[116:119]
  v_rcp_f32 v72, v72
  v_mfma_f32_16x16x32_bf16 v[120:123], a[128:131], a[192:195], v[120:123]
  ds_read_b64_tr_b16 a[160:161], v25 offset:32864
  v_mul_f32 v88, v72, v88
  v_mfma_f32_16x16x32_bf16 v[120:123], a[132:135], a[208:211], v[120:123]
  v_mul_f32 v73, v20, v73
  v_mul_f32 v74, v20, v74
  v_mfma_f32_16x16x32_bf16 v[120:123], a[136:139], a[104:107], v[120:123]
  ds_read_b64_tr_b16 a[162:163], v25 offset:36448
  v_mul_f32_e64 v75, v20, v75
  v_mfma_f32_16x16x32_bf16 v[120:123], a[140:143], a[120:123], v[120:123]
  v_exp_f32 v73, v73
  v_mfma_f32_16x16x32_bf16 v[124:127], a[140:143], a[124:127], v[124:127]
  ds_read_b64_tr_b16 a[164:165], v25 offset:40032
  v_fma_f32 v73, v73, v21, v21
  v_mfma_f32_16x16x32_bf16 v[124:127], a[136:139], a[108:111], v[124:127]
  v_rcp_f32 v73, v73
  v_mfma_f32_16x16x32_bf16 v[124:127], a[132:135], a[212:215], v[124:127]
  ds_read_b64_tr_b16 a[166:167], v25 offset:43616
  v_mul_f32 v89, v73, v89
  v_mfma_f32_16x16x32_bf16 v[124:127], a[128:131], a[196:199], v[124:127]
  s_waitcnt lgkmcnt(4)
  v_exp_f32 v74, v74
  v_mfma_f32_16x16x32_bf16 v[156:159], a[144:147], a[12:15], v[156:159]
  ds_read_b64_tr_b16 a[128:129], v25 offset:47200
  v_fma_f32 v74, v74, v21, v21
  v_mfma_f32_16x16x32_bf16 v[156:159], a[148:151], a[28:31], v[156:159]
  v_rcp_f32 v74, v74
  v_mfma_f32_16x16x32_bf16 v[156:159], a[152:155], a[44:47], v[156:159]
L_pad_2b_6:
  s_cbranch_execz L_ret_2b
  ds_read_b64_tr_b16 a[130:131], v25 offset:50784
  v_mul_f32 v90, v74, v90
  v_mfma_f32_16x16x32_bf16 v[156:159], a[156:159], a[60:63], v[156:159]
  v_exp_f32_e64 v75, v75
  v_mfma_f32_16x16x32_bf16 v[152:155], a[156:159], a[56:59], v[152:155]
  ds_read_b64_tr_b16 a[132:133], v25 offset:54368
  v_fma_f32 v75, v75, v21, v21
  v_mfma_f32_16x16x32_bf16 v[152:155], a[152:155], a[40:43], v[152:155]
  v_rcp_f32 v75, v75
  v_mfma_f32_16x16x32_bf16 v[152:155], a[148:151], a[24:27], v[152:155]
  ds_read_b64_tr_b16 a[134:135], v25 offset:57952
  v_mul_f32 v91, v75, v91
  v_mfma_f32_16x16x32_bf16 v[152:155], a[144:147], a[8:11], v[152:155]
  v_cvt_pk_bf16_f32 v40, v56, v57
  v_cvt_pk_bf16_f32 v41, v58, v59
  v_mfma_f32_16x16x32_bf16 v[148:151], a[144:147], a[4:7], v[148:151]
  ds_read_b64_tr_b16 a[136:137], v25 offset:128
  v_cvt_pk_bf16_f32 v42, v88, v89
  v_mfma_f32_16x16x32_bf16 v[148:151], a[148:151], a[20:23], v[148:151]
  v_cvt_pk_bf16_f32 v43, v90, v91
  buffer_store_dwordx4 v[40:43], v11, s[20:23], s75 offen offset:0 sc1
  v_mfma_f32_16x16x32_bf16 v[148:151], a[152:155], a[36:39], v[148:151]
  ds_read_b64_tr_b16 a[138:139], v25 offset:3712
  v_mul_f32 v44, v22, v44
  v_mfma_f32_16x16x32_bf16 v[148:151], a[156:159], a[52:55], v[148:151]
  v_exp_f32 v44, v44
  v_mfma_f32_16x16x32_bf16 v[144:147], a[156:159], a[48:51], v[144:147]
  ds_read_b64_tr_b16 a[140:141], v25 offset:7296
  v_fma_f32 v44, v44, v23, v23
  v_mfma_f32_16x16x32_bf16 v[144:147], a[152:155], a[32:35], v[144:147]
  v_rcp_f32 v44, v44
  v_mfma_f32_16x16x32_bf16 v[144:147], a[148:151], a[16:19], v[144:147]
  ds_read_b64_tr_b16 a[142:143], v25 offset:10880
  v_mul_f32 v60, v44, v60
  v_mfma_f32_16x16x32_bf16 v[144:147], a[144:147], a[0:3], v[144:147]
  s_waitcnt lgkmcnt(4)
  v_mul_f32 v45, v22, v45
  v_mul_f32 v46, v22, v46
  v_mfma_f32_16x16x32_bf16 v[144:147], a[160:163], a[184:187], v[144:147]
  ds_read_b64_tr_b16 a[144:145], v25 offset:14464
  v_mul_f32 v47, v22, v47
  v_mfma_f32_16x16x32_bf16 v[144:147], a[164:167], a[200:203], v[144:147]
  v_exp_f32 v45, v45
  v_mfma_f32_16x16x32_bf16 v[144:147], a[128:131], a[96:99], v[144:147]
  ds_read_b64_tr_b16 a[146:147], v25 offset:18048
  v_fma_f32 v45, v45, v23, v23
  v_mfma_f32_16x16x32_bf16 v[144:147], a[132:135], a[112:115], v[144:147]
  v_rcp_f32 v45, v45
  v_mfma_f32_16x16x32_bf16 v[148:151], a[132:135], a[116:119], v[148:151]
  ds_read_b64_tr_b16 a[148:149], v25 offset:21632
  v_mul_f32 v61, v45, v61
  v_mfma_f32_16x16x32_bf16 v[148:151], a[128:131], a[100:103], v[148:151]
  v_exp_f32 v46, v46
  v_mfma_f32_16x16x32_bf16 v[148:151], a[164:167], a[204:207], v[148:151]
  ds_read_b64_tr_b16 a[150:151], v25 offset:25216
  v_fma_f32 v46, v46, v23, v23
  v_mfma_f32_16x16x32_bf16 v[148:151], a[160:163], a[188:191], v[148:151]
  v_rcp_f32 v46, v46
  v_mfma_f32_16x16x32_bf16 v[152:155], a[160:163], a[192:195], v[152:155]
  ds_read_b64_tr_b16 a[152:153], v25 offset:32896
  v_mul_f32 v62, v46, v62
  v_mfma_f32_16x16x32_bf16 v[152:155], a[164:167], a[208:211], v[152:155]
  v_exp_f32 v47, v47
  v_mfma_f32_16x16x32_bf16 v[152:155], a[128:131], a[104:107], v[152:155]
  ds_read_b64_tr_b16 a[154:155], v25 offset:36480
  v_fma_f32 v47, v47, v23, v23
  v_mfma_f32_16x16x32_bf16 v[152:155], a[132:135], a[120:123], v[152:155]
  v_rcp_f32 v47, v47
  v_mfma_f32_16x16x32_bf16 v[156:159], a[132:135], a[124:127], v[156:159]
  ds_read_b64_tr_b16 a[156:157], v25 offset:40064
  v_mul_f32 v63, v47, v63
  v_mfma_f32_16x16x32_bf16 v[156:159], a[128:131], a[108:111], v[156:159]
  v_mul_f32_e64 v76, v22, v76
  v_mul_f32 v77, v22, v77
  v_mfma_f32_16x16x32_bf16 v[156:159], a[164:167], a[212:215], v[156:159]
  ds_read_b64_tr_b16 a[158:159], v25 offset:43648
  v_mul_f32 v78, v22, v78
  v_mfma_f32_16x16x32_bf16 v[156:159], a[160:163], a[196:199], v[156:159]
  s_waitcnt lgkmcnt(4)
  v_exp_f32 v76, v76
  v_mfma_f32_16x16x32_bf16 v[188:191], a[136:139], a[12:15], v[188:191]
  ds_read_b64_tr_b16 a[160:161], v25 offset:47232
  v_fma_f32 v76, v76, v23, v23
  v_mfma_f32_16x16x32_bf16 v[188:191], a[140:143], a[28:31], v[188:191]
  v_rcp_f32 v76, v76
  v_mfma_f32_16x16x32_bf16 v[188:191], a[144:147], a[44:47], v[188:191]
  ds_read_b64_tr_b16 a[162:163], v25 offset:50816
  v_mul_f32_e64 v92, v76, v92
  v_mfma_f32_16x16x32_bf16 v[188:191], a[148:151], a[60:63], v[188:191]
  v_exp_f32 v77, v77
  v_mfma_f32_16x16x32_bf16 v[184:187], a[148:151], a[56:59], v[184:187]
  ds_read_b64_tr_b16 a[164:165], v25 offset:54400
  v_fma_f32 v77, v77, v23, v23
  v_mfma_f32_16x16x32_bf16 v[184:187], a[144:147], a[40:43], v[184:187]
  v_rcp_f32 v77, v77
  v_mfma_f32_16x16x32_bf16 v[184:187], a[140:143], a[24:27], v[184:187]
  ds_read_b64_tr_b16 a[166:167], v25 offset:57984
  v_mul_f32 v93, v77, v93
  v_mfma_f32_16x16x32_bf16 v[184:187], a[136:139], a[8:11], v[184:187]
  v_exp_f32 v78, v78
  v_mfma_f32_16x16x32_bf16 v[180:183], a[136:139], a[4:7], v[180:183]
  ds_read_b64_tr_b16 a[128:129], v25 offset:160
  v_fma_f32 v78, v78, v23, v23
  v_mfma_f32_16x16x32_bf16 v[180:183], a[140:143], a[20:23], v[180:183]
  v_rcp_f32 v78, v78
  v_mfma_f32_16x16x32_bf16 v[180:183], a[144:147], a[36:39], v[180:183]
  ds_read_b64_tr_b16 a[130:131], v25 offset:3744
  v_mul_f32 v94, v78, v94
  v_mfma_f32_16x16x32_bf16 v[180:183], a[148:151], a[52:55], v[180:183]
  v_mul_f32 v79, v22, v79
  v_mul_f32 v96, v16, v96
  v_mfma_f32_16x16x32_bf16 v[176:179], a[148:151], a[48:51], v[176:179]
  ds_read_b64_tr_b16 a[132:133], v25 offset:7328
  v_mul_f32 v97, v16, v97
  v_mfma_f32_16x16x32_bf16 v[176:179], a[144:147], a[32:35], v[176:179]
  v_exp_f32 v79, v79
  v_mfma_f32_16x16x32_bf16 v[176:179], a[140:143], a[16:19], v[176:179]
  ds_read_b64_tr_b16 a[134:135], v25 offset:10912
  v_fma_f32 v79, v79, v23, v23
  v_mfma_f32_16x16x32_bf16 v[176:179], a[136:139], a[0:3], v[176:179]
  s_waitcnt lgkmcnt(4)
  v_rcp_f32 v79, v79
  v_mfma_f32_16x16x32_bf16 v[176:179], a[152:155], a[184:187], v[176:179]
  ds_read_b64_tr_b16 a[136:137], v25 offset:14496
  v_mul_f32 v95, v79, v95
  v_mfma_f32_16x16x32_bf16 v[176:179], a[156:159], a[200:203], v[176:179]
  v_exp_f32 v96, v96
  v_mfma_f32_16x16x32_bf16 v[176:179], a[160:163], a[96:99], v[176:179]
  ds_read_b64_tr_b16 a[138:139], v25 offset:18080
  v_cvt_pk_bf16_f32 v44, v60, v61
  v_mfma_f32_16x16x32_bf16 v[176:179], a[164:167], a[112:115], v[176:179]
  v_exp_f32 v97, v97
  v_mfma_f32_16x16x32_bf16 v[180:183], a[164:167], a[116:119], v[180:183]
  ds_read_b64_tr_b16 a[140:141], v25 offset:21664
  v_cvt_pk_bf16_f32 v45, v62, v63
  v_mfma_f32_16x16x32_bf16 v[180:183], a[160:163], a[100:103], v[180:183]
  v_cvt_pk_bf16_f32 v46, v92, v93
  v_cvt_pk_bf16_f32 v47, v94, v95
  v_mfma_f32_16x16x32_bf16 v[180:183], a[156:159], a[204:207], v[180:183]
  ds_read_b64_tr_b16 a[142:143], v25 offset:25248
  buffer_store_dwordx4 v[44:47], v11, s[20:23], s76 offen offset:0 sc1
  v_mfma_f32_16x16x32_bf16 v[180:183], a[152:155], a[188:191], v[180:183]
  v_fma_f32 v96, v96, v17, v17
  v_fma_f32 v97, v97, v17, v17
  v_mfma_f32_16x16x32_bf16 v[184:187], a[152:155], a[192:195], v[184:187]
  ds_read_b64_tr_b16 a[144:145], v25 offset:32928
  v_mul_f32 v98, v16, v98
  v_mfma_f32_16x16x32_bf16 v[184:187], a[156:159], a[208:211], v[184:187]
  v_rcp_f32 v96, v96
  v_mfma_f32_16x16x32_bf16 v[184:187], a[160:163], a[104:107], v[184:187]
  ds_read_b64_tr_b16 a[146:147], v25 offset:36512
  v_mul_f32 v112, v96, v112
  v_mfma_f32_16x16x32_bf16 v[184:187], a[164:167], a[120:123], v[184:187]
  v_rcp_f32 v97, v97
  v_mfma_f32_16x16x32_bf16 v[188:191], a[164:167], a[124:127], v[188:191]
  ds_read_b64_tr_b16 a[148:149], v25 offset:40096
  v_mul_f32 v113, v97, v113
  v_mfma_f32_16x16x32_bf16 v[188:191], a[160:163], a[108:111], v[188:191]
  v_exp_f32 v98, v98
  v_mfma_f32_16x16x32_bf16 v[188:191], a[156:159], a[212:215], v[188:191]
  ds_read_b64_tr_b16 a[150:151], v25 offset:43680
  v_fma_f32 v98, v98, v17, v17
  v_mfma_f32_16x16x32_bf16 v[188:191], a[152:155], a[196:199], v[188:191]
  s_waitcnt lgkmcnt(4)
  v_rcp_f32 v98, v98
  v_mfma_f32_16x16x32_bf16 v[220:223], a[128:131], a[12:15], v[220:223]
  ds_read_b64_tr_b16 a[152:153], v25 offset:47264
  v_mul_f32 v114, v98, v114
  v_mfma_f32_16x16x32_bf16 v[220:223], a[132:135], a[28:31], v[220:223]
  v_mul_f32 v99, v16, v99
  v_mul_f32 v128, v16, v128
  v_mfma_f32_16x16x32_bf16 v[220:223], a[136:139], a[44:47], v[220:223]
  ds_read_b64_tr_b16 a[154:155], v25 offset:50848
  v_mul_f32 v129, v16, v129
  v_mfma_f32_16x16x32_bf16 v[220:223], a[140:143], a[60:63], v[220:223]
  v_exp_f32 v99, v99
  v_mfma_f32_16x16x32_bf16 v[216:219], a[140:143], a[56:59], v[216:219]
  ds_read_b64_tr_b16 a[156:157], v25 offset:54432
  v_fma_f32 v99, v99, v17, v17
  v_mfma_f32_16x16x32_bf16 v[216:219], a[136:139], a[40:43], v[216:219]
  v_rcp_f32 v99, v99
  v_mfma_f32_16x16x32_bf16 v[216:219], a[132:135], a[24:27], v[216:219]
  ds_read_b64_tr_b16 a[158:159], v25 offset:58016
  v_mul_f32 v115, v99, v115
  v_mfma_f32_16x16x32_bf16 v[216:219], a[128:131], a[8:11], v[216:219]
  v_exp_f32 v128, v128
  v_mfma_f32_16x16x32_bf16 v[212:215], a[128:131], a[4:7], v[212:215]
  v_exp_f32 v129, v129
  v_mfma_f32_16x16x32_bf16 v[212:215], a[132:135], a[20:23], v[212:215]
  v_fma_f32 v128, v128, v17, v17
  v_fma_f32 v129, v129, v17, v17
  v_mfma_f32_16x16x32_bf16 v[212:215], a[136:139], a[36:39], v[212:215]
  v_rcp_f32 v128, v128
  v_mfma_f32_16x16x32_bf16 v[212:215], a[140:143], a[52:55], v[212:215]
  v_rcp_f32 v129, v129
  v_mfma_f32_16x16x32_bf16 v[208:211], a[140:143], a[48:51], v[208:211]
  v_mul_f32 v144, v128, v144
  v_mul_f32 v145, v129, v145
  v_mfma_f32_16x16x32_bf16 v[208:211], a[136:139], a[32:35], v[208:211]
  v_mul_f32 v130, v16, v130
  v_mul_f32 v131, v16, v131
  v_mfma_f32_16x16x32_bf16 v[208:211], a[132:135], a[16:19], v[208:211]
  v_exp_f32_e64 v130, v130
  v_mfma_f32_16x16x32_bf16 v[208:211], a[128:131], a[0:3], v[208:211]
  s_waitcnt lgkmcnt(0)
  v_exp_f32 v131, v131
  v_mfma_f32_16x16x32_bf16 v[208:211], a[144:147], a[184:187], v[208:211]
  v_fma_f32 v130, v130, v17, v17
  v_fma_f32 v131, v131, v17, v17
  v_mfma_f32_16x16x32_bf16 v[208:211], a[148:151], a[200:203], v[208:211]
  v_rcp_f32 v130, v130
  v_mfma_f32_16x16x32_bf16 v[208:211], a[152:155], a[96:99], v[208:211]
  v_rcp_f32 v131, v131
  v_mfma_f32_16x16x32_bf16 v[208:211], a[156:159], a[112:115], v[208:211]
  v_mul_f32 v146, v130, v146
  v_mul_f32 v147, v131, v147
  v_mfma_f32_16x16x32_bf16 v[212:215], a[156:159], a[116:119], v[212:215]
  v_cvt_pk_bf16_f32 v96, v112, v113
  v_cvt_pk_bf16_f32 v97, v114, v115
  v_mfma_f32_16x16x32_bf16 v[212:215], a[152:155], a[100:103], v[212:215]
  v_cvt_pk_bf16_f32 v98, v144, v145
  v_cvt_pk_bf16_f32 v99, v146, v147
  v_mfma_f32_16x16x32_bf16 v[212:215], a[148:151], a[204:207], v[212:215]
  buffer_store_dwordx4 v[96:99], v11, s[20:23], 0 offen offset:2048 sc1
  v_mul_f32 v100, v18, v100
  v_mfma_f32_16x16x32_bf16 v[212:215], a[144:147], a[188:191], v[212:215]
  v_exp_f32 v100, v100
  v_mfma_f32_16x16x32_bf16 v[216:219], a[144:147], a[192:195], v[216:219]
  v_fma_f32 v100, v100, v19, v19
  v_mul_f32 v101, v18, v101
  v_mfma_f32_16x16x32_bf16 v[216:219], a[148:151], a[208:211], v[216:219]
  v_rcp_f32 v100, v100
  v_mfma_f32_16x16x32_bf16 v[216:219], a[152:155], a[104:107], v[216:219]
  v_exp_f32 v101, v101
  v_mfma_f32_16x16x32_bf16 v[216:219], a[156:159], a[120:123], v[216:219]
  v_mul_f32 v116, v100, v116
  v_fma_f32 v101, v101, v19, v19
  v_mfma_f32_16x16x32_bf16 v[220:223], a[156:159], a[124:127], v[220:223]
  v_rcp_f32 v101, v101
  v_mfma_f32_16x16x32_bf16 v[220:223], a[152:155], a[108:111], v[220:223]
  v_mul_f32_e64 v117, v101, v117
  v_mul_f32 v102, v18, v102
  v_mfma_f32_16x16x32_bf16 v[220:223], a[148:151], a[212:215], v[220:223]
  v_exp_f32 v102, v102
  v_mfma_f32_16x16x32_bf16 v[220:223], a[144:147], a[196:199], v[220:223]
  v_fma_f32 v102, v102, v19, v19
  v_mul_f32 v103, v18, v103
L_p3u:
  v_pk_mul_f32 v[132:133], v[132:133], v[18:19] op_sel_hi:[1,0]
  v_pk_mul_f32 v[134:135], v[134:135], v[18:19] op_sel_hi:[1,0]
  v_exp_f32 v103, v103
  v_exp_f32 v132, v132
  v_exp_f32 v133, v133
  v_exp_f32 v134, v134
  v_exp_f32 v135, v135
  v_fma_f32 v103, v103, v19, v19
  v_pk_fma_f32 v[132:133], v[132:133], v[18:19], v[18:19] op_sel:[0,1,1] op_sel_hi:[1,1,1]
  v_pk_fma_f32 v[134:135], v[134:135], v[18:19], v[18:19] op_sel:[0,1,1] op_sel_hi:[1,1,1]
  v_rcp_f32 v102, v102
  v_rcp_f32 v103, v103
  v_rcp_f32 v132, v132
  v_rcp_f32 v133, v133
  v_rcp_f32 v134, v134
  v_rcp_f32_e64 v135, v135
  v_pk_mul_f32 v[118:119], v[118:119], v[102:103]
  v_pk_mul_f32 v[148:149], v[148:149], v[132:133]
  v_pk_mul_f32 v[150:151], v[150:151], v[134:135]
  v_cvt_pk_bf16_f32 v100, v116, v117
  v_cvt_pk_bf16_f32 v101, v118, v119
  v_cvt_pk_bf16_f32 v102, v148, v149
  v_cvt_pk_bf16_f32 v103, v150, v151
  buffer_store_dwordx4 v[100:103], v11, s[20:23], s74 offen offset:2048 sc1
  v_pk_mul_f32 v[104:105], v[104:105], v[20:21] op_sel_hi:[1,0]
  v_pk_mul_f32 v[106:107], v[106:107], v[20:21] op_sel_hi:[1,0]
  v_pk_mul_f32 v[136:137], v[136:137], v[20:21] op_sel_hi:[1,0]
  v_pk_mul_f32 v[138:139], v[138:139], v[20:21] op_sel_hi:[1,0]
  v_exp_f32 v104, v104
  v_exp_f32 v105, v105
  v_exp_f32 v106, v106
  v_exp_f32 v107, v107
  v_exp_f32 v136, v136
  v_exp_f32 v137, v137
  v_exp_f32 v138, v138
  v_exp_f32 v139, v139
  v_pk_fma_f32 v[104:105], v[104:105], v[20:21], v[20:21] op_sel:[0,1,1] op_sel_hi:[1,1,1]
  v_pk_fma_f32 v[106:107], v[106:107], v[20:21], v[20:21] op_sel:[0,1,1] op_sel_hi:[1,1,1]
  v_pk_fma_f32 v[136:137], v[136:137], v[20:21], v[20:21] op_sel:[0,1,1] op_sel_hi:[1,1,1]
  v_pk_fma_f32 v[138:139], v[138:139], v[20:21], v[20:21] op_sel:[0,1,1] op_sel_hi:[1,1,1]
  v_rcp_f32 v104, v104
  v_rcp_f32 v105, v105
  v_rcp_f32 v106, v106
  v_rcp_f32 v107, v107
  v_rcp_f32 v136, v136
  v_rcp_f32 v137, v137
  v_rcp_f32 v138, v138
  v_rcp_f32 v139, v139
  v_pk_mul_f32 v[120:121], v[120:121], v[104:105]
  v_pk_mul_f32 v[122:123], v[122:123], v[106:107]
  v_pk_mul_f32 v[152:153], v[152:153], v[136:137]
  v_pk_mul_f32 v[154:155], v[154:155], v[138:139]
  v_cvt_pk_bf16_f32 v104, v120, v121
  v_cvt_pk_bf16_f32 v105, v122, v123
  v_cvt_pk_bf16_f32 v106, v152, v153
  v_cvt_pk_bf16_f32 v107, v154, v155
  buffer_store_dwordx4 v[104:107], v11, s[20:23], s75 offen offset:2048 sc1
  v_pk_mul_f32 v[108:109], v[108:109], v[22:23] op_sel_hi:[1,0]
  v_pk_mul_f32 v[110:111], v[110:111], v[22:23] op_sel_hi:[1,0]
  v_pk_mul_f32 v[140:141], v[140:141], v[22:23] op_sel_hi:[1,0]
  v_pk_mul_f32 v[142:143], v[142:143], v[22:23] op_sel_hi:[1,0]
  v_exp_f32 v108, v108
  v_exp_f32 v109, v109
  v_exp_f32 v110, v110
  v_exp_f32 v111, v111
  v_exp_f32 v140, v140
  v_exp_f32 v141, v141
  v_exp_f32 v142, v142
  v_exp_f32 v143, v143
  v_pk_fma_f32 v[108:109], v[108:109], v[22:23], v[22:23] op_sel:[0,1,1] op_sel_hi:[1,1,1]
  v_pk_fma_f32 v[110:111], v[110:111], v[22:23], v[22:23] op_sel:[0,1,1] op_sel_hi:[1,1,1]
  v_pk_fma_f32 v[140:141], v[140:141], v[22:23], v[22:23] op_sel:[0,1,1] op_sel_hi:[1,1,1]
  v_pk_fma_f32 v[142:143], v[142:143], v[22:23], v[22:23] op_sel:[0,1,1] op_sel_hi:[1,1,1]
  v_rcp_f32 v108, v108
  v_rcp_f32 v109, v109
  v_rcp_f32 v110, v110
  v_rcp_f32 v111, v111
  v_rcp_f32 v140, v140
  v_rcp_f32 v141, v141
  v_rcp_f32 v142, v142
  v_rcp_f32 v143, v143
  v_pk_mul_f32 v[124:125], v[124:125], v[108:109]
  v_pk_mul_f32 v[126:127], v[126:127], v[110:111]
  v_pk_mul_f32 v[156:157], v[156:157], v[140:141]
  v_pk_mul_f32 v[158:159], v[158:159], v[142:143]
  v_cvt_pk_bf16_f32 v108, v124, v125
  v_cvt_pk_bf16_f32 v109, v126, v127
  v_cvt_pk_bf16_f32 v110, v156, v157
  v_cvt_pk_bf16_f32 v111, v158, v159
  buffer_store_dwordx4 v[108:111], v11, s[20:23], s76 offen offset:2048 sc1
  v_pk_mul_f32 v[160:161], v[160:161], v[16:17] op_sel_hi:[1,0]
  v_pk_mul_f32 v[162:163], v[162:163], v[16:17] op_sel_hi:[1,0]
  v_pk_mul_f32 v[192:193], v[192:193], v[16:17] op_sel_hi:[1,0]
  v_pk_mul_f32 v[194:195], v[194:195], v[16:17] op_sel_hi:[1,0]
  v_exp_f32 v160, v160
  v_exp_f32 v161, v161
  v_exp_f32 v162, v162
  v_exp_f32 v163, v163
  v_exp_f32 v192, v192
  v_exp_f32 v193, v193
  v_exp_f32 v194, v194
  v_exp_f32 v195, v195
  v_pk_fma_f32 v[160:161], v[160:161], v[16:17], v[16:17] op_sel:[0,1,1] op_sel_hi:[1,1,1]
  v_pk_fma_f32 v[162:163], v[162:163], v[16:17], v[16:17] op_sel:[0,1,1] op_sel_hi:[1,1,1]
  v_pk_fma_f32 v[192:193], v[192:193], v[16:17], v[16:17] op_sel:[0,1,1] op_sel_hi:[1,1,1]
  v_pk_fma_f32 v[194:195], v[194:195], v[16:17], v[16:17] op_sel:[0,1,1] op_sel_hi:[1,1,1]
  v_rcp_f32 v160, v160
  v_rcp_f32 v161, v161
  v_rcp_f32 v162, v162
  v_rcp_f32 v163, v163
  v_rcp_f32 v192, v192
  v_rcp_f32 v193, v193
  v_rcp_f32 v194, v194
  v_rcp_f32 v195, v195
  v_pk_mul_f32 v[176:177], v[176:177], v[160:161]
  v_pk_mul_f32 v[178:179], v[178:179], v[162:163]
  v_pk_mul_f32 v[208:209], v[208:209], v[192:193]
  v_pk_mul_f32 v[210:211], v[210:211], v[194:195]
  v_cvt_pk_bf16_f32 v160, v176, v177
  v_cvt_pk_bf16_f32 v161, v178, v179
  v_cvt_pk_bf16_f32 v162, v208, v209
  v_cvt_pk_bf16_f32 v163, v210, v211
  buffer_store_dwordx4 v[160:163], v10, s[20:23], 0 offen offset:0 sc1
  v_pk_mul_f32 v[164:165], v[164:165], v[18:19] op_sel_hi:[1,0]
  v_pk_mul_f32 v[166:167], v[166:167], v[18:19] op_sel_hi:[1,0]
  v_pk_mul_f32 v[196:197], v[196:197], v[18:19] op_sel_hi:[1,0]
  v_pk_mul_f32 v[198:199], v[198:199], v[18:19] op_sel_hi:[1,0]
  v_exp_f32 v164, v164
  v_exp_f32 v165, v165
  v_exp_f32 v166, v166
  v_exp_f32 v167, v167
  v_exp_f32 v196, v196
  v_exp_f32 v197, v197
  v_exp_f32 v198, v198
  v_exp_f32 v199, v199
  v_pk_fma_f32 v[164:165], v[164:165], v[18:19], v[18:19] op_sel:[0,1,1] op_sel_hi:[1,1,1]
  v_pk_fma_f32 v[166:167], v[166:167], v[18:19], v[18:19] op_sel:[0,1,1] op_sel_hi:[1,1,1]
  v_pk_fma_f32 v[196:197], v[196:197], v[18:19], v[18:19] op_sel:[0,1,1] op_sel_hi:[1,1,1]
  v_pk_fma_f32 v[198:199], v[198:199], v[18:19], v[18:19] op_sel:[0,1,1] op_sel_hi:[1,1,1]
  v_rcp_f32 v164, v164
  v_rcp_f32 v165, v165
  v_rcp_f32 v166, v166
  v_rcp_f32 v167, v167
  v_rcp_f32 v196, v196
  v_rcp_f32 v197, v197
  v_rcp_f32 v198, v198
  v_rcp_f32 v199, v199
  v_pk_mul_f32 v[180:181], v[180:181], v[164:165]
  v_pk_mul_f32 v[182:183], v[182:183], v[166:167]
  v_pk_mul_f32 v[212:213], v[212:213], v[196:197]
  v_pk_mul_f32 v[214:215], v[214:215], v[198:199]
  v_cvt_pk_bf16_f32 v164, v180, v181
  v_cvt_pk_bf16_f32 v165, v182, v183
  v_cvt_pk_bf16_f32 v166, v212, v213
  v_cvt_pk_bf16_f32 v167, v214, v215
  buffer_store_dwordx4 v[164:167], v10, s[20:23], s74 offen offset:0 sc1
  v_pk_mul_f32 v[168:169], v[168:169], v[20:21] op_sel_hi:[1,0]
  v_pk_mul_f32 v[170:171], v[170:171], v[20:21] op_sel_hi:[1,0]
  v_pk_mul_f32 v[200:201], v[200:201], v[20:21] op_sel_hi:[1,0]
  v_pk_mul_f32 v[202:203], v[202:203], v[20:21] op_sel_hi:[1,0]
  v_exp_f32 v168, v168
  v_exp_f32 v169, v169
  v_exp_f32 v170, v170
  v_exp_f32 v171, v171
  v_exp_f32 v200, v200
  v_exp_f32 v201, v201
  v_exp_f32 v202, v202
  v_exp_f32 v203, v203
  v_pk_fma_f32 v[168:169], v[168:169], v[20:21], v[20:21] op_sel:[0,1,1] op_sel_hi:[1,1,1]
  v_pk_fma_f32 v[170:171], v[170:171], v[20:21], v[20:21] op_sel:[0,1,1] op_sel_hi:[1,1,1]
  v_pk_fma_f32 v[200:201], v[200:201], v[20:21], v[20:21] op_sel:[0,1,1] op_sel_hi:[1,1,1]
  v_pk_fma_f32 v[202:203], v[202:203], v[20:21], v[20:21] op_sel:[0,1,1] op_sel_hi:[1,1,1]
  v_rcp_f32 v168, v168
  v_rcp_f32 v169, v169
  v_rcp_f32 v170, v170
  v_rcp_f32 v171, v171
  v_rcp_f32 v200, v200
  v_rcp_f32 v201, v201
  v_rcp_f32 v202, v202
  v_rcp_f32 v203, v203
  v_pk_mul_f32 v[184:185], v[184:185], v[168:169]
  v_pk_mul_f32 v[186:187], v[186:187], v[170:171]
  v_pk_mul_f32 v[216:217], v[216:217], v[200:201]
  v_pk_mul_f32 v[218:219], v[218:219], v[202:203]
  v_cvt_pk_bf16_f32 v168, v184, v185
  v_cvt_pk_bf16_f32 v169, v186, v187
  v_cvt_pk_bf16_f32 v170, v216, v217
  v_cvt_pk_bf16_f32 v171, v218, v219
  buffer_store_dwordx4 v[168:171], v10, s[20:23], s75 offen offset:0 sc1
  v_pk_mul_f32 v[172:173], v[172:173], v[22:23] op_sel_hi:[1,0]
  v_pk_mul_f32 v[174:175], v[174:175], v[22:23] op_sel_hi:[1,0]
  v_pk_mul_f32 v[204:205], v[204:205], v[22:23] op_sel_hi:[1,0]
  v_pk_mul_f32 v[206:207], v[206:207], v[22:23] op_sel_hi:[1,0]
  v_exp_f32 v172, v172
  v_exp_f32 v173, v173
  v_exp_f32 v174, v174
  v_exp_f32 v175, v175
  v_exp_f32 v204, v204
  v_exp_f32 v205, v205
  v_exp_f32 v206, v206
  v_exp_f32 v207, v207
  v_pk_fma_f32 v[172:173], v[172:173], v[22:23], v[22:23] op_sel:[0,1,1] op_sel_hi:[1,1,1]
  v_pk_fma_f32 v[174:175], v[174:175], v[22:23], v[22:23] op_sel:[0,1,1] op_sel_hi:[1,1,1]
  v_pk_fma_f32 v[204:205], v[204:205], v[22:23], v[22:23] op_sel:[0,1,1] op_sel_hi:[1,1,1]
  v_pk_fma_f32 v[206:207], v[206:207], v[22:23], v[22:23] op_sel:[0,1,1] op_sel_hi:[1,1,1]
  v_rcp_f32 v172, v172
  v_rcp_f32 v173, v173
  v_rcp_f32 v174, v174
  v_rcp_f32 v175, v175
  v_rcp_f32 v204, v204
  v_rcp_f32 v205, v205
  v_rcp_f32 v206, v206
  v_rcp_f32 v207, v207
  v_pk_mul_f32 v[188:189], v[188:189], v[172:173]
  v_pk_mul_f32 v[190:191], v[190:191], v[174:175]
  v_pk_mul_f32 v[220:221], v[220:221], v[204:205]
  v_pk_mul_f32 v[222:223], v[222:223], v[206:207]
  v_cvt_pk_bf16_f32 v172, v188, v189
  v_cvt_pk_bf16_f32 v173, v190, v191
  v_cvt_pk_bf16_f32 v174, v220, v221
  v_cvt_pk_bf16_f32 v175, v222, v223
  buffer_store_dwordx4 v[172:175], v10, s[20:23], s76 offen offset:0 sc1
L_p4s:
  v_lshrrev_b32 v12, 2, v1
  v_bfe_u32 v13, v1, 3, 2
  v_and_b32 v14, 3, v1
  v_lshlrev_b32_e64 v14, 3, v14
  v_lshl_add_u32 v14, v13, 5, v14
  v_lshl_add_u32 v16, v12, 7, v14
  v_xor_b32 v17, 32, v16
  v_xor_b32 v18, 64, v16
  v_xor_b32 v19, 96, v16
  v_add_u32 v20, 65536, v16
  v_add_u32 v21, 65536, v17
  v_add_u32 v22, 65536, v18
  v_add_u32 v23, 65536, v19
  s_lshl_b32 s9, s32, 5
  s_add_u32 s9, s9, s33
  s_and_b32 s34, s9, 224
  s_lshl_b32 s34, s34, 8
  s_bfe_u32 s35, s9, 0x50000
  s_lshl_b32 s35, s35, 3
  s_add_u32 s34, s34, s35
  s_add_u32 s34, s34, 0x3be0000
  v_lshlrev_b32 v10, 8, v1
  v_add_u32 v10, s34, v10
  s_and_b32 s34, s11, 255
  s_lshl_b32 s34, s34, 8
  s_add_u32 s34, s34, 0x3be0000
  v_and_b32 v11, 3, v1
  v_lshl_add_u32 v11, v11, 3, s34
  s_and_b32 s35, s31, 1
  s_mul_i32 s35, s35, 224
  v_add_u32_e64 v11, s35, v11
  s_mul_i32 s41, s99, 32
  s_add_u32 s34, s34, s35
  s_add_u32 s86, s4, s34
  s_addc_u32 s87, s5, 0
  v_add_u32 v160, 0x20000, v16
  v_add_u32 v161, 0x20000, v17
  v_add_u32 v162, 0x20000, v18
  v_add_u32 v163, 0x20000, v19
  v_accvgpr_read_b32 v40, a224
  v_accvgpr_read_b32 v41, a225
  v_accvgpr_read_b32 v42, a226
  v_accvgpr_read_b32 v43, a227
  v_accvgpr_read_b32 v44, a228
  v_accvgpr_read_b32 v45, a229
  v_accvgpr_read_b32 v46, a230
  v_accvgpr_read_b32 v47, a231
  v_accvgpr_read_b32 v48, a232
  v_accvgpr_read_b32 v49, a233
  v_accvgpr_read_b32 v50, a234
  v_accvgpr_read_b32 v51, a235
  v_accvgpr_read_b32 v52, a236
  v_accvgpr_read_b32 v53, a237
  v_accvgpr_read_b32 v54, a238
  v_accvgpr_read_b32 v55, a239
  v_accvgpr_read_b32 v56, a240
  v_accvgpr_read_b32 v57, a241
  v_accvgpr_read_b32 v58, a242
  v_accvgpr_read_b32 v59, a243
  v_accvgpr_read_b32 v60, a244
  v_accvgpr_read_b32 v61, a245
  v_accvgpr_read_b32 v62, a246
  v_accvgpr_read_b32 v63, a247
  v_accvgpr_read_b32 v64, a248
  v_accvgpr_read_b32 v65, a249
  v_accvgpr_read_b32 v66, a250
  v_accvgpr_read_b32 v67, a251
  v_accvgpr_read_b32 v68, a252
  v_accvgpr_read_b32 v69, a253
  v_accvgpr_read_b32 v70, a254
  v_accvgpr_read_b32 v71, a255
  s_mul_i32 s45, s47, 230400
  s_mul_i32 s39, s100, 2048
  s_mul_i32 s99, s99, 2048
  v_add_u32 v8, 40, v1
  v_lshrrev_b32 v8, 6, v8
  v_lshl_add_u32 v8, v8, 7, v3
  v_add_u32 v8, s45, v8
  v_add_u32 v9, 230400, v8
  s_add_u32 s16, s4, 0x1980000
  s_addc_u32 s17, s5, 0
  s_mov_b32 s18, 0x1c20400
  s_mov_b32 s19, 0x00020000
  v_and_b32 v38, 15, v1
  v_lshrrev_b32 v39, 4, v1
  v_and_b32 v14, 7, v38
  v_lshlrev_b32 v14, 1, v14
  v_xor_b32 v39, v39, v14
  v_lshlrev_b32 v39, 3, v39
  v_lshl_add_u32 v38, v38, 7, v39
  s_add_u32 s34, s37, 98304
  v_add_u32 v28, s34, v38
  v_lshrrev_b32 v39, 3, v1
  v_and_b32 v14, 7, v1
  v_xor_b32 v15, v14, v39
  v_lshlrev_b32 v15, 4, v15
  v_lshl_add_u32 v15, v39, 7, v15
  v_add_u32 v26, s34, v15
  v_lshlrev_b32 v14, 4, v14
  v_lshl_add_u32 v14, v39, 11, v14
  s_lshl_b32 s34, s47, 15
  s_lshl_b32 s35, s31, 7
  s_add_u32 s34, s34, s35
  v_add_u32 v27, s34, v14
  v_xor_b32 v29, 32, v28
  v_xor_b32 v30, 64, v28
  v_xor_b32 v31, 96, v28
  s_mov_b32 s20, s68
  s_mov_b32 s21, s69
  s_mov_b32 s22, 0x400000
  s_mov_b32 s23, 0x00020000
  s_lshl_b32 s34, s11, 2
  s_add_u32 s34, s34, s24
  s_lshl_b32 s34, s34, 13
  s_add_u32 s36, s34, 0x4001000
  v_and_b32 v38, 15, v1
  v_lshrrev_b32 v39, 4, v1
  v_lshrrev_b32 v14, 2, v38
  v_cmp_eq_u32 vcc, v39, v14
  v_and_b32 v14, 1, v38
  v_lshlrev_b32 v14, 4, v14
  v_mov_b32 v15, 0x3f80
  v_lshlrev_b32 v15, v14, v15
  v_cndmask_b32 v15, 0, v15, vcc
  v_and_b32 v14, 2, v38
  v_cmp_eq_u32 vcc, 0, v14
  v_mov_b32 v120, 0
  v_mov_b32 v121, 0
  v_cndmask_b32 v122, 0, v15, vcc
  v_cndmask_b32 v123, v15, 0, vcc
  v_mov_b32 v124, 0
  v_mov_b32 v125, 0
  s_lshl_b32 s34, s11, 8
  s_lshl_b32 s35, s24, 3
  s_add_u32 s34, s34, s35
  s_add_u32 s34, s34, 0x3bf0000
  v_mov_b32 v35, s34
  v_xor_b32 v34, 0x100, v35
  v_mov_b32 v36, s6
  v_mov_b32 v37, s7
  v_add_u32 v33, 40, v1
  v_lshrrev_b32 v33, 6, v33
  v_lshl_add_u32 v33, v33, 7, v3
  v_add_u32 v33, s36, v33
  v_xor_b32 v32, 0x8000, v33
  s_waitcnt vmcnt(0)
  s_barrier
  s_cmp_eq_u32 s24, 0
  s_cbranch_scc0 L_nosig_28
  v_mov_b32 v232, s6
  v_mov_b32 v233, s7
  s_mov_b32 exec_lo, 0xffffffff
  s_mov_b32 exec_hi, 0
  global_store_dwordx2 v10, v[232:233], s[4:5] sc1
  s_mov_b64 exec, -1
L_nosig_28:
  s_add_u32 m0, s37, 65536
  s_nop 0
  buffer_load_dwordx4 v4, s[12:15], s38 offen offset:0 lds
  buffer_load_dwordx4 v5, s[12:15], s38 offen offset:1024 lds
  buffer_load_dwordx4 v6, s[12:15], s38 offen offset:2048 lds
  buffer_load_dwordx4 v7, s[12:15], s38 offen offset:3072 lds
  s_add_u32 s38, s38, s96
  s_add_u32 m0, s37, 81920
  s_nop 0
  buffer_load_dwordx4 v4, s[12:15], s38 offen offset:0 lds
  buffer_load_dwordx4 v5, s[12:15], s38 offen offset:1024 lds
  buffer_load_dwordx4 v6, s[12:15], s38 offen offset:2048 lds
  buffer_load_dwordx4 v7, s[12:15], s38 offen offset:3072 lds
  s_add_u32 s38, s38, s96
  s_cmp_eq_u32 s24, 1
  s_cbranch_scc0 L_nopoll_29
  s_mov_b32 s34, 0
L_poll_30:
  s_load_dwordx8 s[88:95], s[86:87], 0 glc
  s_add_u32 s34, s34, 1
  s_waitcnt lgkmcnt(0)
  s_xor_b64 s[88:89], s[88:89], s[6:7]
  s_xor_b64 s[90:91], s[90:91], s[6:7]
  s_xor_b64 s[92:93], s[92:93], s[6:7]
  s_xor_b64 s[94:95], s[94:95], s[6:7]
  s_or_b64 s[88:89], s[88:89], s[90:91]
  s_or_b64 s[92:93], s[92:93], s[94:95]
  s_or_b64 s[88:89], s[88:89], s[92:93]
  s_cbranch_scc0 L_go_31
L_pad_3b_0:
  s_cbranch_execz L_pad_3b_3
  s_cmp_lt_u32 s34, 0x40000
  s_cbranch_scc1 L_poll_30
L_go_31:
L_nopoll_29:
  s_barrier
  buffer_load_dwordx4 a[0:3], v8, s[16:19], s39 offen sc1
  buffer_load_dwordx4 a[4:7], v9, s[16:19], s39 offen sc1
  s_add_u32 s39, s39, s99
  buffer_load_dwordx4 a[8:11], v8, s[16:19], s39 offen sc1
  buffer_load_dwordx4 a[12:15], v9, s[16:19], s39 offen sc1
  s_add_u32 s39, s39, s99
  ds_read_b64_tr_b16 v[168:169], v16 offset:0
  ds_read_b64_tr_b16 v[170:171], v16 offset:2048
  ds_read_b64_tr_b16 v[172:173], v16 offset:4096
  ds_read_b64_tr_b16 v[174:175], v16 offset:6144
  ds_read_b64_tr_b16 v[176:177], v17 offset:0
  ds_read_b64_tr_b16 v[178:179], v17 offset:2048
  ds_read_b64_tr_b16 v[180:181], v17 offset:4096
  ds_read_b64_tr_b16 v[182:183], v17 offset:6144
  buffer_load_dwordx4 a[16:19], v8, s[16:19], s39 offen sc1
  buffer_load_dwordx4 a[20:23], v9, s[16:19], s39 offen sc1
  s_add_u32 s39, s39, s99
  buffer_load_dwordx4 v[200:203], v8, s[16:19], s39 offen sc1
  buffer_load_dwordx4 v[204:207], v9, s[16:19], s39 offen sc1
  s_add_u32 s39, s39, s99
  s_waitcnt vmcnt(4) lgkmcnt(4)
L_p4:
  v_mfma_f32_16x16x32_bf16 v[40:43], v[168:171], a[0:3], v[40:43]
  ds_read_b64_tr_b16 v[184:185], v18 offset:0
  buffer_load_dwordx4 a[32:35], v8, s[16:19], s39 offen sc1
  v_mfma_f32_16x16x32_bf16 v[40:43], v[172:175], a[8:11], v[40:43]
  ds_read_b64_tr_b16 v[186:187], v18 offset:2048
  v_mfma_f32_16x16x32_bf16 v[44:47], v[172:175], a[12:15], v[44:47]
  ds_read_b64_tr_b16 v[188:189], v18 offset:4096
  v_mfma_f32_16x16x32_bf16 v[44:47], v[168:171], a[4:7], v[44:47]
  s_waitcnt lgkmcnt(3)
  ds_read_b64_tr_b16 v[190:191], v18 offset:6144
  buffer_load_dwordx4 a[36:39], v9, s[16:19], s39 offen sc1
  v_mfma_f32_16x16x32_bf16 v[52:55], v[176:179], a[4:7], v[52:55]
  s_add_u32 s39, s39, s99
  ds_read_b64_tr_b16 v[192:193], v19 offset:0
  v_mfma_f32_16x16x32_bf16 v[52:55], v[180:183], a[12:15], v[52:55]
  ds_read_b64_tr_b16 v[194:195], v19 offset:2048
  v_mfma_f32_16x16x32_bf16 v[48:51], v[180:183], a[8:11], v[48:51]
  ds_read_b64_tr_b16 v[196:197], v19 offset:4096
  v_mfma_f32_16x16x32_bf16 v[48:51], v[176:179], a[0:3], v[48:51]
  s_waitcnt lgkmcnt(3)
  ds_read_b64_tr_b16 v[198:199], v19 offset:6144
  buffer_load_dwordx4 a[40:43], v8, s[16:19], s39 offen sc1
  v_mfma_f32_16x16x32_bf16 v[56:59], v[184:187], a[0:3], v[56:59]
  ds_read_b64_tr_b16 v[168:169], v16 offset:8192
  v_mfma_f32_16x16x32_bf16 v[56:59], v[188:191], a[8:11], v[56:59]
  ds_read_b64_tr_b16 v[170:171], v16 offset:10240
  v_mfma_f32_16x16x32_bf16 v[60:63], v[188:191], a[12:15], v[60:63]
  ds_read_b64_tr_b16 v[172:173], v16 offset:12288
  v_mfma_f32_16x16x32_bf16 v[60:63], v[184:187], a[4:7], v[60:63]
  s_waitcnt lgkmcnt(3)
  ds_read_b64_tr_b16 v[174:175], v16 offset:14336
  buffer_load_dwordx4 a[44:47], v9, s[16:19], s39 offen sc1
  v_mfma_f32_16x16x32_bf16 v[68:71], v[192:195], a[4:7], v[68:71]
  s_add_u32 s39, s39, s99
  ds_read_b64_tr_b16 v[176:177], v17 offset:8192
  v_mfma_f32_16x16x32_bf16 v[68:71], v[196:199], a[12:15], v[68:71]
  ds_read_b64_tr_b16 v[178:179], v17 offset:10240
  v_mfma_f32_16x16x32_bf16 v[64:67], v[196:199], a[8:11], v[64:67]
  ds_read_b64_tr_b16 v[180:181], v17 offset:12288
  v_mfma_f32_16x16x32_bf16 v[64:67], v[192:195], a[0:3], v[64:67]
  s_waitcnt lgkmcnt(3)
  ds_read_b64_tr_b16 v[182:183], v17 offset:14336
  v_mfma_f32_16x16x32_bf16 v[72:75], v[168:171], a[0:3], 0
  ds_read_b64_tr_b16 v[184:185], v18 offset:8192
  buffer_load_dwordx4 a[48:51], v8, s[16:19], s39 offen sc1
  v_mfma_f32_16x16x32_bf16 v[72:75], v[172:175], a[8:11], v[72:75]
  ds_read_b64_tr_b16 v[186:187], v18 offset:10240
  v_mfma_f32_16x16x32_bf16 v[76:79], v[172:175], a[12:15], 0
  ds_read_b64_tr_b16 v[188:189], v18 offset:12288
  buffer_load_dwordx4 a[52:55], v9, s[16:19], s39 offen sc1
  v_mfma_f32_16x16x32_bf16 v[76:79], v[168:171], a[4:7], v[76:79]
  s_waitcnt lgkmcnt(3)
  ds_read_b64_tr_b16 v[190:191], v18 offset:14336
  v_mfma_f32_16x16x32_bf16 v[84:87], v[176:179], a[4:7], 0
  s_add_u32 s39, s39, s99
  ds_read_b64_tr_b16 v[192:193], v19 offset:8192
  v_mfma_f32_16x16x32_bf16 v[84:87], v[180:183], a[12:15], v[84:87]
  ds_read_b64_tr_b16 v[194:195], v19 offset:10240
  v_mfma_f32_16x16x32_bf16 v[80:83], v[180:183], a[8:11], 0
  ds_read_b64_tr_b16 v[196:197], v19 offset:12288
  buffer_load_dwordx4 a[56:59], v8, s[16:19], s39 offen sc1
  v_mfma_f32_16x16x32_bf16 v[80:83], v[176:179], a[0:3], v[80:83]
  s_waitcnt lgkmcnt(3)
  ds_read_b64_tr_b16 v[198:199], v19 offset:14336
  v_mfma_f32_16x16x32_bf16 v[88:91], v[184:187], a[0:3], 0
  ds_read_b64_tr_b16 v[168:169], v16 offset:16384
  v_mfma_f32_16x16x32_bf16 v[88:91], v[188:191], a[8:11], v[88:91]
  ds_read_b64_tr_b16 v[170:171], v16 offset:18432
  v_mfma_f32_16x16x32_bf16 v[92:95], v[188:191], a[12:15], 0
  ds_read_b64_tr_b16 v[172:173], v16 offset:20480
  buffer_load_dwordx4 a[60:63], v9, s[16:19], s39 offen sc1
  v_mfma_f32_16x16x32_bf16 v[92:95], v[184:187], a[4:7], v[92:95]
  s_waitcnt vmcnt(8) lgkmcnt(3)
  ds_read_b64_tr_b16 v[174:175], v16 offset:22528
  v_mfma_f32_16x16x32_bf16 v[100:103], v[192:195], a[4:7], 0
  s_add_u32 s39, s39, s99
  ds_read_b64_tr_b16 v[176:177], v17 offset:16384
  v_swap_b32 v202, v204
  v_swap_b32 v203, v205
  v_mfma_f32_16x16x32_bf16 v[100:103], v[196:199], a[12:15], v[100:103]
  ds_read_b64_tr_b16 v[178:179], v17 offset:18432
  v_mfma_f32_16x16x32_bf16 v[96:99], v[196:199], a[8:11], 0
  ds_read_b64_tr_b16 v[180:181], v17 offset:20480
  v_mfma_f32_16x16x32_bf16 v[96:99], v[192:195], a[0:3], v[96:99]
  s_waitcnt vmcnt(8) lgkmcnt(3)
  ds_read_b64_tr_b16 v[182:183], v17 offset:22528
  v_mfma_f32_16x16x32_bf16 v[40:43], v[168:171], a[16:19], v[40:43]
  ds_read_b64_tr_b16 v[184:185], v18 offset:16384
  buffer_load_dwordx4 a[64:67], v8, s[16:19], s39 offen sc1
  v_mfma_f32_16x16x32_bf16 v[40:43], v[172:175], v[200:203], v[40:43]
  ds_read_b64_tr_b16 v[186:187], v18 offset:18432
  v_mfma_f32_16x16x32_bf16 v[44:47], v[172:175], v[204:207], v[44:47]
  ds_read_b64_tr_b16 v[188:189], v18 offset:20480
  buffer_load_dwordx4 a[68:71], v9, s[16:19], s39 offen sc1
  v_mfma_f32_16x16x32_bf16 v[44:47], v[168:171], a[20:23], v[44:47]
  s_waitcnt lgkmcnt(3)
  ds_read_b64_tr_b16 v[190:191], v18 offset:22528
  v_mfma_f32_16x16x32_bf16 v[52:55], v[176:179], a[20:23], v[52:55]
  s_add_u32 s39, s39, s99
  ds_read_b64_tr_b16 v[192:193], v19 offset:16384
  v_mfma_f32_16x16x32_bf16 v[52:55], v[180:183], v[204:207], v[52:55]
  ds_read_b64_tr_b16 v[194:195], v19 offset:18432
  v_mfma_f32_16x16x32_bf16 v[48:51], v[180:183], v[200:203], v[48:51]
  ds_read_b64_tr_b16 v[196:197], v19 offset:20480
  buffer_load_dwordx4 a[72:75], v8, s[16:19], s39 offen sc1
  v_mfma_f32_16x16x32_bf16 v[48:51], v[176:179], a[16:19], v[48:51]
  s_waitcnt lgkmcnt(3)
  ds_read_b64_tr_b16 v[198:199], v19 offset:22528
  v_mfma_f32_16x16x32_bf16 v[56:59], v[184:187], a[16:19], v[56:59]
  ds_read_b64_tr_b16 v[168:169], v16 offset:24576
  v_mfma_f32_16x16x32_bf16 v[56:59], v[188:191], v[200:203], v[56:59]
  ds_read_b64_tr_b16 v[170:171], v16 offset:26624
  v_mfma_f32_16x16x32_bf16 v[60:63], v[188:191], v[204:207], v[60:63]
  ds_read_b64_tr_b16 v[172:173], v16 offset:28672
  buffer_load_dwordx4 a[76:79], v9, s[16:19], s39 offen sc1
  v_mfma_f32_16x16x32_bf16 v[60:63], v[184:187], a[20:23], v[60:63]
  s_waitcnt lgkmcnt(3)
  ds_read_b64_tr_b16 v[174:175], v16 offset:30720
  v_mfma_f32_16x16x32_bf16 v[68:71], v[192:195], a[20:23], v[68:71]
  s_add_u32 s39, s39, s99
  ds_read_b64_tr_b16 v[176:177], v17 offset:24576
  v_mfma_f32_16x16x32_bf16 v[68:71], v[196:199], v[204:207], v[68:71]
  ds_read_b64_tr_b16 v[178:179], v17 offset:26624
  v_mfma_f32_16x16x32_bf16 v[64:67], v[196:199], v[200:203], v[64:67]
  ds_read_b64_tr_b16 v[180:181], v17 offset:28672
  v_mfma_f32_16x16x32_bf16 v[64:67], v[192:195], a[16:19], v[64:67]
  s_waitcnt lgkmcnt(3)
  ds_read_b64_tr_b16 v[182:183], v17 offset:30720
  v_mfma_f32_16x16x32_bf16 v[72:75], v[168:171], a[16:19], v[72:75]
  ds_read_b64_tr_b16 v[184:185], v18 offset:24576
  v_add_u32 v11, s41, v11
  v_mfma_f32_16x16x32_bf16 v[72:75], v[172:175], v[200:203], v[72:75]
  ds_read_b64_tr_b16 v[186:187], v18 offset:26624
  global_load_dwordx2 v[12:13], v11, s[4:5] sc1
  v_mfma_f32_16x16x32_bf16 v[76:79], v[172:175], v[204:207], v[76:79]
  ds_read_b64_tr_b16 v[188:189], v18 offset:28672
  buffer_load_dwordx4 v[208:211], v8, s[16:19], s39 offen sc1
  v_mfma_f32_16x16x32_bf16 v[76:79], v[168:171], a[20:23], v[76:79]
  s_waitcnt lgkmcnt(3)
  ds_read_b64_tr_b16 v[190:191], v18 offset:30720
  v_mfma_f32_16x16x32_bf16 v[84:87], v[176:179], a[20:23], v[84:87]
  ds_read_b64_tr_b16 v[192:193], v19 offset:24576
  buffer_load_dwordx4 v[212:215], v9, s[16:19], s39 offen sc1
  v_mfma_f32_16x16x32_bf16 v[84:87], v[180:183], v[204:207], v[84:87]
  s_add_u32 s39, s39, s99
  ds_read_b64_tr_b16 v[194:195], v19 offset:26624
  v_mfma_f32_16x16x32_bf16 v[80:83], v[180:183], v[200:203], v[80:83]
  ds_read_b64_tr_b16 v[196:197], v19 offset:28672
  v_mfma_f32_16x16x32_bf16 v[80:83], v[176:179], a[16:19], v[80:83]
  s_waitcnt vmcnt(51) lgkmcnt(3)
  ds_read_b64_tr_b16 v[198:199], v19 offset:30720
  v_mfma_f32_16x16x32_bf16 v[88:91], v[184:187], a[16:19], v[88:91]
  s_barrier
  ds_read_b64_tr_b16 v[168:169], v16 offset:32768
  v_mfma_f32_16x16x32_bf16 v[88:91], v[188:191], v[200:203], v[88:91]
  ds_read_b64_tr_b16 v[170:171], v16 offset:34816
  buffer_load_dwordx4 a[88:91], v8, s[16:19], s39 offen sc1
  v_mfma_f32_16x16x32_bf16 v[92:95], v[188:191], v[204:207], v[92:95]
  ds_read_b64_tr_b16 v[172:173], v16 offset:36864
  v_mfma_f32_16x16x32_bf16 v[92:95], v[184:187], a[20:23], v[92:95]
  s_waitcnt lgkmcnt(3)
  ds_read_b64_tr_b16 v[174:175], v16 offset:38912
  v_mfma_f32_16x16x32_bf16 v[100:103], v[192:195], a[20:23], v[100:103]
  ds_read_b64_tr_b16 v[176:177], v17 offset:32768
  buffer_load_dwordx4 a[92:95], v9, s[16:19], s39 offen sc1
  v_mfma_f32_16x16x32_bf16 v[100:103], v[196:199], v[204:207], v[100:103]
  s_add_u32 s39, s39, s99
  ds_read_b64_tr_b16 v[178:179], v17 offset:34816
  v_mfma_f32_16x16x32_bf16 v[96:99], v[196:199], v[200:203], v[96:99]
  ds_read_b64_tr_b16 v[180:181], v17 offset:36864
  v_mfma_f32_16x16x32_bf16 v[96:99], v[192:195], a[16:19], v[96:99]
  s_waitcnt vmcnt(13) lgkmcnt(3)
  ds_read_b64_tr_b16 v[182:183], v17 offset:38912
  v_mfma_f32_16x16x32_bf16 v[40:43], v[168:171], a[32:35], v[40:43]
  ds_read_b64_tr_b16 v[184:185], v18 offset:32768
  buffer_load_dwordx4 a[96:99], v8, s[16:19], s39 offen sc1
  v_mfma_f32_16x16x32_bf16 v[40:43], v[172:175], a[40:43], v[40:43]
  s_add_u32 m0, s37, 98304
  ds_read_b64_tr_b16 v[186:187], v18 offset:34816
  v_mfma_f32_16x16x32_bf16 v[44:47], v[172:175], a[44:47], v[44:47]
  ds_read_b64_tr_b16 v[188:189], v18 offset:36864
  v_mfma_f32_16x16x32_bf16 v[44:47], v[168:171], a[36:39], v[44:47]
  s_waitcnt lgkmcnt(3)
  ds_read_b64_tr_b16 v[190:191], v18 offset:38912
  buffer_load_dwordx4 v4, s[12:15], s38 offen offset:0 lds
  v_mfma_f32_16x16x32_bf16 v[52:55], v[176:179], a[36:39], v[52:55]
  ds_read_b64_tr_b16 v[192:193], v19 offset:32768
  v_mfma_f32_16x16x32_bf16 v[52:55], v[180:183], a[44:47], v[52:55]
  ds_read_b64_tr_b16 v[194:195], v19 offset:34816
  v_mfma_f32_16x16x32_bf16 v[48:51], v[180:183], a[40:43], v[48:51]
  ds_read_b64_tr_b16 v[196:197], v19 offset:36864
  v_mfma_f32_16x16x32_bf16 v[48:51], v[176:179], a[32:35], v[48:51]
  s_waitcnt lgkmcnt(3)
  ds_read_b64_tr_b16 v[198:199], v19 offset:38912
  buffer_load_dwordx4 a[100:103], v9, s[16:19], s39 offen sc1
  v_mfma_f32_16x16x32_bf16 v[56:59], v[184:187], a[32:35], v[56:59]
  ds_read_b64_tr_b16 v[168:169], v16 offset:40960
  v_mfma_f32_16x16x32_bf16 v[56:59], v[188:191], a[40:43], v[56:59]
  ds_read_b64_tr_b16 v[170:171], v16 offset:43008
  v_mfma_f32_16x16x32_bf16 v[60:63], v[188:191], a[44:47], v[60:63]
  ds_read_b64_tr_b16 v[172:173], v16 offset:45056
  v_mfma_f32_16x16x32_bf16 v[60:63], v[184:187], a[36:39], v[60:63]
  s_waitcnt lgkmcnt(3)
  ds_read_b64_tr_b16 v[174:175], v16 offset:47104
  buffer_load_dwordx4 v5, s[12:15], s38 offen offset:1024 lds
  v_mfma_f32_16x16x32_bf16 v[68:71], v[192:195], a[36:39], v[68:71]
  s_add_u32 s39, s39, s99
  ds_read_b64_tr_b16 v[176:177], v17 offset:40960
  v_mfma_f32_16x16x32_bf16 v[68:71], v[196:199], a[44:47], v[68:71]
  ds_read_b64_tr_b16 v[178:179], v17 offset:43008
  v_mfma_f32_16x16x32_bf16 v[64:67], v[196:199], a[40:43], v[64:67]
  ds_read_b64_tr_b16 v[180:181], v17 offset:45056
  v_mfma_f32_16x16x32_bf16 v[64:67], v[192:195], a[32:35], v[64:67]
  s_waitcnt lgkmcnt(3)
  ds_read_b64_tr_b16 v[182:183], v17 offset:47104
  v_mfma_f32_16x16x32_bf16 v[72:75], v[168:171], a[32:35], v[72:75]
  ds_read_b64_tr_b16 v[184:185], v18 offset:40960
  buffer_load_dwordx4 a[104:107], v8, s[16:19], s39 offen sc1
  v_mfma_f32_16x16x32_bf16 v[72:75], v[172:175], a[40:43], v[72:75]
  ds_read_b64_tr_b16 v[186:187], v18 offset:43008
  v_mfma_f32_16x16x32_bf16 v[76:79], v[172:175], a[44:47], v[76:79]
  ds_read_b64_tr_b16 v[188:189], v18 offset:45056
  buffer_load_dwordx4 v6, s[12:15], s38 offen offset:2048 lds
  v_mfma_f32_16x16x32_bf16 v[76:79], v[168:171], a[36:39], v[76:79]
  s_waitcnt lgkmcnt(3)
  ds_read_b64_tr_b16 v[190:191], v18 offset:47104
  v_mfma_f32_16x16x32_bf16 v[84:87], v[176:179], a[36:39], v[84:87]
  ds_read_b64_tr_b16 v[192:193], v19 offset:40960
  v_mfma_f32_16x16x32_bf16 v[84:87], v[180:183], a[44:47], v[84:87]
  ds_read_b64_tr_b16 v[194:195], v19 offset:43008
  v_mfma_f32_16x16x32_bf16 v[80:83], v[180:183], a[40:43], v[80:83]
  ds_read_b64_tr_b16 v[196:197], v19 offset:45056
  buffer_load_dwordx4 a[108:111], v9, s[16:19], s39 offen sc1
  v_mfma_f32_16x16x32_bf16 v[80:83], v[176:179], a[32:35], v[80:83]
  s_waitcnt lgkmcnt(3)
  ds_read_b64_tr_b16 v[198:199], v19 offset:47104
  v_mfma_f32_16x16x32_bf16 v[88:91], v[184:187], a[32:35], v[88:91]
  ds_read_b64_tr_b16 v[168:169], v16 offset:49152
  v_mfma_f32_16x16x32_bf16 v[88:91], v[188:191], a[40:43], v[88:91]
  ds_read_b64_tr_b16 v[170:171], v16 offset:51200
  v_mfma_f32_16x16x32_bf16 v[92:95], v[188:191], a[44:47], v[92:95]
  ds_read_b64_tr_b16 v[172:173], v16 offset:53248
  buffer_load_dwordx4 v7, s[12:15], s38 offen offset:3072 lds
  v_mfma_f32_16x16x32_bf16 v[92:95], v[184:187], a[36:39], v[92:95]
  s_waitcnt lgkmcnt(3)
  ds_read_b64_tr_b16 v[174:175], v16 offset:55296
  v_mfma_f32_16x16x32_bf16 v[100:103], v[192:195], a[36:39], v[100:103]
  s_add_u32 s39, s39, s99
  ds_read_b64_tr_b16 v[176:177], v17 offset:49152
  v_mfma_f32_16x16x32_bf16 v[100:103], v[196:199], a[44:47], v[100:103]
  ds_read_b64_tr_b16 v[178:179], v17 offset:51200
  v_mfma_f32_16x16x32_bf16 v[96:99], v[196:199], a[40:43], v[96:99]
  ds_read_b64_tr_b16 v[180:181], v17 offset:53248
  v_mfma_f32_16x16x32_bf16 v[96:99], v[192:195], a[32:35], v[96:99]
  s_waitcnt vmcnt(12) lgkmcnt(3)
  ds_read_b64_tr_b16 v[182:183], v17 offset:55296
  v_cmp_ne_u64 vcc, s[6:7], v[12:13]
  s_cbranch_vccnz L_slow_32
L_back_33:
  v_mfma_f32_16x16x32_bf16 v[40:43], v[168:171], a[48:51], v[40:43]
  ds_read_b64_tr_b16 v[184:185], v18 offset:49152
  buffer_load_dwordx4 a[112:115], v8, s[16:19], s39 offen sc1
  v_mfma_f32_16x16x32_bf16 v[40:43], v[172:175], a[56:59], v[40:43]
  s_add_u32 s38, s38, s96
  ds_read_b64_tr_b16 v[186:187], v18 offset:51200
  v_mfma_f32_16x16x32_bf16 v[44:47], v[172:175], a[60:63], v[44:47]
  s_add_u32 m0, s37, 114688
  ds_read_b64_tr_b16 v[188:189], v18 offset:53248
  buffer_load_dwordx4 v4, s[12:15], s38 offen offset:0 lds
  v_mfma_f32_16x16x32_bf16 v[44:47], v[168:171], a[52:55], v[44:47]
  s_waitcnt lgkmcnt(3)
  ds_read_b64_tr_b16 v[190:191], v18 offset:55296
  v_mfma_f32_16x16x32_bf16 v[52:55], v[176:179], a[52:55], v[52:55]
  ds_read_b64_tr_b16 v[192:193], v19 offset:49152
  v_mfma_f32_16x16x32_bf16 v[52:55], v[180:183], a[60:63], v[52:55]
  ds_read_b64_tr_b16 v[194:195], v19 offset:51200
  v_mfma_f32_16x16x32_bf16 v[48:51], v[180:183], a[56:59], v[48:51]
  ds_read_b64_tr_b16 v[196:197], v19 offset:53248
  buffer_load_dwordx4 a[116:119], v9, s[16:19], s39 offen sc1
  v_mfma_f32_16x16x32_bf16 v[48:51], v[176:179], a[48:51], v[48:51]
  s_waitcnt lgkmcnt(3)
  ds_read_b64_tr_b16 v[198:199], v19 offset:55296
  v_mfma_f32_16x16x32_bf16 v[56:59], v[184:187], a[48:51], v[56:59]
  ds_read_b64_tr_b16 v[168:169], v16 offset:57344
  v_mfma_f32_16x16x32_bf16 v[56:59], v[188:191], a[56:59], v[56:59]
  ds_read_b64_tr_b16 v[170:171], v16 offset:59392
  v_mfma_f32_16x16x32_bf16 v[60:63], v[188:191], a[60:63], v[60:63]
  ds_read_b64_tr_b16 v[172:173], v16 offset:61440
  buffer_load_dwordx4 v5, s[12:15], s38 offen offset:1024 lds
  v_mfma_f32_16x16x32_bf16 v[60:63], v[184:187], a[52:55], v[60:63]
  s_waitcnt lgkmcnt(3)
  ds_read_b64_tr_b16 v[174:175], v16 offset:63488
  v_mfma_f32_16x16x32_bf16 v[68:71], v[192:195], a[52:55], v[68:71]
  s_add_u32 s39, s39, s99
  ds_read_b64_tr_b16 v[176:177], v17 offset:57344
  v_mfma_f32_16x16x32_bf16 v[68:71], v[196:199], a[60:63], v[68:71]
  ds_read_b64_tr_b16 v[178:179], v17 offset:59392
  v_mfma_f32_16x16x32_bf16 v[64:67], v[196:199], a[56:59], v[64:67]
  ds_read_b64_tr_b16 v[180:181], v17 offset:61440
  v_mfma_f32_16x16x32_bf16 v[64:67], v[192:195], a[48:51], v[64:67]
  s_waitcnt lgkmcnt(3)
  ds_read_b64_tr_b16 v[182:183], v17 offset:63488
  v_mfma_f32_16x16x32_bf16 v[72:75], v[168:171], a[48:51], v[72:75]
  ds_read_b64_tr_b16 v[184:185], v18 offset:57344
  buffer_load_dwordx4 a[120:123], v8, s[16:19], s39 offen sc1
  v_mfma_f32_16x16x32_bf16 v[72:75], v[172:175], a[56:59], v[72:75]
  ds_read_b64_tr_b16 v[186:187], v18 offset:59392
  v_mfma_f32_16x16x32_bf16 v[76:79], v[172:175], a[60:63], v[76:79]
  ds_read_b64_tr_b16 v[188:189], v18 offset:61440
  buffer_load_dwordx4 v6, s[12:15], s38 offen offset:2048 lds
  v_mfma_f32_16x16x32_bf16 v[76:79], v[168:171], a[52:55], v[76:79]
  s_waitcnt lgkmcnt(3)
  ds_read_b64_tr_b16 v[190:191], v18 offset:63488
  v_mfma_f32_16x16x32_bf16 v[84:87], v[176:179], a[52:55], v[84:87]
  ds_read_b64_tr_b16 v[192:193], v19 offset:57344
  v_mfma_f32_16x16x32_bf16 v[84:87], v[180:183], a[60:63], v[84:87]
  ds_read_b64_tr_b16 v[194:195], v19 offset:59392
  v_mfma_f32_16x16x32_bf16 v[80:83], v[180:183], a[56:59], v[80:83]
  ds_read_b64_tr_b16 v[196:197], v19 offset:61440
  buffer_load_dwordx4 a[124:127], v9, s[16:19], s39 offen sc1
  v_mfma_f32_16x16x32_bf16 v[80:83], v[176:179], a[48:51], v[80:83]
  s_waitcnt vmcnt(60) lgkmcnt(3)
  ds_read_b64_tr_b16 v[198:199], v19 offset:63488
  v_mfma_f32_16x16x32_bf16 v[88:91], v[184:187], a[48:51], v[88:91]
  s_barrier
  ds_read_b64_tr_b16 v[168:169], v160 offset:0
  v_mfma_f32_16x16x32_bf16 v[88:91], v[188:191], a[56:59], v[88:91]
  ds_read_b64_tr_b16 v[170:171], v160 offset:2048
  v_mfma_f32_16x16x32_bf16 v[92:95], v[188:191], a[60:63], v[92:95]
  ds_read_b64_tr_b16 v[172:173], v160 offset:4096
  buffer_load_dwordx4 v7, s[12:15], s38 offen offset:3072 lds
  v_mfma_f32_16x16x32_bf16 v[92:95], v[184:187], a[52:55], v[92:95]
  s_waitcnt lgkmcnt(3)
  ds_read_b64_tr_b16 v[174:175], v160 offset:6144
  v_mfma_f32_16x16x32_bf16 v[100:103], v[192:195], a[52:55], v[100:103]
  s_add_u32 s39, s39, s99
  ds_read_b64_tr_b16 v[176:177], v161 offset:0
  v_mfma_f32_16x16x32_bf16 v[100:103], v[196:199], a[60:63], v[100:103]
  ds_read_b64_tr_b16 v[178:179], v161 offset:2048
  v_mfma_f32_16x16x32_bf16 v[96:99], v[196:199], a[56:59], v[96:99]
  ds_read_b64_tr_b16 v[180:181], v161 offset:4096
  v_mfma_f32_16x16x32_bf16 v[96:99], v[192:195], a[48:51], v[96:99]
  s_waitcnt vmcnt(21) lgkmcnt(3)
  ds_read_b64_tr_b16 v[182:183], v161 offset:6144
  v_mfma_f32_16x16x32_bf16 v[40:43], v[168:171], a[64:67], v[40:43]
  ds_read_b64_tr_b16 v[184:185], v162 offset:0
  buffer_load_dwordx4 a[128:131], v8, s[16:19], s39 offen sc1
  v_mfma_f32_16x16x32_bf16 v[40:43], v[172:175], a[72:75], v[40:43]
  s_add_u32 s38, s38, s96
  ds_read_b64_tr_b16 v[186:187], v162 offset:2048
  v_mfma_f32_16x16x32_bf16 v[44:47], v[172:175], a[76:79], v[44:47]
  s_add_u32 m0, s37, 0
  ds_read_b64_tr_b16 v[188:189], v162 offset:4096
  buffer_load_dwordx4 v4, s[12:15], s38 offen offset:0 lds
  v_mfma_f32_16x16x32_bf16 v[44:47], v[168:171], a[68:71], v[44:47]
  s_waitcnt lgkmcnt(3)
  ds_read_b64_tr_b16 v[190:191], v162 offset:6144
  v_mfma_f32_16x16x32_bf16 v[52:55], v[176:179], a[68:71], v[52:55]
  ds_read_b64_tr_b16 v[192:193], v163 offset:0
  v_mfma_f32_16x16x32_bf16 v[52:55], v[180:183], a[76:79], v[52:55]
  ds_read_b64_tr_b16 v[194:195], v163 offset:2048
  v_mfma_f32_16x16x32_bf16 v[48:51], v[180:183], a[72:75], v[48:51]
  ds_read_b64_tr_b16 v[196:197], v163 offset:4096
  buffer_load_dwordx4 a[132:135], v9, s[16:19], s39 offen sc1
  v_mfma_f32_16x16x32_bf16 v[48:51], v[176:179], a[64:67], v[48:51]
  s_waitcnt lgkmcnt(3)
  ds_read_b64_tr_b16 v[198:199], v163 offset:6144
  v_mfma_f32_16x16x32_bf16 v[56:59], v[184:187], a[64:67], v[56:59]
  ds_read_b64_tr_b16 v[168:169], v160 offset:8192
  v_mfma_f32_16x16x32_bf16 v[56:59], v[188:191], a[72:75], v[56:59]
  ds_read_b64_tr_b16 v[170:171], v160 offset:10240
  v_mfma_f32_16x16x32_bf16 v[60:63], v[188:191], a[76:79], v[60:63]
  ds_read_b64_tr_b16 v[172:173], v160 offset:12288
  buffer_load_dwordx4 v5, s[12:15], s38 offen offset:1024 lds
  v_mfma_f32_16x16x32_bf16 v[60:63], v[184:187], a[68:71], v[60:63]
  s_waitcnt lgkmcnt(3)
  ds_read_b64_tr_b16 v[174:175], v160 offset:14336
  v_mfma_f32_16x16x32_bf16 v[68:71], v[192:195], a[68:71], v[68:71]
  s_add_u32 s39, s39, s99
  ds_read_b64_tr_b16 v[176:177], v161 offset:8192
  v_mfma_f32_16x16x32_bf16 v[68:71], v[196:199], a[76:79], v[68:71]
  ds_read_b64_tr_b16 v[178:179], v161 offset:10240
  v_mfma_f32_16x16x32_bf16 v[64:67], v[196:199], a[72:75], v[64:67]
  ds_read_b64_tr_b16 v[180:181], v161 offset:12288
  v_mfma_f32_16x16x32_bf16 v[64:67], v[192:195], a[64:67], v[64:67]
  s_waitcnt lgkmcnt(3)
  ds_read_b64_tr_b16 v[182:183], v161 offset:14336
  v_mfma_f32_16x16x32_bf16 v[72:75], v[168:171], a[64:67], v[72:75]
  ds_read_b64_tr_b16 v[184:185], v162 offset:8192
  buffer_load_dwordx4 v[216:219], v8, s[16:19], s39 offen sc1
  v_mfma_f32_16x16x32_bf16 v[72:75], v[172:175], a[72:75], v[72:75]
  ds_read_b64_tr_b16 v[186:187], v162 offset:10240
  v_mfma_f32_16x16x32_bf16 v[76:79], v[172:175], a[76:79], v[76:79]
  ds_read_b64_tr_b16 v[188:189], v162 offset:12288
  buffer_load_dwordx4 v6, s[12:15], s38 offen offset:2048 lds
  v_mfma_f32_16x16x32_bf16 v[76:79], v[168:171], a[68:71], v[76:79]
  s_waitcnt lgkmcnt(3)
  ds_read_b64_tr_b16 v[190:191], v162 offset:14336
  v_mfma_f32_16x16x32_bf16 v[84:87], v[176:179], a[68:71], v[84:87]
  ds_read_b64_tr_b16 v[192:193], v163 offset:8192
  v_mfma_f32_16x16x32_bf16 v[84:87], v[180:183], a[76:79], v[84:87]
  ds_read_b64_tr_b16 v[194:195], v163 offset:10240
  v_mfma_f32_16x16x32_bf16 v[80:83], v[180:183], a[72:75], v[80:83]
  ds_read_b64_tr_b16 v[196:197], v163 offset:12288
  buffer_load_dwordx4 v[220:223], v9, s[16:19], s39 offen sc1
  v_mfma_f32_16x16x32_bf16 v[80:83], v[176:179], a[64:67], v[80:83]
  s_waitcnt lgkmcnt(3)
  ds_read_b64_tr_b16 v[198:199], v163 offset:14336
  v_mfma_f32_16x16x32_bf16 v[88:91], v[184:187], a[64:67], v[88:91]
  ds_read_b64_tr_b16 v[168:169], v160 offset:16384
  v_mfma_f32_16x16x32_bf16 v[88:91], v[188:191], a[72:75], v[88:91]
  ds_read_b64_tr_b16 v[170:171], v160 offset:18432
  v_mfma_f32_16x16x32_bf16 v[92:95], v[188:191], a[76:79], v[92:95]
  ds_read_b64_tr_b16 v[172:173], v160 offset:20480
  buffer_load_dwordx4 v7, s[12:15], s38 offen offset:3072 lds
  v_mfma_f32_16x16x32_bf16 v[92:95], v[184:187], a[68:71], v[92:95]
  s_waitcnt vmcnt(26) lgkmcnt(3)
  ds_read_b64_tr_b16 v[174:175], v160 offset:22528
  v_mfma_f32_16x16x32_bf16 v[100:103], v[192:195], a[68:71], v[100:103]
  s_add_u32 s39, s39, s99
  ds_read_b64_tr_b16 v[176:177], v161 offset:16384
  v_swap_b32 v210, v212
  v_swap_b32 v211, v213
  v_mfma_f32_16x16x32_bf16 v[100:103], v[196:199], a[76:79], v[100:103]
  ds_read_b64_tr_b16 v[178:179], v161 offset:18432
  v_mfma_f32_16x16x32_bf16 v[96:99], v[196:199], a[72:75], v[96:99]
  ds_read_b64_tr_b16 v[180:181], v161 offset:20480
  v_mfma_f32_16x16x32_bf16 v[96:99], v[192:195], a[64:67], v[96:99]
  s_waitcnt vmcnt(24) lgkmcnt(3)
  ds_read_b64_tr_b16 v[182:183], v161 offset:22528
  v_mfma_f32_16x16x32_bf16 v[40:43], v[168:171], v[208:211], v[40:43]
  ds_read_b64_tr_b16 v[184:185], v162 offset:16384
  buffer_load_dwordx4 a[144:147], v8, s[16:19], s39 offen sc1
  v_mfma_f32_16x16x32_bf16 v[40:43], v[172:175], a[88:91], v[40:43]
  s_add_u32 s38, s38, s96
  ds_read_b64_tr_b16 v[186:187], v162 offset:18432
  v_mfma_f32_16x16x32_bf16 v[44:47], v[172:175], a[92:95], v[44:47]
  s_add_u32 m0, s37, 16384
  ds_read_b64_tr_b16 v[188:189], v162 offset:20480
  buffer_load_dwordx4 v4, s[12:15], s38 offen offset:0 lds
  v_mfma_f32_16x16x32_bf16 v[44:47], v[168:171], v[212:215], v[44:47]
  s_waitcnt lgkmcnt(3)
  ds_read_b64_tr_b16 v[190:191], v162 offset:22528
  v_mfma_f32_16x16x32_bf16 v[52:55], v[176:179], v[212:215], v[52:55]
  ds_read_b64_tr_b16 v[192:193], v163 offset:16384
  v_mfma_f32_16x16x32_bf16 v[52:55], v[180:183], a[92:95], v[52:55]
  ds_read_b64_tr_b16 v[194:195], v163 offset:18432
  v_mfma_f32_16x16x32_bf16 v[48:51], v[180:183], a[88:91], v[48:51]
  ds_read_b64_tr_b16 v[196:197], v163 offset:20480
  buffer_load_dwordx4 a[148:151], v9, s[16:19], s39 offen sc1
  v_mfma_f32_16x16x32_bf16 v[48:51], v[176:179], v[208:211], v[48:51]
  s_waitcnt lgkmcnt(3)
  ds_read_b64_tr_b16 v[198:199], v163 offset:22528
  v_mfma_f32_16x16x32_bf16 v[56:59], v[184:187], v[208:211], v[56:59]
  ds_read_b64_tr_b16 v[168:169], v160 offset:24576
  v_mfma_f32_16x16x32_bf16 v[56:59], v[188:191], a[88:91], v[56:59]
  ds_read_b64_tr_b16 v[170:171], v160 offset:26624
  v_mfma_f32_16x16x32_bf16 v[60:63], v[188:191], a[92:95], v[60:63]
  ds_read_b64_tr_b16 v[172:173], v160 offset:28672
  buffer_load_dwordx4 v5, s[12:15], s38 offen offset:1024 lds
  v_mfma_f32_16x16x32_bf16 v[60:63], v[184:187], v[212:215], v[60:63]
  s_waitcnt lgkmcnt(3)
  ds_read_b64_tr_b16 v[174:175], v160 offset:30720
  v_mfma_f32_16x16x32_bf16 v[68:71], v[192:195], v[212:215], v[68:71]
  s_add_u32 s39, s39, s99
  ds_read_b64_tr_b16 v[176:177], v161 offset:24576
  v_mfma_f32_16x16x32_bf16 v[68:71], v[196:199], a[92:95], v[68:71]
  ds_read_b64_tr_b16 v[178:179], v161 offset:26624
  v_mfma_f32_16x16x32_bf16 v[64:67], v[196:199], a[88:91], v[64:67]
  ds_read_b64_tr_b16 v[180:181], v161 offset:28672
  v_mfma_f32_16x16x32_bf16 v[64:67], v[192:195], v[208:211], v[64:67]
  s_waitcnt lgkmcnt(3)
  ds_read_b64_tr_b16 v[182:183], v161 offset:30720
  v_mfma_f32_16x16x32_bf16 v[72:75], v[168:171], v[208:211], v[72:75]
  ds_read_b64_tr_b16 v[184:185], v162 offset:24576
  buffer_load_dwordx4 a[152:155], v8, s[16:19], s39 offen sc1
  v_mfma_f32_16x16x32_bf16 v[72:75], v[172:175], a[88:91], v[72:75]
  ds_read_b64_tr_b16 v[186:187], v162 offset:26624
  v_mfma_f32_16x16x32_bf16 v[76:79], v[172:175], a[92:95], v[76:79]
  ds_read_b64_tr_b16 v[188:189], v162 offset:28672
  buffer_load_dwordx4 v6, s[12:15], s38 offen offset:2048 lds
  v_mfma_f32_16x16x32_bf16 v[76:79], v[168:171], v[212:215], v[76:79]
  s_waitcnt lgkmcnt(3)
  ds_read_b64_tr_b16 v[190:191], v162 offset:30720
  v_mfma_f32_16x16x32_bf16 v[84:87], v[176:179], v[212:215], v[84:87]
  ds_read_b64_tr_b16 v[192:193], v163 offset:24576
  v_mfma_f32_16x16x32_bf16 v[84:87], v[180:183], a[92:95], v[84:87]
  ds_read_b64_tr_b16 v[194:195], v163 offset:26624
  v_mfma_f32_16x16x32_bf16 v[80:83], v[180:183], a[88:91], v[80:83]
  ds_read_b64_tr_b16 v[196:197], v163 offset:28672
  buffer_load_dwordx4 a[156:159], v9, s[16:19], s39 offen sc1
  v_mfma_f32_16x16x32_bf16 v[80:83], v[176:179], v[208:211], v[80:83]
  s_waitcnt vmcnt(56) lgkmcnt(3)
  ds_read_b64_tr_b16 v[198:199], v163 offset:30720
  v_mfma_f32_16x16x32_bf16 v[88:91], v[184:187], v[208:211], v[88:91]
  s_barrier
  ds_read_b64_tr_b16 v[168:169], v20 offset:0
  v_mfma_f32_16x16x32_bf16 v[88:91], v[188:191], a[88:91], v[88:91]
  ds_read_b64_tr_b16 v[170:171], v20 offset:2048
  v_mfma_f32_16x16x32_bf16 v[92:95], v[188:191], a[92:95], v[92:95]
  ds_read_b64_tr_b16 v[172:173], v20 offset:4096
  buffer_load_dwordx4 v7, s[12:15], s38 offen offset:3072 lds
  v_mfma_f32_16x16x32_bf16 v[92:95], v[184:187], v[212:215], v[92:95]
  s_waitcnt lgkmcnt(3)
  ds_read_b64_tr_b16 v[174:175], v20 offset:6144
  v_mfma_f32_16x16x32_bf16 v[100:103], v[192:195], v[212:215], v[100:103]
  s_add_u32 s39, s39, s99
  ds_read_b64_tr_b16 v[176:177], v21 offset:0
  v_mfma_f32_16x16x32_bf16 v[100:103], v[196:199], a[92:95], v[100:103]
  ds_read_b64_tr_b16 v[178:179], v21 offset:2048
  v_mfma_f32_16x16x32_bf16 v[96:99], v[196:199], a[88:91], v[96:99]
  ds_read_b64_tr_b16 v[180:181], v21 offset:4096
  v_mfma_f32_16x16x32_bf16 v[96:99], v[192:195], v[208:211], v[96:99]
  s_waitcnt vmcnt(25) lgkmcnt(3)
  ds_read_b64_tr_b16 v[182:183], v21 offset:6144
  v_mfma_f32_16x16x32_bf16 v[40:43], v[168:171], a[96:99], v[40:43]
  ds_read_b64_tr_b16 v[184:185], v22 offset:0
  buffer_load_dwordx4 a[160:163], v8, s[16:19], s39 offen sc1
  v_mfma_f32_16x16x32_bf16 v[40:43], v[172:175], a[104:107], v[40:43]
  s_add_u32 s38, s38, s96
  ds_read_b64_tr_b16 v[186:187], v22 offset:2048
  v_mfma_f32_16x16x32_bf16 v[44:47], v[172:175], a[108:111], v[44:47]
  s_add_u32 m0, s37, 32768
  ds_read_b64_tr_b16 v[188:189], v22 offset:4096
  buffer_load_dwordx4 v4, s[12:15], s38 offen offset:0 lds
  v_mfma_f32_16x16x32_bf16 v[44:47], v[168:171], a[100:103], v[44:47]
  s_waitcnt lgkmcnt(3)
  ds_read_b64_tr_b16 v[190:191], v22 offset:6144
  v_mfma_f32_16x16x32_bf16 v[52:55], v[176:179], a[100:103], v[52:55]
  ds_read_b64_tr_b16 v[192:193], v23 offset:0
  v_mfma_f32_16x16x32_bf16 v[52:55], v[180:183], a[108:111], v[52:55]
  ds_read_b64_tr_b16 v[194:195], v23 offset:2048
  v_mfma_f32_16x16x32_bf16 v[48:51], v[180:183], a[104:107], v[48:51]
L_pad_3b_1:
  s_cbranch_execz L_pad_3b_4
  ds_read_b64_tr_b16 v[196:197], v23 offset:4096
  buffer_load_dwordx4 a[164:167], v9, s[16:19], s39 offen sc1
  v_mfma_f32_16x16x32_bf16 v[48:51], v[176:179], a[96:99], v[48:51]
  s_waitcnt lgkmcnt(3)
  ds_read_b64_tr_b16 v[198:199], v23 offset:6144
  v_mfma_f32_16x16x32_bf16 v[56:59], v[184:187], a[96:99], v[56:59]
  ds_read_b64_tr_b16 v[168:169], v20 offset:8192
  v_mfma_f32_16x16x32_bf16 v[56:59], v[188:191], a[104:107], v[56:59]
  ds_read_b64_tr_b16 v[170:171], v20 offset:10240
  v_mfma_f32_16x16x32_bf16 v[60:63], v[188:191], a[108:111], v[60:63]
  ds_read_b64_tr_b16 v[172:173], v20 offset:12288
  buffer_load_dwordx4 v5, s[12:15], s38 offen offset:1024 lds
  v_mfma_f32_16x16x32_bf16 v[60:63], v[184:187], a[100:103], v[60:63]
  s_waitcnt lgkmcnt(3)
  ds_read_b64_tr_b16 v[174:175], v20 offset:14336
  v_mfma_f32_16x16x32_bf16 v[68:71], v[192:195], a[100:103], v[68:71]
  s_add_u32 s39, s39, s99
  ds_read_b64_tr_b16 v[176:177], v21 offset:8192
  v_mfma_f32_16x16x32_bf16 v[68:71], v[196:199], a[108:111], v[68:71]
  ds_read_b64_tr_b16 v[178:179], v21 offset:10240
  v_mfma_f32_16x16x32_bf16 v[64:67], v[196:199], a[104:107], v[64:67]
  ds_read_b64_tr_b16 v[180:181], v21 offset:12288
  v_mfma_f32_16x16x32_bf16 v[64:67], v[192:195], a[96:99], v[64:67]
  s_waitcnt lgkmcnt(3)
  ds_read_b64_tr_b16 v[182:183], v21 offset:14336
  v_mfma_f32_16x16x32_bf16 v[72:75], v[168:171], a[96:99], v[72:75]
  ds_read_b64_tr_b16 v[184:185], v22 offset:8192
  buffer_load_dwordx4 a[168:171], v8, s[16:19], s39 offen sc1
  v_mfma_f32_16x16x32_bf16 v[72:75], v[172:175], a[104:107], v[72:75]
  ds_read_b64_tr_b16 v[186:187], v22 offset:10240
  v_mfma_f32_16x16x32_bf16 v[76:79], v[172:175], a[108:111], v[76:79]
  ds_read_b64_tr_b16 v[188:189], v22 offset:12288
  buffer_load_dwordx4 v6, s[12:15], s38 offen offset:2048 lds
  v_mfma_f32_16x16x32_bf16 v[76:79], v[168:171], a[100:103], v[76:79]
  s_waitcnt lgkmcnt(3)
  ds_read_b64_tr_b16 v[190:191], v22 offset:14336
  v_mfma_f32_16x16x32_bf16 v[84:87], v[176:179], a[100:103], v[84:87]
  ds_read_b64_tr_b16 v[192:193], v23 offset:8192
  v_mfma_f32_16x16x32_bf16 v[84:87], v[180:183], a[108:111], v[84:87]
  ds_read_b64_tr_b16 v[194:195], v23 offset:10240
  v_mfma_f32_16x16x32_bf16 v[80:83], v[180:183], a[104:107], v[80:83]
  ds_read_b64_tr_b16 v[196:197], v23 offset:12288
  buffer_load_dwordx4 a[172:175], v9, s[16:19], s39 offen sc1
  v_mfma_f32_16x16x32_bf16 v[80:83], v[176:179], a[96:99], v[80:83]
  s_waitcnt lgkmcnt(3)
  ds_read_b64_tr_b16 v[198:199], v23 offset:14336
  v_mfma_f32_16x16x32_bf16 v[88:91], v[184:187], a[96:99], v[88:91]
  ds_read_b64_tr_b16 v[168:169], v20 offset:16384
  v_mfma_f32_16x16x32_bf16 v[88:91], v[188:191], a[104:107], v[88:91]
  ds_read_b64_tr_b16 v[170:171], v20 offset:18432
  v_mfma_f32_16x16x32_bf16 v[92:95], v[188:191], a[108:111], v[92:95]
  ds_read_b64_tr_b16 v[172:173], v20 offset:20480
  buffer_load_dwordx4 v7, s[12:15], s38 offen offset:3072 lds
  v_mfma_f32_16x16x32_bf16 v[92:95], v[184:187], a[100:103], v[92:95]
  s_waitcnt lgkmcnt(3)
  ds_read_b64_tr_b16 v[174:175], v20 offset:22528
  v_mfma_f32_16x16x32_bf16 v[100:103], v[192:195], a[100:103], v[100:103]
  s_add_u32 s39, s39, s99
  ds_read_b64_tr_b16 v[176:177], v21 offset:16384
  v_mfma_f32_16x16x32_bf16 v[100:103], v[196:199], a[108:111], v[100:103]
  ds_read_b64_tr_b16 v[178:179], v21 offset:18432
  v_mfma_f32_16x16x32_bf16 v[96:99], v[196:199], a[104:107], v[96:99]
  ds_read_b64_tr_b16 v[180:181], v21 offset:20480
  v_mfma_f32_16x16x32_bf16 v[96:99], v[192:195], a[96:99], v[96:99]
  s_waitcnt vmcnt(25) lgkmcnt(3)
  ds_read_b64_tr_b16 v[182:183], v21 offset:22528
  v_mfma_f32_16x16x32_bf16 v[40:43], v[168:171], a[112:115], v[40:43]
  ds_read_b64_tr_b16 v[184:185], v22 offset:16384
  buffer_load_dwordx4 a[176:179], v8, s[16:19], s39 offen sc1
  v_mfma_f32_16x16x32_bf16 v[40:43], v[172:175], a[120:123], v[40:43]
  s_add_u32 s38, s38, s96
  ds_read_b64_tr_b16 v[186:187], v22 offset:18432
  v_mfma_f32_16x16x32_bf16 v[44:47], v[172:175], a[124:127], v[44:47]
  s_add_u32 m0, s37, 49152
  ds_read_b64_tr_b16 v[188:189], v22 offset:20480
  buffer_load_dwordx4 v4, s[12:15], s38 offen offset:0 lds
  v_mfma_f32_16x16x32_bf16 v[44:47], v[168:171], a[116:119], v[44:47]
  s_waitcnt lgkmcnt(3)
  ds_read_b64_tr_b16 v[190:191], v22 offset:22528
  v_mfma_f32_16x16x32_bf16 v[52:55], v[176:179], a[116:119], v[52:55]
  ds_read_b64_tr_b16 v[192:193], v23 offset:16384
  v_mfma_f32_16x16x32_bf16 v[52:55], v[180:183], a[124:127], v[52:55]
  ds_read_b64_tr_b16 v[194:195], v23 offset:18432
  v_mfma_f32_16x16x32_bf16 v[48:51], v[180:183], a[120:123], v[48:51]
  ds_read_b64_tr_b16 v[196:197], v23 offset:20480
  buffer_load_dwordx4 a[180:183], v9, s[16:19], s39 offen sc1
  v_mfma_f32_16x16x32_bf16 v[48:51], v[176:179], a[112:115], v[48:51]
  s_waitcnt lgkmcnt(3)
  ds_read_b64_tr_b16 v[198:199], v23 offset:22528
  v_mfma_f32_16x16x32_bf16 v[56:59], v[184:187], a[112:115], v[56:59]
  ds_read_b64_tr_b16 v[168:169], v20 offset:24576
  v_mfma_f32_16x16x32_bf16 v[56:59], v[188:191], a[120:123], v[56:59]
  ds_read_b64_tr_b16 v[170:171], v20 offset:26624
  v_mfma_f32_16x16x32_bf16 v[60:63], v[188:191], a[124:127], v[60:63]
  ds_read_b64_tr_b16 v[172:173], v20 offset:28672
  buffer_load_dwordx4 v5, s[12:15], s38 offen offset:1024 lds
  v_mfma_f32_16x16x32_bf16 v[60:63], v[184:187], a[116:119], v[60:63]
  s_waitcnt lgkmcnt(3)
  ds_read_b64_tr_b16 v[174:175], v20 offset:30720
  v_mfma_f32_16x16x32_bf16 v[68:71], v[192:195], a[116:119], v[68:71]
  s_add_u32 s39, s39, s99
  ds_read_b64_tr_b16 v[176:177], v21 offset:24576
  v_mfma_f32_16x16x32_bf16 v[68:71], v[196:199], a[124:127], v[68:71]
  ds_read_b64_tr_b16 v[178:179], v21 offset:26624
  v_mfma_f32_16x16x32_bf16 v[64:67], v[196:199], a[120:123], v[64:67]
  ds_read_b64_tr_b16 v[180:181], v21 offset:28672
  v_mfma_f32_16x16x32_bf16 v[64:67], v[192:195], a[112:115], v[64:67]
  s_waitcnt lgkmcnt(3)
  ds_read_b64_tr_b16 v[182:183], v21 offset:30720
  v_mfma_f32_16x16x32_bf16 v[72:75], v[168:171], a[112:115], v[72:75]
  ds_read_b64_tr_b16 v[184:185], v22 offset:24576
  buffer_load_dwordx4 a[184:187], v8, s[16:19], s39 offen sc1
  v_mfma_f32_16x16x32_bf16 v[72:75], v[172:175], a[120:123], v[72:75]
  ds_read_b64_tr_b16 v[186:187], v22 offset:26624
  v_mfma_f32_16x16x32_bf16 v[76:79], v[172:175], a[124:127], v[76:79]
  ds_read_b64_tr_b16 v[188:189], v22 offset:28672
  buffer_load_dwordx4 v6, s[12:15], s38 offen offset:2048 lds
  v_mfma_f32_16x16x32_bf16 v[76:79], v[168:171], a[116:119], v[76:79]
  s_waitcnt lgkmcnt(3)
  ds_read_b64_tr_b16 v[190:191], v22 offset:30720
  v_mfma_f32_16x16x32_bf16 v[84:87], v[176:179], a[116:119], v[84:87]
  ds_read_b64_tr_b16 v[192:193], v23 offset:24576
  v_mfma_f32_16x16x32_bf16 v[84:87], v[180:183], a[124:127], v[84:87]
  ds_read_b64_tr_b16 v[194:195], v23 offset:26624
  v_mfma_f32_16x16x32_bf16 v[80:83], v[180:183], a[120:123], v[80:83]
  ds_read_b64_tr_b16 v[196:197], v23 offset:28672
  buffer_load_dwordx4 a[188:191], v9, s[16:19], s39 offen sc1
  v_mfma_f32_16x16x32_bf16 v[80:83], v[176:179], a[112:115], v[80:83]
  s_waitcnt vmcnt(31) lgkmcnt(3)
  ds_read_b64_tr_b16 v[198:199], v23 offset:30720
  v_mfma_f32_16x16x32_bf16 v[88:91], v[184:187], a[112:115], v[88:91]
  s_barrier
  ds_read_b64_tr_b16 v[168:169], v20 offset:32768
  v_mfma_f32_16x16x32_bf16 v[88:91], v[188:191], a[120:123], v[88:91]
  ds_read_b64_tr_b16 v[170:171], v20 offset:34816
  v_mfma_f32_16x16x32_bf16 v[92:95], v[188:191], a[124:127], v[92:95]
  ds_read_b64_tr_b16 v[172:173], v20 offset:36864
  buffer_load_dwordx4 v7, s[12:15], s38 offen offset:3072 lds
  v_mfma_f32_16x16x32_bf16 v[92:95], v[184:187], a[116:119], v[92:95]
  s_waitcnt vmcnt(25) lgkmcnt(3)
  ds_read_b64_tr_b16 v[174:175], v20 offset:38912
  v_mfma_f32_16x16x32_bf16 v[100:103], v[192:195], a[116:119], v[100:103]
  s_add_u32 s39, s39, s99
  ds_read_b64_tr_b16 v[176:177], v21 offset:32768
  v_swap_b32 v218, v220
  v_swap_b32 v219, v221
  v_mfma_f32_16x16x32_bf16 v[100:103], v[196:199], a[124:127], v[100:103]
  ds_read_b64_tr_b16 v[178:179], v21 offset:34816
  v_mfma_f32_16x16x32_bf16 v[96:99], v[196:199], a[120:123], v[96:99]
  ds_read_b64_tr_b16 v[180:181], v21 offset:36864
  v_mfma_f32_16x16x32_bf16 v[96:99], v[192:195], a[112:115], v[96:99]
  s_waitcnt vmcnt(25) lgkmcnt(3)
  ds_read_b64_tr_b16 v[182:183], v21 offset:38912
  v_mfma_f32_16x16x32_bf16 v[40:43], v[168:171], a[128:131], v[40:43]
  ds_read_b64_tr_b16 v[184:185], v22 offset:32768
  buffer_load_dwordx4 v[224:227], v8, s[16:19], s39 offen sc1
  v_mfma_f32_16x16x32_bf16 v[40:43], v[172:175], v[216:219], v[40:43]
  s_add_u32 s38, s38, s96
  ds_read_b64_tr_b16 v[186:187], v22 offset:34816
  v_mfma_f32_16x16x32_bf16 v[44:47], v[172:175], v[220:223], v[44:47]
  s_add_u32 m0, s37, 131072
  ds_read_b64_tr_b16 v[188:189], v22 offset:36864
  buffer_load_dwordx4 v4, s[12:15], s38 offen offset:0 lds
  v_mfma_f32_16x16x32_bf16 v[44:47], v[168:171], a[132:135], v[44:47]
  s_waitcnt lgkmcnt(3)
  ds_read_b64_tr_b16 v[190:191], v22 offset:38912
  v_mfma_f32_16x16x32_bf16 v[52:55], v[176:179], a[132:135], v[52:55]
  ds_read_b64_tr_b16 v[192:193], v23 offset:32768
  v_mfma_f32_16x16x32_bf16 v[52:55], v[180:183], v[220:223], v[52:55]
  ds_read_b64_tr_b16 v[194:195], v23 offset:34816
  v_mfma_f32_16x16x32_bf16 v[48:51], v[180:183], v[216:219], v[48:51]
  ds_read_b64_tr_b16 v[196:197], v23 offset:36864
  buffer_load_dwordx4 v[228:231], v9, s[16:19], s39 offen sc1
  v_mfma_f32_16x16x32_bf16 v[48:51], v[176:179], a[128:131], v[48:51]
  s_waitcnt lgkmcnt(3)
  ds_read_b64_tr_b16 v[198:199], v23 offset:38912
  v_mfma_f32_16x16x32_bf16 v[56:59], v[184:187], a[128:131], v[56:59]
  ds_read_b64_tr_b16 v[168:169], v20 offset:40960
  v_mfma_f32_16x16x32_bf16 v[56:59], v[188:191], v[216:219], v[56:59]
  ds_read_b64_tr_b16 v[170:171], v20 offset:43008
  v_mfma_f32_16x16x32_bf16 v[60:63], v[188:191], v[220:223], v[60:63]
  ds_read_b64_tr_b16 v[172:173], v20 offset:45056
  buffer_load_dwordx4 v5, s[12:15], s38 offen offset:1024 lds
  v_mfma_f32_16x16x32_bf16 v[60:63], v[184:187], a[132:135], v[60:63]
  s_waitcnt lgkmcnt(3)
  ds_read_b64_tr_b16 v[174:175], v20 offset:47104
  v_mfma_f32_16x16x32_bf16 v[68:71], v[192:195], a[132:135], v[68:71]
  s_add_u32 s39, s39, s99
  ds_read_b64_tr_b16 v[176:177], v21 offset:40960
  v_mfma_f32_16x16x32_bf16 v[68:71], v[196:199], v[220:223], v[68:71]
  ds_read_b64_tr_b16 v[178:179], v21 offset:43008
  v_mfma_f32_16x16x32_bf16 v[64:67], v[196:199], v[216:219], v[64:67]
  ds_read_b64_tr_b16 v[180:181], v21 offset:45056
  v_mfma_f32_16x16x32_bf16 v[64:67], v[192:195], a[128:131], v[64:67]
  s_waitcnt lgkmcnt(3)
  ds_read_b64_tr_b16 v[182:183], v21 offset:47104
  v_mfma_f32_16x16x32_bf16 v[72:75], v[168:171], a[128:131], v[72:75]
  ds_read_b64_tr_b16 v[184:185], v22 offset:40960
  v_add_u32 v11, s41, v11
  v_mfma_f32_16x16x32_bf16 v[72:75], v[172:175], v[216:219], v[72:75]
  ds_read_b64_tr_b16 v[186:187], v22 offset:43008
  global_load_dwordx2 v[12:13], v11, s[4:5] sc1
  v_mfma_f32_16x16x32_bf16 v[76:79], v[172:175], v[220:223], v[76:79]
  ds_read_b64_tr_b16 v[188:189], v22 offset:45056
  buffer_load_dwordx4 a[200:203], v8, s[16:19], s39 offen sc1
  v_mfma_f32_16x16x32_bf16 v[76:79], v[168:171], a[132:135], v[76:79]
  s_waitcnt lgkmcnt(3)
  ds_read_b64_tr_b16 v[190:191], v22 offset:47104
  v_mfma_f32_16x16x32_bf16 v[84:87], v[176:179], a[132:135], v[84:87]
  ds_read_b64_tr_b16 v[192:193], v23 offset:40960
  buffer_load_dwordx4 v6, s[12:15], s38 offen offset:2048 lds
  v_mfma_f32_16x16x32_bf16 v[84:87], v[180:183], v[220:223], v[84:87]
  ds_read_b64_tr_b16 v[194:195], v23 offset:43008
  v_mfma_f32_16x16x32_bf16 v[80:83], v[180:183], v[216:219], v[80:83]
  ds_read_b64_tr_b16 v[196:197], v23 offset:45056
  v_mfma_f32_16x16x32_bf16 v[80:83], v[176:179], a[128:131], v[80:83]
  s_waitcnt lgkmcnt(3)
  ds_read_b64_tr_b16 v[198:199], v23 offset:47104
  v_mfma_f32_16x16x32_bf16 v[88:91], v[184:187], a[128:131], v[88:91]
  ds_read_b64_tr_b16 v[168:169], v20 offset:49152
  buffer_load_dwordx4 a[204:207], v9, s[16:19], s39 offen sc1
  v_mfma_f32_16x16x32_bf16 v[88:91], v[188:191], v[216:219], v[88:91]
  ds_read_b64_tr_b16 v[170:171], v20 offset:51200
  v_mfma_f32_16x16x32_bf16 v[92:95], v[188:191], v[220:223], v[92:95]
  ds_read_b64_tr_b16 v[172:173], v20 offset:53248
  v_mfma_f32_16x16x32_bf16 v[92:95], v[184:187], a[132:135], v[92:95]
  s_waitcnt lgkmcnt(3)
  ds_read_b64_tr_b16 v[174:175], v20 offset:55296
  v_mfma_f32_16x16x32_bf16 v[100:103], v[192:195], a[132:135], v[100:103]
  ds_read_b64_tr_b16 v[176:177], v21 offset:49152
  buffer_load_dwordx4 v7, s[12:15], s38 offen offset:3072 lds
  v_mfma_f32_16x16x32_bf16 v[100:103], v[196:199], v[220:223], v[100:103]
  s_add_u32 s39, s39, s99
  ds_read_b64_tr_b16 v[178:179], v21 offset:51200
  v_mfma_f32_16x16x32_bf16 v[96:99], v[196:199], v[216:219], v[96:99]
  ds_read_b64_tr_b16 v[180:181], v21 offset:53248
  v_mfma_f32_16x16x32_bf16 v[96:99], v[192:195], a[128:131], v[96:99]
  s_waitcnt vmcnt(26) lgkmcnt(3)
  ds_read_b64_tr_b16 v[182:183], v21 offset:55296
  v_mfma_f32_16x16x32_bf16 v[40:43], v[168:171], a[144:147], v[40:43]
  ds_read_b64_tr_b16 v[184:185], v22 offset:49152
  buffer_load_dwordx4 a[208:211], v8, s[16:19], s39 offen sc1
  v_mfma_f32_16x16x32_bf16 v[40:43], v[172:175], a[152:155], v[40:43]
  s_add_u32 s38, s38, s96
  ds_read_b64_tr_b16 v[186:187], v22 offset:51200
  v_mfma_f32_16x16x32_bf16 v[44:47], v[172:175], a[156:159], v[44:47]
  s_add_u32 m0, s37, 147456
  ds_read_b64_tr_b16 v[188:189], v22 offset:53248
  v_mfma_f32_16x16x32_bf16 v[44:47], v[168:171], a[148:151], v[44:47]
  s_waitcnt lgkmcnt(3)
  ds_read_b64_tr_b16 v[190:191], v22 offset:55296
  buffer_load_dwordx4 v4, s[12:15], s38 offen offset:0 lds
  v_mfma_f32_16x16x32_bf16 v[52:55], v[176:179], a[148:151], v[52:55]
  ds_read_b64_tr_b16 v[192:193], v23 offset:49152
  v_mfma_f32_16x16x32_bf16 v[52:55], v[180:183], a[156:159], v[52:55]
  ds_read_b64_tr_b16 v[194:195], v23 offset:51200
  v_mfma_f32_16x16x32_bf16 v[48:51], v[180:183], a[152:155], v[48:51]
  ds_read_b64_tr_b16 v[196:197], v23 offset:53248
  v_mfma_f32_16x16x32_bf16 v[48:51], v[176:179], a[144:147], v[48:51]
  s_waitcnt lgkmcnt(3)
  ds_read_b64_tr_b16 v[198:199], v23 offset:55296
  buffer_load_dwordx4 a[212:215], v9, s[16:19], s39 offen sc1
  v_mfma_f32_16x16x32_bf16 v[56:59], v[184:187], a[144:147], v[56:59]
  ds_read_b64_tr_b16 v[168:169], v20 offset:57344
  v_mfma_f32_16x16x32_bf16 v[56:59], v[188:191], a[152:155], v[56:59]
  ds_read_b64_tr_b16 v[170:171], v20 offset:59392
  v_mfma_f32_16x16x32_bf16 v[60:63], v[188:191], a[156:159], v[60:63]
  ds_read_b64_tr_b16 v[172:173], v20 offset:61440
  v_mfma_f32_16x16x32_bf16 v[60:63], v[184:187], a[148:151], v[60:63]
  s_waitcnt lgkmcnt(3)
  ds_read_b64_tr_b16 v[174:175], v20 offset:63488
  buffer_load_dwordx4 v5, s[12:15], s38 offen offset:1024 lds
  v_mfma_f32_16x16x32_bf16 v[68:71], v[192:195], a[148:151], v[68:71]
  s_add_u32 s39, s39, s99
  ds_read_b64_tr_b16 v[176:177], v21 offset:57344
  v_mfma_f32_16x16x32_bf16 v[68:71], v[196:199], a[156:159], v[68:71]
  ds_read_b64_tr_b16 v[178:179], v21 offset:59392
  v_mfma_f32_16x16x32_bf16 v[64:67], v[196:199], a[152:155], v[64:67]
  ds_read_b64_tr_b16 v[180:181], v21 offset:61440
  v_mfma_f32_16x16x32_bf16 v[64:67], v[192:195], a[144:147], v[64:67]
  s_waitcnt lgkmcnt(3)
  ds_read_b64_tr_b16 v[182:183], v21 offset:63488
  v_mfma_f32_16x16x32_bf16 v[72:75], v[168:171], a[144:147], v[72:75]
  ds_read_b64_tr_b16 v[184:185], v22 offset:57344
  buffer_load_dwordx4 a[216:219], v8, s[16:19], s39 offen sc1
  v_mfma_f32_16x16x32_bf16 v[72:75], v[172:175], a[152:155], v[72:75]
  ds_read_b64_tr_b16 v[186:187], v22 offset:59392
  v_mfma_f32_16x16x32_bf16 v[76:79], v[172:175], a[156:159], v[76:79]
  ds_read_b64_tr_b16 v[188:189], v22 offset:61440
  buffer_load_dwordx4 v6, s[12:15], s38 offen offset:2048 lds
  v_mfma_f32_16x16x32_bf16 v[76:79], v[168:171], a[148:151], v[76:79]
  s_waitcnt lgkmcnt(3)
  ds_read_b64_tr_b16 v[190:191], v22 offset:63488
  v_mfma_f32_16x16x32_bf16 v[84:87], v[176:179], a[148:151], v[84:87]
  ds_read_b64_tr_b16 v[192:193], v23 offset:57344
  v_mfma_f32_16x16x32_bf16 v[84:87], v[180:183], a[156:159], v[84:87]
  ds_read_b64_tr_b16 v[194:195], v23 offset:59392
  v_mfma_f32_16x16x32_bf16 v[80:83], v[180:183], a[152:155], v[80:83]
  ds_read_b64_tr_b16 v[196:197], v23 offset:61440
  buffer_load_dwordx4 a[220:223], v9, s[16:19], s39 offen sc1
  v_mfma_f32_16x16x32_bf16 v[80:83], v[176:179], a[144:147], v[80:83]
  s_waitcnt vmcnt(32) lgkmcnt(3)
  ds_read_b64_tr_b16 v[198:199], v23 offset:63488
  v_mfma_f32_16x16x32_bf16 v[88:91], v[184:187], a[144:147], v[88:91]
  s_barrier
  ds_read_b64_tr_b16 v[168:169], v16 offset:0
  v_mfma_f32_16x16x32_bf16 v[88:91], v[188:191], a[152:155], v[88:91]
  ds_read_b64_tr_b16 v[170:171], v16 offset:2048
  v_mfma_f32_16x16x32_bf16 v[92:95], v[188:191], a[156:159], v[92:95]
  ds_read_b64_tr_b16 v[172:173], v16 offset:4096
  buffer_load_dwordx4 v7, s[12:15], s38 offen offset:3072 lds
  v_mfma_f32_16x16x32_bf16 v[92:95], v[184:187], a[148:151], v[92:95]
  s_waitcnt lgkmcnt(3)
  ds_read_b64_tr_b16 v[174:175], v16 offset:6144
  v_mfma_f32_16x16x32_bf16 v[100:103], v[192:195], a[148:151], v[100:103]
  s_add_u32 s39, s39, s99
  ds_read_b64_tr_b16 v[176:177], v17 offset:0
  v_mfma_f32_16x16x32_bf16 v[100:103], v[196:199], a[156:159], v[100:103]
  ds_read_b64_tr_b16 v[178:179], v17 offset:2048
  v_mfma_f32_16x16x32_bf16 v[96:99], v[196:199], a[152:155], v[96:99]
  ds_read_b64_tr_b16 v[180:181], v17 offset:4096
  v_mfma_f32_16x16x32_bf16 v[96:99], v[192:195], a[144:147], v[96:99]
  s_waitcnt vmcnt(12) lgkmcnt(3)
  ds_read_b64_tr_b16 v[182:183], v17 offset:6144
  v_cmp_ne_u64 vcc, s[6:7], v[12:13]
  s_cbranch_vccnz L_slow_34
L_back_35:
  v_mfma_f32_16x16x32_bf16 v[40:43], v[168:171], a[160:163], v[40:43]
  ds_read_b64_tr_b16 v[184:185], v18 offset:0
  buffer_load_dwordx4 a[224:227], v8, s[16:19], s39 offen sc1
  v_mfma_f32_16x16x32_bf16 v[40:43], v[172:175], a[168:171], v[40:43]
  s_add_u32 s38, s38, s96
  ds_read_b64_tr_b16 v[186:187], v18 offset:2048
  v_mfma_f32_16x16x32_bf16 v[44:47], v[172:175], a[172:175], v[44:47]
  s_add_u32 m0, s37, 65536
  ds_read_b64_tr_b16 v[188:189], v18 offset:4096
  buffer_load_dwordx4 v4, s[12:15], s38 offen offset:0 lds
  v_mfma_f32_16x16x32_bf16 v[44:47], v[168:171], a[164:167], v[44:47]
  s_waitcnt lgkmcnt(3)
  ds_read_b64_tr_b16 v[190:191], v18 offset:6144
  v_mfma_f32_16x16x32_bf16 v[52:55], v[176:179], a[164:167], v[52:55]
  ds_read_b64_tr_b16 v[192:193], v19 offset:0
  v_mfma_f32_16x16x32_bf16 v[52:55], v[180:183], a[172:175], v[52:55]
  ds_read_b64_tr_b16 v[194:195], v19 offset:2048
  v_mfma_f32_16x16x32_bf16 v[48:51], v[180:183], a[168:171], v[48:51]
  ds_read_b64_tr_b16 v[196:197], v19 offset:4096
  buffer_load_dwordx4 a[228:231], v9, s[16:19], s39 offen sc1
  v_mfma_f32_16x16x32_bf16 v[48:51], v[176:179], a[160:163], v[48:51]
  s_waitcnt lgkmcnt(3)
  ds_read_b64_tr_b16 v[198:199], v19 offset:6144
  v_mfma_f32_16x16x32_bf16 v[56:59], v[184:187], a[160:163], v[56:59]
  ds_read_b64_tr_b16 v[168:169], v16 offset:8192
  v_mfma_f32_16x16x32_bf16 v[56:59], v[188:191], a[168:171], v[56:59]
  ds_read_b64_tr_b16 v[170:171], v16 offset:10240
  v_mfma_f32_16x16x32_bf16 v[60:63], v[188:191], a[172:175], v[60:63]
  ds_read_b64_tr_b16 v[172:173], v16 offset:12288
  buffer_load_dwordx4 v5, s[12:15], s38 offen offset:1024 lds
  v_mfma_f32_16x16x32_bf16 v[60:63], v[184:187], a[164:167], v[60:63]
  s_waitcnt lgkmcnt(3)
  ds_read_b64_tr_b16 v[174:175], v16 offset:14336
  v_mfma_f32_16x16x32_bf16 v[68:71], v[192:195], a[164:167], v[68:71]
  s_add_u32 s39, s39, s99
  ds_read_b64_tr_b16 v[176:177], v17 offset:8192
  v_mfma_f32_16x16x32_bf16 v[68:71], v[196:199], a[172:175], v[68:71]
  ds_read_b64_tr_b16 v[178:179], v17 offset:10240
  v_mfma_f32_16x16x32_bf16 v[64:67], v[196:199], a[168:171], v[64:67]
  ds_read_b64_tr_b16 v[180:181], v17 offset:12288
  v_mfma_f32_16x16x32_bf16 v[64:67], v[192:195], a[160:163], v[64:67]
  s_waitcnt lgkmcnt(3)
  ds_read_b64_tr_b16 v[182:183], v17 offset:14336
  v_mfma_f32_16x16x32_bf16 v[72:75], v[168:171], a[160:163], v[72:75]
  ds_read_b64_tr_b16 v[184:185], v18 offset:8192
  buffer_load_dwordx4 a[232:235], v8, s[16:19], s39 offen sc1
  v_mfma_f32_16x16x32_bf16 v[72:75], v[172:175], a[168:171], v[72:75]
  ds_read_b64_tr_b16 v[186:187], v18 offset:10240
  v_mfma_f32_16x16x32_bf16 v[76:79], v[172:175], a[172:175], v[76:79]
  ds_read_b64_tr_b16 v[188:189], v18 offset:12288
  buffer_load_dwordx4 v6, s[12:15], s38 offen offset:2048 lds
  v_mfma_f32_16x16x32_bf16 v[76:79], v[168:171], a[164:167], v[76:79]
  s_waitcnt lgkmcnt(3)
  ds_read_b64_tr_b16 v[190:191], v18 offset:14336
  v_mfma_f32_16x16x32_bf16 v[84:87], v[176:179], a[164:167], v[84:87]
  ds_read_b64_tr_b16 v[192:193], v19 offset:8192
  v_mfma_f32_16x16x32_bf16 v[84:87], v[180:183], a[172:175], v[84:87]
  ds_read_b64_tr_b16 v[194:195], v19 offset:10240
  v_mfma_f32_16x16x32_bf16 v[80:83], v[180:183], a[168:171], v[80:83]
  ds_read_b64_tr_b16 v[196:197], v19 offset:12288
  buffer_load_dwordx4 a[236:239], v9, s[16:19], s39 offen sc1
  v_mfma_f32_16x16x32_bf16 v[80:83], v[176:179], a[160:163], v[80:83]
  s_waitcnt lgkmcnt(3)
  ds_read_b64_tr_b16 v[198:199], v19 offset:14336
  v_mfma_f32_16x16x32_bf16 v[88:91], v[184:187], a[160:163], v[88:91]
  ds_read_b64_tr_b16 v[168:169], v16 offset:16384
  v_mfma_f32_16x16x32_bf16 v[88:91], v[188:191], a[168:171], v[88:91]
  ds_read_b64_tr_b16 v[170:171], v16 offset:18432
  v_mfma_f32_16x16x32_bf16 v[92:95], v[188:191], a[172:175], v[92:95]
  ds_read_b64_tr_b16 v[172:173], v16 offset:20480
  buffer_load_dwordx4 v7, s[12:15], s38 offen offset:3072 lds
  v_mfma_f32_16x16x32_bf16 v[92:95], v[184:187], a[164:167], v[92:95]
  s_waitcnt lgkmcnt(3)
  ds_read_b64_tr_b16 v[174:175], v16 offset:22528
  v_mfma_f32_16x16x32_bf16 v[100:103], v[192:195], a[164:167], v[100:103]
  s_add_u32 s39, s39, s99
  ds_read_b64_tr_b16 v[176:177], v17 offset:16384
  v_mfma_f32_16x16x32_bf16 v[100:103], v[196:199], a[172:175], v[100:103]
  ds_read_b64_tr_b16 v[178:179], v17 offset:18432
  v_mfma_f32_16x16x32_bf16 v[96:99], v[196:199], a[168:171], v[96:99]
  ds_read_b64_tr_b16 v[180:181], v17 offset:20480
  v_mfma_f32_16x16x32_bf16 v[96:99], v[192:195], a[160:163], v[96:99]
  s_waitcnt vmcnt(26) lgkmcnt(3)
  ds_read_b64_tr_b16 v[182:183], v17 offset:22528
  v_mfma_f32_16x16x32_bf16 v[40:43], v[168:171], a[176:179], v[40:43]
  ds_read_b64_tr_b16 v[184:185], v18 offset:16384
  buffer_load_dwordx4 a[240:243], v8, s[16:19], s39 offen sc1
  v_mfma_f32_16x16x32_bf16 v[40:43], v[172:175], a[184:187], v[40:43]
  s_add_u32 s38, s38, s96
  ds_read_b64_tr_b16 v[186:187], v18 offset:18432
  v_mfma_f32_16x16x32_bf16 v[44:47], v[172:175], a[188:191], v[44:47]
  s_add_u32 m0, s37, 81920
  ds_read_b64_tr_b16 v[188:189], v18 offset:20480
  buffer_load_dwordx4 v4, s[12:15], s38 offen offset:0 lds
  v_mfma_f32_16x16x32_bf16 v[44:47], v[168:171], a[180:183], v[44:47]
  s_waitcnt lgkmcnt(3)
  ds_read_b64_tr_b16 v[190:191], v18 offset:22528
  v_mfma_f32_16x16x32_bf16 v[52:55], v[176:179], a[180:183], v[52:55]
  ds_read_b64_tr_b16 v[192:193], v19 offset:16384
  v_mfma_f32_16x16x32_bf16 v[52:55], v[180:183], a[188:191], v[52:55]
  ds_read_b64_tr_b16 v[194:195], v19 offset:18432
  v_mfma_f32_16x16x32_bf16 v[48:51], v[180:183], a[184:187], v[48:51]
  ds_read_b64_tr_b16 v[196:197], v19 offset:20480
  buffer_load_dwordx4 a[244:247], v9, s[16:19], s39 offen sc1
  v_mfma_f32_16x16x32_bf16 v[48:51], v[176:179], a[176:179], v[48:51]
  s_waitcnt lgkmcnt(3)
  ds_read_b64_tr_b16 v[198:199], v19 offset:22528
  v_mfma_f32_16x16x32_bf16 v[56:59], v[184:187], a[176:179], v[56:59]
  ds_read_b64_tr_b16 v[168:169], v16 offset:24576
  v_mfma_f32_16x16x32_bf16 v[56:59], v[188:191], a[184:187], v[56:59]
  ds_read_b64_tr_b16 v[170:171], v16 offset:26624
  v_mfma_f32_16x16x32_bf16 v[60:63], v[188:191], a[188:191], v[60:63]
  ds_read_b64_tr_b16 v[172:173], v16 offset:28672
  buffer_load_dwordx4 v5, s[12:15], s38 offen offset:1024 lds
  v_mfma_f32_16x16x32_bf16 v[60:63], v[184:187], a[180:183], v[60:63]
  s_waitcnt lgkmcnt(3)
  ds_read_b64_tr_b16 v[174:175], v16 offset:30720
  v_mfma_f32_16x16x32_bf16 v[68:71], v[192:195], a[180:183], v[68:71]
  s_add_u32 s39, s39, s99
  ds_read_b64_tr_b16 v[176:177], v17 offset:24576
  v_mfma_f32_16x16x32_bf16 v[68:71], v[196:199], a[188:191], v[68:71]
  ds_read_b64_tr_b16 v[178:179], v17 offset:26624
  v_mfma_f32_16x16x32_bf16 v[64:67], v[196:199], a[184:187], v[64:67]
  ds_read_b64_tr_b16 v[180:181], v17 offset:28672
  v_mfma_f32_16x16x32_bf16 v[64:67], v[192:195], a[176:179], v[64:67]
  s_waitcnt lgkmcnt(3)
  ds_read_b64_tr_b16 v[182:183], v17 offset:30720
  v_mfma_f32_16x16x32_bf16 v[72:75], v[168:171], a[176:179], v[72:75]
  ds_read_b64_tr_b16 v[184:185], v18 offset:24576
  buffer_load_dwordx4 v[200:203], v8, s[16:19], s39 offen sc1
  v_mfma_f32_16x16x32_bf16 v[72:75], v[172:175], a[184:187], v[72:75]
  ds_read_b64_tr_b16 v[186:187], v18 offset:26624
  v_mfma_f32_16x16x32_bf16 v[76:79], v[172:175], a[188:191], v[76:79]
  ds_read_b64_tr_b16 v[188:189], v18 offset:28672
  buffer_load_dwordx4 v6, s[12:15], s38 offen offset:2048 lds
  v_mfma_f32_16x16x32_bf16 v[76:79], v[168:171], a[180:183], v[76:79]
  s_waitcnt lgkmcnt(3)
  ds_read_b64_tr_b16 v[190:191], v18 offset:30720
  v_mfma_f32_16x16x32_bf16 v[84:87], v[176:179], a[180:183], v[84:87]
  ds_read_b64_tr_b16 v[192:193], v19 offset:24576
  v_mfma_f32_16x16x32_bf16 v[84:87], v[180:183], a[188:191], v[84:87]
  ds_read_b64_tr_b16 v[194:195], v19 offset:26624
  v_mfma_f32_16x16x32_bf16 v[80:83], v[180:183], a[184:187], v[80:83]
  ds_read_b64_tr_b16 v[196:197], v19 offset:28672
  buffer_load_dwordx4 v[204:207], v9, s[16:19], s39 offen sc1
  v_mfma_f32_16x16x32_bf16 v[80:83], v[176:179], a[176:179], v[80:83]
  s_waitcnt vmcnt(32) lgkmcnt(3)
  ds_read_b64_tr_b16 v[198:199], v19 offset:30720
  v_mfma_f32_16x16x32_bf16 v[88:91], v[184:187], a[176:179], v[88:91]
  s_barrier
  ds_read_b64_tr_b16 v[168:169], v16 offset:32768
  v_mfma_f32_16x16x32_bf16 v[88:91], v[188:191], a[184:187], v[88:91]
  ds_read_b64_tr_b16 v[170:171], v16 offset:34816
  v_mfma_f32_16x16x32_bf16 v[92:95], v[188:191], a[188:191], v[92:95]
  ds_read_b64_tr_b16 v[172:173], v16 offset:36864
  buffer_load_dwordx4 v7, s[12:15], s38 offen offset:3072 lds
  v_mfma_f32_16x16x32_bf16 v[92:95], v[184:187], a[180:183], v[92:95]
  s_waitcnt vmcnt(30) lgkmcnt(3)
  ds_read_b64_tr_b16 v[174:175], v16 offset:38912
  v_mfma_f32_16x16x32_bf16 v[100:103], v[192:195], a[180:183], v[100:103]
  s_add_u32 s39, s39, s99
  ds_read_b64_tr_b16 v[176:177], v17 offset:32768
  v_swap_b32 v226, v228
  v_swap_b32 v227, v229
  v_mfma_f32_16x16x32_bf16 v[100:103], v[196:199], a[188:191], v[100:103]
  ds_read_b64_tr_b16 v[178:179], v17 offset:34816
  v_mfma_f32_16x16x32_bf16 v[96:99], v[196:199], a[184:187], v[96:99]
  ds_read_b64_tr_b16 v[180:181], v17 offset:36864
  v_mfma_f32_16x16x32_bf16 v[96:99], v[192:195], a[176:179], v[96:99]
  s_waitcnt vmcnt(25) lgkmcnt(3)
  ds_read_b64_tr_b16 v[182:183], v17 offset:38912
  v_mfma_f32_16x16x32_bf16 v[40:43], v[168:171], v[224:227], v[40:43]
  ds_read_b64_tr_b16 v[184:185], v18 offset:32768
  buffer_load_dwordx4 a[0:3], v8, s[16:19], s39 offen sc1
  v_mfma_f32_16x16x32_bf16 v[40:43], v[172:175], a[200:203], v[40:43]
  s_add_u32 s38, s38, s96
  ds_read_b64_tr_b16 v[186:187], v18 offset:34816
  v_mfma_f32_16x16x32_bf16 v[44:47], v[172:175], a[204:207], v[44:47]
  s_add_u32 m0, s37, 98304
  ds_read_b64_tr_b16 v[188:189], v18 offset:36864
  buffer_load_dwordx4 v4, s[12:15], s38 offen offset:0 lds
  v_mfma_f32_16x16x32_bf16 v[44:47], v[168:171], v[228:231], v[44:47]
  s_waitcnt lgkmcnt(3)
  ds_read_b64_tr_b16 v[190:191], v18 offset:38912
  v_mfma_f32_16x16x32_bf16 v[52:55], v[176:179], v[228:231], v[52:55]
  ds_read_b64_tr_b16 v[192:193], v19 offset:32768
  v_mfma_f32_16x16x32_bf16 v[52:55], v[180:183], a[204:207], v[52:55]
  ds_read_b64_tr_b16 v[194:195], v19 offset:34816
  v_mfma_f32_16x16x32_bf16 v[48:51], v[180:183], a[200:203], v[48:51]
  ds_read_b64_tr_b16 v[196:197], v19 offset:36864
  buffer_load_dwordx4 a[4:7], v9, s[16:19], s39 offen sc1
  v_mfma_f32_16x16x32_bf16 v[48:51], v[176:179], v[224:227], v[48:51]
  s_waitcnt lgkmcnt(3)
  ds_read_b64_tr_b16 v[198:199], v19 offset:38912
  v_mfma_f32_16x16x32_bf16 v[56:59], v[184:187], v[224:227], v[56:59]
  ds_read_b64_tr_b16 v[168:169], v16 offset:40960
  v_mfma_f32_16x16x32_bf16 v[56:59], v[188:191], a[200:203], v[56:59]
  ds_read_b64_tr_b16 v[170:171], v16 offset:43008
  v_mfma_f32_16x16x32_bf16 v[60:63], v[188:191], a[204:207], v[60:63]
  ds_read_b64_tr_b16 v[172:173], v16 offset:45056
  buffer_load_dwordx4 v5, s[12:15], s38 offen offset:1024 lds
  v_mfma_f32_16x16x32_bf16 v[60:63], v[184:187], v[228:231], v[60:63]
  s_waitcnt lgkmcnt(3)
  ds_read_b64_tr_b16 v[174:175], v16 offset:47104
  v_mfma_f32_16x16x32_bf16 v[68:71], v[192:195], v[228:231], v[68:71]
  s_add_u32 s39, s39, s99
  ds_read_b64_tr_b16 v[176:177], v17 offset:40960
  v_mfma_f32_16x16x32_bf16 v[68:71], v[196:199], a[204:207], v[68:71]
  ds_read_b64_tr_b16 v[178:179], v17 offset:43008
  v_mfma_f32_16x16x32_bf16 v[64:67], v[196:199], a[200:203], v[64:67]
  ds_read_b64_tr_b16 v[180:181], v17 offset:45056
  v_mfma_f32_16x16x32_bf16 v[64:67], v[192:195], v[224:227], v[64:67]
  s_waitcnt lgkmcnt(3)
  ds_read_b64_tr_b16 v[182:183], v17 offset:47104
  v_mfma_f32_16x16x32_bf16 v[72:75], v[168:171], v[224:227], v[72:75]
  ds_read_b64_tr_b16 v[184:185], v18 offset:40960
  buffer_load_dwordx4 a[8:11], v8, s[16:19], s39 offen sc1
  v_mfma_f32_16x16x32_bf16 v[72:75], v[172:175], a[200:203], v[72:75]
  ds_read_b64_tr_b16 v[186:187], v18 offset:43008
  v_mfma_f32_16x16x32_bf16 v[76:79], v[172:175], a[204:207], v[76:79]
  ds_read_b64_tr_b16 v[188:189], v18 offset:45056
  buffer_load_dwordx4 v6, s[12:15], s38 offen offset:2048 lds
  v_mfma_f32_16x16x32_bf16 v[76:79], v[168:171], v[228:231], v[76:79]
  s_waitcnt lgkmcnt(3)
  ds_read_b64_tr_b16 v[190:191], v18 offset:47104
  v_mfma_f32_16x16x32_bf16 v[84:87], v[176:179], v[228:231], v[84:87]
L_pad_3b_2:
  s_cbranch_execz L_ret_3b
  ds_read_b64_tr_b16 v[192:193], v19 offset:40960
  v_mfma_f32_16x16x32_bf16 v[84:87], v[180:183], a[204:207], v[84:87]
  ds_read_b64_tr_b16 v[194:195], v19 offset:43008
  v_mfma_f32_16x16x32_bf16 v[80:83], v[180:183], a[200:203], v[80:83]
  ds_read_b64_tr_b16 v[196:197], v19 offset:45056
  buffer_load_dwordx4 a[12:15], v9, s[16:19], s39 offen sc1
  v_mfma_f32_16x16x32_bf16 v[80:83], v[176:179], v[224:227], v[80:83]
  s_waitcnt lgkmcnt(3)
  ds_read_b64_tr_b16 v[198:199], v19 offset:47104
  v_mfma_f32_16x16x32_bf16 v[88:91], v[184:187], v[224:227], v[88:91]
  ds_read_b64_tr_b16 v[168:169], v16 offset:49152
  v_mfma_f32_16x16x32_bf16 v[88:91], v[188:191], a[200:203], v[88:91]
  ds_read_b64_tr_b16 v[170:171], v16 offset:51200
  v_mfma_f32_16x16x32_bf16 v[92:95], v[188:191], a[204:207], v[92:95]
  ds_read_b64_tr_b16 v[172:173], v16 offset:53248
  buffer_load_dwordx4 v7, s[12:15], s38 offen offset:3072 lds
  v_mfma_f32_16x16x32_bf16 v[92:95], v[184:187], v[228:231], v[92:95]
  s_waitcnt lgkmcnt(3)
  ds_read_b64_tr_b16 v[174:175], v16 offset:55296
  v_mfma_f32_16x16x32_bf16 v[100:103], v[192:195], v[228:231], v[100:103]
  s_add_u32 s39, s39, s99
  ds_read_b64_tr_b16 v[176:177], v17 offset:49152
  v_mfma_f32_16x16x32_bf16 v[100:103], v[196:199], a[204:207], v[100:103]
  ds_read_b64_tr_b16 v[178:179], v17 offset:51200
  v_mfma_f32_16x16x32_bf16 v[96:99], v[196:199], a[200:203], v[96:99]
  ds_read_b64_tr_b16 v[180:181], v17 offset:53248
  v_mfma_f32_16x16x32_bf16 v[96:99], v[192:195], v[224:227], v[96:99]
  s_waitcnt vmcnt(25) lgkmcnt(3)
  ds_read_b64_tr_b16 v[182:183], v17 offset:55296
  v_mfma_f32_16x16x32_bf16 v[40:43], v[168:171], a[208:211], v[40:43]
  ds_read_b64_tr_b16 v[184:185], v18 offset:49152
  buffer_load_dwordx4 a[16:19], v8, s[16:19], s39 offen sc1
  v_mfma_f32_16x16x32_bf16 v[40:43], v[172:175], a[216:219], v[40:43]
  s_add_u32 s38, s38, s96
  ds_read_b64_tr_b16 v[186:187], v18 offset:51200
  v_mfma_f32_16x16x32_bf16 v[44:47], v[172:175], a[220:223], v[44:47]
  s_add_u32 m0, s37, 114688
  ds_read_b64_tr_b16 v[188:189], v18 offset:53248
  buffer_load_dwordx4 v4, s[12:15], s38 offen offset:0 lds
  v_mfma_f32_16x16x32_bf16 v[44:47], v[168:171], a[212:215], v[44:47]
  s_waitcnt lgkmcnt(3)
  ds_read_b64_tr_b16 v[190:191], v18 offset:55296
  v_mfma_f32_16x16x32_bf16 v[52:55], v[176:179], a[212:215], v[52:55]
  ds_read_b64_tr_b16 v[192:193], v19 offset:49152
  v_mfma_f32_16x16x32_bf16 v[52:55], v[180:183], a[220:223], v[52:55]
  ds_read_b64_tr_b16 v[194:195], v19 offset:51200
  v_mfma_f32_16x16x32_bf16 v[48:51], v[180:183], a[216:219], v[48:51]
  ds_read_b64_tr_b16 v[196:197], v19 offset:53248
  buffer_load_dwordx4 a[20:23], v9, s[16:19], s39 offen sc1
  v_mfma_f32_16x16x32_bf16 v[48:51], v[176:179], a[208:211], v[48:51]
  s_waitcnt lgkmcnt(3)
  ds_read_b64_tr_b16 v[198:199], v19 offset:55296
  v_mfma_f32_16x16x32_bf16 v[56:59], v[184:187], a[208:211], v[56:59]
  ds_read_b64_tr_b16 v[168:169], v16 offset:57344
  v_mfma_f32_16x16x32_bf16 v[56:59], v[188:191], a[216:219], v[56:59]
  ds_read_b64_tr_b16 v[170:171], v16 offset:59392
  v_mfma_f32_16x16x32_bf16 v[60:63], v[188:191], a[220:223], v[60:63]
  ds_read_b64_tr_b16 v[172:173], v16 offset:61440
  buffer_load_dwordx4 v5, s[12:15], s38 offen offset:1024 lds
  v_mfma_f32_16x16x32_bf16 v[60:63], v[184:187], a[212:215], v[60:63]
  s_waitcnt lgkmcnt(3)
  ds_read_b64_tr_b16 v[174:175], v16 offset:63488
  v_mfma_f32_16x16x32_bf16 v[68:71], v[192:195], a[212:215], v[68:71]
  s_add_u32 s39, s39, s99
  ds_read_b64_tr_b16 v[176:177], v17 offset:57344
  v_mfma_f32_16x16x32_bf16 v[68:71], v[196:199], a[220:223], v[68:71]
  ds_read_b64_tr_b16 v[178:179], v17 offset:59392
  v_mfma_f32_16x16x32_bf16 v[64:67], v[196:199], a[216:219], v[64:67]
  ds_read_b64_tr_b16 v[180:181], v17 offset:61440
  v_mfma_f32_16x16x32_bf16 v[64:67], v[192:195], a[208:211], v[64:67]
  s_waitcnt lgkmcnt(3)
  ds_read_b64_tr_b16 v[182:183], v17 offset:63488
  v_mfma_f32_16x16x32_bf16 v[72:75], v[168:171], a[208:211], v[72:75]
  ds_read_b64_tr_b16 v[184:185], v18 offset:57344
  buffer_load_dwordx4 a[24:27], v8, s[16:19], s39 offen sc1
  v_mfma_f32_16x16x32_bf16 v[72:75], v[172:175], a[216:219], v[72:75]
  ds_read_b64_tr_b16 v[186:187], v18 offset:59392
  v_mfma_f32_16x16x32_bf16 v[76:79], v[172:175], a[220:223], v[76:79]
  ds_read_b64_tr_b16 v[188:189], v18 offset:61440
  buffer_load_dwordx4 v6, s[12:15], s38 offen offset:2048 lds
  v_mfma_f32_16x16x32_bf16 v[76:79], v[168:171], a[212:215], v[76:79]
  s_waitcnt lgkmcnt(3)
  ds_read_b64_tr_b16 v[190:191], v18 offset:63488
  v_mfma_f32_16x16x32_bf16 v[84:87], v[176:179], a[212:215], v[84:87]
  ds_read_b64_tr_b16 v[192:193], v19 offset:57344
  v_mfma_f32_16x16x32_bf16 v[84:87], v[180:183], a[220:223], v[84:87]
  ds_read_b64_tr_b16 v[194:195], v19 offset:59392
  v_mfma_f32_16x16x32_bf16 v[80:83], v[180:183], a[216:219], v[80:83]
  ds_read_b64_tr_b16 v[196:197], v19 offset:61440
  buffer_load_dwordx4 a[28:31], v9, s[16:19], s39 offen sc1
  v_mfma_f32_16x16x32_bf16 v[80:83], v[176:179], a[208:211], v[80:83]
  s_waitcnt vmcnt(31) lgkmcnt(3)
  ds_read_b64_tr_b16 v[198:199], v19 offset:63488
  v_mfma_f32_16x16x32_bf16 v[88:91], v[184:187], a[208:211], v[88:91]
  s_barrier
  ds_read_b64_tr_b16 v[168:169], v160 offset:0
  v_mfma_f32_16x16x32_bf16 v[88:91], v[188:191], a[216:219], v[88:91]
  ds_read_b64_tr_b16 v[170:171], v160 offset:2048
  v_mfma_f32_16x16x32_bf16 v[92:95], v[188:191], a[220:223], v[92:95]
  ds_read_b64_tr_b16 v[172:173], v160 offset:4096
  buffer_load_dwordx4 v7, s[12:15], s38 offen offset:3072 lds
  v_mfma_f32_16x16x32_bf16 v[92:95], v[184:187], a[212:215], v[92:95]
  s_waitcnt lgkmcnt(3)
  ds_read_b64_tr_b16 v[174:175], v160 offset:6144
  v_mfma_f32_16x16x32_bf16 v[100:103], v[192:195], a[212:215], v[100:103]
  s_add_u32 s39, s39, s99
  ds_read_b64_tr_b16 v[176:177], v161 offset:0
  v_mfma_f32_16x16x32_bf16 v[100:103], v[196:199], a[220:223], v[100:103]
  ds_read_b64_tr_b16 v[178:179], v161 offset:2048
  v_mfma_f32_16x16x32_bf16 v[96:99], v[196:199], a[216:219], v[96:99]
  ds_read_b64_tr_b16 v[180:181], v161 offset:4096
  v_mfma_f32_16x16x32_bf16 v[96:99], v[192:195], a[208:211], v[96:99]
  s_waitcnt vmcnt(25) lgkmcnt(3)
  ds_read_b64_tr_b16 v[182:183], v161 offset:6144
  v_mfma_f32_16x16x32_bf16 v[40:43], v[168:171], a[224:227], v[40:43]
  ds_read_b64_tr_b16 v[184:185], v162 offset:0
  buffer_load_dwordx4 a[32:35], v8, s[16:19], s39 offen sc1
  v_mfma_f32_16x16x32_bf16 v[40:43], v[172:175], a[232:235], v[40:43]
  s_add_u32 s38, s38, s96
  ds_read_b64_tr_b16 v[186:187], v162 offset:2048
  v_mfma_f32_16x16x32_bf16 v[44:47], v[172:175], a[236:239], v[44:47]
  s_add_u32 m0, s37, 0
  ds_read_b64_tr_b16 v[188:189], v162 offset:4096
  buffer_load_dwordx4 v4, s[12:15], s38 offen offset:0 lds
  v_mfma_f32_16x16x32_bf16 v[44:47], v[168:171], a[228:231], v[44:47]
  s_waitcnt lgkmcnt(3)
  ds_read_b64_tr_b16 v[190:191], v162 offset:6144
  v_mfma_f32_16x16x32_bf16 v[52:55], v[176:179], a[228:231], v[52:55]
  ds_read_b64_tr_b16 v[192:193], v163 offset:0
  v_mfma_f32_16x16x32_bf16 v[52:55], v[180:183], a[236:239], v[52:55]
  ds_read_b64_tr_b16 v[194:195], v163 offset:2048
  v_mfma_f32_16x16x32_bf16 v[48:51], v[180:183], a[232:235], v[48:51]
  ds_read_b64_tr_b16 v[196:197], v163 offset:4096
  buffer_load_dwordx4 a[36:39], v9, s[16:19], s39 offen sc1
  v_mfma_f32_16x16x32_bf16 v[48:51], v[176:179], a[224:227], v[48:51]
  s_waitcnt lgkmcnt(3)
  ds_read_b64_tr_b16 v[198:199], v163 offset:6144
  v_mfma_f32_16x16x32_bf16 v[56:59], v[184:187], a[224:227], v[56:59]
  ds_read_b64_tr_b16 v[168:169], v160 offset:8192
  v_mfma_f32_16x16x32_bf16 v[56:59], v[188:191], a[232:235], v[56:59]
  ds_read_b64_tr_b16 v[170:171], v160 offset:10240
  v_mfma_f32_16x16x32_bf16 v[60:63], v[188:191], a[236:239], v[60:63]
  ds_read_b64_tr_b16 v[172:173], v160 offset:12288
  buffer_load_dwordx4 v5, s[12:15], s38 offen offset:1024 lds
  v_mfma_f32_16x16x32_bf16 v[60:63], v[184:187], a[228:231], v[60:63]
  s_waitcnt lgkmcnt(3)
  ds_read_b64_tr_b16 v[174:175], v160 offset:14336
  v_mfma_f32_16x16x32_bf16 v[68:71], v[192:195], a[228:231], v[68:71]
  s_add_u32 s39, s39, s99
  ds_read_b64_tr_b16 v[176:177], v161 offset:8192
  v_mfma_f32_16x16x32_bf16 v[68:71], v[196:199], a[236:239], v[68:71]
  ds_read_b64_tr_b16 v[178:179], v161 offset:10240
  v_mfma_f32_16x16x32_bf16 v[64:67], v[196:199], a[232:235], v[64:67]
  ds_read_b64_tr_b16 v[180:181], v161 offset:12288
  v_mfma_f32_16x16x32_bf16 v[64:67], v[192:195], a[224:227], v[64:67]
  s_waitcnt lgkmcnt(3)
  ds_read_b64_tr_b16 v[182:183], v161 offset:14336
  v_mfma_f32_16x16x32_bf16 v[72:75], v[168:171], a[224:227], v[72:75]
  ds_read_b64_tr_b16 v[184:185], v162 offset:8192
  buffer_load_dwordx4 a[40:43], v8, s[16:19], s39 offen sc1
  v_mfma_f32_16x16x32_bf16 v[72:75], v[172:175], a[232:235], v[72:75]
  ds_read_b64_tr_b16 v[186:187], v162 offset:10240
  v_mfma_f32_16x16x32_bf16 v[76:79], v[172:175], a[236:239], v[76:79]
  ds_read_b64_tr_b16 v[188:189], v162 offset:12288
  buffer_load_dwordx4 v6, s[12:15], s38 offen offset:2048 lds
  v_mfma_f32_16x16x32_bf16 v[76:79], v[168:171], a[228:231], v[76:79]
  s_waitcnt lgkmcnt(3)
  ds_read_b64_tr_b16 v[190:191], v162 offset:14336
  v_mfma_f32_16x16x32_bf16 v[84:87], v[176:179], a[228:231], v[84:87]
  ds_read_b64_tr_b16 v[192:193], v163 offset:8192
  v_mfma_f32_16x16x32_bf16 v[84:87], v[180:183], a[236:239], v[84:87]
  ds_read_b64_tr_b16 v[194:195], v163 offset:10240
  v_mfma_f32_16x16x32_bf16 v[80:83], v[180:183], a[232:235], v[80:83]
  ds_read_b64_tr_b16 v[196:197], v163 offset:12288
  buffer_load_dwordx4 a[44:47], v9, s[16:19], s39 offen sc1
  v_mfma_f32_16x16x32_bf16 v[80:83], v[176:179], a[224:227], v[80:83]
  s_waitcnt lgkmcnt(3)
  ds_read_b64_tr_b16 v[198:199], v163 offset:14336
  v_mfma_f32_16x16x32_bf16 v[88:91], v[184:187], a[224:227], v[88:91]
  ds_read_b64_tr_b16 v[168:169], v160 offset:16384
  v_mfma_f32_16x16x32_bf16 v[88:91], v[188:191], a[232:235], v[88:91]
  ds_read_b64_tr_b16 v[170:171], v160 offset:18432
  v_mfma_f32_16x16x32_bf16 v[92:95], v[188:191], a[236:239], v[92:95]
  ds_read_b64_tr_b16 v[172:173], v160 offset:20480
  buffer_load_dwordx4 v7, s[12:15], s38 offen offset:3072 lds
  v_mfma_f32_16x16x32_bf16 v[92:95], v[184:187], a[228:231], v[92:95]
  s_waitcnt vmcnt(25) lgkmcnt(3)
  ds_read_b64_tr_b16 v[174:175], v160 offset:22528
  v_mfma_f32_16x16x32_bf16 v[100:103], v[192:195], a[228:231], v[100:103]
  s_add_u32 s39, s39, s99
  ds_read_b64_tr_b16 v[176:177], v161 offset:16384
  v_swap_b32 v202, v204
  v_swap_b32 v203, v205
  v_mfma_f32_16x16x32_bf16 v[100:103], v[196:199], a[236:239], v[100:103]
  ds_read_b64_tr_b16 v[178:179], v161 offset:18432
  v_mfma_f32_16x16x32_bf16 v[96:99], v[196:199], a[232:235], v[96:99]
  ds_read_b64_tr_b16 v[180:181], v161 offset:20480
  v_mfma_f32_16x16x32_bf16 v[96:99], v[192:195], a[224:227], v[96:99]
  s_waitcnt vmcnt(25) lgkmcnt(3)
  ds_read_b64_tr_b16 v[182:183], v161 offset:22528
  v_mfma_f32_16x16x32_bf16 v[40:43], v[168:171], a[240:243], v[40:43]
  ds_read_b64_tr_b16 v[184:185], v162 offset:16384
  buffer_load_dwordx4 v[208:211], v8, s[16:19], s39 offen sc1
  v_mfma_f32_16x16x32_bf16 v[40:43], v[172:175], v[200:203], v[40:43]
  s_add_u32 s38, s38, s96
  ds_read_b64_tr_b16 v[186:187], v162 offset:18432
  v_mfma_f32_16x16x32_bf16 v[44:47], v[172:175], v[204:207], v[44:47]
  s_add_u32 m0, s37, 16384
  ds_read_b64_tr_b16 v[188:189], v162 offset:20480
  buffer_load_dwordx4 v4, s[12:15], s38 offen offset:0 lds
  v_mfma_f32_16x16x32_bf16 v[44:47], v[168:171], a[244:247], v[44:47]
  s_waitcnt lgkmcnt(3)
  ds_read_b64_tr_b16 v[190:191], v162 offset:22528
  v_mfma_f32_16x16x32_bf16 v[52:55], v[176:179], a[244:247], v[52:55]
  ds_read_b64_tr_b16 v[192:193], v163 offset:16384
  v_mfma_f32_16x16x32_bf16 v[52:55], v[180:183], v[204:207], v[52:55]
  ds_read_b64_tr_b16 v[194:195], v163 offset:18432
  v_mfma_f32_16x16x32_bf16 v[48:51], v[180:183], v[200:203], v[48:51]
  ds_read_b64_tr_b16 v[196:197], v163 offset:20480
  buffer_load_dwordx4 v[212:215], v9, s[16:19], s39 offen sc1
  v_mfma_f32_16x16x32_bf16 v[48:51], v[176:179], a[240:243], v[48:51]
  s_waitcnt lgkmcnt(3)
  ds_read_b64_tr_b16 v[198:199], v163 offset:22528
  v_mfma_f32_16x16x32_bf16 v[56:59], v[184:187], a[240:243], v[56:59]
  ds_read_b64_tr_b16 v[168:169], v160 offset:24576
  v_mfma_f32_16x16x32_bf16 v[56:59], v[188:191], v[200:203], v[56:59]
  ds_read_b64_tr_b16 v[170:171], v160 offset:26624
  v_mfma_f32_16x16x32_bf16 v[60:63], v[188:191], v[204:207], v[60:63]
  ds_read_b64_tr_b16 v[172:173], v160 offset:28672
  buffer_load_dwordx4 v5, s[12:15], s38 offen offset:1024 lds
  v_mfma_f32_16x16x32_bf16 v[60:63], v[184:187], a[244:247], v[60:63]
  s_waitcnt lgkmcnt(3)
  ds_read_b64_tr_b16 v[174:175], v160 offset:30720
  v_mfma_f32_16x16x32_bf16 v[68:71], v[192:195], a[244:247], v[68:71]
  s_add_u32 s39, s39, s99
  ds_read_b64_tr_b16 v[176:177], v161 offset:24576
  v_mfma_f32_16x16x32_bf16 v[68:71], v[196:199], v[204:207], v[68:71]
  ds_read_b64_tr_b16 v[178:179], v161 offset:26624
  v_mfma_f32_16x16x32_bf16 v[64:67], v[196:199], v[200:203], v[64:67]
  ds_read_b64_tr_b16 v[180:181], v161 offset:28672
  v_mfma_f32_16x16x32_bf16 v[64:67], v[192:195], a[240:243], v[64:67]
  s_waitcnt lgkmcnt(3)
  ds_read_b64_tr_b16 v[182:183], v161 offset:30720
  v_mfma_f32_16x16x32_bf16 v[72:75], v[168:171], a[240:243], v[72:75]
  ds_read_b64_tr_b16 v[184:185], v162 offset:24576
  v_add_u32 v11, s41, v11
  v_mfma_f32_16x16x32_bf16 v[72:75], v[172:175], v[200:203], v[72:75]
  ds_read_b64_tr_b16 v[186:187], v162 offset:26624
  global_load_dwordx2 v[12:13], v11, s[4:5] sc1
  v_mfma_f32_16x16x32_bf16 v[76:79], v[172:175], v[204:207], v[76:79]
  ds_read_b64_tr_b16 v[188:189], v162 offset:28672
  buffer_load_dwordx4 a[56:59], v8, s[16:19], s39 offen sc1
  v_mfma_f32_16x16x32_bf16 v[76:79], v[168:171], a[244:247], v[76:79]
  s_waitcnt lgkmcnt(3)
  ds_read_b64_tr_b16 v[190:191], v162 offset:30720
  v_mfma_f32_16x16x32_bf16 v[84:87], v[176:179], a[244:247], v[84:87]
  ds_read_b64_tr_b16 v[192:193], v163 offset:24576
  buffer_load_dwordx4 v6, s[12:15], s38 offen offset:2048 lds
  v_mfma_f32_16x16x32_bf16 v[84:87], v[180:183], v[204:207], v[84:87]
  ds_read_b64_tr_b16 v[194:195], v163 offset:26624
  v_mfma_f32_16x16x32_bf16 v[80:83], v[180:183], v[200:203], v[80:83]
  ds_read_b64_tr_b16 v[196:197], v163 offset:28672
  v_mfma_f32_16x16x32_bf16 v[80:83], v[176:179], a[240:243], v[80:83]
  s_waitcnt vmcnt(31) lgkmcnt(3)
  ds_read_b64_tr_b16 v[198:199], v163 offset:30720
  v_mfma_f32_16x16x32_bf16 v[88:91], v[184:187], a[240:243], v[88:91]
  s_barrier
  ds_read_b64_tr_b16 v[168:169], v20 offset:0
  v_mfma_f32_16x16x32_bf16 v[88:91], v[188:191], v[200:203], v[88:91]
  ds_read_b64_tr_b16 v[170:171], v20 offset:2048
  buffer_load_dwordx4 a[60:63], v9, s[16:19], s39 offen sc1
  v_mfma_f32_16x16x32_bf16 v[92:95], v[188:191], v[204:207], v[92:95]
  ds_read_b64_tr_b16 v[172:173], v20 offset:4096
  v_mfma_f32_16x16x32_bf16 v[92:95], v[184:187], a[244:247], v[92:95]
  s_waitcnt lgkmcnt(3)
  ds_read_b64_tr_b16 v[174:175], v20 offset:6144
  v_mfma_f32_16x16x32_bf16 v[100:103], v[192:195], a[244:247], v[100:103]
  ds_read_b64_tr_b16 v[176:177], v21 offset:0
  buffer_load_dwordx4 v7, s[12:15], s38 offen offset:3072 lds
  v_mfma_f32_16x16x32_bf16 v[100:103], v[196:199], v[204:207], v[100:103]
  s_add_u32 s39, s39, s99
  ds_read_b64_tr_b16 v[178:179], v21 offset:2048
  v_mfma_f32_16x16x32_bf16 v[96:99], v[196:199], v[200:203], v[96:99]
  ds_read_b64_tr_b16 v[180:181], v21 offset:4096
  v_mfma_f32_16x16x32_bf16 v[96:99], v[192:195], a[240:243], v[96:99]
  s_waitcnt vmcnt(26) lgkmcnt(3)
  ds_read_b64_tr_b16 v[182:183], v21 offset:6144
  v_mfma_f32_16x16x32_bf16 v[40:43], v[168:171], a[0:3], v[40:43]
  ds_read_b64_tr_b16 v[184:185], v22 offset:0
  buffer_load_dwordx4 a[64:67], v8, s[16:19], s39 offen sc1
  v_mfma_f32_16x16x32_bf16 v[40:43], v[172:175], a[8:11], v[40:43]
  s_add_u32 s38, s38, s96
  ds_read_b64_tr_b16 v[186:187], v22 offset:2048
  v_mfma_f32_16x16x32_bf16 v[44:47], v[172:175], a[12:15], v[44:47]
  s_add_u32 m0, s37, 32768
  ds_read_b64_tr_b16 v[188:189], v22 offset:4096
  v_mfma_f32_16x16x32_bf16 v[44:47], v[168:171], a[4:7], v[44:47]
  s_waitcnt lgkmcnt(3)
  ds_read_b64_tr_b16 v[190:191], v22 offset:6144
  buffer_load_dwordx4 v4, s[12:15], s38 offen offset:0 lds
  v_mfma_f32_16x16x32_bf16 v[52:55], v[176:179], a[4:7], v[52:55]
  ds_read_b64_tr_b16 v[192:193], v23 offset:0
  v_mfma_f32_16x16x32_bf16 v[52:55], v[180:183], a[12:15], v[52:55]
  ds_read_b64_tr_b16 v[194:195], v23 offset:2048
  v_mfma_f32_16x16x32_bf16 v[48:51], v[180:183], a[8:11], v[48:51]
  ds_read_b64_tr_b16 v[196:197], v23 offset:4096
  v_mfma_f32_16x16x32_bf16 v[48:51], v[176:179], a[0:3], v[48:51]
  s_waitcnt lgkmcnt(3)
  ds_read_b64_tr_b16 v[198:199], v23 offset:6144
  buffer_load_dwordx4 a[68:71], v9, s[16:19], s39 offen sc1
  v_mfma_f32_16x16x32_bf16 v[56:59], v[184:187], a[0:3], v[56:59]
  ds_read_b64_tr_b16 v[168:169], v20 offset:8192
  v_mfma_f32_16x16x32_bf16 v[56:59], v[188:191], a[8:11], v[56:59]
  ds_read_b64_tr_b16 v[170:171], v20 offset:10240
  v_mfma_f32_16x16x32_bf16 v[60:63], v[188:191], a[12:15], v[60:63]
  ds_read_b64_tr_b16 v[172:173], v20 offset:12288
  v_mfma_f32_16x16x32_bf16 v[60:63], v[184:187], a[4:7], v[60:63]
  s_waitcnt lgkmcnt(3)
  ds_read_b64_tr_b16 v[174:175], v20 offset:14336
  buffer_load_dwordx4 v5, s[12:15], s38 offen offset:1024 lds
  v_mfma_f32_16x16x32_bf16 v[68:71], v[192:195], a[4:7], v[68:71]
  s_add_u32 s39, s39, s99
  ds_read_b64_tr_b16 v[176:177], v21 offset:8192
  v_mfma_f32_16x16x32_bf16 v[68:71], v[196:199], a[12:15], v[68:71]
  ds_read_b64_tr_b16 v[178:179], v21 offset:10240
  v_mfma_f32_16x16x32_bf16 v[64:67], v[196:199], a[8:11], v[64:67]
  ds_read_b64_tr_b16 v[180:181], v21 offset:12288
  v_mfma_f32_16x16x32_bf16 v[64:67], v[192:195], a[0:3], v[64:67]
  s_waitcnt lgkmcnt(3)
  ds_read_b64_tr_b16 v[182:183], v21 offset:14336
  v_mfma_f32_16x16x32_bf16 v[72:75], v[168:171], a[0:3], v[72:75]
  ds_read_b64_tr_b16 v[184:185], v22 offset:8192
  buffer_load_dwordx4 a[72:75], v8, s[16:19], s39 offen sc1
  v_mfma_f32_16x16x32_bf16 v[72:75], v[172:175], a[8:11], v[72:75]
  ds_read_b64_tr_b16 v[186:187], v22 offset:10240
  v_mfma_f32_16x16x32_bf16 v[76:79], v[172:175], a[12:15], v[76:79]
  ds_read_b64_tr_b16 v[188:189], v22 offset:12288
  buffer_load_dwordx4 v6, s[12:15], s38 offen offset:2048 lds
  v_mfma_f32_16x16x32_bf16 v[76:79], v[168:171], a[4:7], v[76:79]
  s_waitcnt lgkmcnt(3)
  ds_read_b64_tr_b16 v[190:191], v22 offset:14336
  v_mfma_f32_16x16x32_bf16 v[84:87], v[176:179], a[4:7], v[84:87]
  ds_read_b64_tr_b16 v[192:193], v23 offset:8192
  v_mfma_f32_16x16x32_bf16 v[84:87], v[180:183], a[12:15], v[84:87]
  ds_read_b64_tr_b16 v[194:195], v23 offset:10240
  v_mfma_f32_16x16x32_bf16 v[80:83], v[180:183], a[8:11], v[80:83]
  ds_read_b64_tr_b16 v[196:197], v23 offset:12288
  buffer_load_dwordx4 a[76:79], v9, s[16:19], s39 offen sc1
  v_mfma_f32_16x16x32_bf16 v[80:83], v[176:179], a[0:3], v[80:83]
  s_waitcnt lgkmcnt(3)
  ds_read_b64_tr_b16 v[198:199], v23 offset:14336
  v_mfma_f32_16x16x32_bf16 v[88:91], v[184:187], a[0:3], v[88:91]
  ds_read_b64_tr_b16 v[168:169], v20 offset:16384
  v_mfma_f32_16x16x32_bf16 v[88:91], v[188:191], a[8:11], v[88:91]
  ds_read_b64_tr_b16 v[170:171], v20 offset:18432
  v_mfma_f32_16x16x32_bf16 v[92:95], v[188:191], a[12:15], v[92:95]
  ds_read_b64_tr_b16 v[172:173], v20 offset:20480
  buffer_load_dwordx4 v7, s[12:15], s38 offen offset:3072 lds
  v_mfma_f32_16x16x32_bf16 v[92:95], v[184:187], a[4:7], v[92:95]
  s_waitcnt lgkmcnt(3)
  ds_read_b64_tr_b16 v[174:175], v20 offset:22528
  v_mfma_f32_16x16x32_bf16 v[100:103], v[192:195], a[4:7], v[100:103]
  s_add_u32 s39, s39, s99
  ds_read_b64_tr_b16 v[176:177], v21 offset:16384
  v_mfma_f32_16x16x32_bf16 v[100:103], v[196:199], a[12:15], v[100:103]
  ds_read_b64_tr_b16 v[178:179], v21 offset:18432
  v_mfma_f32_16x16x32_bf16 v[96:99], v[196:199], a[8:11], v[96:99]
  ds_read_b64_tr_b16 v[180:181], v21 offset:20480
  v_mfma_f32_16x16x32_bf16 v[96:99], v[192:195], a[0:3], v[96:99]
  s_waitcnt vmcnt(12) lgkmcnt(3)
  ds_read_b64_tr_b16 v[182:183], v21 offset:22528
  v_cmp_ne_u64 vcc, s[6:7], v[12:13]
  s_cbranch_vccnz L_slow_36
L_back_37:
  v_mfma_f32_16x16x32_bf16 v[40:43], v[168:171], a[16:19], v[40:43]
  ds_read_b64_tr_b16 v[184:185], v22 offset:16384
  buffer_load_dwordx4 a[80:83], v8, s[16:19], s39 offen sc1
  v_mfma_f32_16x16x32_bf16 v[40:43], v[172:175], a[24:27], v[40:43]
  s_add_u32 s38, s38, s96
  ds_read_b64_tr_b16 v[186:187], v22 offset:18432
  v_mfma_f32_16x16x32_bf16 v[44:47], v[172:175], a[28:31], v[44:47]
  s_add_u32 m0, s37, 49152
  ds_read_b64_tr_b16 v[188:189], v22 offset:20480
  buffer_load_dwordx4 v4, s[12:15], s38 offen offset:0 lds
  v_mfma_f32_16x16x32_bf16 v[44:47], v[168:171], a[20:23], v[44:47]
  s_waitcnt lgkmcnt(3)
  ds_read_b64_tr_b16 v[190:191], v22 offset:22528
  v_mfma_f32_16x16x32_bf16 v[52:55], v[176:179], a[20:23], v[52:55]
  ds_read_b64_tr_b16 v[192:193], v23 offset:16384
  v_mfma_f32_16x16x32_bf16 v[52:55], v[180:183], a[28:31], v[52:55]
  ds_read_b64_tr_b16 v[194:195], v23 offset:18432
  v_mfma_f32_16x16x32_bf16 v[48:51], v[180:183], a[24:27], v[48:51]
  ds_read_b64_tr_b16 v[196:197], v23 offset:20480
  buffer_load_dwordx4 a[84:87], v9, s[16:19], s39 offen sc1
  v_mfma_f32_16x16x32_bf16 v[48:51], v[176:179], a[16:19], v[48:51]
  s_waitcnt lgkmcnt(3)
  ds_read_b64_tr_b16 v[198:199], v23 offset:22528
  v_mfma_f32_16x16x32_bf16 v[56:59], v[184:187], a[16:19], v[56:59]
  ds_read_b64_tr_b16 v[168:169], v20 offset:24576
  v_mfma_f32_16x16x32_bf16 v[56:59], v[188:191], a[24:27], v[56:59]
  ds_read_b64_tr_b16 v[170:171], v20 offset:26624
  v_mfma_f32_16x16x32_bf16 v[60:63], v[188:191], a[28:31], v[60:63]
  ds_read_b64_tr_b16 v[172:173], v20 offset:28672
  buffer_load_dwordx4 v5, s[12:15], s38 offen offset:1024 lds
  v_mfma_f32_16x16x32_bf16 v[60:63], v[184:187], a[20:23], v[60:63]
  s_waitcnt lgkmcnt(3)
  ds_read_b64_tr_b16 v[174:175], v20 offset:30720
  v_mfma_f32_16x16x32_bf16 v[68:71], v[192:195], a[20:23], v[68:71]
  s_add_u32 s39, s39, s99
  ds_read_b64_tr_b16 v[176:177], v21 offset:24576
  v_mfma_f32_16x16x32_bf16 v[68:71], v[196:199], a[28:31], v[68:71]
  ds_read_b64_tr_b16 v[178:179], v21 offset:26624
  v_mfma_f32_16x16x32_bf16 v[64:67], v[196:199], a[24:27], v[64:67]
  ds_read_b64_tr_b16 v[180:181], v21 offset:28672
  v_mfma_f32_16x16x32_bf16 v[64:67], v[192:195], a[16:19], v[64:67]
  s_waitcnt lgkmcnt(3)
  ds_read_b64_tr_b16 v[182:183], v21 offset:30720
  v_mfma_f32_16x16x32_bf16 v[72:75], v[168:171], a[16:19], v[72:75]
  ds_read_b64_tr_b16 v[184:185], v22 offset:24576
  buffer_load_dwordx4 a[88:91], v8, s[16:19], s39 offen sc1
  v_mfma_f32_16x16x32_bf16 v[72:75], v[172:175], a[24:27], v[72:75]
  ds_read_b64_tr_b16 v[186:187], v22 offset:26624
  v_mfma_f32_16x16x32_bf16 v[76:79], v[172:175], a[28:31], v[76:79]
  ds_read_b64_tr_b16 v[188:189], v22 offset:28672
  buffer_load_dwordx4 v6, s[12:15], s38 offen offset:2048 lds
  v_mfma_f32_16x16x32_bf16 v[76:79], v[168:171], a[20:23], v[76:79]
  s_waitcnt lgkmcnt(3)
  ds_read_b64_tr_b16 v[190:191], v22 offset:30720
  v_mfma_f32_16x16x32_bf16 v[84:87], v[176:179], a[20:23], v[84:87]
  ds_read_b64_tr_b16 v[192:193], v23 offset:24576
  v_mfma_f32_16x16x32_bf16 v[84:87], v[180:183], a[28:31], v[84:87]
  ds_read_b64_tr_b16 v[194:195], v23 offset:26624
  v_mfma_f32_16x16x32_bf16 v[80:83], v[180:183], a[24:27], v[80:83]
  ds_read_b64_tr_b16 v[196:197], v23 offset:28672
  buffer_load_dwordx4 a[92:95], v9, s[16:19], s39 offen sc1
  v_mfma_f32_16x16x32_bf16 v[80:83], v[176:179], a[16:19], v[80:83]
  s_waitcnt vmcnt(32) lgkmcnt(3)
  ds_read_b64_tr_b16 v[198:199], v23 offset:30720
  v_mfma_f32_16x16x32_bf16 v[88:91], v[184:187], a[16:19], v[88:91]
  s_barrier
  ds_read_b64_tr_b16 v[168:169], v20 offset:32768
  v_mfma_f32_16x16x32_bf16 v[88:91], v[188:191], a[24:27], v[88:91]
  ds_read_b64_tr_b16 v[170:171], v20 offset:34816
  v_mfma_f32_16x16x32_bf16 v[92:95], v[188:191], a[28:31], v[92:95]
  ds_read_b64_tr_b16 v[172:173], v20 offset:36864
  buffer_load_dwordx4 v7, s[12:15], s38 offen offset:3072 lds
  v_mfma_f32_16x16x32_bf16 v[92:95], v[184:187], a[20:23], v[92:95]
  s_waitcnt lgkmcnt(3)
  ds_read_b64_tr_b16 v[174:175], v20 offset:38912
  v_mfma_f32_16x16x32_bf16 v[100:103], v[192:195], a[20:23], v[100:103]
  s_add_u32 s39, s39, s99
  ds_read_b64_tr_b16 v[176:177], v21 offset:32768
  v_mfma_f32_16x16x32_bf16 v[100:103], v[196:199], a[28:31], v[100:103]
  ds_read_b64_tr_b16 v[178:179], v21 offset:34816
  v_mfma_f32_16x16x32_bf16 v[96:99], v[196:199], a[24:27], v[96:99]
  ds_read_b64_tr_b16 v[180:181], v21 offset:36864
  v_mfma_f32_16x16x32_bf16 v[96:99], v[192:195], a[16:19], v[96:99]
  s_waitcnt vmcnt(26) lgkmcnt(3)
  ds_read_b64_tr_b16 v[182:183], v21 offset:38912
  v_mfma_f32_16x16x32_bf16 v[40:43], v[168:171], a[32:35], v[40:43]
  ds_read_b64_tr_b16 v[184:185], v22 offset:32768
  buffer_load_dwordx4 a[96:99], v8, s[16:19], s39 offen sc1
  v_mfma_f32_16x16x32_bf16 v[40:43], v[172:175], a[40:43], v[40:43]
  s_add_u32 s38, s38, s96
  ds_read_b64_tr_b16 v[186:187], v22 offset:34816
  v_mfma_f32_16x16x32_bf16 v[44:47], v[172:175], a[44:47], v[44:47]
  s_add_u32 m0, s37, 131072
  ds_read_b64_tr_b16 v[188:189], v22 offset:36864
  v_mfma_f32_16x16x32_bf16 v[44:47], v[168:171], a[36:39], v[44:47]
  s_waitcnt lgkmcnt(3)
  ds_read_b64_tr_b16 v[190:191], v22 offset:38912
  v_mfma_f32_16x16x32_bf16 v[52:55], v[176:179], a[36:39], v[52:55]
  s_mov_b32 s38, s98
  ds_read_b64_tr_b16 v[192:193], v23 offset:32768
  v_mfma_f32_16x16x32_bf16 v[52:55], v[180:183], a[44:47], v[52:55]
  s_lshl_b32 s96, s96, 1
  ds_read_b64_tr_b16 v[194:195], v23 offset:34816
  v_mfma_f32_16x16x32_bf16 v[48:51], v[180:183], a[40:43], v[48:51]
  s_mov_b32 s12, s80
  ds_read_b64_tr_b16 v[196:197], v23 offset:36864
  v_mfma_f32_16x16x32_bf16 v[48:51], v[176:179], a[32:35], v[48:51]
  s_waitcnt lgkmcnt(3)
  ds_read_b64_tr_b16 v[198:199], v23 offset:38912
  v_mfma_f32_16x16x32_bf16 v[56:59], v[184:187], a[32:35], v[56:59]
  s_mov_b32 s13, s81
  ds_read_b64_tr_b16 v[168:169], v20 offset:40960
  buffer_load_dwordx4 v4, s[12:15], s38 offen offset:0 lds
  v_mfma_f32_16x16x32_bf16 v[56:59], v[188:191], a[40:43], v[56:59]
  ds_read_b64_tr_b16 v[170:171], v20 offset:43008
  v_mfma_f32_16x16x32_bf16 v[60:63], v[188:191], a[44:47], v[60:63]
  ds_read_b64_tr_b16 v[172:173], v20 offset:45056
  buffer_load_dwordx4 a[100:103], v9, s[16:19], s39 offen sc1
  v_mfma_f32_16x16x32_bf16 v[60:63], v[184:187], a[36:39], v[60:63]
  s_waitcnt lgkmcnt(3)
  ds_read_b64_tr_b16 v[174:175], v20 offset:47104
  v_mfma_f32_16x16x32_bf16 v[68:71], v[192:195], a[36:39], v[68:71]
  ds_read_b64_tr_b16 v[176:177], v21 offset:40960
  v_mfma_f32_16x16x32_bf16 v[68:71], v[196:199], a[44:47], v[68:71]
  ds_read_b64_tr_b16 v[178:179], v21 offset:43008
  v_mfma_f32_16x16x32_bf16 v[64:67], v[196:199], a[40:43], v[64:67]
  ds_read_b64_tr_b16 v[180:181], v21 offset:45056
  buffer_load_dwordx4 v5, s[12:15], s38 offen offset:1024 lds
  v_mfma_f32_16x16x32_bf16 v[64:67], v[192:195], a[32:35], v[64:67]
  s_waitcnt lgkmcnt(3)
  ds_read_b64_tr_b16 v[182:183], v21 offset:47104
  v_mfma_f32_16x16x32_bf16 v[72:75], v[168:171], a[32:35], v[72:75]
  s_add_u32 s39, s39, s99
  ds_read_b64_tr_b16 v[184:185], v22 offset:40960
  v_mfma_f32_16x16x32_bf16 v[72:75], v[172:175], a[40:43], v[72:75]
  ds_read_b64_tr_b16 v[186:187], v22 offset:43008
  v_mfma_f32_16x16x32_bf16 v[76:79], v[172:175], a[44:47], v[76:79]
  ds_read_b64_tr_b16 v[188:189], v22 offset:45056
  buffer_load_dwordx4 v[216:219], v8, s[16:19], s39 offen sc1
  v_mfma_f32_16x16x32_bf16 v[76:79], v[168:171], a[36:39], v[76:79]
  s_waitcnt lgkmcnt(3)
  ds_read_b64_tr_b16 v[190:191], v22 offset:47104
  v_mfma_f32_16x16x32_bf16 v[84:87], v[176:179], a[36:39], v[84:87]
  ds_read_b64_tr_b16 v[192:193], v23 offset:40960
  v_mfma_f32_16x16x32_bf16 v[84:87], v[180:183], a[44:47], v[84:87]
  ds_read_b64_tr_b16 v[194:195], v23 offset:43008
  v_mfma_f32_16x16x32_bf16 v[80:83], v[180:183], a[40:43], v[80:83]
  ds_read_b64_tr_b16 v[196:197], v23 offset:45056
  buffer_load_dwordx4 v6, s[12:15], s38 offen offset:2048 lds
  v_mfma_f32_16x16x32_bf16 v[80:83], v[176:179], a[32:35], v[80:83]
  s_waitcnt lgkmcnt(3)
  ds_read_b64_tr_b16 v[198:199], v23 offset:47104
  v_mfma_f32_16x16x32_bf16 v[88:91], v[184:187], a[32:35], v[88:91]
  ds_read_b64_tr_b16 v[168:169], v20 offset:57344
  v_mfma_f32_16x16x32_bf16 v[88:91], v[188:191], a[40:43], v[88:91]
  ds_read_b64_tr_b16 v[170:171], v20 offset:59392
  buffer_load_dwordx4 v[220:223], v9, s[16:19], s39 offen sc1
  v_mfma_f32_16x16x32_bf16 v[92:95], v[188:191], a[44:47], v[92:95]
  ds_read_b64_tr_b16 v[172:173], v20 offset:61440
  v_mfma_f32_16x16x32_bf16 v[92:95], v[184:187], a[36:39], v[92:95]
  s_waitcnt vmcnt(29) lgkmcnt(3)
  ds_read_b64_tr_b16 v[174:175], v20 offset:63488
  v_mfma_f32_16x16x32_bf16 v[100:103], v[192:195], a[36:39], v[100:103]
  ds_read_b64_tr_b16 v[176:177], v21 offset:57344
  v_swap_b32 v210, v212
  v_swap_b32 v211, v213
  v_mfma_f32_16x16x32_bf16 v[100:103], v[196:199], a[44:47], v[100:103]
  ds_read_b64_tr_b16 v[178:179], v21 offset:59392
  buffer_load_dwordx4 v7, s[12:15], s38 offen offset:3072 lds
  v_mfma_f32_16x16x32_bf16 v[96:99], v[196:199], a[40:43], v[96:99]
  s_add_u32 s39, s39, s99
  ds_read_b64_tr_b16 v[180:181], v21 offset:61440
  v_mfma_f32_16x16x32_bf16 v[96:99], v[192:195], a[32:35], v[96:99]
  s_waitcnt vmcnt(25) lgkmcnt(3)
  ds_read_b64_tr_b16 v[182:183], v21 offset:63488
  v_mfma_f32_16x16x32_bf16 v[72:75], v[168:171], v[208:211], v[72:75]
  ds_read_b64_tr_b16 v[184:185], v22 offset:57344
  v_mfma_f32_16x16x32_bf16 v[72:75], v[172:175], a[56:59], v[72:75]
  ds_read_b64_tr_b16 v[186:187], v22 offset:59392
  buffer_load_dwordx4 a[112:115], v8, s[16:19], s39 offen sc1
  v_mfma_f32_16x16x32_bf16 v[76:79], v[172:175], a[60:63], v[76:79]
L_pad_3b_3:
  s_cbranch_execz L_ret_3b
  ds_read_b64_tr_b16 v[188:189], v22 offset:61440
  v_mfma_f32_16x16x32_bf16 v[76:79], v[168:171], v[212:215], v[76:79]
  s_waitcnt lgkmcnt(3)
  ds_read_b64_tr_b16 v[190:191], v22 offset:63488
  v_mfma_f32_16x16x32_bf16 v[84:87], v[176:179], v[212:215], v[84:87]
  ds_read_b64_tr_b16 v[192:193], v23 offset:57344
  v_mfma_f32_16x16x32_bf16 v[84:87], v[180:183], a[60:63], v[84:87]
  ds_read_b64_tr_b16 v[194:195], v23 offset:59392
  buffer_load_dwordx4 a[116:119], v9, s[16:19], s39 offen sc1
  v_mfma_f32_16x16x32_bf16 v[80:83], v[180:183], a[56:59], v[80:83]
  s_add_u32 s39, s39, s99
  ds_read_b64_tr_b16 v[196:197], v23 offset:61440
  v_mfma_f32_16x16x32_bf16 v[80:83], v[176:179], v[208:211], v[80:83]
  s_waitcnt vmcnt(26) lgkmcnt(3)
  ds_read_b64_tr_b16 v[198:199], v23 offset:63488
  v_mfma_f32_16x16x32_bf16 v[88:91], v[184:187], v[208:211], v[88:91]
  s_barrier
  ds_read_b64_tr_b16 v[168:169], v16 offset:8192
  v_mfma_f32_16x16x32_bf16 v[88:91], v[188:191], a[56:59], v[88:91]
  ds_read_b64_tr_b16 v[170:171], v16 offset:10240
  buffer_load_dwordx4 a[120:123], v8, s[16:19], s39 offen sc1
  v_mfma_f32_16x16x32_bf16 v[92:95], v[188:191], a[60:63], v[92:95]
  ds_read_b64_tr_b16 v[172:173], v16 offset:12288
  v_mfma_f32_16x16x32_bf16 v[92:95], v[184:187], v[212:215], v[92:95]
  s_waitcnt lgkmcnt(3)
  ds_read_b64_tr_b16 v[174:175], v16 offset:14336
  v_mfma_f32_16x16x32_bf16 v[100:103], v[192:195], v[212:215], v[100:103]
  ds_read_b64_tr_b16 v[176:177], v17 offset:8192
  buffer_load_dwordx4 a[124:127], v9, s[16:19], s39 offen sc1
  v_mfma_f32_16x16x32_bf16 v[100:103], v[196:199], a[60:63], v[100:103]
  s_add_u32 s39, s39, s99
  ds_read_b64_tr_b16 v[178:179], v17 offset:10240
  v_mfma_f32_16x16x32_bf16 v[96:99], v[196:199], a[56:59], v[96:99]
  ds_read_b64_tr_b16 v[180:181], v17 offset:12288
  v_mfma_f32_16x16x32_bf16 v[96:99], v[192:195], v[208:211], v[96:99]
  s_waitcnt vmcnt(21) lgkmcnt(3)
  ds_read_b64_tr_b16 v[182:183], v17 offset:14336
  v_mfma_f32_16x16x32_bf16 v[72:75], v[168:171], a[64:67], v[72:75]
  s_add_u32 s38, s38, s96
  ds_read_b64_tr_b16 v[184:185], v18 offset:8192
  v_mfma_f32_16x16x32_bf16 v[72:75], v[172:175], a[72:75], v[72:75]
  s_add_u32 m0, s37, 147456
  ds_read_b64_tr_b16 v[186:187], v18 offset:10240
  buffer_load_dwordx4 v4, s[12:15], s38 offen offset:0 lds
  v_mfma_f32_16x16x32_bf16 v[76:79], v[172:175], a[76:79], v[76:79]
  ds_read_b64_tr_b16 v[188:189], v18 offset:12288
  v_mfma_f32_16x16x32_bf16 v[76:79], v[168:171], a[68:71], v[76:79]
  s_waitcnt lgkmcnt(3)
  ds_read_b64_tr_b16 v[190:191], v18 offset:14336
  v_mfma_f32_16x16x32_bf16 v[84:87], v[176:179], a[68:71], v[84:87]
  ds_read_b64_tr_b16 v[192:193], v19 offset:8192
  buffer_load_dwordx4 v5, s[12:15], s38 offen offset:1024 lds
  v_mfma_f32_16x16x32_bf16 v[84:87], v[180:183], a[76:79], v[84:87]
  ds_read_b64_tr_b16 v[194:195], v19 offset:10240
  v_mfma_f32_16x16x32_bf16 v[80:83], v[180:183], a[72:75], v[80:83]
  ds_read_b64_tr_b16 v[196:197], v19 offset:12288
  v_mfma_f32_16x16x32_bf16 v[80:83], v[176:179], a[64:67], v[80:83]
  s_waitcnt lgkmcnt(3)
  ds_read_b64_tr_b16 v[198:199], v19 offset:14336
  buffer_load_dwordx4 v6, s[12:15], s38 offen offset:2048 lds
  v_mfma_f32_16x16x32_bf16 v[88:91], v[184:187], a[64:67], v[88:91]
  ds_read_b64_tr_b16 v[168:169], v16 offset:24576
  v_mfma_f32_16x16x32_bf16 v[88:91], v[188:191], a[72:75], v[88:91]
  ds_read_b64_tr_b16 v[170:171], v16 offset:26624
  v_mfma_f32_16x16x32_bf16 v[92:95], v[188:191], a[76:79], v[92:95]
  ds_read_b64_tr_b16 v[172:173], v16 offset:28672
  v_mfma_f32_16x16x32_bf16 v[92:95], v[184:187], a[68:71], v[92:95]
  s_waitcnt lgkmcnt(3)
  ds_read_b64_tr_b16 v[174:175], v16 offset:30720
  buffer_load_dwordx4 v7, s[12:15], s38 offen offset:3072 lds
  v_mfma_f32_16x16x32_bf16 v[100:103], v[192:195], a[68:71], v[100:103]
  ds_read_b64_tr_b16 v[176:177], v17 offset:24576
  v_mfma_f32_16x16x32_bf16 v[100:103], v[196:199], a[76:79], v[100:103]
  ds_read_b64_tr_b16 v[178:179], v17 offset:26624
  v_mfma_f32_16x16x32_bf16 v[96:99], v[196:199], a[72:75], v[96:99]
  ds_read_b64_tr_b16 v[180:181], v17 offset:28672
  v_mfma_f32_16x16x32_bf16 v[96:99], v[192:195], a[64:67], v[96:99]
  s_waitcnt vmcnt(17) lgkmcnt(3)
  ds_read_b64_tr_b16 v[182:183], v17 offset:30720
  v_mfma_f32_16x16x32_bf16 v[72:75], v[168:171], a[80:83], v[72:75]
  s_add_u32 s38, s38, s96
  ds_read_b64_tr_b16 v[184:185], v18 offset:24576
  v_mfma_f32_16x16x32_bf16 v[72:75], v[172:175], a[88:91], v[72:75]
  s_add_u32 m0, s37, 65536
  ds_read_b64_tr_b16 v[186:187], v18 offset:26624
  buffer_load_dwordx4 v4, s[12:15], s38 offen offset:0 lds
  v_mfma_f32_16x16x32_bf16 v[76:79], v[172:175], a[92:95], v[76:79]
  ds_read_b64_tr_b16 v[188:189], v18 offset:28672
  v_mfma_f32_16x16x32_bf16 v[76:79], v[168:171], a[84:87], v[76:79]
  s_waitcnt lgkmcnt(3)
  ds_read_b64_tr_b16 v[190:191], v18 offset:30720
  buffer_load_dwordx4 v5, s[12:15], s38 offen offset:1024 lds
  v_mfma_f32_16x16x32_bf16 v[84:87], v[176:179], a[84:87], v[84:87]
  ds_read_b64_tr_b16 v[192:193], v19 offset:24576
  v_mfma_f32_16x16x32_bf16 v[84:87], v[180:183], a[92:95], v[84:87]
  ds_read_b64_tr_b16 v[194:195], v19 offset:26624
  v_mfma_f32_16x16x32_bf16 v[80:83], v[180:183], a[88:91], v[80:83]
  ds_read_b64_tr_b16 v[196:197], v19 offset:28672
  v_mfma_f32_16x16x32_bf16 v[80:83], v[176:179], a[80:83], v[80:83]
  s_waitcnt vmcnt(18) lgkmcnt(3)
  ds_read_b64_tr_b16 v[198:199], v19 offset:30720
  buffer_load_dwordx4 v6, s[12:15], s38 offen offset:2048 lds
  v_mfma_f32_16x16x32_bf16 v[88:91], v[184:187], a[80:83], v[88:91]
  s_barrier
  ds_read_b64_tr_b16 v[168:169], v16 offset:40960
  v_mfma_f32_16x16x32_bf16 v[88:91], v[188:191], a[88:91], v[88:91]
  ds_read_b64_tr_b16 v[170:171], v16 offset:43008
  v_mfma_f32_16x16x32_bf16 v[92:95], v[188:191], a[92:95], v[92:95]
  ds_read_b64_tr_b16 v[172:173], v16 offset:45056
  v_mfma_f32_16x16x32_bf16 v[92:95], v[184:187], a[84:87], v[92:95]
  s_waitcnt vmcnt(12) lgkmcnt(3)
  ds_read_b64_tr_b16 v[174:175], v16 offset:47104
  buffer_load_dwordx4 v7, s[12:15], s38 offen offset:3072 lds
  v_mfma_f32_16x16x32_bf16 v[100:103], v[192:195], a[84:87], v[100:103]
  ds_read_b64_tr_b16 v[176:177], v17 offset:40960
  v_swap_b32 v218, v220
  v_swap_b32 v219, v221
  v_mfma_f32_16x16x32_bf16 v[100:103], v[196:199], a[92:95], v[100:103]
  ds_read_b64_tr_b16 v[178:179], v17 offset:43008
  v_mfma_f32_16x16x32_bf16 v[96:99], v[196:199], a[88:91], v[96:99]
  ds_read_b64_tr_b16 v[180:181], v17 offset:45056
  v_mfma_f32_16x16x32_bf16 v[96:99], v[192:195], a[80:83], v[96:99]
  s_waitcnt vmcnt(13) lgkmcnt(3)
  ds_read_b64_tr_b16 v[182:183], v17 offset:47104
  v_mfma_f32_16x16x32_bf16 v[72:75], v[168:171], a[96:99], v[72:75]
  s_add_u32 s38, s38, s96
  ds_read_b64_tr_b16 v[184:185], v18 offset:40960
  v_mfma_f32_16x16x32_bf16 v[72:75], v[172:175], v[216:219], v[72:75]
  s_add_u32 m0, s37, 81920
  ds_read_b64_tr_b16 v[186:187], v18 offset:43008
  buffer_load_dwordx4 v4, s[12:15], s38 offen offset:0 lds
  v_mfma_f32_16x16x32_bf16 v[76:79], v[172:175], v[220:223], v[76:79]
  ds_read_b64_tr_b16 v[188:189], v18 offset:45056
  v_mfma_f32_16x16x32_bf16 v[76:79], v[168:171], a[100:103], v[76:79]
  s_waitcnt lgkmcnt(3)
  ds_read_b64_tr_b16 v[190:191], v18 offset:47104
  buffer_load_dwordx4 v5, s[12:15], s38 offen offset:1024 lds
  v_mfma_f32_16x16x32_bf16 v[84:87], v[176:179], a[100:103], v[84:87]
  ds_read_b64_tr_b16 v[192:193], v19 offset:40960
  v_mfma_f32_16x16x32_bf16 v[84:87], v[180:183], v[220:223], v[84:87]
  ds_read_b64_tr_b16 v[194:195], v19 offset:43008
  v_mfma_f32_16x16x32_bf16 v[80:83], v[180:183], v[216:219], v[80:83]
  ds_read_b64_tr_b16 v[196:197], v19 offset:45056
  v_mfma_f32_16x16x32_bf16 v[80:83], v[176:179], a[96:99], v[80:83]
  s_waitcnt lgkmcnt(3)
  ds_read_b64_tr_b16 v[198:199], v19 offset:47104
  buffer_load_dwordx4 v6, s[12:15], s38 offen offset:2048 lds
  v_mfma_f32_16x16x32_bf16 v[88:91], v[184:187], a[96:99], v[88:91]
  ds_read_b64_tr_b16 v[168:169], v16 offset:57344
  v_mfma_f32_16x16x32_bf16 v[88:91], v[188:191], v[216:219], v[88:91]
  ds_read_b64_tr_b16 v[170:171], v16 offset:59392
  v_mfma_f32_16x16x32_bf16 v[92:95], v[188:191], v[220:223], v[92:95]
  ds_read_b64_tr_b16 v[172:173], v16 offset:61440
  v_mfma_f32_16x16x32_bf16 v[92:95], v[184:187], a[100:103], v[92:95]
  s_waitcnt lgkmcnt(3)
  ds_read_b64_tr_b16 v[174:175], v16 offset:63488
  buffer_load_dwordx4 v7, s[12:15], s38 offen offset:3072 lds
  v_mfma_f32_16x16x32_bf16 v[100:103], v[192:195], a[100:103], v[100:103]
  s_add_u32 s38, s38, s96
  ds_read_b64_tr_b16 v[176:177], v17 offset:57344
  v_mfma_f32_16x16x32_bf16 v[100:103], v[196:199], v[220:223], v[100:103]
  ds_read_b64_tr_b16 v[178:179], v17 offset:59392
  v_mfma_f32_16x16x32_bf16 v[96:99], v[196:199], v[216:219], v[96:99]
  ds_read_b64_tr_b16 v[180:181], v17 offset:61440
  v_mfma_f32_16x16x32_bf16 v[96:99], v[192:195], a[96:99], v[96:99]
  s_waitcnt vmcnt(12) lgkmcnt(3)
  ds_read_b64_tr_b16 v[182:183], v17 offset:63488
  v_mfma_f32_16x16x32_bf16 v[72:75], v[168:171], a[112:115], v[72:75]
  ds_read_b64_tr_b16 v[184:185], v18 offset:57344
  v_mfma_f32_16x16x32_bf16 v[72:75], v[172:175], a[120:123], v[72:75]
  ds_read_b64_tr_b16 v[186:187], v18 offset:59392
  v_mfma_f32_16x16x32_bf16 v[76:79], v[172:175], a[124:127], v[76:79]
  ds_read_b64_tr_b16 v[188:189], v18 offset:61440
  v_mfma_f32_16x16x32_bf16 v[76:79], v[168:171], a[116:119], v[76:79]
  s_waitcnt lgkmcnt(3)
  ds_read_b64_tr_b16 v[190:191], v18 offset:63488
  v_mfma_f32_16x16x32_bf16 v[84:87], v[176:179], a[116:119], v[84:87]
  ds_read_b64_tr_b16 v[192:193], v19 offset:57344
  v_mfma_f32_16x16x32_bf16 v[84:87], v[180:183], a[124:127], v[84:87]
  ds_read_b64_tr_b16 v[194:195], v19 offset:59392
  v_mfma_f32_16x16x32_bf16 v[80:83], v[180:183], a[120:123], v[80:83]
  ds_read_b64_tr_b16 v[196:197], v19 offset:61440
  v_mfma_f32_16x16x32_bf16 v[80:83], v[176:179], a[112:115], v[80:83]
  s_waitcnt lgkmcnt(3)
  ds_read_b64_tr_b16 v[198:199], v19 offset:63488
  v_mfma_f32_16x16x32_bf16 v[88:91], v[184:187], a[112:115], v[88:91]
  ds_read_b64_tr_b16 v[168:169], v20 offset:49152
  v_mfma_f32_16x16x32_bf16 v[88:91], v[188:191], a[120:123], v[88:91]
  ds_read_b64_tr_b16 v[170:171], v20 offset:51200
  v_mfma_f32_16x16x32_bf16 v[92:95], v[188:191], a[124:127], v[92:95]
  ds_read_b64_tr_b16 v[172:173], v20 offset:53248
  v_mfma_f32_16x16x32_bf16 v[92:95], v[184:187], a[116:119], v[92:95]
  s_waitcnt lgkmcnt(3)
  ds_read_b64_tr_b16 v[174:175], v20 offset:55296
  v_mfma_f32_16x16x32_bf16 v[100:103], v[192:195], a[116:119], v[100:103]
  ds_read_b64_tr_b16 v[176:177], v21 offset:49152
  v_mfma_f32_16x16x32_bf16 v[100:103], v[196:199], a[124:127], v[100:103]
  ds_read_b64_tr_b16 v[178:179], v21 offset:51200
  v_mfma_f32_16x16x32_bf16 v[96:99], v[196:199], a[120:123], v[96:99]
  ds_read_b64_tr_b16 v[180:181], v21 offset:53248
  v_mfma_f32_16x16x32_bf16 v[96:99], v[192:195], a[112:115], v[96:99]
  s_waitcnt lgkmcnt(3)
  ds_read_b64_tr_b16 v[182:183], v21 offset:55296
  v_mfma_f32_16x16x32_bf16 v[40:43], v[168:171], v[208:211], v[40:43]
  ds_read_b64_tr_b16 v[184:185], v22 offset:49152
  v_mfma_f32_16x16x32_bf16 v[40:43], v[172:175], a[56:59], v[40:43]
  ds_read_b64_tr_b16 v[186:187], v22 offset:51200
  v_mfma_f32_16x16x32_bf16 v[44:47], v[172:175], a[60:63], v[44:47]
  ds_read_b64_tr_b16 v[188:189], v22 offset:53248
  v_cvt_pk_bf16_f32 v128, v72, v73
  v_mfma_f32_16x16x32_bf16 v[44:47], v[168:171], v[212:215], v[44:47]
  s_waitcnt lgkmcnt(3)
  ds_read_b64_tr_b16 v[190:191], v22 offset:55296
  v_cvt_pk_bf16_f32 v129, v74, v75
  v_mfma_f32_16x16x32_bf16 v[52:55], v[176:179], v[212:215], v[52:55]
  ds_read_b64_tr_b16 v[192:193], v23 offset:49152
  v_cvt_pk_bf16_f32 v130, v80, v81
  v_mfma_f32_16x16x32_bf16 v[52:55], v[180:183], a[60:63], v[52:55]
  ds_read_b64_tr_b16 v[194:195], v23 offset:51200
  v_cvt_pk_bf16_f32 v131, v82, v83
  v_mfma_f32_16x16x32_bf16 v[48:51], v[180:183], a[56:59], v[48:51]
  ds_read_b64_tr_b16 v[196:197], v23 offset:53248
  v_mfma_f32_16x16x32_bf16 v[48:51], v[176:179], v[208:211], v[48:51]
  s_waitcnt lgkmcnt(3)
  ds_read_b64_tr_b16 v[198:199], v23 offset:55296
  v_mfma_f32_16x16x32_bf16 v[56:59], v[184:187], v[208:211], v[56:59]
  ds_read_b64_tr_b16 v[168:169], v16 offset:0
  global_store_dwordx4 v32, v[128:131], s[4:5] offset:-4096 sc1
  v_mfma_f32_16x16x32_bf16 v[56:59], v[188:191], a[56:59], v[56:59]
  ds_read_b64_tr_b16 v[170:171], v16 offset:2048
  v_mfma_f32_16x16x32_bf16 v[60:63], v[188:191], a[60:63], v[60:63]
  ds_read_b64_tr_b16 v[172:173], v16 offset:4096
  v_cvt_pk_bf16_f32 v132, v88, v89
  v_mfma_f32_16x16x32_bf16 v[60:63], v[184:187], v[212:215], v[60:63]
  s_waitcnt lgkmcnt(3)
  ds_read_b64_tr_b16 v[174:175], v16 offset:6144
  v_cvt_pk_bf16_f32 v133, v90, v91
  v_mfma_f32_16x16x32_bf16 v[68:71], v[192:195], v[212:215], v[68:71]
  ds_read_b64_tr_b16 v[176:177], v17 offset:0
  v_cvt_pk_bf16_f32 v134, v96, v97
  v_mfma_f32_16x16x32_bf16 v[68:71], v[196:199], a[60:63], v[68:71]
  ds_read_b64_tr_b16 v[178:179], v17 offset:2048
  v_cvt_pk_bf16_f32 v135, v98, v99
  v_mfma_f32_16x16x32_bf16 v[64:67], v[196:199], a[56:59], v[64:67]
  ds_read_b64_tr_b16 v[180:181], v17 offset:4096
  v_mfma_f32_16x16x32_bf16 v[64:67], v[192:195], v[208:211], v[64:67]
  s_waitcnt lgkmcnt(3)
  ds_read_b64_tr_b16 v[182:183], v17 offset:6144
  v_mfma_f32_16x16x32_bf16 v[40:43], v[168:171], a[64:67], v[40:43]
  ds_read_b64_tr_b16 v[184:185], v18 offset:0
  global_store_dwordx4 v32, v[132:135], s[4:5] offset:-2048 sc1
  v_mfma_f32_16x16x32_bf16 v[40:43], v[172:175], a[72:75], v[40:43]
  ds_read_b64_tr_b16 v[186:187], v18 offset:2048
  v_mfma_f32_16x16x32_bf16 v[44:47], v[172:175], a[76:79], v[44:47]
  ds_read_b64_tr_b16 v[188:189], v18 offset:4096
  v_cvt_pk_bf16_f32 v136, v76, v77
  v_mfma_f32_16x16x32_bf16 v[44:47], v[168:171], a[68:71], v[44:47]
  s_waitcnt lgkmcnt(3)
  ds_read_b64_tr_b16 v[190:191], v18 offset:6144
  v_cvt_pk_bf16_f32 v137, v78, v79
  v_mfma_f32_16x16x32_bf16 v[52:55], v[176:179], a[68:71], v[52:55]
  ds_read_b64_tr_b16 v[192:193], v19 offset:0
  v_cvt_pk_bf16_f32 v138, v84, v85
  v_mfma_f32_16x16x32_bf16 v[52:55], v[180:183], a[76:79], v[52:55]
  ds_read_b64_tr_b16 v[194:195], v19 offset:2048
  v_cvt_pk_bf16_f32 v139, v86, v87
  v_mfma_f32_16x16x32_bf16 v[48:51], v[180:183], a[72:75], v[48:51]
  ds_read_b64_tr_b16 v[196:197], v19 offset:4096
  v_mfma_f32_16x16x32_bf16 v[48:51], v[176:179], a[64:67], v[48:51]
  s_waitcnt lgkmcnt(3)
  ds_read_b64_tr_b16 v[198:199], v19 offset:6144
  v_mfma_f32_16x16x32_bf16 v[56:59], v[184:187], a[64:67], v[56:59]
  ds_read_b64_tr_b16 v[168:169], v16 offset:16384
  global_store_dwordx4 v32, v[136:139], s[4:5] offset:0 sc1
  v_mfma_f32_16x16x32_bf16 v[56:59], v[188:191], a[72:75], v[56:59]
  ds_read_b64_tr_b16 v[170:171], v16 offset:18432
  v_mfma_f32_16x16x32_bf16 v[60:63], v[188:191], a[76:79], v[60:63]
  ds_read_b64_tr_b16 v[172:173], v16 offset:20480
  v_cvt_pk_bf16_f32 v140, v92, v93
  v_mfma_f32_16x16x32_bf16 v[60:63], v[184:187], a[68:71], v[60:63]
  s_waitcnt lgkmcnt(3)
  ds_read_b64_tr_b16 v[174:175], v16 offset:22528
  v_cvt_pk_bf16_f32 v141, v94, v95
  v_mfma_f32_16x16x32_bf16 v[68:71], v[192:195], a[68:71], v[68:71]
  ds_read_b64_tr_b16 v[176:177], v17 offset:16384
  v_cvt_pk_bf16_f32 v142, v100, v101
  v_mfma_f32_16x16x32_bf16 v[68:71], v[196:199], a[76:79], v[68:71]
  ds_read_b64_tr_b16 v[178:179], v17 offset:18432
  v_cvt_pk_bf16_f32 v143, v102, v103
  v_mfma_f32_16x16x32_bf16 v[64:67], v[196:199], a[72:75], v[64:67]
  ds_read_b64_tr_b16 v[180:181], v17 offset:20480
  v_mfma_f32_16x16x32_bf16 v[64:67], v[192:195], a[64:67], v[64:67]
  s_waitcnt lgkmcnt(3)
  ds_read_b64_tr_b16 v[182:183], v17 offset:22528
  v_mfma_f32_16x16x32_bf16 v[40:43], v[168:171], a[80:83], v[40:43]
  ds_read_b64_tr_b16 v[184:185], v18 offset:16384
  global_store_dwordx4 v32, v[140:143], s[4:5] offset:2048 sc1
  v_mfma_f32_16x16x32_bf16 v[40:43], v[172:175], a[88:91], v[40:43]
  ds_read_b64_tr_b16 v[186:187], v18 offset:18432
  v_mfma_f32_16x16x32_bf16 v[44:47], v[172:175], a[92:95], v[44:47]
  ds_read_b64_tr_b16 v[188:189], v18 offset:20480
  buffer_load_dwordx4 a[128:131], v8, s[16:19], s39 offen sc1
  v_mfma_f32_16x16x32_bf16 v[44:47], v[168:171], a[84:87], v[44:47]
  s_waitcnt lgkmcnt(3)
  ds_read_b64_tr_b16 v[190:191], v18 offset:22528
  v_mfma_f32_16x16x32_bf16 v[52:55], v[176:179], a[84:87], v[52:55]
  ds_read_b64_tr_b16 v[192:193], v19 offset:16384
  v_mfma_f32_16x16x32_bf16 v[52:55], v[180:183], a[92:95], v[52:55]
  ds_read_b64_tr_b16 v[194:195], v19 offset:18432
  v_mfma_f32_16x16x32_bf16 v[48:51], v[180:183], a[88:91], v[48:51]
  ds_read_b64_tr_b16 v[196:197], v19 offset:20480
  buffer_load_dwordx4 a[132:135], v9, s[16:19], s39 offen sc1
  v_mfma_f32_16x16x32_bf16 v[48:51], v[176:179], a[80:83], v[48:51]
  s_waitcnt lgkmcnt(3)
  ds_read_b64_tr_b16 v[198:199], v19 offset:22528
  v_mfma_f32_16x16x32_bf16 v[56:59], v[184:187], a[80:83], v[56:59]
  s_add_u32 s39, s39, s99
  ds_read_b64_tr_b16 v[168:169], v16 offset:32768
  v_mfma_f32_16x16x32_bf16 v[56:59], v[188:191], a[88:91], v[56:59]
  ds_read_b64_tr_b16 v[170:171], v16 offset:34816
  v_mfma_f32_16x16x32_bf16 v[60:63], v[188:191], a[92:95], v[60:63]
  ds_read_b64_tr_b16 v[172:173], v16 offset:36864
  buffer_load_dwordx4 a[136:139], v8, s[16:19], s39 offen sc1
  v_mfma_f32_16x16x32_bf16 v[60:63], v[184:187], a[84:87], v[60:63]
  s_waitcnt lgkmcnt(3)
  ds_read_b64_tr_b16 v[174:175], v16 offset:38912
  v_mfma_f32_16x16x32_bf16 v[68:71], v[192:195], a[84:87], v[68:71]
  ds_read_b64_tr_b16 v[176:177], v17 offset:32768
  v_mfma_f32_16x16x32_bf16 v[68:71], v[196:199], a[92:95], v[68:71]
  ds_read_b64_tr_b16 v[178:179], v17 offset:34816
  v_mfma_f32_16x16x32_bf16 v[64:67], v[196:199], a[88:91], v[64:67]
  ds_read_b64_tr_b16 v[180:181], v17 offset:36864
  buffer_load_dwordx4 a[140:143], v9, s[16:19], s39 offen sc1
  v_mfma_f32_16x16x32_bf16 v[64:67], v[192:195], a[80:83], v[64:67]
  s_waitcnt lgkmcnt(3)
  ds_read_b64_tr_b16 v[182:183], v17 offset:38912
  v_mfma_f32_16x16x32_bf16 v[40:43], v[168:171], a[96:99], v[40:43]
  s_add_u32 s39, s39, s99
  ds_read_b64_tr_b16 v[184:185], v18 offset:32768
  v_add_u32 v11, s41, v11
  v_mfma_f32_16x16x32_bf16 v[40:43], v[172:175], v[216:219], v[40:43]
  ds_read_b64_tr_b16 v[186:187], v18 offset:34816
  global_load_dwordx2 v[12:13], v11, s[4:5] sc1
  v_mfma_f32_16x16x32_bf16 v[44:47], v[172:175], v[220:223], v[44:47]
  ds_read_b64_tr_b16 v[188:189], v18 offset:36864
  buffer_load_dwordx4 a[144:147], v8, s[16:19], s39 offen sc1
  v_mfma_f32_16x16x32_bf16 v[44:47], v[168:171], a[100:103], v[44:47]
  s_waitcnt lgkmcnt(3)
  ds_read_b64_tr_b16 v[190:191], v18 offset:38912
  v_mfma_f32_16x16x32_bf16 v[52:55], v[176:179], a[100:103], v[52:55]
  ds_read_b64_tr_b16 v[192:193], v19 offset:32768
  v_mfma_f32_16x16x32_bf16 v[52:55], v[180:183], v[220:223], v[52:55]
  ds_read_b64_tr_b16 v[194:195], v19 offset:34816
  buffer_load_dwordx4 a[148:151], v9, s[16:19], s39 offen sc1
  v_mfma_f32_16x16x32_bf16 v[48:51], v[180:183], v[216:219], v[48:51]
  s_add_u32 s39, s39, s99
  ds_read_b64_tr_b16 v[196:197], v19 offset:36864
  v_mfma_f32_16x16x32_bf16 v[48:51], v[176:179], a[96:99], v[48:51]
  s_waitcnt lgkmcnt(3)
  ds_read_b64_tr_b16 v[198:199], v19 offset:38912
  v_mfma_f32_16x16x32_bf16 v[56:59], v[184:187], a[96:99], v[56:59]
  ds_read_b64_tr_b16 v[168:169], v16 offset:49152
  v_mfma_f32_16x16x32_bf16 v[56:59], v[188:191], v[216:219], v[56:59]
  ds_read_b64_tr_b16 v[170:171], v16 offset:51200
  buffer_load_dwordx4 a[152:155], v8, s[16:19], s39 offen sc1
  v_mfma_f32_16x16x32_bf16 v[60:63], v[188:191], v[220:223], v[60:63]
  ds_read_b64_tr_b16 v[172:173], v16 offset:53248
  v_mfma_f32_16x16x32_bf16 v[60:63], v[184:187], a[100:103], v[60:63]
  s_waitcnt lgkmcnt(3)
  ds_read_b64_tr_b16 v[174:175], v16 offset:55296
  v_mfma_f32_16x16x32_bf16 v[68:71], v[192:195], a[100:103], v[68:71]
  ds_read_b64_tr_b16 v[176:177], v17 offset:49152
  v_mfma_f32_16x16x32_bf16 v[68:71], v[196:199], v[220:223], v[68:71]
  ds_read_b64_tr_b16 v[178:179], v17 offset:51200
  buffer_load_dwordx4 a[156:159], v9, s[16:19], s39 offen sc1
  v_mfma_f32_16x16x32_bf16 v[64:67], v[196:199], v[216:219], v[64:67]
  s_add_u32 s39, s39, s99
  ds_read_b64_tr_b16 v[180:181], v17 offset:53248
  v_mfma_f32_16x16x32_bf16 v[64:67], v[192:195], a[96:99], v[64:67]
  s_waitcnt lgkmcnt(3)
  ds_read_b64_tr_b16 v[182:183], v17 offset:55296
  v_mfma_f32_16x16x32_bf16 v[40:43], v[168:171], a[112:115], v[40:43]
  ds_read_b64_tr_b16 v[184:185], v18 offset:49152
  buffer_load_dwordx4 v[224:227], v8, s[16:19], s39 offen sc1
  v_mfma_f32_16x16x32_bf16 v[40:43], v[172:175], a[120:123], v[40:43]
  ds_read_b64_tr_b16 v[186:187], v18 offset:51200
  v_mfma_f32_16x16x32_bf16 v[44:47], v[172:175], a[124:127], v[44:47]
  ds_read_b64_tr_b16 v[188:189], v18 offset:53248
  v_mfma_f32_16x16x32_bf16 v[44:47], v[168:171], a[116:119], v[44:47]
  s_waitcnt lgkmcnt(3)
  ds_read_b64_tr_b16 v[190:191], v18 offset:55296
  v_mfma_f32_16x16x32_bf16 v[52:55], v[176:179], a[116:119], v[52:55]
  ds_read_b64_tr_b16 v[192:193], v19 offset:49152
  buffer_load_dwordx4 v[228:231], v9, s[16:19], s39 offen sc1
  v_mfma_f32_16x16x32_bf16 v[52:55], v[180:183], a[124:127], v[52:55]
  s_add_u32 s39, s39, s99
  ds_read_b64_tr_b16 v[194:195], v19 offset:51200
  v_mfma_f32_16x16x32_bf16 v[48:51], v[180:183], a[120:123], v[48:51]
  ds_read_b64_tr_b16 v[196:197], v19 offset:53248
  v_mfma_f32_16x16x32_bf16 v[48:51], v[176:179], a[112:115], v[48:51]
  s_waitcnt vmcnt(23) lgkmcnt(3)
  ds_read_b64_tr_b16 v[198:199], v19 offset:55296
  v_mfma_f32_16x16x32_bf16 v[56:59], v[184:187], a[112:115], v[56:59]
  s_barrier
  ds_read_b64_tr_b16 v[168:169], v160 offset:0
  v_mfma_f32_16x16x32_bf16 v[56:59], v[188:191], a[120:123], v[56:59]
  ds_read_b64_tr_b16 v[170:171], v160 offset:2048
  buffer_load_dwordx4 a[168:171], v8, s[16:19], s39 offen sc1
  v_mfma_f32_16x16x32_bf16 v[60:63], v[188:191], a[124:127], v[60:63]
  ds_read_b64_tr_b16 v[172:173], v160 offset:4096
  v_mfma_f32_16x16x32_bf16 v[60:63], v[184:187], a[116:119], v[60:63]
  s_waitcnt lgkmcnt(3)
  ds_read_b64_tr_b16 v[174:175], v160 offset:6144
  v_mfma_f32_16x16x32_bf16 v[68:71], v[192:195], a[116:119], v[68:71]
  ds_read_b64_tr_b16 v[176:177], v161 offset:0
  buffer_load_dwordx4 a[172:175], v9, s[16:19], s39 offen sc1
  v_mfma_f32_16x16x32_bf16 v[68:71], v[196:199], a[124:127], v[68:71]
  s_add_u32 s39, s39, s99
  ds_read_b64_tr_b16 v[178:179], v161 offset:2048
  v_mfma_f32_16x16x32_bf16 v[64:67], v[196:199], a[120:123], v[64:67]
  ds_read_b64_tr_b16 v[180:181], v161 offset:4096
  v_mfma_f32_16x16x32_bf16 v[64:67], v[192:195], a[112:115], v[64:67]
  s_waitcnt vmcnt(9) lgkmcnt(3)
  ds_read_b64_tr_b16 v[182:183], v161 offset:6144
  v_mfma_f32_16x16x32_bf16 v[40:43], v[168:171], a[128:131], v[40:43]
  ds_read_b64_tr_b16 v[184:185], v162 offset:0
  global_store_dwordx2 v34, v[36:37], s[4:5] sc1
  v_mfma_f32_16x16x32_bf16 v[40:43], v[172:175], a[136:139], v[40:43]
  ds_read_b64_tr_b16 v[186:187], v162 offset:2048
  buffer_load_dwordx4 a[176:179], v8, s[16:19], s39 offen sc1
  v_mfma_f32_16x16x32_bf16 v[44:47], v[172:175], a[140:143], v[44:47]
  ds_read_b64_tr_b16 v[188:189], v162 offset:4096
  v_mfma_f32_16x16x32_bf16 v[44:47], v[168:171], a[132:135], v[44:47]
  s_waitcnt lgkmcnt(3)
  ds_read_b64_tr_b16 v[190:191], v162 offset:6144
  buffer_load_dwordx4 a[180:183], v9, s[16:19], s39 offen sc1
  v_mfma_f32_16x16x32_bf16 v[52:55], v[176:179], a[132:135], v[52:55]
  s_add_u32 s39, s39, s99
  ds_read_b64_tr_b16 v[192:193], v163 offset:0
  v_mfma_f32_16x16x32_bf16 v[52:55], v[180:183], a[140:143], v[52:55]
  ds_read_b64_tr_b16 v[194:195], v163 offset:2048
  v_mfma_f32_16x16x32_bf16 v[48:51], v[180:183], a[136:139], v[48:51]
  ds_read_b64_tr_b16 v[196:197], v163 offset:4096
  v_mfma_f32_16x16x32_bf16 v[48:51], v[176:179], a[128:131], v[48:51]
  s_waitcnt lgkmcnt(3)
  ds_read_b64_tr_b16 v[198:199], v163 offset:6144
  buffer_load_dwordx4 a[184:187], v8, s[16:19], s39 offen sc1
  v_mfma_f32_16x16x32_bf16 v[56:59], v[184:187], a[128:131], v[56:59]
  ds_read_b64_tr_b16 v[168:169], v160 offset:8192
  v_mfma_f32_16x16x32_bf16 v[56:59], v[188:191], a[136:139], v[56:59]
  ds_read_b64_tr_b16 v[170:171], v160 offset:10240
  v_mfma_f32_16x16x32_bf16 v[60:63], v[188:191], a[140:143], v[60:63]
  ds_read_b64_tr_b16 v[172:173], v160 offset:12288
  v_mfma_f32_16x16x32_bf16 v[60:63], v[184:187], a[132:135], v[60:63]
  s_waitcnt lgkmcnt(3)
  ds_read_b64_tr_b16 v[174:175], v160 offset:14336
  buffer_load_dwordx4 a[188:191], v9, s[16:19], s39 offen sc1
  v_mfma_f32_16x16x32_bf16 v[68:71], v[192:195], a[132:135], v[68:71]
  s_add_u32 s39, s39, s99
  ds_read_b64_tr_b16 v[176:177], v161 offset:8192
  v_mfma_f32_16x16x32_bf16 v[68:71], v[196:199], a[140:143], v[68:71]
  ds_read_b64_tr_b16 v[178:179], v161 offset:10240
  v_mfma_f32_16x16x32_bf16 v[64:67], v[196:199], a[136:139], v[64:67]
  ds_read_b64_tr_b16 v[180:181], v161 offset:12288
  v_mfma_f32_16x16x32_bf16 v[64:67], v[192:195], a[128:131], v[64:67]
  s_waitcnt vmcnt(9) lgkmcnt(3)
  ds_read_b64_tr_b16 v[182:183], v161 offset:14336
  v_cmp_ne_u64 vcc, s[6:7], v[12:13]
  s_cbranch_vccnz L_slow_38
L_back_39:
  v_mfma_f32_16x16x32_bf16 v[40:43], v[168:171], a[144:147], v[40:43]
  ds_read_b64_tr_b16 v[184:185], v162 offset:8192
  buffer_load_dwordx4 a[192:195], v8, s[16:19], s39 offen sc1
  v_mfma_f32_16x16x32_bf16 v[40:43], v[172:175], a[152:155], v[40:43]
  ds_read_b64_tr_b16 v[186:187], v162 offset:10240
  v_mfma_f32_16x16x32_bf16 v[44:47], v[172:175], a[156:159], v[44:47]
  ds_read_b64_tr_b16 v[188:189], v162 offset:12288
  buffer_load_dwordx4 a[196:199], v9, s[16:19], s39 offen sc1
  v_mfma_f32_16x16x32_bf16 v[44:47], v[168:171], a[148:151], v[44:47]
  s_waitcnt lgkmcnt(3)
  ds_read_b64_tr_b16 v[190:191], v162 offset:14336
  v_mfma_f32_16x16x32_bf16 v[52:55], v[176:179], a[148:151], v[52:55]
  s_add_u32 s39, s39, s99
  ds_read_b64_tr_b16 v[192:193], v163 offset:8192
  v_mfma_f32_16x16x32_bf16 v[52:55], v[180:183], a[156:159], v[52:55]
  ds_read_b64_tr_b16 v[194:195], v163 offset:10240
  v_mfma_f32_16x16x32_bf16 v[48:51], v[180:183], a[152:155], v[48:51]
  ds_read_b64_tr_b16 v[196:197], v163 offset:12288
  buffer_load_dwordx4 a[200:203], v8, s[16:19], s39 offen sc1
  v_mfma_f32_16x16x32_bf16 v[48:51], v[176:179], a[144:147], v[48:51]
  s_waitcnt lgkmcnt(3)
  ds_read_b64_tr_b16 v[198:199], v163 offset:14336
  v_mfma_f32_16x16x32_bf16 v[56:59], v[184:187], a[144:147], v[56:59]
  ds_read_b64_tr_b16 v[168:169], v160 offset:16384
  v_mfma_f32_16x16x32_bf16 v[56:59], v[188:191], a[152:155], v[56:59]
  ds_read_b64_tr_b16 v[170:171], v160 offset:18432
  v_mfma_f32_16x16x32_bf16 v[60:63], v[188:191], a[156:159], v[60:63]
  ds_read_b64_tr_b16 v[172:173], v160 offset:20480
  buffer_load_dwordx4 a[204:207], v9, s[16:19], s39 offen sc1
  v_mfma_f32_16x16x32_bf16 v[60:63], v[184:187], a[148:151], v[60:63]
  s_waitcnt vmcnt(11) lgkmcnt(3)
  ds_read_b64_tr_b16 v[174:175], v160 offset:22528
  v_mfma_f32_16x16x32_bf16 v[68:71], v[192:195], a[148:151], v[68:71]
  s_add_u32 s39, s39, s99
  ds_read_b64_tr_b16 v[176:177], v161 offset:16384
  v_swap_b32 v226, v228
  v_swap_b32 v227, v229
  v_mfma_f32_16x16x32_bf16 v[68:71], v[196:199], a[156:159], v[68:71]
  ds_read_b64_tr_b16 v[178:179], v161 offset:18432
  v_mfma_f32_16x16x32_bf16 v[64:67], v[196:199], a[152:155], v[64:67]
  ds_read_b64_tr_b16 v[180:181], v161 offset:20480
  v_mfma_f32_16x16x32_bf16 v[64:67], v[192:195], a[144:147], v[64:67]
  s_waitcnt vmcnt(9) lgkmcnt(3)
  ds_read_b64_tr_b16 v[182:183], v161 offset:22528
  v_mfma_f32_16x16x32_bf16 v[40:43], v[168:171], v[224:227], v[40:43]
  ds_read_b64_tr_b16 v[184:185], v162 offset:16384
  buffer_load_dwordx4 a[208:211], v8, s[16:19], s39 offen sc1
  v_mfma_f32_16x16x32_bf16 v[40:43], v[172:175], a[168:171], v[40:43]
  ds_read_b64_tr_b16 v[186:187], v162 offset:18432
  v_mfma_f32_16x16x32_bf16 v[44:47], v[172:175], a[172:175], v[44:47]
  ds_read_b64_tr_b16 v[188:189], v162 offset:20480
  buffer_load_dwordx4 a[212:215], v9, s[16:19], s39 offen sc1
  v_mfma_f32_16x16x32_bf16 v[44:47], v[168:171], v[228:231], v[44:47]
  s_waitcnt lgkmcnt(3)
  ds_read_b64_tr_b16 v[190:191], v162 offset:22528
  v_mfma_f32_16x16x32_bf16 v[52:55], v[176:179], v[228:231], v[52:55]
  s_add_u32 s39, s39, s99
  ds_read_b64_tr_b16 v[192:193], v163 offset:16384
  v_mfma_f32_16x16x32_bf16 v[52:55], v[180:183], a[172:175], v[52:55]
  ds_read_b64_tr_b16 v[194:195], v163 offset:18432
  v_mfma_f32_16x16x32_bf16 v[48:51], v[180:183], a[168:171], v[48:51]
  ds_read_b64_tr_b16 v[196:197], v163 offset:20480
  buffer_load_dwordx4 v[200:203], v8, s[16:19], s39 offen sc1
  v_mfma_f32_16x16x32_bf16 v[48:51], v[176:179], v[224:227], v[48:51]
  s_waitcnt lgkmcnt(3)
  ds_read_b64_tr_b16 v[198:199], v163 offset:22528
  v_mfma_f32_16x16x32_bf16 v[56:59], v[184:187], v[224:227], v[56:59]
  ds_read_b64_tr_b16 v[168:169], v160 offset:24576
  global_load_dwordx2 v[38:39], v35, s[4:5] sc1
  v_mfma_f32_16x16x32_bf16 v[56:59], v[188:191], a[168:171], v[56:59]
  ds_read_b64_tr_b16 v[170:171], v160 offset:26624
  v_mfma_f32_16x16x32_bf16 v[60:63], v[188:191], a[172:175], v[60:63]
  ds_read_b64_tr_b16 v[172:173], v160 offset:28672
  buffer_load_dwordx4 v[204:207], v9, s[16:19], s39 offen sc1
  v_mfma_f32_16x16x32_bf16 v[60:63], v[184:187], v[228:231], v[60:63]
  s_waitcnt lgkmcnt(3)
  ds_read_b64_tr_b16 v[174:175], v160 offset:30720
  v_mfma_f32_16x16x32_bf16 v[68:71], v[192:195], v[228:231], v[68:71]
  s_add_u32 s39, s39, s99
  ds_read_b64_tr_b16 v[176:177], v161 offset:24576
  v_mfma_f32_16x16x32_bf16 v[68:71], v[196:199], a[172:175], v[68:71]
L_pad_3b_4:
  s_cbranch_execz L_ret_3b
  ds_read_b64_tr_b16 v[178:179], v161 offset:26624
  v_mfma_f32_16x16x32_bf16 v[64:67], v[196:199], a[168:171], v[64:67]
  ds_read_b64_tr_b16 v[180:181], v161 offset:28672
  v_mfma_f32_16x16x32_bf16 v[64:67], v[192:195], v[224:227], v[64:67]
  s_waitcnt vmcnt(9) lgkmcnt(3)
  ds_read_b64_tr_b16 v[182:183], v161 offset:30720
  v_mfma_f32_16x16x32_bf16 v[40:43], v[168:171], a[176:179], v[40:43]
  ds_read_b64_tr_b16 v[184:185], v162 offset:24576
  buffer_load_dwordx4 a[224:227], v8, s[16:19], s39 offen sc1
  v_mfma_f32_16x16x32_bf16 v[40:43], v[172:175], a[184:187], v[40:43]
  ds_read_b64_tr_b16 v[186:187], v162 offset:26624
  v_mfma_f32_16x16x32_bf16 v[44:47], v[172:175], a[188:191], v[44:47]
  ds_read_b64_tr_b16 v[188:189], v162 offset:28672
  buffer_load_dwordx4 a[228:231], v9, s[16:19], s39 offen sc1
  v_mfma_f32_16x16x32_bf16 v[44:47], v[168:171], a[180:183], v[44:47]
  s_waitcnt lgkmcnt(3)
  ds_read_b64_tr_b16 v[190:191], v162 offset:30720
  v_mfma_f32_16x16x32_bf16 v[52:55], v[176:179], a[180:183], v[52:55]
  s_add_u32 s39, s39, s99
  ds_read_b64_tr_b16 v[192:193], v163 offset:24576
  v_mfma_f32_16x16x32_bf16 v[52:55], v[180:183], a[188:191], v[52:55]
  ds_read_b64_tr_b16 v[194:195], v163 offset:26624
  v_mfma_f32_16x16x32_bf16 v[48:51], v[180:183], a[184:187], v[48:51]
  ds_read_b64_tr_b16 v[196:197], v163 offset:28672
  buffer_load_dwordx4 a[232:235], v8, s[16:19], s39 offen sc1
  v_mfma_f32_16x16x32_bf16 v[48:51], v[176:179], a[176:179], v[48:51]
  s_waitcnt vmcnt(34) lgkmcnt(3)
  ds_read_b64_tr_b16 v[198:199], v163 offset:30720
  v_mfma_f32_16x16x32_bf16 v[56:59], v[184:187], a[176:179], v[56:59]
  s_barrier
  ds_read_b64_tr_b16 v[168:169], v20 offset:0
  v_mfma_f32_16x16x32_bf16 v[56:59], v[188:191], a[184:187], v[56:59]
  ds_read_b64_tr_b16 v[170:171], v20 offset:2048
  v_mfma_f32_16x16x32_bf16 v[60:63], v[188:191], a[188:191], v[60:63]
  ds_read_b64_tr_b16 v[172:173], v20 offset:4096
  buffer_load_dwordx4 a[236:239], v9, s[16:19], s39 offen sc1
  v_mfma_f32_16x16x32_bf16 v[60:63], v[184:187], a[180:183], v[60:63]
  s_waitcnt lgkmcnt(3)
  ds_read_b64_tr_b16 v[174:175], v20 offset:6144
  v_mfma_f32_16x16x32_bf16 v[68:71], v[192:195], a[180:183], v[68:71]
  s_add_u32 s39, s39, s99
  ds_read_b64_tr_b16 v[176:177], v21 offset:0
  v_mfma_f32_16x16x32_bf16 v[68:71], v[196:199], a[188:191], v[68:71]
  ds_read_b64_tr_b16 v[178:179], v21 offset:2048
  v_mfma_f32_16x16x32_bf16 v[64:67], v[196:199], a[184:187], v[64:67]
  ds_read_b64_tr_b16 v[180:181], v21 offset:4096
  v_mfma_f32_16x16x32_bf16 v[64:67], v[192:195], a[176:179], v[64:67]
  s_waitcnt vmcnt(9) lgkmcnt(3)
  ds_read_b64_tr_b16 v[182:183], v21 offset:6144
  v_mfma_f32_16x16x32_bf16 v[40:43], v[168:171], a[192:195], v[40:43]
  ds_read_b64_tr_b16 v[184:185], v22 offset:0
  buffer_load_dwordx4 a[240:243], v8, s[16:19], s39 offen sc1
  v_mfma_f32_16x16x32_bf16 v[40:43], v[172:175], a[200:203], v[40:43]
  ds_read_b64_tr_b16 v[186:187], v22 offset:2048
  v_mfma_f32_16x16x32_bf16 v[44:47], v[172:175], a[204:207], v[44:47]
  ds_read_b64_tr_b16 v[188:189], v22 offset:4096
  buffer_load_dwordx4 a[244:247], v9, s[16:19], s39 offen sc1
  v_mfma_f32_16x16x32_bf16 v[44:47], v[168:171], a[196:199], v[44:47]
  s_waitcnt lgkmcnt(3)
  ds_read_b64_tr_b16 v[190:191], v22 offset:6144
  v_mfma_f32_16x16x32_bf16 v[52:55], v[176:179], a[196:199], v[52:55]
  s_add_u32 s39, s39, s99
  ds_read_b64_tr_b16 v[192:193], v23 offset:0
  v_mfma_f32_16x16x32_bf16 v[52:55], v[180:183], a[204:207], v[52:55]
  ds_read_b64_tr_b16 v[194:195], v23 offset:2048
  v_mfma_f32_16x16x32_bf16 v[48:51], v[180:183], a[200:203], v[48:51]
  ds_read_b64_tr_b16 v[196:197], v23 offset:4096
  buffer_load_dwordx4 a[248:251], v8, s[16:19], s39 offen sc1
  v_mfma_f32_16x16x32_bf16 v[48:51], v[176:179], a[192:195], v[48:51]
  s_waitcnt vmcnt(8) lgkmcnt(3)
  ds_read_b64_tr_b16 v[198:199], v23 offset:6144
  v_cmp_ne_u64 vcc, s[6:7], v[38:39]
  s_cbranch_vccnz L_slow_40
L_back_41:
  v_mfma_f32_16x16x32_bf16 v[56:59], v[184:187], a[192:195], v[56:59]
  ds_read_b64_tr_b16 v[168:169], v20 offset:8192
  v_mfma_f32_16x16x32_bf16 v[56:59], v[188:191], a[200:203], v[56:59]
  ds_read_b64_tr_b16 v[170:171], v20 offset:10240
  v_mfma_f32_16x16x32_bf16 v[60:63], v[188:191], a[204:207], v[60:63]
  ds_read_b64_tr_b16 v[172:173], v20 offset:12288
  global_load_dwordx4 v[144:147], v33, s[4:5] offset:-4096 sc1
  v_mfma_f32_16x16x32_bf16 v[60:63], v[184:187], a[196:199], v[60:63]
  s_waitcnt vmcnt(8) lgkmcnt(3)
  ds_read_b64_tr_b16 v[174:175], v20 offset:14336
  v_mfma_f32_16x16x32_bf16 v[68:71], v[192:195], a[196:199], v[68:71]
  ds_read_b64_tr_b16 v[176:177], v21 offset:8192
  v_swap_b32 v202, v204
  v_swap_b32 v203, v205
  v_mfma_f32_16x16x32_bf16 v[68:71], v[196:199], a[204:207], v[68:71]
  ds_read_b64_tr_b16 v[178:179], v21 offset:10240
  v_mfma_f32_16x16x32_bf16 v[64:67], v[196:199], a[200:203], v[64:67]
  ds_read_b64_tr_b16 v[180:181], v21 offset:12288
  buffer_load_dwordx4 a[252:255], v9, s[16:19], s39 offen sc1
  v_mfma_f32_16x16x32_bf16 v[64:67], v[192:195], a[192:195], v[64:67]
  s_waitcnt vmcnt(9) lgkmcnt(3)
  ds_read_b64_tr_b16 v[182:183], v21 offset:14336
  v_mfma_f32_16x16x32_bf16 v[40:43], v[168:171], a[208:211], v[40:43]
  ds_read_b64_tr_b16 v[184:185], v22 offset:8192
  v_mfma_f32_16x16x32_bf16 v[40:43], v[172:175], v[200:203], v[40:43]
  ds_read_b64_tr_b16 v[186:187], v22 offset:10240
  global_load_dwordx4 v[148:151], v33, s[4:5] offset:-2048 sc1
  v_mfma_f32_16x16x32_bf16 v[44:47], v[172:175], v[204:207], v[44:47]
  s_add_u32 s39, s39, s99
  ds_read_b64_tr_b16 v[188:189], v22 offset:12288
  v_mfma_f32_16x16x32_bf16 v[44:47], v[168:171], a[212:215], v[44:47]
  s_waitcnt lgkmcnt(3)
  ds_read_b64_tr_b16 v[190:191], v22 offset:14336
  v_mfma_f32_16x16x32_bf16 v[52:55], v[176:179], a[212:215], v[52:55]
  ds_read_b64_tr_b16 v[192:193], v23 offset:8192
  v_mfma_f32_16x16x32_bf16 v[52:55], v[180:183], v[204:207], v[52:55]
  ds_read_b64_tr_b16 v[194:195], v23 offset:10240
  v_mfma_f32_16x16x32_bf16 v[48:51], v[180:183], v[200:203], v[48:51]
  ds_read_b64_tr_b16 v[196:197], v23 offset:12288
  v_mfma_f32_16x16x32_bf16 v[48:51], v[176:179], a[208:211], v[48:51]
  s_waitcnt lgkmcnt(3)
  ds_read_b64_tr_b16 v[198:199], v23 offset:14336
  v_mfma_f32_16x16x32_bf16 v[56:59], v[184:187], a[208:211], v[56:59]
  ds_read_b64_tr_b16 v[168:169], v20 offset:16384
  global_load_dwordx4 v[152:155], v33, s[4:5] offset:0 sc1
  v_mfma_f32_16x16x32_bf16 v[56:59], v[188:191], v[200:203], v[56:59]
  ds_read_b64_tr_b16 v[170:171], v20 offset:18432
  v_mfma_f32_16x16x32_bf16 v[60:63], v[188:191], v[204:207], v[60:63]
  ds_read_b64_tr_b16 v[172:173], v20 offset:20480
  v_mfma_f32_16x16x32_bf16 v[60:63], v[184:187], a[212:215], v[60:63]
  s_waitcnt lgkmcnt(3)
  ds_read_b64_tr_b16 v[174:175], v20 offset:22528
  v_mfma_f32_16x16x32_bf16 v[68:71], v[192:195], a[212:215], v[68:71]
  ds_read_b64_tr_b16 v[176:177], v21 offset:16384
  v_mfma_f32_16x16x32_bf16 v[68:71], v[196:199], v[204:207], v[68:71]
  ds_read_b64_tr_b16 v[178:179], v21 offset:18432
  v_mfma_f32_16x16x32_bf16 v[64:67], v[196:199], v[200:203], v[64:67]
  ds_read_b64_tr_b16 v[180:181], v21 offset:20480
  v_mfma_f32_16x16x32_bf16 v[64:67], v[192:195], a[208:211], v[64:67]
  s_waitcnt vmcnt(7) lgkmcnt(3)
  ds_read_b64_tr_b16 v[182:183], v21 offset:22528
  v_mfma_f32_16x16x32_bf16 v[40:43], v[168:171], a[224:227], v[40:43]
  ds_read_b64_tr_b16 v[184:185], v22 offset:16384
  global_load_dwordx4 v[156:159], v33, s[4:5] offset:2048 sc1
  v_mfma_f32_16x16x32_bf16 v[40:43], v[172:175], a[232:235], v[40:43]
  ds_read_b64_tr_b16 v[186:187], v22 offset:18432
  v_mfma_f32_16x16x32_bf16 v[44:47], v[172:175], a[236:239], v[44:47]
  ds_read_b64_tr_b16 v[188:189], v22 offset:20480
  v_mfma_f32_16x16x32_bf16 v[44:47], v[168:171], a[228:231], v[44:47]
  s_waitcnt lgkmcnt(3)
  ds_read_b64_tr_b16 v[190:191], v22 offset:22528
  v_mfma_f32_16x16x32_bf16 v[52:55], v[176:179], a[228:231], v[52:55]
  ds_read_b64_tr_b16 v[192:193], v23 offset:16384
  v_mfma_f32_16x16x32_bf16 v[52:55], v[180:183], a[236:239], v[52:55]
  ds_read_b64_tr_b16 v[194:195], v23 offset:18432
  v_mfma_f32_16x16x32_bf16 v[48:51], v[180:183], a[232:235], v[48:51]
  ds_read_b64_tr_b16 v[196:197], v23 offset:20480
  v_mfma_f32_16x16x32_bf16 v[48:51], v[176:179], a[224:227], v[48:51]
  s_waitcnt lgkmcnt(3)
  ds_read_b64_tr_b16 v[198:199], v23 offset:22528
  v_mfma_f32_16x16x32_bf16 v[56:59], v[184:187], a[224:227], v[56:59]
  ds_read_b64_tr_b16 v[168:169], v20 offset:24576
  v_mfma_f32_16x16x32_bf16 v[56:59], v[188:191], a[232:235], v[56:59]
  ds_read_b64_tr_b16 v[170:171], v20 offset:26624
  v_mfma_f32_16x16x32_bf16 v[60:63], v[188:191], a[236:239], v[60:63]
  ds_read_b64_tr_b16 v[172:173], v20 offset:28672
  v_mfma_f32_16x16x32_bf16 v[60:63], v[184:187], a[228:231], v[60:63]
  s_waitcnt lgkmcnt(3)
  ds_read_b64_tr_b16 v[174:175], v20 offset:30720
  v_mfma_f32_16x16x32_bf16 v[68:71], v[192:195], a[228:231], v[68:71]
  ds_read_b64_tr_b16 v[176:177], v21 offset:24576
  v_mfma_f32_16x16x32_bf16 v[68:71], v[196:199], a[236:239], v[68:71]
  ds_read_b64_tr_b16 v[178:179], v21 offset:26624
  v_mfma_f32_16x16x32_bf16 v[64:67], v[196:199], a[232:235], v[64:67]
  ds_read_b64_tr_b16 v[180:181], v21 offset:28672
  v_mfma_f32_16x16x32_bf16 v[64:67], v[192:195], a[224:227], v[64:67]
  s_waitcnt vmcnt(3) lgkmcnt(3)
  ds_read_b64_tr_b16 v[182:183], v21 offset:30720
  v_mfma_f32_16x16x32_bf16 v[40:43], v[168:171], a[240:243], v[40:43]
  ds_read_b64_tr_b16 v[184:185], v22 offset:24576
  v_mfma_f32_16x16x32_bf16 v[40:43], v[172:175], a[248:251], v[40:43]
  ds_read_b64_tr_b16 v[186:187], v22 offset:26624
  v_mfma_f32_16x16x32_bf16 v[44:47], v[172:175], a[252:255], v[44:47]
  ds_read_b64_tr_b16 v[188:189], v22 offset:28672
  v_mfma_f32_16x16x32_bf16 v[44:47], v[168:171], a[244:247], v[44:47]
  s_waitcnt lgkmcnt(3)
  ds_read_b64_tr_b16 v[190:191], v22 offset:30720
  v_mfma_f32_16x16x32_bf16 v[52:55], v[176:179], a[244:247], v[52:55]
  ds_read_b64_tr_b16 v[192:193], v23 offset:24576
  v_mfma_f32_16x16x32_bf16 v[52:55], v[180:183], a[252:255], v[52:55]
  ds_read_b64_tr_b16 v[194:195], v23 offset:26624
  v_mfma_f32_16x16x32_bf16 v[48:51], v[180:183], a[248:251], v[48:51]
  ds_read_b64_tr_b16 v[196:197], v23 offset:28672
  v_mfma_f32_16x16x32_bf16 v[48:51], v[176:179], a[240:243], v[48:51]
  s_waitcnt lgkmcnt(3)
  ds_read_b64_tr_b16 v[198:199], v23 offset:30720
  v_mfma_f32_16x16x32_bf16 v[56:59], v[184:187], a[240:243], v[56:59]
  v_mfma_f32_16x16x32_bf16 v[56:59], v[188:191], a[248:251], v[56:59]
  v_mfma_f32_16x16x32_bf16 v[60:63], v[188:191], a[252:255], v[60:63]
  v_mfma_f32_16x16x32_bf16 v[60:63], v[184:187], a[244:247], v[60:63]
  s_waitcnt lgkmcnt(0)
  v_mfma_f32_16x16x32_bf16 v[68:71], v[192:195], a[244:247], v[68:71]
  v_mfma_f32_16x16x32_bf16 v[68:71], v[196:199], a[252:255], v[68:71]
  v_mfma_f32_16x16x32_bf16 v[64:67], v[196:199], a[248:251], v[64:67]
  v_mfma_f32_16x16x32_bf16 v[64:67], v[192:195], a[240:243], v[64:67]
  s_waitcnt vmcnt(4)
  v_mfma_f32_16x16x32_bf16 v[40:43], v[122:125], v[144:147], v[40:43]
  v_mfma_f32_16x16x32_bf16 v[48:51], v[120:123], v[144:147], v[48:51]
  s_waitcnt vmcnt(2)
  v_mfma_f32_16x16x32_bf16 v[56:59], v[122:125], v[148:151], v[56:59]
  v_mfma_f32_16x16x32_bf16 v[64:67], v[120:123], v[148:151], v[64:67]
  s_waitcnt vmcnt(1)
  v_mfma_f32_16x16x32_bf16 v[44:47], v[122:125], v[152:155], v[44:47]
  v_mfma_f32_16x16x32_bf16 v[52:55], v[120:123], v[152:155], v[52:55]
  s_waitcnt vmcnt(0)
  v_mfma_f32_16x16x32_bf16 v[60:63], v[122:125], v[156:159], v[60:63]
  v_mfma_f32_16x16x32_bf16 v[68:71], v[120:123], v[156:159], v[68:71]
  v_cvt_pk_bf16_f32 v104, v40, v41
  v_cvt_pk_bf16_f32 v105, v42, v43
  ds_write_b64 v28, v[104:105] offset:0
  v_cvt_pk_bf16_f32 v106, v48, v49
  v_cvt_pk_bf16_f32 v107, v50, v51
  ds_write_b64 v29, v[106:107] offset:0
  v_cvt_pk_bf16_f32 v108, v56, v57
  v_cvt_pk_bf16_f32 v109, v58, v59
  ds_write_b64 v30, v[108:109] offset:0
  v_cvt_pk_bf16_f32 v110, v64, v65
  v_cvt_pk_bf16_f32 v111, v66, v67
  ds_write_b64 v31, v[110:111] offset:0
  ds_read_b128 v[128:131], v26 offset:0
  ds_read_b128 v[132:135], v26 offset:1024
  v_cvt_pk_bf16_f32 v112, v44, v45
  v_cvt_pk_bf16_f32 v113, v46, v47
  ds_write_b64 v28, v[112:113] offset:2048
  v_cvt_pk_bf16_f32 v114, v52, v53
  v_cvt_pk_bf16_f32 v115, v54, v55
  ds_write_b64 v29, v[114:115] offset:2048
  v_cvt_pk_bf16_f32 v116, v60, v61
  v_cvt_pk_bf16_f32 v117, v62, v63
  ds_write_b64 v30, v[116:117] offset:2048
  v_cvt_pk_bf16_f32 v118, v68, v69
  v_cvt_pk_bf16_f32 v119, v70, v71
  ds_write_b64 v31, v[118:119] offset:2048
  ds_read_b128 v[136:139], v26 offset:2048
  ds_read_b128 v[140:143], v26 offset:3072
  s_mov_b32 s34, 0
  s_waitcnt lgkmcnt(7)
  buffer_store_dwordx4 v[128:131], v27, s[20:23], s34 offen sc1
  s_mov_b32 s34, 16384
  s_waitcnt lgkmcnt(6)
  buffer_store_dwordx4 v[132:135], v27, s[20:23], s34 offen sc1
  s_mov_b32 s34, 32768
  s_waitcnt lgkmcnt(1)
  buffer_store_dwordx4 v[136:139], v27, s[20:23], s34 offen sc1
  s_mov_b32 s34, 49152
  s_waitcnt lgkmcnt(0)
  buffer_store_dwordx4 v[140:143], v27, s[20:23], s34 offen sc1
  s_or_b32 s34, s2, s24
  s_cmp_eq_u32 s34, 0
  s_cbranch_scc0 L_noep
  v_mov_b32 v10, 0x3c00000
  v_mov_b32 v11, s6
  s_mov_b64 exec, 1
  global_store_dword v10, v11, s[4:5] sc1
  s_mov_b64 exec, -1
L_noep:
L_end:
  s_endpgm
L_slow_7:
  s_mov_b32 s101, 0
L_poll_42:
  global_load_dwordx2 v[254:255], v253, s[4:5] offset:0 sc1
  s_waitcnt vmcnt(0)
L_chk_44:
  v_cmp_ne_u64 vcc, s[6:7], v[254:255]
  s_add_u32 s101, s101, 1
  s_cbranch_vccz L_go_43
  s_cmp_lt_u32 s101, 0x40000
  s_cbranch_scc1 L_poll_42
L_go_43:
  s_branch L_back_8
L_slow_14:
  s_mov_b32 s101, 0
L_poll_45:
  global_load_dwordx2 v[26:27], v100, s[4:5] offset:32 sc1
  s_waitcnt vmcnt(0)
L_chk_47:
  v_cmp_ne_u64 vcc, s[6:7], v[26:27]
  s_add_u32 s101, s101, 1
  s_cbranch_vccz L_go_46
  s_cmp_lt_u32 s101, 0x40000
  s_cbranch_scc1 L_poll_45
L_go_46:
  s_branch L_back_15
L_slow_16:
  s_mov_b32 s101, 0
L_poll_48:
  global_load_dwordx2 v[26:27], v100, s[4:5] offset:64 sc1
  s_waitcnt vmcnt(0)
L_chk_50:
  v_cmp_ne_u64_e64 vcc, s[6:7], v[26:27]
  s_add_u32 s101, s101, 1
  s_cbranch_vccz L_go_49
  s_cmp_lt_u32 s101, 0x40000
  s_cbranch_scc1 L_poll_48
L_go_49:
  s_branch L_back_17
L_slow_18:
  s_mov_b32 s101, 0
L_poll_51:
  global_load_dwordx2 v[26:27], v100, s[4:5] offset:96 sc1
  s_waitcnt vmcnt(0)
L_chk_53:
  v_cmp_ne_u64 vcc, s[6:7], v[26:27]
  s_add_u32 s101, s101, 1
  s_cbranch_vccz L_go_52
  s_cmp_lt_u32 s101, 0x40000
  s_cbranch_scc1 L_poll_51
L_go_52:
  s_branch L_back_19
L_slow_26:
  s_mov_b32 s101, 0
L_poll_54:
  global_load_dwordx2 v[18:19], v16, s[4:5] offset:0 sc1
  s_waitcnt vmcnt(0)
L_chk_56:
  v_cmp_ne_u64 vcc, s[6:7], v[18:19]
  s_add_u32 s101, s101, 1
  s_cbranch_vccz L_go_55
  s_cmp_lt_u32 s101, 0x40000
  s_cbranch_scc1 L_poll_54
L_go_55:
  s_branch L_back_27
L_slow_32:
  s_mov_b32 s101, 0
L_poll_57:
  global_load_dwordx2 v[12:13], v11, s[4:5] offset:0 sc1
  s_waitcnt vmcnt(0)
L_chk_59:
  v_cmp_ne_u64 vcc, s[6:7], v[12:13]
  s_add_u32 s101, s101, 1
  s_cbranch_vccz L_go_58
  s_cmp_lt_u32 s101, 0x40000
  s_cbranch_scc1 L_poll_57
L_go_58:
  s_branch L_back_33
L_slow_34:
  s_mov_b32 s101, 0
L_poll_60:
  global_load_dwordx2 v[12:13], v11, s[4:5] offset:0 sc1
  s_waitcnt vmcnt(0)
L_chk_62:
  v_cmp_ne_u64 vcc, s[6:7], v[12:13]
  s_add_u32 s101, s101, 1
  s_cbranch_vccz L_go_61
  s_cmp_lt_u32 s101, 0x40000
  s_cbranch_scc1 L_poll_60
L_go_61:
  s_branch L_back_35
L_slow_36:
  s_mov_b32 s101, 0
L_poll_63:
  global_load_dwordx2 v[12:13], v11, s[4:5] offset:0 sc1
  s_waitcnt vmcnt(0)
L_chk_65:
  v_cmp_ne_u64_e64 vcc, s[6:7], v[12:13]
  s_add_u32 s101, s101, 1
  s_cbranch_vccz L_go_64
  s_cmp_lt_u32 s101, 0x40000
  s_cbranch_scc1 L_poll_63
L_go_64:
  s_branch L_back_37
L_slow_38:
  s_mov_b32 s101, 0
L_poll_66:
  global_load_dwordx2 v[12:13], v11, s[4:5] offset:0 sc1
  s_waitcnt vmcnt(0)
L_chk_68:
  v_cmp_ne_u64 vcc, s[6:7], v[12:13]
  s_add_u32 s101, s101, 1
  s_cbranch_vccz L_go_67
  s_cmp_lt_u32 s101, 0x40000
  s_cbranch_scc1 L_poll_66
L_go_67:
  s_branch L_back_39
L_slow_40:
  s_mov_b32 s101, 0
L_poll_69:
  global_load_dwordx2 v[38:39], v35, s[4:5] offset:0 sc1
  s_waitcnt vmcnt(0)
L_chk_71:
  v_cmp_ne_u64 vcc, s[6:7], v[38:39]
  s_add_u32 s101, s101, 1
  s_cbranch_vccz L_go_70
  s_cmp_lt_u32 s101, 0x40000
  s_cbranch_scc1 L_poll_69
L_go_70:
  s_branch L_back_41
.section .rodata,"a"
.p2align 6
.amdhsa_kernel sequential_preLN__linear_kernel_hedgehog__glu_gated_glu__prompt_kernel
  .amdhsa_next_free_vgpr 512
  .amdhsa_next_free_sgpr 102
  .amdhsa_accum_offset 256
  .amdhsa_group_segment_fixed_size 0
  .amdhsa_kernarg_size 88
  .amdhsa_user_sgpr_count 2
  .amdhsa_user_sgpr_kernarg_segment_ptr 1
  .amdhsa_system_sgpr_workgroup_id_x 1
  .amdhsa_float_denorm_mode_32 3
.end_amdhsa_kernel
```
